```python
import torch

def _softmax(x, axis=-1):
    return torch.softmax(x, dim=axis)
def _gelu(x):
    return torch.nn.functional.gelu(x, approximate="tanh")
def _silu(x):
    return torch.nn.functional.silu(x)
def _sigmoid(x):
    return torch.sigmoid(x)
def _layernorm(x, axis=-1, eps=1e-5):
    m = x.mean(dim=axis, keepdim=True)
    v = x.var(dim=axis, keepdim=True, unbiased=False)
    return (x - m) / torch.sqrt(v + eps)
def _scatter_add(tgt, idx, src, axis=0):
    return tgt.clone().index_add_(axis, idx, src)
def _segment_sum(src, seg, n):
    out = torch.zeros((n,) + src.shape[1:], dtype=src.dtype)
    return out.index_add_(0, seg, src)
def _pad(x, pw):
    flat = tuple(v for pair in reversed(pw) for v in pair)
    return torch.nn.functional.pad(x, flat)

kernel_name = 'concat_heads__mha_block_cached__mha_block_cached__decode'

def setup_inputs():

    _w = (lambda a: (lambda t: t.to(torch.bfloat16) if t.is_floating_point() else t)(torch.as_tensor(a)))
    def _A_setup():
        B, Sq, D = 8, 1, 1024
        H, Sk, Dh = 32, 4096, 128
        return {
            "x": _w((lambda *s: torch.randn(*s, dtype=torch.bfloat16) * 0.8)(B, Sq, D)),
            "k_cache": _w((lambda *s: torch.randn(*s, dtype=torch.bfloat16) * 0.8)(B, H, Sk, Dh)),
            "v_cache": _w((lambda *s: torch.randn(*s, dtype=torch.bfloat16) * 0.05)(B, H, Sk, Dh)),
            "wq": _w((lambda *s: torch.randn(*s, dtype=torch.bfloat16) * 0.8)(D, H * Dh) * (D ** -0.5)),
            "wo": _w((lambda *s: torch.randn(*s, dtype=torch.bfloat16) * 0.05)(H * Dh, D) * ((H * Dh) ** -0.5)),
        }
    _A_in = _A_setup()

    def _B_setup():
        B, Sq, D = 8, 1, 1024
        H, Sk, Dh = 32, 4096, 128
        return {
            "x": _w((lambda *s: torch.randn(*s, dtype=torch.bfloat16) * 0.8)(B, Sq, D)),
            "k_cache": _w((lambda *s: torch.randn(*s, dtype=torch.bfloat16) * 0.8)(B, H, Sk, Dh)),
            "v_cache": _w((lambda *s: torch.randn(*s, dtype=torch.bfloat16) * 0.05)(B, H, Sk, Dh)),
            "wq": _w((lambda *s: torch.randn(*s, dtype=torch.bfloat16) * 0.8)(D, H * Dh) * (D ** -0.5)),
            "wo": _w((lambda *s: torch.randn(*s, dtype=torch.bfloat16) * 0.05)(H * Dh, D) * ((H * Dh) ** -0.5)),
        }
    _B_in = _B_setup()

    return {
        "A_x": _A_in["x"],
        "A_k_cache": _A_in["k_cache"],
        "A_v_cache": _A_in["v_cache"],
        "A_wq": _A_in["wq"],
        "A_wo": _A_in["wo"],
        "B_x": _B_in["x"],
        "B_k_cache": _B_in["k_cache"],
        "B_v_cache": _B_in["v_cache"],
        "B_wq": _B_in["wq"],
        "B_wo": _B_in["wo"],
    }

def reference(A_x, A_k_cache, A_v_cache, A_wq, A_wo, B_x, B_k_cache, B_v_cache, B_wq, B_wo):
    def _A_ref(x, k_cache, v_cache, wq, wo):
        B, Sq, D = x.shape
        H, Dh = 32, 128
        q = (lambda x, *d: x.permute(*d))((x @ wq).reshape(B, Sq, H, Dh), 0, 2, 1, 3)
        scores = torch.einsum("bhqd,bhkd->bhqk", q, k_cache) * (Dh ** -0.5)
        p = _softmax(scores, axis=-1)
        o = torch.einsum("bhqk,bhkd->bhqd", p, v_cache)
        return (lambda x, *d: x.permute(*d))(o, 0, 2, 1, 3).reshape(B, Sq, H * Dh) @ wo

    def _B_ref(x, k_cache, v_cache, wq, wo):
        B, Sq, D = x.shape
        H, Dh = 32, 128
        q = (lambda x, *d: x.permute(*d))((x @ wq).reshape(B, Sq, H, Dh), 0, 2, 1, 3)
        scores = torch.einsum("bhqd,bhkd->bhqk", q, k_cache) * (Dh ** -0.5)
        p = _softmax(scores, axis=-1)
        o = torch.einsum("bhqk,bhkd->bhqd", p, v_cache)
        return (lambda x, *d: x.permute(*d))(o, 0, 2, 1, 3).reshape(B, Sq, H * Dh) @ wo

    a = _A_ref(A_x, A_k_cache, A_v_cache, A_wq, A_wo)
    b = _B_ref(B_x, B_k_cache, B_v_cache, B_wq, B_wo)
    return torch.concatenate([a, b], axis=-1)
```

```asm
; @launch grid=(256,1,1) block=(256,1,1) lds=8528
.amdgcn_target "amdgcn-amd-amdhsa--gfx950"
.text
.globl concat_heads__mha_block_cached__mha_block_cached__decode_kernel
.p2align 8
.type concat_heads__mha_block_cached__mha_block_cached__decode_kernel,@function
concat_heads__mha_block_cached__mha_block_cached__decode_kernel:
  s_cmp_ge_u32 s2, 256
  s_cbranch_scc0 L_start
L_bail:
  s_endpgm
L_start:
  s_load_dwordx16 s[40:55], s[0:1], 0
  s_load_dwordx4 s[56:59], s[0:1], 64
  s_load_dwordx2 s[20:21], s[0:1], 96
  s_load_dwordx2 s[32:33], s[0:1], 80
  s_load_dwordx2 s[82:83], s[0:1], 88
  v_lshrrev_b32 v4, 6, v0
  v_and_b32 v5, 63, v0
  v_readfirstlane_b32 s64, v4
  v_lshrrev_b32 v6, 4, v5
  v_and_b32 v7, 15, v5
  v_lshlrev_b32 v1, 4, v5
  v_lshlrev_b32 v8, 4, v7
  v_lshl_add_u32 v2, v6, 19, v8
  v_lshl_add_u32 v3, v6, 16, v8
  s_and_b32 s67, s2, 7
  s_lshr_b32 s37, s2, 3
  s_and_b32 s66, s37, 7
  s_lshr_b32 s37, s2, 6
  s_lshl_b32 s38, s67, 2
  s_or_b32 s65, s37, s38
  s_mov_b32 s6, 0x10000000
  s_mov_b32 s7, 0x20000
  s_mov_b32 s10, 0x10000000
  s_mov_b32 s11, 0x20000
  s_mov_b32 s14, 0x10000000
  s_mov_b32 s15, 0x20000
  s_mov_b32 s18, 0x10000000
  s_mov_b32 s19, 0x20000
  s_mov_b32 s22, 0x210000
  s_mov_b32 s23, 0x20000
  s_mov_b32 s26, 0x800000
  s_mov_b32 s27, 0x20000
  s_mov_b32 s30, 0x4000
  s_mov_b32 s31, 0x20000
  s_mov_b32 s34, 0x8000
  s_mov_b32 s35, 0x20000
  s_lshl_b32 s37, s64, 21
  s_lshl_b32 s38, s65, 8
  s_add_u32 s72, s37, s38
  s_add_u32 s38, s66, 0
  s_and_b32 s74, s38, 7
  s_add_u32 s38, s66, 1
  s_and_b32 s75, s38, 7
  s_add_u32 s38, s66, 2
  s_and_b32 s76, s38, 7
  s_add_u32 s38, s66, 3
  s_and_b32 s77, s38, 7
  s_add_u32 s38, s66, 4
  s_and_b32 s78, s38, 7
  s_add_u32 s38, s66, 5
  s_and_b32 s79, s38, 7
  s_add_u32 s38, s66, 6
  s_and_b32 s80, s38, 7
  s_add_u32 s38, s66, 7
  s_and_b32 s81, s38, 7
  s_lshl_b32 s38, s66, 1
  v_add_u32 v9, s38, v7
  v_and_b32 v9, 15, v9
  v_lshlrev_b32 v9, 3, v9
  v_lshl_add_u32 v9, v6, 7, v9
  s_lshl_b32 s37, s66, 11
  s_lshl_b32 s38, s64, 9
  s_add_u32 s37, s37, s38
  v_add_u32 v37, s37, v9
  s_lshl_b32 s70, s66, 25
  s_lshl_b32 s38, s65, 20
  s_add_u32 s70, s70, s38
  s_lshr_b32 s38, s66, 1
  s_and_b32 s39, s65, 1
  s_xor_b32 s38, s38, s39
  s_lshl_b32 s38, s38, 17
  v_and_b32 v10, 1, v6
  v_lshrrev_b32 v11, 1, v6
  v_lshl_add_u32 v63, v10, 9, v8
  v_lshl_add_u32 v63, v11, 15, v63
  s_or_b32 s70, s70, s38
  s_and_b32 s38, s64, 1
  s_lshl_b32 s38, s38, 12
  s_xor_b32 s70, s70, s38
  s_lshr_b32 s38, s64, 1
  s_lshl_b32 s38, s38, 13
  s_xor_b32 s70, s70, s38
  s_mov_b32 s69, 0
  s_mov_b32 s68, s70
  s_waitcnt lgkmcnt(0)
  s_mov_b32 s24, s46
  s_mov_b32 s25, s47
  s_mov_b32 s28, s40
  s_mov_b32 s29, s41
  s_mov_b32 s4, s42
  s_mov_b32 s5, s43
  s_lshl_b32 s73, s74, 16
  s_add_u32 s73, s73, s72
  buffer_load_dwordx4 a[0:3], v2, s[24:27], s73 offen
  s_add_u32 s73, s73, 8192
  buffer_load_dwordx4 a[4:7], v2, s[24:27], s73 offen
  s_add_u32 s73, s73, 8192
  buffer_load_dwordx4 a[8:11], v2, s[24:27], s73 offen
  s_add_u32 s73, s73, 8192
  buffer_load_dwordx4 a[12:15], v2, s[24:27], s73 offen
  s_add_u32 s73, s73, 8192
  buffer_load_dwordx4 a[16:19], v2, s[24:27], s73 offen
  s_add_u32 s73, s73, 8192
  buffer_load_dwordx4 a[20:23], v2, s[24:27], s73 offen
  s_add_u32 s73, s73, 8192
  buffer_load_dwordx4 a[24:27], v2, s[24:27], s73 offen
  s_add_u32 s73, s73, 8192
  buffer_load_dwordx4 a[28:31], v2, s[24:27], s73 offen
  buffer_load_dwordx2 v[38:39], v37, s[28:31], 0 offen
  s_xor_b32 s68, s70, 0x0
  buffer_load_dwordx4 v[64:67], v63, s[4:7], s68 offen nt
  s_xor_b32 s68, s70, 0x100
  buffer_load_dwordx4 v[68:71], v63, s[4:7], s68 offen nt
  s_xor_b32 s68, s70, 0x400
  buffer_load_dwordx4 v[72:75], v63, s[4:7], s68 offen nt
  s_xor_b32 s68, s70, 0x500
  buffer_load_dwordx4 v[76:79], v63, s[4:7], s68 offen nt
  s_mov_b32 s8, s44
  s_mov_b32 s9, s45
  s_mov_b32 s12, s52
  s_mov_b32 s13, s53
  s_mov_b32 s16, s54
  s_mov_b32 s17, s55
  v_mov_b32 v16, 0
  v_mov_b32 v17, 0
  v_mov_b32 v18, 0
  v_mov_b32 v19, 0
  s_cmp_eq_u32 s65, 0
  s_cbranch_scc0 L_nozero
  s_lshl_b32 s38, s64, 3
  s_add_u32 s38, s38, s66
  s_lshl_b32 s38, s38, 10
  s_add_u32 s38, s38, 2097152
  buffer_store_dwordx4 v[16:19], v1, s[20:23], s38 offen sc1
  s_add_u32 s38, s38, 32768
  buffer_store_dwordx4 v[16:19], v1, s[20:23], s38 offen sc1
L_nozero:
  s_mov_b32 s87, 0x80000
  s_lshl_b32 s38, s66, 5
  s_add_u32 s38, s38, s65
  s_lshl_b32 s86, s38, 13
  v_lshlrev_b32 v32, 4, v0
  v_mov_b32 v12, -1
  v_mov_b32 v13, -1
  v_mov_b32 v14, -1
  v_mov_b32 v15, -1
  buffer_store_dwordx4 v[12:15], v32, s[20:23], s86 offen sc1
  s_add_u32 s38, s86, 4096
  buffer_store_dwordx4 v[12:15], v32, s[20:23], s38 offen sc1
  ds_write_b32 v16, v16 offset:8512
  s_lshl_b32 s38, s2, 7
  s_add_u32 s88, s38, 2097152
  s_mov_b32 s71, 0x3e0293ee
  v_and_b32 v10, 7, v7
  v_lshrrev_b32 v11, 1, v10
  v_and_b32 v10, 1, v10
  v_lshlrev_b32 v10, 4, v10
  v_mov_b32 v20, 0xffff
  v_lshlrev_b32 v20, v10, v20
  v_cmp_eq_u32 vcc, 0, v11
  s_nop 1
  v_cndmask_b32 v40, 0, v20, vcc
  v_cmp_eq_u32 vcc, 1, v11
  s_nop 1
  v_cndmask_b32 v41, 0, v20, vcc
  v_cmp_eq_u32 vcc, 2, v11
  s_nop 1
  v_cndmask_b32 v42, 0, v20, vcc
  v_cmp_eq_u32 vcc, 3, v11
  s_nop 1
  v_cndmask_b32 v43, 0, v20, vcc
  s_lshl_b32 s38, s64, 9
  v_lshlrev_b32 v36, 3, v6
  v_lshl_add_u32 v36, v7, 5, v36
  v_add_u32 v36, s38, v36
  v_lshrrev_b32 v34, 2, v1
  v_and_b32 v34, 28, v34
  s_mov_b64 vcc, 0
  s_bitcmp1_b32 s2, 3
  s_cbranch_scc1 L_frontB
  s_waitcnt vmcnt(6)
  s_mov_b32 s38, 0x01000100
  s_mov_b32 s39, 0x03020302
  v_perm_b32 v44, v38, v38, s38
  v_perm_b32 v45, v38, v38, s39
  v_perm_b32 v46, v39, v39, s38
  v_perm_b32 v47, v39, v39, s39
  s_lshl_b32 s73, s75, 16
  s_add_u32 s73, s73, s72
  buffer_load_dwordx4 a[32:35], v2, s[24:27], s73 offen
  s_add_u32 s73, s73, 8192
  buffer_load_dwordx4 a[36:39], v2, s[24:27], s73 offen
  s_add_u32 s73, s73, 8192
  buffer_load_dwordx4 a[40:43], v2, s[24:27], s73 offen
  s_add_u32 s73, s73, 8192
  buffer_load_dwordx4 a[44:47], v2, s[24:27], s73 offen
  s_add_u32 s73, s73, 8192
  buffer_load_dwordx4 a[48:51], v2, s[24:27], s73 offen
  s_add_u32 s73, s73, 8192
  buffer_load_dwordx4 a[52:55], v2, s[24:27], s73 offen
  s_add_u32 s73, s73, 8192
  buffer_load_dwordx4 a[56:59], v2, s[24:27], s73 offen
  s_add_u32 s73, s73, 8192
  buffer_load_dwordx4 a[60:63], v2, s[24:27], s73 offen
  s_lshl_b32 s73, s76, 16
  s_add_u32 s73, s73, s72
  buffer_load_dwordx4 a[64:67], v2, s[24:27], s73 offen
  s_add_u32 s73, s73, 8192
  buffer_load_dwordx4 a[68:71], v2, s[24:27], s73 offen
  s_add_u32 s73, s73, 8192
  buffer_load_dwordx4 a[72:75], v2, s[24:27], s73 offen
  s_add_u32 s73, s73, 8192
  buffer_load_dwordx4 a[76:79], v2, s[24:27], s73 offen
  s_add_u32 s73, s73, 8192
  buffer_load_dwordx4 a[80:83], v2, s[24:27], s73 offen
  s_add_u32 s73, s73, 8192
  buffer_load_dwordx4 a[84:87], v2, s[24:27], s73 offen
  s_add_u32 s73, s73, 8192
  buffer_load_dwordx4 a[88:91], v2, s[24:27], s73 offen
  s_add_u32 s73, s73, 8192
  buffer_load_dwordx4 a[92:95], v2, s[24:27], s73 offen
  s_lshl_b32 s73, s77, 16
  s_add_u32 s73, s73, s72
  buffer_load_dwordx4 a[96:99], v2, s[24:27], s73 offen
  s_add_u32 s73, s73, 8192
  buffer_load_dwordx4 a[100:103], v2, s[24:27], s73 offen
  s_add_u32 s73, s73, 8192
  buffer_load_dwordx4 a[104:107], v2, s[24:27], s73 offen
  s_add_u32 s73, s73, 8192
  buffer_load_dwordx4 a[108:111], v2, s[24:27], s73 offen
  s_add_u32 s73, s73, 8192
  buffer_load_dwordx4 a[112:115], v2, s[24:27], s73 offen
  s_add_u32 s73, s73, 8192
  buffer_load_dwordx4 a[116:119], v2, s[24:27], s73 offen
  s_add_u32 s73, s73, 8192
  buffer_load_dwordx4 a[120:123], v2, s[24:27], s73 offen
  s_add_u32 s73, s73, 8192
  buffer_load_dwordx4 a[124:127], v2, s[24:27], s73 offen
  s_lshl_b32 s73, s78, 16
  s_add_u32 s73, s73, s72
  buffer_load_dwordx4 a[128:131], v2, s[24:27], s73 offen
  s_add_u32 s73, s73, 8192
  buffer_load_dwordx4 a[132:135], v2, s[24:27], s73 offen
  s_add_u32 s73, s73, 8192
  v_and_b32_dpp v48, v44, v40 row_newbcast:0
  v_and_b32_dpp v49, v44, v41 row_newbcast:0
  v_and_b32_dpp v50, v44, v42 row_newbcast:0
  v_and_b32_dpp v51, v44, v43 row_newbcast:0
  v_and_b32_dpp v52, v45, v40 row_newbcast:0
  v_and_b32_dpp v53, v45, v41 row_newbcast:0
  v_and_b32_dpp v54, v45, v42 row_newbcast:0
  v_and_b32_dpp v55, v45, v43 row_newbcast:0
  v_mfma_f32_16x16x32_bf16 v[56:59], v[48:51], a[0:3], 0
  v_and_b32_dpp v48, v46, v40 row_newbcast:0
  v_and_b32_dpp v49, v46, v41 row_newbcast:0
  v_and_b32_dpp v50, v46, v42 row_newbcast:0
  v_and_b32_dpp v51, v46, v43 row_newbcast:0
  v_mfma_f32_16x16x32_bf16 v[56:59], v[52:55], a[4:7], v[56:59]
  v_and_b32_dpp v52, v47, v40 row_newbcast:0
  v_and_b32_dpp v53, v47, v41 row_newbcast:0
  v_and_b32_dpp v54, v47, v42 row_newbcast:0
  v_and_b32_dpp v55, v47, v43 row_newbcast:0
  v_mfma_f32_16x16x32_bf16 v[56:59], v[48:51], a[8:11], v[56:59]
  v_and_b32_dpp v48, v44, v40 row_newbcast:1
  v_and_b32_dpp v49, v44, v41 row_newbcast:1
  v_and_b32_dpp v50, v44, v42 row_newbcast:1
  v_and_b32_dpp v51, v44, v43 row_newbcast:1
  v_mfma_f32_16x16x32_bf16 v[56:59], v[52:55], a[12:15], v[56:59]
  v_and_b32_dpp v52, v45, v40 row_newbcast:1
  v_and_b32_dpp v53, v45, v41 row_newbcast:1
  v_and_b32_dpp v54, v45, v42 row_newbcast:1
  v_and_b32_dpp v55, v45, v43 row_newbcast:1
  v_mfma_f32_16x16x32_bf16 v[56:59], v[48:51], a[16:19], v[56:59]
  v_and_b32_dpp v48, v46, v40 row_newbcast:1
  v_and_b32_dpp v49, v46, v41 row_newbcast:1
  v_and_b32_dpp v50, v46, v42 row_newbcast:1
  v_and_b32_dpp v51, v46, v43 row_newbcast:1
  v_mfma_f32_16x16x32_bf16 v[56:59], v[52:55], a[20:23], v[56:59]
  v_and_b32_dpp v52, v47, v40 row_newbcast:1
  v_and_b32_dpp v53, v47, v41 row_newbcast:1
  v_and_b32_dpp v54, v47, v42 row_newbcast:1
  v_and_b32_dpp v55, v47, v43 row_newbcast:1
  v_mfma_f32_16x16x32_bf16 v[56:59], v[48:51], a[24:27], v[56:59]
  v_and_b32_dpp v48, v44, v40 row_newbcast:2
  v_and_b32_dpp v49, v44, v41 row_newbcast:2
  v_and_b32_dpp v50, v44, v42 row_newbcast:2
  v_and_b32_dpp v51, v44, v43 row_newbcast:2
  v_mfma_f32_16x16x32_bf16 v[56:59], v[52:55], a[28:31], v[56:59]
  v_and_b32_dpp v52, v45, v40 row_newbcast:2
  v_and_b32_dpp v53, v45, v41 row_newbcast:2
  v_and_b32_dpp v54, v45, v42 row_newbcast:2
  v_and_b32_dpp v55, v45, v43 row_newbcast:2
  s_waitcnt vmcnt(25)
  v_mfma_f32_16x16x32_bf16 v[56:59], v[48:51], a[32:35], v[56:59]
  buffer_load_dwordx4 a[136:139], v2, s[24:27], s73 offen
  s_add_u32 s73, s73, 8192
  buffer_load_dwordx4 a[140:143], v2, s[24:27], s73 offen
  s_add_u32 s73, s73, 8192
  buffer_load_dwordx4 a[144:147], v2, s[24:27], s73 offen
  s_add_u32 s73, s73, 8192
  buffer_load_dwordx4 a[148:151], v2, s[24:27], s73 offen
  s_add_u32 s73, s73, 8192
  buffer_load_dwordx4 a[152:155], v2, s[24:27], s73 offen
  s_add_u32 s73, s73, 8192
  buffer_load_dwordx4 a[156:159], v2, s[24:27], s73 offen
  s_lshl_b32 s73, s79, 16
  s_add_u32 s73, s73, s72
  buffer_load_dwordx4 a[160:163], v2, s[24:27], s73 offen
  s_add_u32 s73, s73, 8192
  v_and_b32_dpp v48, v46, v40 row_newbcast:2
  v_and_b32_dpp v49, v46, v41 row_newbcast:2
  v_and_b32_dpp v50, v46, v42 row_newbcast:2
  v_and_b32_dpp v51, v46, v43 row_newbcast:2
  s_waitcnt vmcnt(31)
  v_mfma_f32_16x16x32_bf16 v[56:59], v[52:55], a[36:39], v[56:59]
  buffer_load_dwordx4 a[164:167], v2, s[24:27], s73 offen
  s_add_u32 s73, s73, 8192
  v_and_b32_dpp v52, v47, v40 row_newbcast:2
  v_and_b32_dpp v53, v47, v41 row_newbcast:2
  v_and_b32_dpp v54, v47, v42 row_newbcast:2
  v_and_b32_dpp v55, v47, v43 row_newbcast:2
  s_waitcnt vmcnt(31)
  v_mfma_f32_16x16x32_bf16 v[56:59], v[48:51], a[40:43], v[56:59]
  buffer_load_dwordx4 a[168:171], v2, s[24:27], s73 offen
  s_add_u32 s73, s73, 8192
  v_and_b32_dpp v48, v44, v40 row_newbcast:3
  v_and_b32_dpp v49, v44, v41 row_newbcast:3
  v_and_b32_dpp v50, v44, v42 row_newbcast:3
  v_and_b32_dpp v51, v44, v43 row_newbcast:3
  s_waitcnt vmcnt(31)
  v_mfma_f32_16x16x32_bf16 v[56:59], v[52:55], a[44:47], v[56:59]
  buffer_load_dwordx4 a[172:175], v2, s[24:27], s73 offen
  s_add_u32 s73, s73, 8192
  v_and_b32_dpp v52, v45, v40 row_newbcast:3
  v_and_b32_dpp v53, v45, v41 row_newbcast:3
  v_and_b32_dpp v54, v45, v42 row_newbcast:3
  v_and_b32_dpp v55, v45, v43 row_newbcast:3
  s_waitcnt vmcnt(31)
  v_mfma_f32_16x16x32_bf16 v[56:59], v[48:51], a[48:51], v[56:59]
  buffer_load_dwordx4 a[176:179], v2, s[24:27], s73 offen
  s_add_u32 s73, s73, 8192
  v_and_b32_dpp v48, v46, v40 row_newbcast:3
  v_and_b32_dpp v49, v46, v41 row_newbcast:3
  v_and_b32_dpp v50, v46, v42 row_newbcast:3
  v_and_b32_dpp v51, v46, v43 row_newbcast:3
  s_waitcnt vmcnt(31)
  v_mfma_f32_16x16x32_bf16 v[56:59], v[52:55], a[52:55], v[56:59]
  buffer_load_dwordx4 a[180:183], v2, s[24:27], s73 offen
  s_add_u32 s73, s73, 8192
  v_and_b32_dpp v52, v47, v40 row_newbcast:3
  v_and_b32_dpp v53, v47, v41 row_newbcast:3
  v_and_b32_dpp v54, v47, v42 row_newbcast:3
  v_and_b32_dpp v55, v47, v43 row_newbcast:3
  s_waitcnt vmcnt(31)
  v_mfma_f32_16x16x32_bf16 v[56:59], v[48:51], a[56:59], v[56:59]
  buffer_load_dwordx4 a[184:187], v2, s[24:27], s73 offen
  s_add_u32 s73, s73, 8192
  v_and_b32_dpp v48, v44, v40 row_newbcast:4
  v_and_b32_dpp v49, v44, v41 row_newbcast:4
  v_and_b32_dpp v50, v44, v42 row_newbcast:4
  v_and_b32_dpp v51, v44, v43 row_newbcast:4
  s_waitcnt vmcnt(31)
  v_mfma_f32_16x16x32_bf16 v[56:59], v[52:55], a[60:63], v[56:59]
  buffer_load_dwordx4 a[188:191], v2, s[24:27], s73 offen
  v_and_b32_dpp v52, v45, v40 row_newbcast:4
  v_and_b32_dpp v53, v45, v41 row_newbcast:4
  v_and_b32_dpp v54, v45, v42 row_newbcast:4
  v_and_b32_dpp v55, v45, v43 row_newbcast:4
  s_waitcnt vmcnt(31)
  v_mfma_f32_16x16x32_bf16 v[56:59], v[48:51], a[64:67], v[56:59]
  s_lshl_b32 s73, s80, 16
  s_add_u32 s73, s73, s72
  buffer_load_dwordx4 a[192:195], v2, s[24:27], s73 offen
  s_add_u32 s73, s73, 8192
  v_and_b32_dpp v48, v46, v40 row_newbcast:4
  v_and_b32_dpp v49, v46, v41 row_newbcast:4
  v_and_b32_dpp v50, v46, v42 row_newbcast:4
  v_and_b32_dpp v51, v46, v43 row_newbcast:4
  s_waitcnt vmcnt(31)
  v_mfma_f32_16x16x32_bf16 v[56:59], v[52:55], a[68:71], v[56:59]
  buffer_load_dwordx4 a[196:199], v2, s[24:27], s73 offen
  s_add_u32 s73, s73, 8192
  v_and_b32_dpp v52, v47, v40 row_newbcast:4
  v_and_b32_dpp v53, v47, v41 row_newbcast:4
  v_and_b32_dpp v54, v47, v42 row_newbcast:4
  v_and_b32_dpp v55, v47, v43 row_newbcast:4
  s_waitcnt vmcnt(31)
  v_mfma_f32_16x16x32_bf16 v[56:59], v[48:51], a[72:75], v[56:59]
  buffer_load_dwordx4 a[200:203], v2, s[24:27], s73 offen
  s_add_u32 s73, s73, 8192
  v_and_b32_dpp v48, v44, v40 row_newbcast:5
  v_and_b32_dpp v49, v44, v41 row_newbcast:5
  v_and_b32_dpp v50, v44, v42 row_newbcast:5
  v_and_b32_dpp v51, v44, v43 row_newbcast:5
  s_waitcnt vmcnt(31)
  v_mfma_f32_16x16x32_bf16 v[56:59], v[52:55], a[76:79], v[56:59]
  buffer_load_dwordx4 a[204:207], v2, s[24:27], s73 offen
  s_add_u32 s73, s73, 8192
  v_and_b32_dpp v52, v45, v40 row_newbcast:5
  v_and_b32_dpp v53, v45, v41 row_newbcast:5
  v_and_b32_dpp v54, v45, v42 row_newbcast:5
  v_and_b32_dpp v55, v45, v43 row_newbcast:5
  s_waitcnt vmcnt(31)
  v_mfma_f32_16x16x32_bf16 v[56:59], v[48:51], a[80:83], v[56:59]
  buffer_load_dwordx4 a[208:211], v2, s[24:27], s73 offen
  s_add_u32 s73, s73, 8192
  v_and_b32_dpp v48, v46, v40 row_newbcast:5
  v_and_b32_dpp v49, v46, v41 row_newbcast:5
  v_and_b32_dpp v50, v46, v42 row_newbcast:5
  v_and_b32_dpp v51, v46, v43 row_newbcast:5
  s_waitcnt vmcnt(31)
  v_mfma_f32_16x16x32_bf16 v[56:59], v[52:55], a[84:87], v[56:59]
  buffer_load_dwordx4 a[212:215], v2, s[24:27], s73 offen
  s_add_u32 s73, s73, 8192
  v_and_b32_dpp v52, v47, v40 row_newbcast:5
  v_and_b32_dpp v53, v47, v41 row_newbcast:5
  v_and_b32_dpp v54, v47, v42 row_newbcast:5
  v_and_b32_dpp v55, v47, v43 row_newbcast:5
  s_waitcnt vmcnt(31)
  v_mfma_f32_16x16x32_bf16 v[56:59], v[48:51], a[88:91], v[56:59]
  buffer_load_dwordx4 a[216:219], v2, s[24:27], s73 offen
  s_add_u32 s73, s73, 8192
  v_and_b32_dpp v48, v44, v40 row_newbcast:6
  v_and_b32_dpp v49, v44, v41 row_newbcast:6
  v_and_b32_dpp v50, v44, v42 row_newbcast:6
  v_and_b32_dpp v51, v44, v43 row_newbcast:6
  s_waitcnt vmcnt(31)
  v_mfma_f32_16x16x32_bf16 v[56:59], v[52:55], a[92:95], v[56:59]
  buffer_load_dwordx4 a[220:223], v2, s[24:27], s73 offen
  v_and_b32_dpp v52, v45, v40 row_newbcast:6
  v_and_b32_dpp v53, v45, v41 row_newbcast:6
  v_and_b32_dpp v54, v45, v42 row_newbcast:6
  v_and_b32_dpp v55, v45, v43 row_newbcast:6
  s_waitcnt vmcnt(31)
  v_mfma_f32_16x16x32_bf16 v[56:59], v[48:51], a[96:99], v[56:59]
  s_lshl_b32 s73, s81, 16
  s_add_u32 s73, s73, s72
  buffer_load_dwordx4 a[224:227], v2, s[24:27], s73 offen
  s_add_u32 s73, s73, 8192
  v_and_b32_dpp v48, v46, v40 row_newbcast:6
  v_and_b32_dpp v49, v46, v41 row_newbcast:6
  v_and_b32_dpp v50, v46, v42 row_newbcast:6
  v_and_b32_dpp v51, v46, v43 row_newbcast:6
  s_waitcnt vmcnt(31)
  v_mfma_f32_16x16x32_bf16 v[56:59], v[52:55], a[100:103], v[56:59]
  buffer_load_dwordx4 a[228:231], v2, s[24:27], s73 offen
  s_add_u32 s73, s73, 8192
  v_and_b32_dpp v52, v47, v40 row_newbcast:6
  v_and_b32_dpp v53, v47, v41 row_newbcast:6
  v_and_b32_dpp v54, v47, v42 row_newbcast:6
  v_and_b32_dpp v55, v47, v43 row_newbcast:6
  s_waitcnt vmcnt(31)
  v_mfma_f32_16x16x32_bf16 v[56:59], v[48:51], a[104:107], v[56:59]
  buffer_load_dwordx4 a[232:235], v2, s[24:27], s73 offen
  s_add_u32 s73, s73, 8192
  v_and_b32_dpp v48, v44, v40 row_newbcast:7
  v_and_b32_dpp v49, v44, v41 row_newbcast:7
  v_and_b32_dpp v50, v44, v42 row_newbcast:7
  v_and_b32_dpp v51, v44, v43 row_newbcast:7
  s_waitcnt vmcnt(31)
  v_mfma_f32_16x16x32_bf16 v[56:59], v[52:55], a[108:111], v[56:59]
  buffer_load_dwordx4 a[236:239], v2, s[24:27], s73 offen
  s_add_u32 s73, s73, 8192
  v_and_b32_dpp v52, v45, v40 row_newbcast:7
  v_and_b32_dpp v53, v45, v41 row_newbcast:7
  v_and_b32_dpp v54, v45, v42 row_newbcast:7
  v_and_b32_dpp v55, v45, v43 row_newbcast:7
  s_waitcnt vmcnt(31)
  v_mfma_f32_16x16x32_bf16 v[56:59], v[48:51], a[112:115], v[56:59]
  buffer_load_dwordx4 a[240:243], v2, s[24:27], s73 offen
  s_add_u32 s73, s73, 8192
  v_and_b32_dpp v48, v46, v40 row_newbcast:7
  v_and_b32_dpp v49, v46, v41 row_newbcast:7
  v_and_b32_dpp v50, v46, v42 row_newbcast:7
  v_and_b32_dpp v51, v46, v43 row_newbcast:7
  s_waitcnt vmcnt(31)
  v_mfma_f32_16x16x32_bf16 v[56:59], v[52:55], a[116:119], v[56:59]
  buffer_load_dwordx4 a[244:247], v2, s[24:27], s73 offen
  s_add_u32 s73, s73, 8192
  v_and_b32_dpp v52, v47, v40 row_newbcast:7
  v_and_b32_dpp v53, v47, v41 row_newbcast:7
  v_and_b32_dpp v54, v47, v42 row_newbcast:7
  v_and_b32_dpp v55, v47, v43 row_newbcast:7
  s_waitcnt vmcnt(31)
  v_mfma_f32_16x16x32_bf16 v[56:59], v[48:51], a[120:123], v[56:59]
  buffer_load_dwordx4 a[248:251], v2, s[24:27], s73 offen
  s_add_u32 s73, s73, 8192
  v_and_b32_dpp v48, v44, v40 row_newbcast:8
  v_and_b32_dpp v49, v44, v41 row_newbcast:8
  v_and_b32_dpp v50, v44, v42 row_newbcast:8
  v_and_b32_dpp v51, v44, v43 row_newbcast:8
  s_waitcnt vmcnt(31)
  v_mfma_f32_16x16x32_bf16 v[56:59], v[52:55], a[124:127], v[56:59]
  buffer_load_dwordx4 a[252:255], v2, s[24:27], s73 offen
  v_and_b32_dpp v52, v45, v40 row_newbcast:8
  v_and_b32_dpp v53, v45, v41 row_newbcast:8
  v_and_b32_dpp v54, v45, v42 row_newbcast:8
  v_and_b32_dpp v55, v45, v43 row_newbcast:8
  s_waitcnt vmcnt(31)
  v_mfma_f32_16x16x32_bf16 v[56:59], v[48:51], a[128:131], v[56:59]
  v_and_b32_dpp v48, v46, v40 row_newbcast:8
  v_and_b32_dpp v49, v46, v41 row_newbcast:8
  v_and_b32_dpp v50, v46, v42 row_newbcast:8
  v_and_b32_dpp v51, v46, v43 row_newbcast:8
  s_waitcnt vmcnt(30)
  v_mfma_f32_16x16x32_bf16 v[56:59], v[52:55], a[132:135], v[56:59]
  v_and_b32_dpp v52, v47, v40 row_newbcast:8
  v_and_b32_dpp v53, v47, v41 row_newbcast:8
  v_and_b32_dpp v54, v47, v42 row_newbcast:8
  v_and_b32_dpp v55, v47, v43 row_newbcast:8
  s_waitcnt vmcnt(29)
  v_mfma_f32_16x16x32_bf16 v[56:59], v[48:51], a[136:139], v[56:59]
  v_and_b32_dpp v48, v44, v40 row_newbcast:9
  v_and_b32_dpp v49, v44, v41 row_newbcast:9
  v_and_b32_dpp v50, v44, v42 row_newbcast:9
  v_and_b32_dpp v51, v44, v43 row_newbcast:9
  s_waitcnt vmcnt(28)
  v_mfma_f32_16x16x32_bf16 v[56:59], v[52:55], a[140:143], v[56:59]
  v_and_b32_dpp v52, v45, v40 row_newbcast:9
  v_and_b32_dpp v53, v45, v41 row_newbcast:9
  v_and_b32_dpp v54, v45, v42 row_newbcast:9
  v_and_b32_dpp v55, v45, v43 row_newbcast:9
  s_waitcnt vmcnt(27)
  v_mfma_f32_16x16x32_bf16 v[56:59], v[48:51], a[144:147], v[56:59]
  v_and_b32_dpp v48, v46, v40 row_newbcast:9
  v_and_b32_dpp v49, v46, v41 row_newbcast:9
  v_and_b32_dpp v50, v46, v42 row_newbcast:9
  v_and_b32_dpp v51, v46, v43 row_newbcast:9
  s_waitcnt vmcnt(26)
  v_mfma_f32_16x16x32_bf16 v[56:59], v[52:55], a[148:151], v[56:59]
  v_and_b32_dpp v52, v47, v40 row_newbcast:9
  v_and_b32_dpp v53, v47, v41 row_newbcast:9
  v_and_b32_dpp v54, v47, v42 row_newbcast:9
  v_and_b32_dpp v55, v47, v43 row_newbcast:9
  s_waitcnt vmcnt(25)
  v_mfma_f32_16x16x32_bf16 v[56:59], v[48:51], a[152:155], v[56:59]
  v_and_b32_dpp v48, v44, v40 row_newbcast:10
  v_and_b32_dpp v49, v44, v41 row_newbcast:10
  v_and_b32_dpp v50, v44, v42 row_newbcast:10
  v_and_b32_dpp v51, v44, v43 row_newbcast:10
  s_waitcnt vmcnt(24)
  v_mfma_f32_16x16x32_bf16 v[56:59], v[52:55], a[156:159], v[56:59]
  v_and_b32_dpp v52, v45, v40 row_newbcast:10
  v_and_b32_dpp v53, v45, v41 row_newbcast:10
  v_and_b32_dpp v54, v45, v42 row_newbcast:10
  v_and_b32_dpp v55, v45, v43 row_newbcast:10
  s_waitcnt vmcnt(23)
  v_mfma_f32_16x16x32_bf16 v[56:59], v[48:51], a[160:163], v[56:59]
  v_and_b32_dpp v48, v46, v40 row_newbcast:10
  v_and_b32_dpp v49, v46, v41 row_newbcast:10
  v_and_b32_dpp v50, v46, v42 row_newbcast:10
  v_and_b32_dpp v51, v46, v43 row_newbcast:10
  s_waitcnt vmcnt(22)
  v_mfma_f32_16x16x32_bf16 v[56:59], v[52:55], a[164:167], v[56:59]
  v_and_b32_dpp v52, v47, v40 row_newbcast:10
  v_and_b32_dpp v53, v47, v41 row_newbcast:10
  v_and_b32_dpp v54, v47, v42 row_newbcast:10
  v_and_b32_dpp v55, v47, v43 row_newbcast:10
  s_waitcnt vmcnt(21)
  v_mfma_f32_16x16x32_bf16 v[56:59], v[48:51], a[168:171], v[56:59]
  v_and_b32_dpp v48, v44, v40 row_newbcast:11
  v_and_b32_dpp v49, v44, v41 row_newbcast:11
  v_and_b32_dpp v50, v44, v42 row_newbcast:11
  v_and_b32_dpp v51, v44, v43 row_newbcast:11
  s_waitcnt vmcnt(20)
  v_mfma_f32_16x16x32_bf16 v[56:59], v[52:55], a[172:175], v[56:59]
  v_and_b32_dpp v52, v45, v40 row_newbcast:11
  v_and_b32_dpp v53, v45, v41 row_newbcast:11
  v_and_b32_dpp v54, v45, v42 row_newbcast:11
  v_and_b32_dpp v55, v45, v43 row_newbcast:11
  s_waitcnt vmcnt(19)
  v_mfma_f32_16x16x32_bf16 v[56:59], v[48:51], a[176:179], v[56:59]
  v_and_b32_dpp v48, v46, v40 row_newbcast:11
  v_and_b32_dpp v49, v46, v41 row_newbcast:11
  v_and_b32_dpp v50, v46, v42 row_newbcast:11
  v_and_b32_dpp v51, v46, v43 row_newbcast:11
  s_waitcnt vmcnt(18)
  v_mfma_f32_16x16x32_bf16 v[56:59], v[52:55], a[180:183], v[56:59]
  v_and_b32_dpp v52, v47, v40 row_newbcast:11
  v_and_b32_dpp v53, v47, v41 row_newbcast:11
  v_and_b32_dpp v54, v47, v42 row_newbcast:11
  v_and_b32_dpp v55, v47, v43 row_newbcast:11
  s_waitcnt vmcnt(17)
  v_mfma_f32_16x16x32_bf16 v[56:59], v[48:51], a[184:187], v[56:59]
  v_and_b32_dpp v48, v44, v40 row_newbcast:12
  v_and_b32_dpp v49, v44, v41 row_newbcast:12
  v_and_b32_dpp v50, v44, v42 row_newbcast:12
  v_and_b32_dpp v51, v44, v43 row_newbcast:12
  s_waitcnt vmcnt(16)
  v_mfma_f32_16x16x32_bf16 v[56:59], v[52:55], a[188:191], v[56:59]
  v_and_b32_dpp v52, v45, v40 row_newbcast:12
  v_and_b32_dpp v53, v45, v41 row_newbcast:12
  v_and_b32_dpp v54, v45, v42 row_newbcast:12
  v_and_b32_dpp v55, v45, v43 row_newbcast:12
  s_waitcnt vmcnt(15)
  v_mfma_f32_16x16x32_bf16 v[56:59], v[48:51], a[192:195], v[56:59]
  v_and_b32_dpp v48, v46, v40 row_newbcast:12
  v_and_b32_dpp v49, v46, v41 row_newbcast:12
  v_and_b32_dpp v50, v46, v42 row_newbcast:12
  v_and_b32_dpp v51, v46, v43 row_newbcast:12
  s_waitcnt vmcnt(14)
  v_mfma_f32_16x16x32_bf16 v[56:59], v[52:55], a[196:199], v[56:59]
  v_and_b32_dpp v52, v47, v40 row_newbcast:12
  v_and_b32_dpp v53, v47, v41 row_newbcast:12
  v_and_b32_dpp v54, v47, v42 row_newbcast:12
  v_and_b32_dpp v55, v47, v43 row_newbcast:12
  s_waitcnt vmcnt(13)
  v_mfma_f32_16x16x32_bf16 v[56:59], v[48:51], a[200:203], v[56:59]
  v_and_b32_dpp v48, v44, v40 row_newbcast:13
  v_and_b32_dpp v49, v44, v41 row_newbcast:13
  v_and_b32_dpp v50, v44, v42 row_newbcast:13
  v_and_b32_dpp v51, v44, v43 row_newbcast:13
  s_waitcnt vmcnt(12)
  v_mfma_f32_16x16x32_bf16 v[56:59], v[52:55], a[204:207], v[56:59]
  v_and_b32_dpp v52, v45, v40 row_newbcast:13
  v_and_b32_dpp v53, v45, v41 row_newbcast:13
  v_and_b32_dpp v54, v45, v42 row_newbcast:13
  v_and_b32_dpp v55, v45, v43 row_newbcast:13
  s_waitcnt vmcnt(11)
  v_mfma_f32_16x16x32_bf16 v[56:59], v[48:51], a[208:211], v[56:59]
  v_and_b32_dpp v48, v46, v40 row_newbcast:13
  v_and_b32_dpp v49, v46, v41 row_newbcast:13
  v_and_b32_dpp v50, v46, v42 row_newbcast:13
  v_and_b32_dpp v51, v46, v43 row_newbcast:13
  s_waitcnt vmcnt(10)
  v_mfma_f32_16x16x32_bf16 v[56:59], v[52:55], a[212:215], v[56:59]
  v_and_b32_dpp v52, v47, v40 row_newbcast:13
  v_and_b32_dpp v53, v47, v41 row_newbcast:13
  v_and_b32_dpp v54, v47, v42 row_newbcast:13
  v_and_b32_dpp v55, v47, v43 row_newbcast:13
  s_waitcnt vmcnt(9)
  v_mfma_f32_16x16x32_bf16 v[56:59], v[48:51], a[216:219], v[56:59]
  v_and_b32_dpp v48, v44, v40 row_newbcast:14
  v_and_b32_dpp v49, v44, v41 row_newbcast:14
  v_and_b32_dpp v50, v44, v42 row_newbcast:14
  v_and_b32_dpp v51, v44, v43 row_newbcast:14
  s_waitcnt vmcnt(8)
  v_mfma_f32_16x16x32_bf16 v[56:59], v[52:55], a[220:223], v[56:59]
  v_and_b32_dpp v52, v45, v40 row_newbcast:14
  v_and_b32_dpp v53, v45, v41 row_newbcast:14
  v_and_b32_dpp v54, v45, v42 row_newbcast:14
  v_and_b32_dpp v55, v45, v43 row_newbcast:14
  s_waitcnt vmcnt(7)
  v_mfma_f32_16x16x32_bf16 v[56:59], v[48:51], a[224:227], v[56:59]
  v_and_b32_dpp v48, v46, v40 row_newbcast:14
  v_and_b32_dpp v49, v46, v41 row_newbcast:14
  v_and_b32_dpp v50, v46, v42 row_newbcast:14
  v_and_b32_dpp v51, v46, v43 row_newbcast:14
  s_waitcnt vmcnt(6)
  v_mfma_f32_16x16x32_bf16 v[56:59], v[52:55], a[228:231], v[56:59]
  v_and_b32_dpp v52, v47, v40 row_newbcast:14
  v_and_b32_dpp v53, v47, v41 row_newbcast:14
  v_and_b32_dpp v54, v47, v42 row_newbcast:14
  v_and_b32_dpp v55, v47, v43 row_newbcast:14
  s_waitcnt vmcnt(5)
  v_mfma_f32_16x16x32_bf16 v[56:59], v[48:51], a[232:235], v[56:59]
  v_and_b32_dpp v48, v44, v40 row_newbcast:15
  v_and_b32_dpp v49, v44, v41 row_newbcast:15
  v_and_b32_dpp v50, v44, v42 row_newbcast:15
  v_and_b32_dpp v51, v44, v43 row_newbcast:15
  s_waitcnt vmcnt(4)
  v_mfma_f32_16x16x32_bf16 v[56:59], v[52:55], a[236:239], v[56:59]
  v_and_b32_dpp v52, v45, v40 row_newbcast:15
  v_and_b32_dpp v53, v45, v41 row_newbcast:15
  v_and_b32_dpp v54, v45, v42 row_newbcast:15
  v_and_b32_dpp v55, v45, v43 row_newbcast:15
  s_waitcnt vmcnt(3)
  v_mfma_f32_16x16x32_bf16 v[56:59], v[48:51], a[240:243], v[56:59]
  v_and_b32_dpp v48, v46, v40 row_newbcast:15
  v_and_b32_dpp v49, v46, v41 row_newbcast:15
  v_and_b32_dpp v50, v46, v42 row_newbcast:15
  v_and_b32_dpp v51, v46, v43 row_newbcast:15
  s_waitcnt vmcnt(2)
  v_mfma_f32_16x16x32_bf16 v[56:59], v[52:55], a[244:247], v[56:59]
  v_and_b32_dpp v52, v47, v40 row_newbcast:15
  v_and_b32_dpp v53, v47, v41 row_newbcast:15
  v_and_b32_dpp v54, v47, v42 row_newbcast:15
  v_and_b32_dpp v55, v47, v43 row_newbcast:15
  s_waitcnt vmcnt(1)
  v_mfma_f32_16x16x32_bf16 v[56:59], v[48:51], a[248:251], v[56:59]
  s_waitcnt vmcnt(0)
  v_mfma_f32_16x16x32_bf16 v[56:59], v[52:55], a[252:255], v[56:59]
  v_lshrrev_b32 v26, 8, v1
  v_and_b32 v27, 0xf0, v1
  v_lshlrev_b32 v26, 4, v26
  v_lshl_add_u32 v26, v27, 1, v26
  s_lshl_b32 s38, s64, 9
  v_add_u32 v26, s38, v26
  s_mov_b64 exec, 0xffffffff
  s_nop 0
  ds_write_b128 v26, v[56:59] offset:0
  s_mov_b64 exec, -1
  s_xor_b32 s68, s70, 0x800
  buffer_load_dwordx4 v[80:83], v63, s[4:7], s68 offen nt
  s_xor_b32 s68, s70, 0x900
  buffer_load_dwordx4 v[84:87], v63, s[4:7], s68 offen nt
  s_xor_b32 s68, s70, 0xc00
  buffer_load_dwordx4 v[88:91], v63, s[4:7], s68 offen nt
  s_xor_b32 s68, s70, 0xd00
  buffer_load_dwordx4 v[92:95], v63, s[4:7], s68 offen nt
  s_xor_b32 s68, s70, 0x10000
  buffer_load_dwordx4 v[96:99], v63, s[4:7], s68 offen nt
  s_xor_b32 s68, s70, 0x10100
  buffer_load_dwordx4 v[100:103], v63, s[4:7], s68 offen nt
  s_xor_b32 s68, s70, 0x10400
  buffer_load_dwordx4 v[104:107], v63, s[4:7], s68 offen nt
  s_xor_b32 s68, s70, 0x10500
  buffer_load_dwordx4 v[108:111], v63, s[4:7], s68 offen nt
  s_xor_b32 s68, s70, 0x10800
  buffer_load_dwordx4 v[112:115], v63, s[4:7], s68 offen nt
  s_xor_b32 s68, s70, 0x10900
  buffer_load_dwordx4 v[116:119], v63, s[4:7], s68 offen nt
  s_xor_b32 s68, s70, 0x10c00
  buffer_load_dwordx4 v[120:123], v63, s[4:7], s68 offen nt
  s_xor_b32 s68, s70, 0x10d00
  buffer_load_dwordx4 v[124:127], v63, s[4:7], s68 offen nt
  s_waitcnt lgkmcnt(0)
  s_barrier
  v_and_b32 v26, 0xf0, v1
  v_lshlrev_b32 v26, 1, v26
  ds_read_b128 v[12:15], v26 offset:0
  ds_read_b128 v[16:19], v26 offset:512
  ds_read_b128 v[48:51], v26 offset:1024
  ds_read_b128 v[52:55], v26 offset:1536
  ds_read_b128 v[56:59], v26 offset:16
  ds_read_b128 v[192:195], v26 offset:528
  ds_read_b128 v[196:199], v26 offset:1040
  ds_read_b128 v[200:203], v26 offset:1552
  s_waitcnt lgkmcnt(4)
  v_pk_add_f32 v[12:13], v[12:13], v[16:17]
  v_pk_add_f32 v[48:49], v[48:49], v[52:53]
  v_pk_add_f32 v[14:15], v[14:15], v[18:19]
  v_pk_add_f32 v[50:51], v[50:51], v[54:55]
  v_pk_add_f32 v[12:13], v[12:13], v[48:49]
  v_pk_add_f32 v[14:15], v[14:15], v[50:51]
  v_cvt_pk_bf16_f32 v4, v12, v13
  v_cvt_pk_bf16_f32 v5, v14, v15
  s_waitcnt lgkmcnt(0)
  v_pk_add_f32 v[56:57], v[56:57], v[192:193]
  v_pk_add_f32 v[196:197], v[196:197], v[200:201]
  v_pk_add_f32 v[58:59], v[58:59], v[194:195]
  v_pk_add_f32 v[198:199], v[198:199], v[202:203]
  v_pk_add_f32 v[56:57], v[56:57], v[196:197]
  v_pk_add_f32 v[58:59], v[58:59], v[198:199]
  v_cvt_pk_bf16_f32 v6, v56, v57
  v_cvt_pk_bf16_f32 v7, v58, v59
  s_or_b32 s38, s64, s65
  s_cmp_eq_u32 s38, 0
  s_cbranch_scc0 L_nosigA
  s_lshl_b32 s38, s66, 2
  v_mov_b32 v26, s38
  v_mov_b32 v27, 1
  s_mov_b64 exec, 1
  global_store_dword v26, v27, s[82:83] sc1
  s_mov_b64 exec, -1
L_nosigA:
  v_dot2_f32_bf16 v22, v64, v4, 0
  v_dot2_f32_bf16 v22, v65, v5, v22
  v_dot2_f32_bf16 v22, v66, v6, v22
  v_dot2_f32_bf16 v22, v67, v7, v22
  v_dot2_f32_bf16 v23, v68, v4, 0
  v_dot2_f32_bf16 v23, v69, v5, v23
  v_dot2_f32_bf16 v23, v70, v6, v23
  v_dot2_f32_bf16 v23, v71, v7, v23
  v_dot2_f32_bf16 v24, v72, v4, 0
  v_dot2_f32_bf16 v24, v73, v5, v24
  v_dot2_f32_bf16 v24, v74, v6, v24
  v_dot2_f32_bf16 v24, v75, v7, v24
  s_mov_b32 s24, s56
  s_mov_b32 s25, s57
  s_mov_b32 s28, s50
  s_mov_b32 s29, s51
  s_lshl_b32 s73, s74, 16
  s_add_u32 s73, s73, s72
  buffer_load_dwordx4 a[0:3], v2, s[24:27], s73 offen
  s_add_u32 s73, s73, 8192
  buffer_load_dwordx4 a[4:7], v2, s[24:27], s73 offen
  s_add_u32 s73, s73, 8192
  buffer_load_dwordx4 a[8:11], v2, s[24:27], s73 offen
  s_add_u32 s73, s73, 8192
  buffer_load_dwordx4 a[12:15], v2, s[24:27], s73 offen
  s_add_u32 s73, s73, 8192
  buffer_load_dwordx4 a[16:19], v2, s[24:27], s73 offen
  s_add_u32 s73, s73, 8192
  buffer_load_dwordx4 a[20:23], v2, s[24:27], s73 offen
  s_add_u32 s73, s73, 8192
  buffer_load_dwordx4 a[24:27], v2, s[24:27], s73 offen
  s_add_u32 s73, s73, 8192
  buffer_load_dwordx4 a[28:31], v2, s[24:27], s73 offen
  v_dot2_f32_bf16 v25, v76, v4, 0
  v_dot2_f32_bf16 v25, v77, v5, v25
  v_dot2_f32_bf16 v25, v78, v6, v25
  v_dot2_f32_bf16 v25, v79, v7, v25
  v_add_f32_dpp v26, v22, v22 row_ror:8 row_mask:0xf bank_mask:0x3
  v_add_f32_dpp v27, v24, v24 row_ror:8 row_mask:0xf bank_mask:0x3
  s_nop 0
  v_add_f32_dpp v26, v23, v23 row_ror:8 row_mask:0xf bank_mask:0xc
  v_add_f32_dpp v27, v25, v25 row_ror:8 row_mask:0xf bank_mask:0xc
  s_nop 0
  v_add_f32_dpp v28, v26, v26 row_half_mirror row_mask:0xf bank_mask:0x5
  s_nop 1
  v_add_f32_dpp v28, v27, v27 row_half_mirror row_mask:0xf bank_mask:0xa
  s_nop 1
  v_add_f32_dpp v28, v28, v28 quad_perm:[1,0,3,2]
  s_nop 1
  v_add_f32_dpp v192, v28, v28 quad_perm:[2,3,0,1]
  v_mov_b32 v20, v192
  buffer_load_dwordx2 v[38:39], v37, s[28:31], 0 offen
  s_waitcnt vmcnt(20)
  v_dot2_f32_bf16 v22, v80, v4, 0
  v_dot2_f32_bf16 v22, v81, v5, v22
  v_dot2_f32_bf16 v22, v82, v6, v22
  v_dot2_f32_bf16 v22, v83, v7, v22
  s_waitcnt vmcnt(19)
  v_dot2_f32_bf16 v23, v84, v4, 0
  v_dot2_f32_bf16 v23, v85, v5, v23
  v_dot2_f32_bf16 v23, v86, v6, v23
  v_dot2_f32_bf16 v23, v87, v7, v23
  s_waitcnt vmcnt(18)
  v_dot2_f32_bf16 v24, v88, v4, 0
  v_dot2_f32_bf16 v24, v89, v5, v24
  v_dot2_f32_bf16 v24, v90, v6, v24
  v_dot2_f32_bf16 v24, v91, v7, v24
  s_xor_b32 s68, s70, 0x20000
  buffer_load_dwordx4 v[128:131], v63, s[4:7], s68 offen nt
  s_waitcnt vmcnt(18)
  v_dot2_f32_bf16 v25, v92, v4, 0
  v_dot2_f32_bf16 v25, v93, v5, v25
  v_dot2_f32_bf16 v25, v94, v6, v25
  v_dot2_f32_bf16 v25, v95, v7, v25
  s_xor_b32 s68, s70, 0x20100
  buffer_load_dwordx4 v[132:135], v63, s[4:7], s68 offen nt
  v_add_f32_dpp v26, v22, v22 row_ror:8 row_mask:0xf bank_mask:0x3
  v_add_f32_dpp v27, v24, v24 row_ror:8 row_mask:0xf bank_mask:0x3
  s_nop 0
  v_add_f32_dpp v26, v23, v23 row_ror:8 row_mask:0xf bank_mask:0xc
  v_add_f32_dpp v27, v25, v25 row_ror:8 row_mask:0xf bank_mask:0xc
  s_nop 0
  v_add_f32_dpp v28, v26, v26 row_half_mirror row_mask:0xf bank_mask:0x5
  s_nop 1
  v_add_f32_dpp v28, v27, v27 row_half_mirror row_mask:0xf bank_mask:0xa
  s_nop 1
  v_add_f32_dpp v28, v28, v28 quad_perm:[1,0,3,2]
  s_nop 1
  v_add_f32_dpp v193, v28, v28 quad_perm:[2,3,0,1]
  v_max_f32 v20, v20, v193
  s_waitcnt vmcnt(18)
  v_dot2_f32_bf16 v22, v96, v4, 0
  v_dot2_f32_bf16 v22, v97, v5, v22
  v_dot2_f32_bf16 v22, v98, v6, v22
  v_dot2_f32_bf16 v22, v99, v7, v22
  s_xor_b32 s68, s70, 0x20400
  buffer_load_dwordx4 v[136:139], v63, s[4:7], s68 offen nt
  s_waitcnt vmcnt(18)
  v_dot2_f32_bf16 v23, v100, v4, 0
  v_dot2_f32_bf16 v23, v101, v5, v23
  v_dot2_f32_bf16 v23, v102, v6, v23
  v_dot2_f32_bf16 v23, v103, v7, v23
  s_xor_b32 s68, s70, 0x20500
  buffer_load_dwordx4 v[140:143], v63, s[4:7], s68 offen nt
  s_waitcnt vmcnt(18)
  v_dot2_f32_bf16 v24, v104, v4, 0
  v_dot2_f32_bf16 v24, v105, v5, v24
  v_dot2_f32_bf16 v24, v106, v6, v24
  v_dot2_f32_bf16 v24, v107, v7, v24
  s_xor_b32 s68, s70, 0x20800
  buffer_load_dwordx4 v[144:147], v63, s[4:7], s68 offen nt
  s_waitcnt vmcnt(18)
  v_dot2_f32_bf16 v25, v108, v4, 0
  v_dot2_f32_bf16 v25, v109, v5, v25
  v_dot2_f32_bf16 v25, v110, v6, v25
  v_dot2_f32_bf16 v25, v111, v7, v25
  s_xor_b32 s68, s70, 0x20900
  buffer_load_dwordx4 v[148:151], v63, s[4:7], s68 offen nt
  v_add_f32_dpp v26, v22, v22 row_ror:8 row_mask:0xf bank_mask:0x3
  v_add_f32_dpp v27, v24, v24 row_ror:8 row_mask:0xf bank_mask:0x3
  s_nop 0
  v_add_f32_dpp v26, v23, v23 row_ror:8 row_mask:0xf bank_mask:0xc
  v_add_f32_dpp v27, v25, v25 row_ror:8 row_mask:0xf bank_mask:0xc
  s_nop 0
  v_add_f32_dpp v28, v26, v26 row_half_mirror row_mask:0xf bank_mask:0x5
  s_nop 1
  v_add_f32_dpp v28, v27, v27 row_half_mirror row_mask:0xf bank_mask:0xa
  s_nop 1
  v_add_f32_dpp v28, v28, v28 quad_perm:[1,0,3,2]
  s_nop 1
  v_add_f32_dpp v194, v28, v28 quad_perm:[2,3,0,1]
  v_max_f32 v20, v20, v194
  s_waitcnt vmcnt(18)
  v_dot2_f32_bf16 v22, v112, v4, 0
  v_dot2_f32_bf16 v22, v113, v5, v22
  v_dot2_f32_bf16 v22, v114, v6, v22
  v_dot2_f32_bf16 v22, v115, v7, v22
  s_xor_b32 s68, s70, 0x20c00
  buffer_load_dwordx4 v[152:155], v63, s[4:7], s68 offen nt
  s_waitcnt vmcnt(18)
  v_dot2_f32_bf16 v23, v116, v4, 0
  v_dot2_f32_bf16 v23, v117, v5, v23
  v_dot2_f32_bf16 v23, v118, v6, v23
  v_dot2_f32_bf16 v23, v119, v7, v23
  s_xor_b32 s68, s70, 0x20d00
  buffer_load_dwordx4 v[156:159], v63, s[4:7], s68 offen nt
  s_waitcnt vmcnt(18)
  v_dot2_f32_bf16 v24, v120, v4, 0
  v_dot2_f32_bf16 v24, v121, v5, v24
  v_dot2_f32_bf16 v24, v122, v6, v24
  v_dot2_f32_bf16 v24, v123, v7, v24
  s_xor_b32 s68, s70, 0x30000
  buffer_load_dwordx4 v[160:163], v63, s[4:7], s68 offen nt
  s_waitcnt vmcnt(18)
  v_dot2_f32_bf16 v25, v124, v4, 0
  v_dot2_f32_bf16 v25, v125, v5, v25
  v_dot2_f32_bf16 v25, v126, v6, v25
  v_dot2_f32_bf16 v25, v127, v7, v25
  s_xor_b32 s68, s70, 0x30100
  buffer_load_dwordx4 v[164:167], v63, s[4:7], s68 offen nt
  v_add_f32_dpp v26, v22, v22 row_ror:8 row_mask:0xf bank_mask:0x3
  v_add_f32_dpp v27, v24, v24 row_ror:8 row_mask:0xf bank_mask:0x3
  s_nop 0
  v_add_f32_dpp v26, v23, v23 row_ror:8 row_mask:0xf bank_mask:0xc
  v_add_f32_dpp v27, v25, v25 row_ror:8 row_mask:0xf bank_mask:0xc
  s_nop 0
  v_add_f32_dpp v28, v26, v26 row_half_mirror row_mask:0xf bank_mask:0x5
  s_nop 1
  v_add_f32_dpp v28, v27, v27 row_half_mirror row_mask:0xf bank_mask:0xa
  s_nop 1
  v_add_f32_dpp v28, v28, v28 quad_perm:[1,0,3,2]
  s_nop 1
  v_add_f32_dpp v195, v28, v28 quad_perm:[2,3,0,1]
  v_max_f32 v20, v20, v195
  s_waitcnt vmcnt(9)
  v_dot2_f32_bf16 v22, v128, v4, 0
  v_dot2_f32_bf16 v22, v129, v5, v22
  v_dot2_f32_bf16 v22, v130, v6, v22
  v_dot2_f32_bf16 v22, v131, v7, v22
  s_xor_b32 s68, s70, 0x30400
  buffer_load_dwordx4 v[168:171], v63, s[4:7], s68 offen nt
  s_waitcnt vmcnt(9)
  v_dot2_f32_bf16 v23, v132, v4, 0
  v_dot2_f32_bf16 v23, v133, v5, v23
  v_dot2_f32_bf16 v23, v134, v6, v23
  v_dot2_f32_bf16 v23, v135, v7, v23
  s_xor_b32 s68, s70, 0x30500
  buffer_load_dwordx4 v[172:175], v63, s[4:7], s68 offen nt
  s_waitcnt vmcnt(9)
  v_dot2_f32_bf16 v24, v136, v4, 0
  v_dot2_f32_bf16 v24, v137, v5, v24
  v_dot2_f32_bf16 v24, v138, v6, v24
  v_dot2_f32_bf16 v24, v139, v7, v24
  s_xor_b32 s68, s70, 0x30800
  buffer_load_dwordx4 v[176:179], v63, s[4:7], s68 offen nt
  s_waitcnt vmcnt(9)
  v_dot2_f32_bf16 v25, v140, v4, 0
  v_dot2_f32_bf16 v25, v141, v5, v25
  v_dot2_f32_bf16 v25, v142, v6, v25
  v_dot2_f32_bf16 v25, v143, v7, v25
  s_xor_b32 s68, s70, 0x30900
  buffer_load_dwordx4 v[180:183], v63, s[4:7], s68 offen nt
  v_add_f32_dpp v26, v22, v22 row_ror:8 row_mask:0xf bank_mask:0x3
  v_add_f32_dpp v27, v24, v24 row_ror:8 row_mask:0xf bank_mask:0x3
  s_nop 0
  v_add_f32_dpp v26, v23, v23 row_ror:8 row_mask:0xf bank_mask:0xc
  v_add_f32_dpp v27, v25, v25 row_ror:8 row_mask:0xf bank_mask:0xc
  s_nop 0
  v_add_f32_dpp v28, v26, v26 row_half_mirror row_mask:0xf bank_mask:0x5
  s_nop 1
  v_add_f32_dpp v28, v27, v27 row_half_mirror row_mask:0xf bank_mask:0xa
  s_nop 1
  v_add_f32_dpp v28, v28, v28 quad_perm:[1,0,3,2]
  s_nop 1
  v_add_f32_dpp v196, v28, v28 quad_perm:[2,3,0,1]
  v_max_f32 v20, v20, v196
  s_waitcnt vmcnt(9)
  v_dot2_f32_bf16 v22, v144, v4, 0
  v_dot2_f32_bf16 v22, v145, v5, v22
  v_dot2_f32_bf16 v22, v146, v6, v22
  v_dot2_f32_bf16 v22, v147, v7, v22
  s_xor_b32 s68, s70, 0x30c00
  buffer_load_dwordx4 v[184:187], v63, s[4:7], s68 offen nt
  s_waitcnt vmcnt(9)
  v_dot2_f32_bf16 v23, v148, v4, 0
  v_dot2_f32_bf16 v23, v149, v5, v23
  v_dot2_f32_bf16 v23, v150, v6, v23
  v_dot2_f32_bf16 v23, v151, v7, v23
  s_xor_b32 s68, s70, 0x30d00
  buffer_load_dwordx4 v[188:191], v63, s[4:7], s68 offen nt
  s_waitcnt vmcnt(9)
  v_dot2_f32_bf16 v24, v152, v4, 0
  v_dot2_f32_bf16 v24, v153, v5, v24
  v_dot2_f32_bf16 v24, v154, v6, v24
  v_dot2_f32_bf16 v24, v155, v7, v24
  s_xor_b32 s68, s70, 0x80000
  buffer_load_dwordx4 v[204:207], v63, s[4:7], s68 offen nt
  s_waitcnt vmcnt(9)
  v_dot2_f32_bf16 v25, v156, v4, 0
  v_dot2_f32_bf16 v25, v157, v5, v25
  v_dot2_f32_bf16 v25, v158, v6, v25
  v_dot2_f32_bf16 v25, v159, v7, v25
  s_xor_b32 s68, s70, 0x80100
  buffer_load_dwordx4 v[208:211], v63, s[4:7], s68 offen nt
  v_add_f32_dpp v26, v22, v22 row_ror:8 row_mask:0xf bank_mask:0x3
  v_add_f32_dpp v27, v24, v24 row_ror:8 row_mask:0xf bank_mask:0x3
  s_nop 0
  v_add_f32_dpp v26, v23, v23 row_ror:8 row_mask:0xf bank_mask:0xc
  v_add_f32_dpp v27, v25, v25 row_ror:8 row_mask:0xf bank_mask:0xc
  s_nop 0
  v_add_f32_dpp v28, v26, v26 row_half_mirror row_mask:0xf bank_mask:0x5
  s_nop 1
  v_add_f32_dpp v28, v27, v27 row_half_mirror row_mask:0xf bank_mask:0xa
  s_nop 1
  v_add_f32_dpp v28, v28, v28 quad_perm:[1,0,3,2]
  s_nop 1
  v_add_f32_dpp v197, v28, v28 quad_perm:[2,3,0,1]
  v_max_f32 v20, v20, v197
  s_waitcnt vmcnt(9)
  v_dot2_f32_bf16 v22, v160, v4, 0
  v_dot2_f32_bf16 v22, v161, v5, v22
  v_dot2_f32_bf16 v22, v162, v6, v22
  v_dot2_f32_bf16 v22, v163, v7, v22
  s_xor_b32 s68, s70, 0x80400
  buffer_load_dwordx4 v[212:215], v63, s[4:7], s68 offen nt
  s_waitcnt vmcnt(9)
  v_dot2_f32_bf16 v23, v164, v4, 0
  v_dot2_f32_bf16 v23, v165, v5, v23
  v_dot2_f32_bf16 v23, v166, v6, v23
  v_dot2_f32_bf16 v23, v167, v7, v23
  s_xor_b32 s68, s70, 0x80500
  buffer_load_dwordx4 v[216:219], v63, s[4:7], s68 offen nt
  s_waitcnt vmcnt(9)
  v_dot2_f32_bf16 v24, v168, v4, 0
  v_dot2_f32_bf16 v24, v169, v5, v24
  v_dot2_f32_bf16 v24, v170, v6, v24
  v_dot2_f32_bf16 v24, v171, v7, v24
  s_waitcnt vmcnt(8)
  v_dot2_f32_bf16 v25, v172, v4, 0
  v_dot2_f32_bf16 v25, v173, v5, v25
  v_dot2_f32_bf16 v25, v174, v6, v25
  v_dot2_f32_bf16 v25, v175, v7, v25
  v_add_f32_dpp v26, v22, v22 row_ror:8 row_mask:0xf bank_mask:0x3
  v_add_f32_dpp v27, v24, v24 row_ror:8 row_mask:0xf bank_mask:0x3
  s_nop 0
  v_add_f32_dpp v26, v23, v23 row_ror:8 row_mask:0xf bank_mask:0xc
  v_add_f32_dpp v27, v25, v25 row_ror:8 row_mask:0xf bank_mask:0xc
  s_nop 0
  v_add_f32_dpp v28, v26, v26 row_half_mirror row_mask:0xf bank_mask:0x5
  s_nop 1
  v_add_f32_dpp v28, v27, v27 row_half_mirror row_mask:0xf bank_mask:0xa
  s_nop 1
  v_add_f32_dpp v28, v28, v28 quad_perm:[1,0,3,2]
  s_nop 1
  v_add_f32_dpp v198, v28, v28 quad_perm:[2,3,0,1]
  v_max_f32 v20, v20, v198
  s_waitcnt vmcnt(7)
  v_dot2_f32_bf16 v22, v176, v4, 0
  v_dot2_f32_bf16 v22, v177, v5, v22
  v_dot2_f32_bf16 v22, v178, v6, v22
  v_dot2_f32_bf16 v22, v179, v7, v22
  s_waitcnt vmcnt(6)
  v_dot2_f32_bf16 v23, v180, v4, 0
  v_dot2_f32_bf16 v23, v181, v5, v23
  v_dot2_f32_bf16 v23, v182, v6, v23
  v_dot2_f32_bf16 v23, v183, v7, v23
  s_waitcnt vmcnt(5)
  v_dot2_f32_bf16 v24, v184, v4, 0
  v_dot2_f32_bf16 v24, v185, v5, v24
  v_dot2_f32_bf16 v24, v186, v6, v24
  v_dot2_f32_bf16 v24, v187, v7, v24
  s_xor_b32 s68, s70, 0x80800
  buffer_load_dwordx4 v[220:223], v63, s[4:7], s68 offen nt
  s_waitcnt vmcnt(5)
  v_dot2_f32_bf16 v25, v188, v4, 0
  v_dot2_f32_bf16 v25, v189, v5, v25
  v_dot2_f32_bf16 v25, v190, v6, v25
  v_dot2_f32_bf16 v25, v191, v7, v25
  s_xor_b32 s68, s70, 0x80900
  buffer_load_dwordx4 v[224:227], v63, s[4:7], s68 offen nt
  v_add_f32_dpp v26, v22, v22 row_ror:8 row_mask:0xf bank_mask:0x3
  v_add_f32_dpp v27, v24, v24 row_ror:8 row_mask:0xf bank_mask:0x3
  s_nop 0
  v_add_f32_dpp v26, v23, v23 row_ror:8 row_mask:0xf bank_mask:0xc
  v_add_f32_dpp v27, v25, v25 row_ror:8 row_mask:0xf bank_mask:0xc
  s_nop 0
  v_add_f32_dpp v28, v26, v26 row_half_mirror row_mask:0xf bank_mask:0x5
  s_nop 1
  v_add_f32_dpp v28, v27, v27 row_half_mirror row_mask:0xf bank_mask:0xa
  s_nop 1
  v_add_f32_dpp v28, v28, v28 quad_perm:[1,0,3,2]
  s_nop 1
  v_add_f32_dpp v199, v28, v28 quad_perm:[2,3,0,1]
  v_max_f32 v20, v20, v199
  s_waitcnt vmcnt(5)
  v_dot2_f32_bf16 v22, v204, v4, 0
  v_dot2_f32_bf16 v22, v205, v5, v22
  v_dot2_f32_bf16 v22, v206, v6, v22
  v_dot2_f32_bf16 v22, v207, v7, v22
  s_xor_b32 s68, s70, 0x80c00
  buffer_load_dwordx4 v[228:231], v63, s[4:7], s68 offen nt
  s_waitcnt vmcnt(5)
  v_dot2_f32_bf16 v23, v208, v4, 0
  v_dot2_f32_bf16 v23, v209, v5, v23
  v_dot2_f32_bf16 v23, v210, v6, v23
  v_dot2_f32_bf16 v23, v211, v7, v23
  s_xor_b32 s68, s70, 0x80d00
  buffer_load_dwordx4 v[232:235], v63, s[4:7], s68 offen nt
  s_waitcnt vmcnt(5)
  v_dot2_f32_bf16 v24, v212, v4, 0
  v_dot2_f32_bf16 v24, v213, v5, v24
  v_dot2_f32_bf16 v24, v214, v6, v24
  v_dot2_f32_bf16 v24, v215, v7, v24
  s_xor_b32 s68, s70, 0x90000
  buffer_load_dwordx4 v[236:239], v63, s[4:7], s68 offen nt
  s_waitcnt vmcnt(5)
  v_dot2_f32_bf16 v25, v216, v4, 0
  v_dot2_f32_bf16 v25, v217, v5, v25
  v_dot2_f32_bf16 v25, v218, v6, v25
  v_dot2_f32_bf16 v25, v219, v7, v25
  s_xor_b32 s68, s70, 0x90100
  buffer_load_dwordx4 v[240:243], v63, s[4:7], s68 offen nt
  v_add_f32_dpp v26, v22, v22 row_ror:8 row_mask:0xf bank_mask:0x3
  v_add_f32_dpp v27, v24, v24 row_ror:8 row_mask:0xf bank_mask:0x3
  s_nop 0
  v_add_f32_dpp v26, v23, v23 row_ror:8 row_mask:0xf bank_mask:0xc
  v_add_f32_dpp v27, v25, v25 row_ror:8 row_mask:0xf bank_mask:0xc
  s_nop 0
  v_add_f32_dpp v28, v26, v26 row_half_mirror row_mask:0xf bank_mask:0x5
  s_nop 1
  v_add_f32_dpp v28, v27, v27 row_half_mirror row_mask:0xf bank_mask:0xa
  s_nop 1
  v_add_f32_dpp v28, v28, v28 quad_perm:[1,0,3,2]
  s_nop 1
  v_add_f32_dpp v200, v28, v28 quad_perm:[2,3,0,1]
  v_max_f32 v20, v20, v200
  s_waitcnt vmcnt(5)
  v_dot2_f32_bf16 v22, v220, v4, 0
  v_dot2_f32_bf16 v22, v221, v5, v22
  v_dot2_f32_bf16 v22, v222, v6, v22
  v_dot2_f32_bf16 v22, v223, v7, v22
  s_xor_b32 s68, s70, 0x90400
  buffer_load_dwordx4 v[244:247], v63, s[4:7], s68 offen nt
  s_waitcnt vmcnt(5)
  v_dot2_f32_bf16 v23, v224, v4, 0
  v_dot2_f32_bf16 v23, v225, v5, v23
  v_dot2_f32_bf16 v23, v226, v6, v23
  v_dot2_f32_bf16 v23, v227, v7, v23
  s_xor_b32 s68, s70, 0x90500
  buffer_load_dwordx4 v[248:251], v63, s[4:7], s68 offen nt
  s_waitcnt vmcnt(5)
  v_dot2_f32_bf16 v24, v228, v4, 0
  v_dot2_f32_bf16 v24, v229, v5, v24
  v_dot2_f32_bf16 v24, v230, v6, v24
  v_dot2_f32_bf16 v24, v231, v7, v24
  s_xor_b32 s68, s70, 0x90800
  buffer_load_dwordx4 v[252:255], v63, s[4:7], s68 offen nt
  s_waitcnt vmcnt(5)
  v_dot2_f32_bf16 v25, v232, v4, 0
  v_dot2_f32_bf16 v25, v233, v5, v25
  v_dot2_f32_bf16 v25, v234, v6, v25
  v_dot2_f32_bf16 v25, v235, v7, v25
  s_xor_b32 s68, s70, 0x90900
  buffer_load_dwordx4 v[116:119], v63, s[4:7], s68 offen nt
  v_add_f32_dpp v26, v22, v22 row_ror:8 row_mask:0xf bank_mask:0x3
  v_add_f32_dpp v27, v24, v24 row_ror:8 row_mask:0xf bank_mask:0x3
  s_nop 0
  v_add_f32_dpp v26, v23, v23 row_ror:8 row_mask:0xf bank_mask:0xc
  v_add_f32_dpp v27, v25, v25 row_ror:8 row_mask:0xf bank_mask:0xc
  s_nop 0
  v_add_f32_dpp v28, v26, v26 row_half_mirror row_mask:0xf bank_mask:0x5
  s_nop 1
  v_add_f32_dpp v28, v27, v27 row_half_mirror row_mask:0xf bank_mask:0xa
  s_nop 1
  v_add_f32_dpp v28, v28, v28 quad_perm:[1,0,3,2]
  s_nop 1
  v_add_f32_dpp v201, v28, v28 quad_perm:[2,3,0,1]
  v_max_f32 v20, v20, v201
  s_waitcnt vmcnt(5)
  v_dot2_f32_bf16 v22, v236, v4, 0
  v_dot2_f32_bf16 v22, v237, v5, v22
  v_dot2_f32_bf16 v22, v238, v6, v22
  v_dot2_f32_bf16 v22, v239, v7, v22
  s_xor_b32 s68, s70, 0x90c00
  buffer_load_dwordx4 v[120:123], v63, s[4:7], s68 offen nt
  s_waitcnt vmcnt(5)
  v_dot2_f32_bf16 v23, v240, v4, 0
  v_dot2_f32_bf16 v23, v241, v5, v23
  v_dot2_f32_bf16 v23, v242, v6, v23
  v_dot2_f32_bf16 v23, v243, v7, v23
  s_xor_b32 s68, s70, 0x90d00
  buffer_load_dwordx4 v[124:127], v63, s[4:7], s68 offen nt
  s_waitcnt vmcnt(5)
  v_dot2_f32_bf16 v24, v244, v4, 0
  v_dot2_f32_bf16 v24, v245, v5, v24
  v_dot2_f32_bf16 v24, v246, v6, v24
  v_dot2_f32_bf16 v24, v247, v7, v24
  s_xor_b32 s68, s70, 0xa0000
  buffer_load_dwordx4 v[64:67], v63, s[4:7], s68 offen nt
  s_lshl_b32 s73, s75, 16
  s_add_u32 s73, s73, s72
  buffer_load_dwordx4 a[32:35], v2, s[24:27], s73 offen
  s_add_u32 s73, s73, 8192
  s_waitcnt vmcnt(6)
  v_dot2_f32_bf16 v25, v248, v4, 0
  v_dot2_f32_bf16 v25, v249, v5, v25
  v_dot2_f32_bf16 v25, v250, v6, v25
  v_dot2_f32_bf16 v25, v251, v7, v25
  s_xor_b32 s68, s70, 0xa0100
  buffer_load_dwordx4 v[68:71], v63, s[4:7], s68 offen nt
  v_add_f32_dpp v26, v22, v22 row_ror:8 row_mask:0xf bank_mask:0x3
  v_add_f32_dpp v27, v24, v24 row_ror:8 row_mask:0xf bank_mask:0x3
  s_nop 0
  v_add_f32_dpp v26, v23, v23 row_ror:8 row_mask:0xf bank_mask:0xc
  v_add_f32_dpp v27, v25, v25 row_ror:8 row_mask:0xf bank_mask:0xc
  s_nop 0
  v_add_f32_dpp v28, v26, v26 row_half_mirror row_mask:0xf bank_mask:0x5
  s_nop 1
  v_add_f32_dpp v28, v27, v27 row_half_mirror row_mask:0xf bank_mask:0xa
  s_nop 1
  v_add_f32_dpp v28, v28, v28 quad_perm:[1,0,3,2]
  s_nop 1
  v_add_f32_dpp v202, v28, v28 quad_perm:[2,3,0,1]
  v_max_f32 v20, v20, v202
  s_waitcnt vmcnt(6)
  v_dot2_f32_bf16 v22, v252, v4, 0
  v_dot2_f32_bf16 v22, v253, v5, v22
  v_dot2_f32_bf16 v22, v254, v6, v22
  v_dot2_f32_bf16 v22, v255, v7, v22
  s_xor_b32 s68, s70, 0xa0400
  buffer_load_dwordx4 v[72:75], v63, s[4:7], s68 offen nt
  s_waitcnt vmcnt(6)
  v_dot2_f32_bf16 v23, v116, v4, 0
  v_dot2_f32_bf16 v23, v117, v5, v23
  v_dot2_f32_bf16 v23, v118, v6, v23
  v_dot2_f32_bf16 v23, v119, v7, v23
  s_xor_b32 s68, s70, 0xa0500
  buffer_load_dwordx4 v[76:79], v63, s[4:7], s68 offen nt
  s_mov_b32 s38, 0x01000100
  s_mov_b32 s39, 0x03020302
  v_perm_b32 v44, v38, v38, s38
  v_perm_b32 v45, v38, v38, s39
  v_perm_b32 v46, v39, v39, s38
  v_perm_b32 v47, v39, v39, s39
  v_and_b32_dpp v48, v44, v40 row_newbcast:0
  v_and_b32_dpp v49, v44, v41 row_newbcast:0
  v_and_b32_dpp v50, v44, v42 row_newbcast:0
  v_and_b32_dpp v51, v44, v43 row_newbcast:0
  s_nop 1
  v_mfma_f32_16x16x32_bf16 v[56:59], v[48:51], a[0:3], 0
  v_and_b32_dpp v52, v45, v40 row_newbcast:0
  v_and_b32_dpp v53, v45, v41 row_newbcast:0
  v_and_b32_dpp v54, v45, v42 row_newbcast:0
  v_and_b32_dpp v55, v45, v43 row_newbcast:0
  s_nop 1
  v_mfma_f32_16x16x32_bf16 v[56:59], v[52:55], a[4:7], v[56:59]
  v_and_b32_dpp v48, v46, v40 row_newbcast:0
  v_and_b32_dpp v49, v46, v41 row_newbcast:0
  v_and_b32_dpp v50, v46, v42 row_newbcast:0
  v_and_b32_dpp v51, v46, v43 row_newbcast:0
  s_nop 1
  v_mfma_f32_16x16x32_bf16 v[56:59], v[48:51], a[8:11], v[56:59]
  v_and_b32_dpp v52, v47, v40 row_newbcast:0
  v_and_b32_dpp v53, v47, v41 row_newbcast:0
  v_and_b32_dpp v54, v47, v42 row_newbcast:0
  v_and_b32_dpp v55, v47, v43 row_newbcast:0
  s_nop 1
  v_mfma_f32_16x16x32_bf16 v[56:59], v[52:55], a[12:15], v[56:59]
  v_and_b32_dpp v48, v44, v40 row_newbcast:1
  v_and_b32_dpp v49, v44, v41 row_newbcast:1
  v_and_b32_dpp v50, v44, v42 row_newbcast:1
  v_and_b32_dpp v51, v44, v43 row_newbcast:1
  s_nop 1
  v_mfma_f32_16x16x32_bf16 v[56:59], v[48:51], a[16:19], v[56:59]
  v_and_b32_dpp v52, v45, v40 row_newbcast:1
  v_and_b32_dpp v53, v45, v41 row_newbcast:1
  v_and_b32_dpp v54, v45, v42 row_newbcast:1
  v_and_b32_dpp v55, v45, v43 row_newbcast:1
  s_nop 1
  v_mfma_f32_16x16x32_bf16 v[56:59], v[52:55], a[20:23], v[56:59]
  v_and_b32_dpp v48, v46, v40 row_newbcast:1
  v_and_b32_dpp v49, v46, v41 row_newbcast:1
  v_and_b32_dpp v50, v46, v42 row_newbcast:1
  v_and_b32_dpp v51, v46, v43 row_newbcast:1
  s_nop 1
  v_mfma_f32_16x16x32_bf16 v[56:59], v[48:51], a[24:27], v[56:59]
  v_and_b32_dpp v52, v47, v40 row_newbcast:1
  v_and_b32_dpp v53, v47, v41 row_newbcast:1
  v_and_b32_dpp v54, v47, v42 row_newbcast:1
  v_and_b32_dpp v55, v47, v43 row_newbcast:1
  s_nop 1
  v_mfma_f32_16x16x32_bf16 v[56:59], v[52:55], a[28:31], v[56:59]
  s_waitcnt vmcnt(6)
  v_dot2_f32_bf16 v24, v120, v4, 0
  v_dot2_f32_bf16 v24, v121, v5, v24
  v_dot2_f32_bf16 v24, v122, v6, v24
  v_dot2_f32_bf16 v24, v123, v7, v24
  s_xor_b32 s68, s70, 0xa0800
  buffer_load_dwordx4 v[80:83], v63, s[4:7], s68 offen nt
  buffer_load_dwordx4 a[36:39], v2, s[24:27], s73 offen
  s_add_u32 s73, s73, 8192
  s_waitcnt vmcnt(7)
  v_dot2_f32_bf16 v25, v124, v4, 0
  v_dot2_f32_bf16 v25, v125, v5, v25
  v_dot2_f32_bf16 v25, v126, v6, v25
  v_dot2_f32_bf16 v25, v127, v7, v25
  s_xor_b32 s68, s70, 0xa0900
  buffer_load_dwordx4 v[84:87], v63, s[4:7], s68 offen nt
  v_add_f32_dpp v26, v22, v22 row_ror:8 row_mask:0xf bank_mask:0x3
  v_add_f32_dpp v27, v24, v24 row_ror:8 row_mask:0xf bank_mask:0x3
  s_nop 0
  v_add_f32_dpp v26, v23, v23 row_ror:8 row_mask:0xf bank_mask:0xc
  v_add_f32_dpp v27, v25, v25 row_ror:8 row_mask:0xf bank_mask:0xc
  s_nop 0
  v_add_f32_dpp v28, v26, v26 row_half_mirror row_mask:0xf bank_mask:0x5
  s_nop 1
  v_add_f32_dpp v28, v27, v27 row_half_mirror row_mask:0xf bank_mask:0xa
  s_nop 1
  v_add_f32_dpp v28, v28, v28 quad_perm:[1,0,3,2]
  s_nop 1
  v_add_f32_dpp v203, v28, v28 quad_perm:[2,3,0,1]
  v_max_f32 v20, v20, v203
  s_waitcnt vmcnt(7)
  v_dot2_f32_bf16 v22, v64, v4, 0
  v_dot2_f32_bf16 v22, v65, v5, v22
  v_dot2_f32_bf16 v22, v66, v6, v22
  v_dot2_f32_bf16 v22, v67, v7, v22
  s_xor_b32 s68, s70, 0xa0c00
  buffer_load_dwordx4 v[88:91], v63, s[4:7], s68 offen nt
  s_waitcnt vmcnt(6)
  v_dot2_f32_bf16 v23, v68, v4, 0
  v_dot2_f32_bf16 v23, v69, v5, v23
  v_dot2_f32_bf16 v23, v70, v6, v23
  v_dot2_f32_bf16 v23, v71, v7, v23
  s_xor_b32 s68, s70, 0xa0d00
  buffer_load_dwordx4 v[92:95], v63, s[4:7], s68 offen nt
  s_waitcnt vmcnt(6)
  v_dot2_f32_bf16 v24, v72, v4, 0
  v_dot2_f32_bf16 v24, v73, v5, v24
  v_dot2_f32_bf16 v24, v74, v6, v24
  v_dot2_f32_bf16 v24, v75, v7, v24
  s_xor_b32 s68, s70, 0xb0000
  buffer_load_dwordx4 v[96:99], v63, s[4:7], s68 offen nt
  buffer_load_dwordx4 a[40:43], v2, s[24:27], s73 offen
  s_add_u32 s73, s73, 8192
  s_waitcnt vmcnt(7)
  v_dot2_f32_bf16 v25, v76, v4, 0
  v_dot2_f32_bf16 v25, v77, v5, v25
  v_dot2_f32_bf16 v25, v78, v6, v25
  v_dot2_f32_bf16 v25, v79, v7, v25
  s_xor_b32 s68, s70, 0xb0100
  buffer_load_dwordx4 v[100:103], v63, s[4:7], s68 offen nt
  v_add_f32_dpp v26, v22, v22 row_ror:8 row_mask:0xf bank_mask:0x3
  v_add_f32_dpp v27, v24, v24 row_ror:8 row_mask:0xf bank_mask:0x3
  s_nop 0
  v_add_f32_dpp v26, v23, v23 row_ror:8 row_mask:0xf bank_mask:0xc
  v_add_f32_dpp v27, v25, v25 row_ror:8 row_mask:0xf bank_mask:0xc
  s_nop 0
  v_add_f32_dpp v28, v26, v26 row_half_mirror row_mask:0xf bank_mask:0x5
  s_nop 1
  v_add_f32_dpp v28, v27, v27 row_half_mirror row_mask:0xf bank_mask:0xa
  s_nop 1
  v_add_f32_dpp v28, v28, v28 quad_perm:[1,0,3,2]
  s_nop 1
  v_add_f32_dpp v204, v28, v28 quad_perm:[2,3,0,1]
  v_max_f32 v20, v20, v204
  s_waitcnt vmcnt(7)
  v_dot2_f32_bf16 v22, v80, v4, 0
  v_dot2_f32_bf16 v22, v81, v5, v22
  v_dot2_f32_bf16 v22, v82, v6, v22
  v_dot2_f32_bf16 v22, v83, v7, v22
  s_xor_b32 s68, s70, 0xb0400
  buffer_load_dwordx4 v[104:107], v63, s[4:7], s68 offen nt
  s_waitcnt vmcnt(6)
  v_dot2_f32_bf16 v23, v84, v4, 0
  v_dot2_f32_bf16 v23, v85, v5, v23
  v_dot2_f32_bf16 v23, v86, v6, v23
  v_dot2_f32_bf16 v23, v87, v7, v23
  s_xor_b32 s68, s70, 0xb0500
  buffer_load_dwordx4 v[108:111], v63, s[4:7], s68 offen nt
  v_and_b32_dpp v48, v44, v40 row_newbcast:2
  v_and_b32_dpp v49, v44, v41 row_newbcast:2
  v_and_b32_dpp v50, v44, v42 row_newbcast:2
  v_and_b32_dpp v51, v44, v43 row_newbcast:2
  s_nop 1
  v_mfma_f32_16x16x32_bf16 v[56:59], v[48:51], a[32:35], v[56:59]
  s_waitcnt vmcnt(6)
  v_dot2_f32_bf16 v24, v88, v4, 0
  v_dot2_f32_bf16 v24, v89, v5, v24
  v_dot2_f32_bf16 v24, v90, v6, v24
  v_dot2_f32_bf16 v24, v91, v7, v24
  s_xor_b32 s68, s70, 0xb0800
  buffer_load_dwordx4 v[112:115], v63, s[4:7], s68 offen nt
  buffer_load_dwordx4 a[44:47], v2, s[24:27], s73 offen
  s_add_u32 s73, s73, 8192
  s_waitcnt vmcnt(7)
  v_dot2_f32_bf16 v25, v92, v4, 0
  v_dot2_f32_bf16 v25, v93, v5, v25
  v_dot2_f32_bf16 v25, v94, v6, v25
  v_dot2_f32_bf16 v25, v95, v7, v25
  s_xor_b32 s68, s70, 0xb0900
  buffer_load_dwordx4 v[116:119], v63, s[4:7], s68 offen nt
  v_add_f32_dpp v26, v22, v22 row_ror:8 row_mask:0xf bank_mask:0x3
  v_add_f32_dpp v27, v24, v24 row_ror:8 row_mask:0xf bank_mask:0x3
  s_nop 0
  v_add_f32_dpp v26, v23, v23 row_ror:8 row_mask:0xf bank_mask:0xc
  v_add_f32_dpp v27, v25, v25 row_ror:8 row_mask:0xf bank_mask:0xc
  s_nop 0
  v_add_f32_dpp v28, v26, v26 row_half_mirror row_mask:0xf bank_mask:0x5
  s_nop 1
  v_add_f32_dpp v28, v27, v27 row_half_mirror row_mask:0xf bank_mask:0xa
  s_nop 1
  v_add_f32_dpp v28, v28, v28 quad_perm:[1,0,3,2]
  s_nop 1
  v_add_f32_dpp v205, v28, v28 quad_perm:[2,3,0,1]
  v_max_f32 v20, v20, v205
  s_branch L_join
L_frontB:
  s_xor_b32 s68, s70, 0x800
  buffer_load_dwordx4 v[80:83], v63, s[4:7], s68 offen nt
  s_xor_b32 s68, s70, 0x900
  buffer_load_dwordx4 v[84:87], v63, s[4:7], s68 offen nt
  s_xor_b32 s68, s70, 0xc00
  buffer_load_dwordx4 v[88:91], v63, s[4:7], s68 offen nt
  s_xor_b32 s68, s70, 0xd00
  buffer_load_dwordx4 v[92:95], v63, s[4:7], s68 offen nt
  s_xor_b32 s68, s70, 0x10000
  buffer_load_dwordx4 v[96:99], v63, s[4:7], s68 offen nt
  s_xor_b32 s68, s70, 0x10100
  buffer_load_dwordx4 v[100:103], v63, s[4:7], s68 offen nt
  s_xor_b32 s68, s70, 0x10400
  buffer_load_dwordx4 v[104:107], v63, s[4:7], s68 offen nt
  s_xor_b32 s68, s70, 0x10500
  buffer_load_dwordx4 v[108:111], v63, s[4:7], s68 offen nt
  s_xor_b32 s68, s70, 0x10800
  buffer_load_dwordx4 v[112:115], v63, s[4:7], s68 offen nt
  s_xor_b32 s68, s70, 0x10900
  buffer_load_dwordx4 v[116:119], v63, s[4:7], s68 offen nt
  s_xor_b32 s68, s70, 0x10c00
  buffer_load_dwordx4 v[120:123], v63, s[4:7], s68 offen nt
  s_xor_b32 s68, s70, 0x10d00
  buffer_load_dwordx4 v[124:127], v63, s[4:7], s68 offen nt
  s_xor_b32 s68, s70, 0x20000
  buffer_load_dwordx4 v[128:131], v63, s[4:7], s68 offen nt
  s_xor_b32 s68, s70, 0x20100
  buffer_load_dwordx4 v[132:135], v63, s[4:7], s68 offen nt
  s_xor_b32 s68, s70, 0x20400
  buffer_load_dwordx4 v[136:139], v63, s[4:7], s68 offen nt
  s_xor_b32 s68, s70, 0x20500
  buffer_load_dwordx4 v[140:143], v63, s[4:7], s68 offen nt
  s_xor_b32 s68, s70, 0x20800
  buffer_load_dwordx4 v[144:147], v63, s[4:7], s68 offen nt
  s_xor_b32 s68, s70, 0x20900
  buffer_load_dwordx4 v[148:151], v63, s[4:7], s68 offen nt
  s_xor_b32 s68, s70, 0x20c00
  buffer_load_dwordx4 v[152:155], v63, s[4:7], s68 offen nt
  s_xor_b32 s68, s70, 0x20d00
  buffer_load_dwordx4 v[156:159], v63, s[4:7], s68 offen nt
  s_xor_b32 s68, s70, 0x30000
  buffer_load_dwordx4 v[160:163], v63, s[4:7], s68 offen nt
  s_xor_b32 s68, s70, 0x30100
  buffer_load_dwordx4 v[164:167], v63, s[4:7], s68 offen nt
  s_xor_b32 s68, s70, 0x30400
  buffer_load_dwordx4 v[168:171], v63, s[4:7], s68 offen nt
  s_xor_b32 s68, s70, 0x30500
  buffer_load_dwordx4 v[172:175], v63, s[4:7], s68 offen nt
  s_waitcnt vmcnt(30)
  s_mov_b32 s38, 0x01000100
  s_mov_b32 s39, 0x03020302
  v_perm_b32 v44, v38, v38, s38
  v_perm_b32 v45, v38, v38, s39
  v_perm_b32 v46, v39, v39, s38
  v_perm_b32 v47, v39, v39, s39
  s_lshl_b32 s73, s75, 16
  s_add_u32 s73, s73, s72
  buffer_load_dwordx4 a[32:35], v2, s[24:27], s73 offen
  s_add_u32 s73, s73, 8192
  buffer_load_dwordx4 a[36:39], v2, s[24:27], s73 offen
  s_add_u32 s73, s73, 8192
  buffer_load_dwordx4 a[40:43], v2, s[24:27], s73 offen
  s_add_u32 s73, s73, 8192
  buffer_load_dwordx4 a[44:47], v2, s[24:27], s73 offen
  s_add_u32 s73, s73, 8192
  buffer_load_dwordx4 a[48:51], v2, s[24:27], s73 offen
  s_add_u32 s73, s73, 8192
  buffer_load_dwordx4 a[52:55], v2, s[24:27], s73 offen
  s_add_u32 s73, s73, 8192
  buffer_load_dwordx4 a[56:59], v2, s[24:27], s73 offen
  s_add_u32 s73, s73, 8192
  buffer_load_dwordx4 a[60:63], v2, s[24:27], s73 offen
  s_lshl_b32 s73, s76, 16
  s_add_u32 s73, s73, s72
  buffer_load_dwordx4 a[64:67], v2, s[24:27], s73 offen
  s_add_u32 s73, s73, 8192
  buffer_load_dwordx4 a[68:71], v2, s[24:27], s73 offen
  s_add_u32 s73, s73, 8192
  buffer_load_dwordx4 a[72:75], v2, s[24:27], s73 offen
  s_add_u32 s73, s73, 8192
  buffer_load_dwordx4 a[76:79], v2, s[24:27], s73 offen
  s_add_u32 s73, s73, 8192
  buffer_load_dwordx4 a[80:83], v2, s[24:27], s73 offen
  s_add_u32 s73, s73, 8192
  buffer_load_dwordx4 a[84:87], v2, s[24:27], s73 offen
  s_add_u32 s73, s73, 8192
  buffer_load_dwordx4 a[88:91], v2, s[24:27], s73 offen
  s_add_u32 s73, s73, 8192
  buffer_load_dwordx4 a[92:95], v2, s[24:27], s73 offen
  s_lshl_b32 s73, s77, 16
  s_add_u32 s73, s73, s72
  buffer_load_dwordx4 a[96:99], v2, s[24:27], s73 offen
  s_add_u32 s73, s73, 8192
  buffer_load_dwordx4 a[100:103], v2, s[24:27], s73 offen
  s_add_u32 s73, s73, 8192
  buffer_load_dwordx4 a[104:107], v2, s[24:27], s73 offen
  s_add_u32 s73, s73, 8192
  buffer_load_dwordx4 a[108:111], v2, s[24:27], s73 offen
  s_add_u32 s73, s73, 8192
  buffer_load_dwordx4 a[112:115], v2, s[24:27], s73 offen
  s_add_u32 s73, s73, 8192
  buffer_load_dwordx4 a[116:119], v2, s[24:27], s73 offen
  s_add_u32 s73, s73, 8192
  buffer_load_dwordx4 a[120:123], v2, s[24:27], s73 offen
  s_add_u32 s73, s73, 8192
  buffer_load_dwordx4 a[124:127], v2, s[24:27], s73 offen
  s_lshl_b32 s73, s78, 16
  s_add_u32 s73, s73, s72
  buffer_load_dwordx4 a[128:131], v2, s[24:27], s73 offen
  s_add_u32 s73, s73, 8192
  buffer_load_dwordx4 a[132:135], v2, s[24:27], s73 offen
  s_add_u32 s73, s73, 8192
  v_and_b32_dpp v48, v44, v40 row_newbcast:0
  v_and_b32_dpp v49, v44, v41 row_newbcast:0
  v_and_b32_dpp v50, v44, v42 row_newbcast:0
  v_and_b32_dpp v51, v44, v43 row_newbcast:0
  v_and_b32_dpp v52, v45, v40 row_newbcast:0
  v_and_b32_dpp v53, v45, v41 row_newbcast:0
  v_and_b32_dpp v54, v45, v42 row_newbcast:0
  v_and_b32_dpp v55, v45, v43 row_newbcast:0
  v_mfma_f32_16x16x32_bf16 v[56:59], v[48:51], a[0:3], 0
  v_and_b32_dpp v48, v46, v40 row_newbcast:0
  v_and_b32_dpp v49, v46, v41 row_newbcast:0
  v_and_b32_dpp v50, v46, v42 row_newbcast:0
  v_and_b32_dpp v51, v46, v43 row_newbcast:0
  v_mfma_f32_16x16x32_bf16 v[56:59], v[52:55], a[4:7], v[56:59]
  v_and_b32_dpp v52, v47, v40 row_newbcast:0
  v_and_b32_dpp v53, v47, v41 row_newbcast:0
  v_and_b32_dpp v54, v47, v42 row_newbcast:0
  v_and_b32_dpp v55, v47, v43 row_newbcast:0
  v_mfma_f32_16x16x32_bf16 v[56:59], v[48:51], a[8:11], v[56:59]
  v_and_b32_dpp v48, v44, v40 row_newbcast:1
  v_and_b32_dpp v49, v44, v41 row_newbcast:1
  v_and_b32_dpp v50, v44, v42 row_newbcast:1
  v_and_b32_dpp v51, v44, v43 row_newbcast:1
  v_mfma_f32_16x16x32_bf16 v[56:59], v[52:55], a[12:15], v[56:59]
  v_and_b32_dpp v52, v45, v40 row_newbcast:1
  v_and_b32_dpp v53, v45, v41 row_newbcast:1
  v_and_b32_dpp v54, v45, v42 row_newbcast:1
  v_and_b32_dpp v55, v45, v43 row_newbcast:1
  v_mfma_f32_16x16x32_bf16 v[56:59], v[48:51], a[16:19], v[56:59]
  v_and_b32_dpp v48, v46, v40 row_newbcast:1
  v_and_b32_dpp v49, v46, v41 row_newbcast:1
  v_and_b32_dpp v50, v46, v42 row_newbcast:1
  v_and_b32_dpp v51, v46, v43 row_newbcast:1
  v_mfma_f32_16x16x32_bf16 v[56:59], v[52:55], a[20:23], v[56:59]
  v_and_b32_dpp v52, v47, v40 row_newbcast:1
  v_and_b32_dpp v53, v47, v41 row_newbcast:1
  v_and_b32_dpp v54, v47, v42 row_newbcast:1
  v_and_b32_dpp v55, v47, v43 row_newbcast:1
  v_mfma_f32_16x16x32_bf16 v[56:59], v[48:51], a[24:27], v[56:59]
  v_and_b32_dpp v48, v44, v40 row_newbcast:2
  v_and_b32_dpp v49, v44, v41 row_newbcast:2
  v_and_b32_dpp v50, v44, v42 row_newbcast:2
  v_and_b32_dpp v51, v44, v43 row_newbcast:2
  v_mfma_f32_16x16x32_bf16 v[56:59], v[52:55], a[28:31], v[56:59]
  v_and_b32_dpp v52, v45, v40 row_newbcast:2
  v_and_b32_dpp v53, v45, v41 row_newbcast:2
  v_and_b32_dpp v54, v45, v42 row_newbcast:2
  v_and_b32_dpp v55, v45, v43 row_newbcast:2
  s_waitcnt vmcnt(25)
  v_mfma_f32_16x16x32_bf16 v[56:59], v[48:51], a[32:35], v[56:59]
  buffer_load_dwordx4 a[136:139], v2, s[24:27], s73 offen
  s_add_u32 s73, s73, 8192
  buffer_load_dwordx4 a[140:143], v2, s[24:27], s73 offen
  s_add_u32 s73, s73, 8192
  buffer_load_dwordx4 a[144:147], v2, s[24:27], s73 offen
  s_add_u32 s73, s73, 8192
  buffer_load_dwordx4 a[148:151], v2, s[24:27], s73 offen
  s_add_u32 s73, s73, 8192
  buffer_load_dwordx4 a[152:155], v2, s[24:27], s73 offen
  s_add_u32 s73, s73, 8192
  buffer_load_dwordx4 a[156:159], v2, s[24:27], s73 offen
  s_lshl_b32 s73, s79, 16
  s_add_u32 s73, s73, s72
  buffer_load_dwordx4 a[160:163], v2, s[24:27], s73 offen
  s_add_u32 s73, s73, 8192
  v_and_b32_dpp v48, v46, v40 row_newbcast:2
  v_and_b32_dpp v49, v46, v41 row_newbcast:2
  v_and_b32_dpp v50, v46, v42 row_newbcast:2
  v_and_b32_dpp v51, v46, v43 row_newbcast:2
  s_waitcnt vmcnt(31)
  v_mfma_f32_16x16x32_bf16 v[56:59], v[52:55], a[36:39], v[56:59]
  buffer_load_dwordx4 a[164:167], v2, s[24:27], s73 offen
  s_add_u32 s73, s73, 8192
  v_and_b32_dpp v52, v47, v40 row_newbcast:2
  v_and_b32_dpp v53, v47, v41 row_newbcast:2
  v_and_b32_dpp v54, v47, v42 row_newbcast:2
  v_and_b32_dpp v55, v47, v43 row_newbcast:2
  s_waitcnt vmcnt(31)
  v_mfma_f32_16x16x32_bf16 v[56:59], v[48:51], a[40:43], v[56:59]
  buffer_load_dwordx4 a[168:171], v2, s[24:27], s73 offen
  s_add_u32 s73, s73, 8192
  v_and_b32_dpp v48, v44, v40 row_newbcast:3
  v_and_b32_dpp v49, v44, v41 row_newbcast:3
  v_and_b32_dpp v50, v44, v42 row_newbcast:3
  v_and_b32_dpp v51, v44, v43 row_newbcast:3
  s_waitcnt vmcnt(31)
  v_mfma_f32_16x16x32_bf16 v[56:59], v[52:55], a[44:47], v[56:59]
  buffer_load_dwordx4 a[172:175], v2, s[24:27], s73 offen
  s_add_u32 s73, s73, 8192
  v_and_b32_dpp v52, v45, v40 row_newbcast:3
  v_and_b32_dpp v53, v45, v41 row_newbcast:3
  v_and_b32_dpp v54, v45, v42 row_newbcast:3
  v_and_b32_dpp v55, v45, v43 row_newbcast:3
  s_waitcnt vmcnt(31)
  v_mfma_f32_16x16x32_bf16 v[56:59], v[48:51], a[48:51], v[56:59]
  buffer_load_dwordx4 a[176:179], v2, s[24:27], s73 offen
  s_add_u32 s73, s73, 8192
  v_and_b32_dpp v48, v46, v40 row_newbcast:3
  v_and_b32_dpp v49, v46, v41 row_newbcast:3
  v_and_b32_dpp v50, v46, v42 row_newbcast:3
  v_and_b32_dpp v51, v46, v43 row_newbcast:3
  s_waitcnt vmcnt(31)
  v_mfma_f32_16x16x32_bf16 v[56:59], v[52:55], a[52:55], v[56:59]
  buffer_load_dwordx4 a[180:183], v2, s[24:27], s73 offen
  s_add_u32 s73, s73, 8192
  v_and_b32_dpp v52, v47, v40 row_newbcast:3
  v_and_b32_dpp v53, v47, v41 row_newbcast:3
  v_and_b32_dpp v54, v47, v42 row_newbcast:3
  v_and_b32_dpp v55, v47, v43 row_newbcast:3
  s_waitcnt vmcnt(31)
  v_mfma_f32_16x16x32_bf16 v[56:59], v[48:51], a[56:59], v[56:59]
  buffer_load_dwordx4 a[184:187], v2, s[24:27], s73 offen
  s_add_u32 s73, s73, 8192
  v_and_b32_dpp v48, v44, v40 row_newbcast:4
  v_and_b32_dpp v49, v44, v41 row_newbcast:4
  v_and_b32_dpp v50, v44, v42 row_newbcast:4
  v_and_b32_dpp v51, v44, v43 row_newbcast:4
  s_waitcnt vmcnt(31)
  v_mfma_f32_16x16x32_bf16 v[56:59], v[52:55], a[60:63], v[56:59]
  buffer_load_dwordx4 a[188:191], v2, s[24:27], s73 offen
  v_and_b32_dpp v52, v45, v40 row_newbcast:4
  v_and_b32_dpp v53, v45, v41 row_newbcast:4
  v_and_b32_dpp v54, v45, v42 row_newbcast:4
  v_and_b32_dpp v55, v45, v43 row_newbcast:4
  s_waitcnt vmcnt(31)
  v_mfma_f32_16x16x32_bf16 v[56:59], v[48:51], a[64:67], v[56:59]
  s_lshl_b32 s73, s80, 16
  s_add_u32 s73, s73, s72
  buffer_load_dwordx4 a[192:195], v2, s[24:27], s73 offen
  s_add_u32 s73, s73, 8192
  v_and_b32_dpp v48, v46, v40 row_newbcast:4
  v_and_b32_dpp v49, v46, v41 row_newbcast:4
  v_and_b32_dpp v50, v46, v42 row_newbcast:4
  v_and_b32_dpp v51, v46, v43 row_newbcast:4
  s_waitcnt vmcnt(31)
  v_mfma_f32_16x16x32_bf16 v[56:59], v[52:55], a[68:71], v[56:59]
  buffer_load_dwordx4 a[196:199], v2, s[24:27], s73 offen
  s_add_u32 s73, s73, 8192
  v_and_b32_dpp v52, v47, v40 row_newbcast:4
  v_and_b32_dpp v53, v47, v41 row_newbcast:4
  v_and_b32_dpp v54, v47, v42 row_newbcast:4
  v_and_b32_dpp v55, v47, v43 row_newbcast:4
  s_waitcnt vmcnt(31)
  v_mfma_f32_16x16x32_bf16 v[56:59], v[48:51], a[72:75], v[56:59]
  buffer_load_dwordx4 a[200:203], v2, s[24:27], s73 offen
  s_add_u32 s73, s73, 8192
  v_and_b32_dpp v48, v44, v40 row_newbcast:5
  v_and_b32_dpp v49, v44, v41 row_newbcast:5
  v_and_b32_dpp v50, v44, v42 row_newbcast:5
  v_and_b32_dpp v51, v44, v43 row_newbcast:5
  s_waitcnt vmcnt(31)
  v_mfma_f32_16x16x32_bf16 v[56:59], v[52:55], a[76:79], v[56:59]
  buffer_load_dwordx4 a[204:207], v2, s[24:27], s73 offen
  s_add_u32 s73, s73, 8192
  v_and_b32_dpp v52, v45, v40 row_newbcast:5
  v_and_b32_dpp v53, v45, v41 row_newbcast:5
  v_and_b32_dpp v54, v45, v42 row_newbcast:5
  v_and_b32_dpp v55, v45, v43 row_newbcast:5
  s_waitcnt vmcnt(31)
  v_mfma_f32_16x16x32_bf16 v[56:59], v[48:51], a[80:83], v[56:59]
  buffer_load_dwordx4 a[208:211], v2, s[24:27], s73 offen
  s_add_u32 s73, s73, 8192
  v_and_b32_dpp v48, v46, v40 row_newbcast:5
  v_and_b32_dpp v49, v46, v41 row_newbcast:5
  v_and_b32_dpp v50, v46, v42 row_newbcast:5
  v_and_b32_dpp v51, v46, v43 row_newbcast:5
  s_waitcnt vmcnt(31)
  v_mfma_f32_16x16x32_bf16 v[56:59], v[52:55], a[84:87], v[56:59]
  buffer_load_dwordx4 a[212:215], v2, s[24:27], s73 offen
  s_add_u32 s73, s73, 8192
  v_and_b32_dpp v52, v47, v40 row_newbcast:5
  v_and_b32_dpp v53, v47, v41 row_newbcast:5
  v_and_b32_dpp v54, v47, v42 row_newbcast:5
  v_and_b32_dpp v55, v47, v43 row_newbcast:5
  s_waitcnt vmcnt(31)
  v_mfma_f32_16x16x32_bf16 v[56:59], v[48:51], a[88:91], v[56:59]
  buffer_load_dwordx4 a[216:219], v2, s[24:27], s73 offen
  s_add_u32 s73, s73, 8192
  v_and_b32_dpp v48, v44, v40 row_newbcast:6
  v_and_b32_dpp v49, v44, v41 row_newbcast:6
  v_and_b32_dpp v50, v44, v42 row_newbcast:6
  v_and_b32_dpp v51, v44, v43 row_newbcast:6
  s_waitcnt vmcnt(31)
  v_mfma_f32_16x16x32_bf16 v[56:59], v[52:55], a[92:95], v[56:59]
  buffer_load_dwordx4 a[220:223], v2, s[24:27], s73 offen
  v_and_b32_dpp v52, v45, v40 row_newbcast:6
  v_and_b32_dpp v53, v45, v41 row_newbcast:6
  v_and_b32_dpp v54, v45, v42 row_newbcast:6
  v_and_b32_dpp v55, v45, v43 row_newbcast:6
  s_waitcnt vmcnt(31)
  v_mfma_f32_16x16x32_bf16 v[56:59], v[48:51], a[96:99], v[56:59]
  s_lshl_b32 s73, s81, 16
  s_add_u32 s73, s73, s72
  buffer_load_dwordx4 a[224:227], v2, s[24:27], s73 offen
  s_add_u32 s73, s73, 8192
  v_and_b32_dpp v48, v46, v40 row_newbcast:6
  v_and_b32_dpp v49, v46, v41 row_newbcast:6
  v_and_b32_dpp v50, v46, v42 row_newbcast:6
  v_and_b32_dpp v51, v46, v43 row_newbcast:6
  s_waitcnt vmcnt(31)
  v_mfma_f32_16x16x32_bf16 v[56:59], v[52:55], a[100:103], v[56:59]
  buffer_load_dwordx4 a[228:231], v2, s[24:27], s73 offen
  s_add_u32 s73, s73, 8192
  v_and_b32_dpp v52, v47, v40 row_newbcast:6
  v_and_b32_dpp v53, v47, v41 row_newbcast:6
  v_and_b32_dpp v54, v47, v42 row_newbcast:6
  v_and_b32_dpp v55, v47, v43 row_newbcast:6
  s_waitcnt vmcnt(31)
  v_mfma_f32_16x16x32_bf16 v[56:59], v[48:51], a[104:107], v[56:59]
  buffer_load_dwordx4 a[232:235], v2, s[24:27], s73 offen
  s_add_u32 s73, s73, 8192
  v_and_b32_dpp v48, v44, v40 row_newbcast:7
  v_and_b32_dpp v49, v44, v41 row_newbcast:7
  v_and_b32_dpp v50, v44, v42 row_newbcast:7
  v_and_b32_dpp v51, v44, v43 row_newbcast:7
  s_waitcnt vmcnt(31)
  v_mfma_f32_16x16x32_bf16 v[56:59], v[52:55], a[108:111], v[56:59]
  buffer_load_dwordx4 a[236:239], v2, s[24:27], s73 offen
  s_add_u32 s73, s73, 8192
  v_and_b32_dpp v52, v45, v40 row_newbcast:7
  v_and_b32_dpp v53, v45, v41 row_newbcast:7
  v_and_b32_dpp v54, v45, v42 row_newbcast:7
  v_and_b32_dpp v55, v45, v43 row_newbcast:7
  s_waitcnt vmcnt(31)
  v_mfma_f32_16x16x32_bf16 v[56:59], v[48:51], a[112:115], v[56:59]
  buffer_load_dwordx4 a[240:243], v2, s[24:27], s73 offen
  s_add_u32 s73, s73, 8192
  v_and_b32_dpp v48, v46, v40 row_newbcast:7
  v_and_b32_dpp v49, v46, v41 row_newbcast:7
  v_and_b32_dpp v50, v46, v42 row_newbcast:7
  v_and_b32_dpp v51, v46, v43 row_newbcast:7
  s_waitcnt vmcnt(31)
  v_mfma_f32_16x16x32_bf16 v[56:59], v[52:55], a[116:119], v[56:59]
  buffer_load_dwordx4 a[244:247], v2, s[24:27], s73 offen
  s_add_u32 s73, s73, 8192
  v_and_b32_dpp v52, v47, v40 row_newbcast:7
  v_and_b32_dpp v53, v47, v41 row_newbcast:7
  v_and_b32_dpp v54, v47, v42 row_newbcast:7
  v_and_b32_dpp v55, v47, v43 row_newbcast:7
  s_waitcnt vmcnt(31)
  v_mfma_f32_16x16x32_bf16 v[56:59], v[48:51], a[120:123], v[56:59]
  buffer_load_dwordx4 a[248:251], v2, s[24:27], s73 offen
  s_add_u32 s73, s73, 8192
  v_and_b32_dpp v48, v44, v40 row_newbcast:8
  v_and_b32_dpp v49, v44, v41 row_newbcast:8
  v_and_b32_dpp v50, v44, v42 row_newbcast:8
  v_and_b32_dpp v51, v44, v43 row_newbcast:8
  s_waitcnt vmcnt(31)
  v_mfma_f32_16x16x32_bf16 v[56:59], v[52:55], a[124:127], v[56:59]
  buffer_load_dwordx4 a[252:255], v2, s[24:27], s73 offen
  v_and_b32_dpp v52, v45, v40 row_newbcast:8
  v_and_b32_dpp v53, v45, v41 row_newbcast:8
  v_and_b32_dpp v54, v45, v42 row_newbcast:8
  v_and_b32_dpp v55, v45, v43 row_newbcast:8
  s_waitcnt vmcnt(31)
  v_mfma_f32_16x16x32_bf16 v[56:59], v[48:51], a[128:131], v[56:59]
  v_and_b32_dpp v48, v46, v40 row_newbcast:8
  v_and_b32_dpp v49, v46, v41 row_newbcast:8
  v_and_b32_dpp v50, v46, v42 row_newbcast:8
  v_and_b32_dpp v51, v46, v43 row_newbcast:8
  s_waitcnt vmcnt(30)
  v_mfma_f32_16x16x32_bf16 v[56:59], v[52:55], a[132:135], v[56:59]
  v_and_b32_dpp v52, v47, v40 row_newbcast:8
  v_and_b32_dpp v53, v47, v41 row_newbcast:8
  v_and_b32_dpp v54, v47, v42 row_newbcast:8
  v_and_b32_dpp v55, v47, v43 row_newbcast:8
  s_waitcnt vmcnt(29)
  v_mfma_f32_16x16x32_bf16 v[56:59], v[48:51], a[136:139], v[56:59]
  v_and_b32_dpp v48, v44, v40 row_newbcast:9
  v_and_b32_dpp v49, v44, v41 row_newbcast:9
  v_and_b32_dpp v50, v44, v42 row_newbcast:9
  v_and_b32_dpp v51, v44, v43 row_newbcast:9
  s_waitcnt vmcnt(28)
  v_mfma_f32_16x16x32_bf16 v[56:59], v[52:55], a[140:143], v[56:59]
  v_and_b32_dpp v52, v45, v40 row_newbcast:9
  v_and_b32_dpp v53, v45, v41 row_newbcast:9
  v_and_b32_dpp v54, v45, v42 row_newbcast:9
  v_and_b32_dpp v55, v45, v43 row_newbcast:9
  s_waitcnt vmcnt(27)
  v_mfma_f32_16x16x32_bf16 v[56:59], v[48:51], a[144:147], v[56:59]
  v_and_b32_dpp v48, v46, v40 row_newbcast:9
  v_and_b32_dpp v49, v46, v41 row_newbcast:9
  v_and_b32_dpp v50, v46, v42 row_newbcast:9
  v_and_b32_dpp v51, v46, v43 row_newbcast:9
  s_waitcnt vmcnt(26)
  v_mfma_f32_16x16x32_bf16 v[56:59], v[52:55], a[148:151], v[56:59]
  v_and_b32_dpp v52, v47, v40 row_newbcast:9
  v_and_b32_dpp v53, v47, v41 row_newbcast:9
  v_and_b32_dpp v54, v47, v42 row_newbcast:9
  v_and_b32_dpp v55, v47, v43 row_newbcast:9
  s_waitcnt vmcnt(25)
  v_mfma_f32_16x16x32_bf16 v[56:59], v[48:51], a[152:155], v[56:59]
  v_and_b32_dpp v48, v44, v40 row_newbcast:10
  v_and_b32_dpp v49, v44, v41 row_newbcast:10
  v_and_b32_dpp v50, v44, v42 row_newbcast:10
  v_and_b32_dpp v51, v44, v43 row_newbcast:10
  s_waitcnt vmcnt(24)
  v_mfma_f32_16x16x32_bf16 v[56:59], v[52:55], a[156:159], v[56:59]
  v_and_b32_dpp v52, v45, v40 row_newbcast:10
  v_and_b32_dpp v53, v45, v41 row_newbcast:10
  v_and_b32_dpp v54, v45, v42 row_newbcast:10
  v_and_b32_dpp v55, v45, v43 row_newbcast:10
  s_waitcnt vmcnt(23)
  v_mfma_f32_16x16x32_bf16 v[56:59], v[48:51], a[160:163], v[56:59]
  v_and_b32_dpp v48, v46, v40 row_newbcast:10
  v_and_b32_dpp v49, v46, v41 row_newbcast:10
  v_and_b32_dpp v50, v46, v42 row_newbcast:10
  v_and_b32_dpp v51, v46, v43 row_newbcast:10
  s_waitcnt vmcnt(22)
  v_mfma_f32_16x16x32_bf16 v[56:59], v[52:55], a[164:167], v[56:59]
  v_and_b32_dpp v52, v47, v40 row_newbcast:10
  v_and_b32_dpp v53, v47, v41 row_newbcast:10
  v_and_b32_dpp v54, v47, v42 row_newbcast:10
  v_and_b32_dpp v55, v47, v43 row_newbcast:10
  s_waitcnt vmcnt(21)
  v_mfma_f32_16x16x32_bf16 v[56:59], v[48:51], a[168:171], v[56:59]
  v_and_b32_dpp v48, v44, v40 row_newbcast:11
  v_and_b32_dpp v49, v44, v41 row_newbcast:11
  v_and_b32_dpp v50, v44, v42 row_newbcast:11
  v_and_b32_dpp v51, v44, v43 row_newbcast:11
  s_waitcnt vmcnt(20)
  v_mfma_f32_16x16x32_bf16 v[56:59], v[52:55], a[172:175], v[56:59]
  v_and_b32_dpp v52, v45, v40 row_newbcast:11
  v_and_b32_dpp v53, v45, v41 row_newbcast:11
  v_and_b32_dpp v54, v45, v42 row_newbcast:11
  v_and_b32_dpp v55, v45, v43 row_newbcast:11
  s_waitcnt vmcnt(19)
  v_mfma_f32_16x16x32_bf16 v[56:59], v[48:51], a[176:179], v[56:59]
  v_and_b32_dpp v48, v46, v40 row_newbcast:11
  v_and_b32_dpp v49, v46, v41 row_newbcast:11
  v_and_b32_dpp v50, v46, v42 row_newbcast:11
  v_and_b32_dpp v51, v46, v43 row_newbcast:11
  s_waitcnt vmcnt(18)
  v_mfma_f32_16x16x32_bf16 v[56:59], v[52:55], a[180:183], v[56:59]
  v_and_b32_dpp v52, v47, v40 row_newbcast:11
  v_and_b32_dpp v53, v47, v41 row_newbcast:11
  v_and_b32_dpp v54, v47, v42 row_newbcast:11
  v_and_b32_dpp v55, v47, v43 row_newbcast:11
  s_waitcnt vmcnt(17)
  v_mfma_f32_16x16x32_bf16 v[56:59], v[48:51], a[184:187], v[56:59]
  v_and_b32_dpp v48, v44, v40 row_newbcast:12
  v_and_b32_dpp v49, v44, v41 row_newbcast:12
  v_and_b32_dpp v50, v44, v42 row_newbcast:12
  v_and_b32_dpp v51, v44, v43 row_newbcast:12
  s_waitcnt vmcnt(16)
  v_mfma_f32_16x16x32_bf16 v[56:59], v[52:55], a[188:191], v[56:59]
  v_and_b32_dpp v52, v45, v40 row_newbcast:12
  v_and_b32_dpp v53, v45, v41 row_newbcast:12
  v_and_b32_dpp v54, v45, v42 row_newbcast:12
  v_and_b32_dpp v55, v45, v43 row_newbcast:12
  s_waitcnt vmcnt(15)
  v_mfma_f32_16x16x32_bf16 v[56:59], v[48:51], a[192:195], v[56:59]
  v_and_b32_dpp v48, v46, v40 row_newbcast:12
  v_and_b32_dpp v49, v46, v41 row_newbcast:12
  v_and_b32_dpp v50, v46, v42 row_newbcast:12
  v_and_b32_dpp v51, v46, v43 row_newbcast:12
  s_waitcnt vmcnt(14)
  v_mfma_f32_16x16x32_bf16 v[56:59], v[52:55], a[196:199], v[56:59]
  v_and_b32_dpp v52, v47, v40 row_newbcast:12
  v_and_b32_dpp v53, v47, v41 row_newbcast:12
  v_and_b32_dpp v54, v47, v42 row_newbcast:12
  v_and_b32_dpp v55, v47, v43 row_newbcast:12
  s_waitcnt vmcnt(13)
  v_mfma_f32_16x16x32_bf16 v[56:59], v[48:51], a[200:203], v[56:59]
  v_and_b32_dpp v48, v44, v40 row_newbcast:13
  v_and_b32_dpp v49, v44, v41 row_newbcast:13
  v_and_b32_dpp v50, v44, v42 row_newbcast:13
  v_and_b32_dpp v51, v44, v43 row_newbcast:13
  s_waitcnt vmcnt(12)
  v_mfma_f32_16x16x32_bf16 v[56:59], v[52:55], a[204:207], v[56:59]
  v_and_b32_dpp v52, v45, v40 row_newbcast:13
  v_and_b32_dpp v53, v45, v41 row_newbcast:13
  v_and_b32_dpp v54, v45, v42 row_newbcast:13
  v_and_b32_dpp v55, v45, v43 row_newbcast:13
  s_waitcnt vmcnt(11)
  v_mfma_f32_16x16x32_bf16 v[56:59], v[48:51], a[208:211], v[56:59]
  v_and_b32_dpp v48, v46, v40 row_newbcast:13
  v_and_b32_dpp v49, v46, v41 row_newbcast:13
  v_and_b32_dpp v50, v46, v42 row_newbcast:13
  v_and_b32_dpp v51, v46, v43 row_newbcast:13
  s_waitcnt vmcnt(10)
  v_mfma_f32_16x16x32_bf16 v[56:59], v[52:55], a[212:215], v[56:59]
  v_and_b32_dpp v52, v47, v40 row_newbcast:13
  v_and_b32_dpp v53, v47, v41 row_newbcast:13
  v_and_b32_dpp v54, v47, v42 row_newbcast:13
  v_and_b32_dpp v55, v47, v43 row_newbcast:13
  s_waitcnt vmcnt(9)
  v_mfma_f32_16x16x32_bf16 v[56:59], v[48:51], a[216:219], v[56:59]
  v_and_b32_dpp v48, v44, v40 row_newbcast:14
  v_and_b32_dpp v49, v44, v41 row_newbcast:14
  v_and_b32_dpp v50, v44, v42 row_newbcast:14
  v_and_b32_dpp v51, v44, v43 row_newbcast:14
  s_waitcnt vmcnt(8)
  v_mfma_f32_16x16x32_bf16 v[56:59], v[52:55], a[220:223], v[56:59]
  v_and_b32_dpp v52, v45, v40 row_newbcast:14
  v_and_b32_dpp v53, v45, v41 row_newbcast:14
  v_and_b32_dpp v54, v45, v42 row_newbcast:14
  v_and_b32_dpp v55, v45, v43 row_newbcast:14
  s_waitcnt vmcnt(7)
  v_mfma_f32_16x16x32_bf16 v[56:59], v[48:51], a[224:227], v[56:59]
  v_and_b32_dpp v48, v46, v40 row_newbcast:14
  v_and_b32_dpp v49, v46, v41 row_newbcast:14
  v_and_b32_dpp v50, v46, v42 row_newbcast:14
  v_and_b32_dpp v51, v46, v43 row_newbcast:14
  s_waitcnt vmcnt(6)
  v_mfma_f32_16x16x32_bf16 v[56:59], v[52:55], a[228:231], v[56:59]
  v_and_b32_dpp v52, v47, v40 row_newbcast:14
  v_and_b32_dpp v53, v47, v41 row_newbcast:14
  v_and_b32_dpp v54, v47, v42 row_newbcast:14
  v_and_b32_dpp v55, v47, v43 row_newbcast:14
  s_waitcnt vmcnt(5)
  v_mfma_f32_16x16x32_bf16 v[56:59], v[48:51], a[232:235], v[56:59]
  v_and_b32_dpp v48, v44, v40 row_newbcast:15
  v_and_b32_dpp v49, v44, v41 row_newbcast:15
  v_and_b32_dpp v50, v44, v42 row_newbcast:15
  v_and_b32_dpp v51, v44, v43 row_newbcast:15
  s_waitcnt vmcnt(4)
  v_mfma_f32_16x16x32_bf16 v[56:59], v[52:55], a[236:239], v[56:59]
  v_and_b32_dpp v52, v45, v40 row_newbcast:15
  v_and_b32_dpp v53, v45, v41 row_newbcast:15
  v_and_b32_dpp v54, v45, v42 row_newbcast:15
  v_and_b32_dpp v55, v45, v43 row_newbcast:15
  s_waitcnt vmcnt(3)
  v_mfma_f32_16x16x32_bf16 v[56:59], v[48:51], a[240:243], v[56:59]
  v_and_b32_dpp v48, v46, v40 row_newbcast:15
  v_and_b32_dpp v49, v46, v41 row_newbcast:15
  v_and_b32_dpp v50, v46, v42 row_newbcast:15
  v_and_b32_dpp v51, v46, v43 row_newbcast:15
  s_waitcnt vmcnt(2)
  v_mfma_f32_16x16x32_bf16 v[56:59], v[52:55], a[244:247], v[56:59]
  v_and_b32_dpp v52, v47, v40 row_newbcast:15
  v_and_b32_dpp v53, v47, v41 row_newbcast:15
  v_and_b32_dpp v54, v47, v42 row_newbcast:15
  v_and_b32_dpp v55, v47, v43 row_newbcast:15
  s_waitcnt vmcnt(1)
  v_mfma_f32_16x16x32_bf16 v[56:59], v[48:51], a[248:251], v[56:59]
  s_waitcnt vmcnt(0)
  v_mfma_f32_16x16x32_bf16 v[56:59], v[52:55], a[252:255], v[56:59]
  v_lshrrev_b32 v26, 8, v1
  v_and_b32 v27, 0xf0, v1
  v_lshlrev_b32 v26, 4, v26
  v_lshl_add_u32 v26, v27, 1, v26
  s_lshl_b32 s38, s64, 9
  v_add_u32 v26, s38, v26
  s_mov_b64 exec, 0xffffffff
  s_nop 0
  ds_write_b128 v26, v[56:59] offset:0
  s_mov_b64 exec, -1
  s_xor_b32 s68, s70, 0x30800
  buffer_load_dwordx4 v[176:179], v63, s[4:7], s68 offen nt
  s_xor_b32 s68, s70, 0x30900
  buffer_load_dwordx4 v[180:183], v63, s[4:7], s68 offen nt
  s_xor_b32 s68, s70, 0x30c00
  buffer_load_dwordx4 v[184:187], v63, s[4:7], s68 offen nt
  s_xor_b32 s68, s70, 0x30d00
  buffer_load_dwordx4 v[188:191], v63, s[4:7], s68 offen nt
  s_waitcnt lgkmcnt(0)
  s_barrier
  v_and_b32 v26, 0xf0, v1
  v_lshlrev_b32 v26, 1, v26
  ds_read_b128 v[12:15], v26 offset:0
  ds_read_b128 v[16:19], v26 offset:512
  ds_read_b128 v[48:51], v26 offset:1024
  ds_read_b128 v[52:55], v26 offset:1536
  ds_read_b128 v[56:59], v26 offset:16
  ds_read_b128 v[192:195], v26 offset:528
  ds_read_b128 v[196:199], v26 offset:1040
  ds_read_b128 v[200:203], v26 offset:1552
  s_waitcnt lgkmcnt(4)
  v_pk_add_f32 v[12:13], v[12:13], v[16:17]
  v_pk_add_f32 v[48:49], v[48:49], v[52:53]
  v_pk_add_f32 v[14:15], v[14:15], v[18:19]
  v_pk_add_f32 v[50:51], v[50:51], v[54:55]
  v_pk_add_f32 v[12:13], v[12:13], v[48:49]
  v_pk_add_f32 v[14:15], v[14:15], v[50:51]
  v_cvt_pk_bf16_f32 v4, v12, v13
  v_cvt_pk_bf16_f32 v5, v14, v15
  s_waitcnt lgkmcnt(0)
  v_pk_add_f32 v[56:57], v[56:57], v[192:193]
  v_pk_add_f32 v[196:197], v[196:197], v[200:201]
  v_pk_add_f32 v[58:59], v[58:59], v[194:195]
  v_pk_add_f32 v[198:199], v[198:199], v[202:203]
  v_pk_add_f32 v[56:57], v[56:57], v[196:197]
  v_pk_add_f32 v[58:59], v[58:59], v[198:199]
  v_cvt_pk_bf16_f32 v6, v56, v57
  v_cvt_pk_bf16_f32 v7, v58, v59
  s_or_b32 s38, s64, s65
  s_cmp_eq_u32 s38, 0
  s_cbranch_scc0 L_nosigB
  s_lshl_b32 s38, s66, 2
  v_mov_b32 v26, s38
  v_mov_b32 v27, 1
  s_mov_b64 exec, 1
  global_store_dword v26, v27, s[82:83] sc1
  s_mov_b64 exec, -1
L_nosigB:
  v_dot2_f32_bf16 v22, v64, v4, 0
  v_dot2_f32_bf16 v22, v65, v5, v22
  v_dot2_f32_bf16 v22, v66, v6, v22
  v_dot2_f32_bf16 v22, v67, v7, v22
  s_xor_b32 s68, s70, 0x80000
  buffer_load_dwordx4 v[204:207], v63, s[4:7], s68 offen nt
  s_xor_b32 s68, s70, 0x80100
  buffer_load_dwordx4 v[208:211], v63, s[4:7], s68 offen nt
  s_xor_b32 s68, s70, 0x80400
  buffer_load_dwordx4 v[212:215], v63, s[4:7], s68 offen nt
  s_xor_b32 s68, s70, 0x80500
  buffer_load_dwordx4 v[216:219], v63, s[4:7], s68 offen nt
  s_xor_b32 s68, s70, 0x80800
  buffer_load_dwordx4 v[220:223], v63, s[4:7], s68 offen nt
  s_xor_b32 s68, s70, 0x80900
  buffer_load_dwordx4 v[224:227], v63, s[4:7], s68 offen nt
  v_dot2_f32_bf16 v23, v68, v4, 0
  v_dot2_f32_bf16 v23, v69, v5, v23
  v_dot2_f32_bf16 v23, v70, v6, v23
  v_dot2_f32_bf16 v23, v71, v7, v23
  v_dot2_f32_bf16 v24, v72, v4, 0
  v_dot2_f32_bf16 v24, v73, v5, v24
  v_dot2_f32_bf16 v24, v74, v6, v24
  v_dot2_f32_bf16 v24, v75, v7, v24
  s_mov_b32 s24, s56
  s_mov_b32 s25, s57
  s_mov_b32 s28, s50
  s_mov_b32 s29, s51
  s_lshl_b32 s73, s74, 16
  s_add_u32 s73, s73, s72
  buffer_load_dwordx4 a[0:3], v2, s[24:27], s73 offen
  s_add_u32 s73, s73, 8192
  buffer_load_dwordx4 a[4:7], v2, s[24:27], s73 offen
  s_add_u32 s73, s73, 8192
  buffer_load_dwordx4 a[8:11], v2, s[24:27], s73 offen
  s_add_u32 s73, s73, 8192
  buffer_load_dwordx4 a[12:15], v2, s[24:27], s73 offen
  s_add_u32 s73, s73, 8192
  buffer_load_dwordx4 a[16:19], v2, s[24:27], s73 offen
  s_add_u32 s73, s73, 8192
  buffer_load_dwordx4 a[20:23], v2, s[24:27], s73 offen
  s_add_u32 s73, s73, 8192
  buffer_load_dwordx4 a[24:27], v2, s[24:27], s73 offen
  s_add_u32 s73, s73, 8192
  buffer_load_dwordx4 a[28:31], v2, s[24:27], s73 offen
  v_dot2_f32_bf16 v25, v76, v4, 0
  v_dot2_f32_bf16 v25, v77, v5, v25
  v_dot2_f32_bf16 v25, v78, v6, v25
  v_dot2_f32_bf16 v25, v79, v7, v25
  v_add_f32_dpp v26, v22, v22 row_ror:8 row_mask:0xf bank_mask:0x3
  v_add_f32_dpp v27, v24, v24 row_ror:8 row_mask:0xf bank_mask:0x3
  s_nop 0
  v_add_f32_dpp v26, v23, v23 row_ror:8 row_mask:0xf bank_mask:0xc
  v_add_f32_dpp v27, v25, v25 row_ror:8 row_mask:0xf bank_mask:0xc
  s_nop 0
  v_add_f32_dpp v28, v26, v26 row_half_mirror row_mask:0xf bank_mask:0x5
  s_nop 1
  v_add_f32_dpp v28, v27, v27 row_half_mirror row_mask:0xf bank_mask:0xa
  s_nop 1
  v_add_f32_dpp v28, v28, v28 quad_perm:[1,0,3,2]
  s_nop 1
  v_add_f32_dpp v192, v28, v28 quad_perm:[2,3,0,1]
  v_mov_b32 v20, v192
  buffer_load_dwordx2 v[38:39], v37, s[28:31], 0 offen
  v_dot2_f32_bf16 v22, v80, v4, 0
  v_dot2_f32_bf16 v22, v81, v5, v22
  v_dot2_f32_bf16 v22, v82, v6, v22
  v_dot2_f32_bf16 v22, v83, v7, v22
  v_dot2_f32_bf16 v23, v84, v4, 0
  v_dot2_f32_bf16 v23, v85, v5, v23
  v_dot2_f32_bf16 v23, v86, v6, v23
  v_dot2_f32_bf16 v23, v87, v7, v23
  v_dot2_f32_bf16 v24, v88, v4, 0
  v_dot2_f32_bf16 v24, v89, v5, v24
  v_dot2_f32_bf16 v24, v90, v6, v24
  v_dot2_f32_bf16 v24, v91, v7, v24
  v_dot2_f32_bf16 v25, v92, v4, 0
  v_dot2_f32_bf16 v25, v93, v5, v25
  v_dot2_f32_bf16 v25, v94, v6, v25
  v_dot2_f32_bf16 v25, v95, v7, v25
  v_add_f32_dpp v26, v22, v22 row_ror:8 row_mask:0xf bank_mask:0x3
  v_add_f32_dpp v27, v24, v24 row_ror:8 row_mask:0xf bank_mask:0x3
  s_nop 0
  v_add_f32_dpp v26, v23, v23 row_ror:8 row_mask:0xf bank_mask:0xc
  v_add_f32_dpp v27, v25, v25 row_ror:8 row_mask:0xf bank_mask:0xc
  s_nop 0
  v_add_f32_dpp v28, v26, v26 row_half_mirror row_mask:0xf bank_mask:0x5
  s_nop 1
  v_add_f32_dpp v28, v27, v27 row_half_mirror row_mask:0xf bank_mask:0xa
  s_nop 1
  v_add_f32_dpp v28, v28, v28 quad_perm:[1,0,3,2]
  s_nop 1
  v_add_f32_dpp v193, v28, v28 quad_perm:[2,3,0,1]
  v_max_f32 v20, v20, v193
  v_dot2_f32_bf16 v22, v96, v4, 0
  v_dot2_f32_bf16 v22, v97, v5, v22
  v_dot2_f32_bf16 v22, v98, v6, v22
  v_dot2_f32_bf16 v22, v99, v7, v22
  v_dot2_f32_bf16 v23, v100, v4, 0
  v_dot2_f32_bf16 v23, v101, v5, v23
  v_dot2_f32_bf16 v23, v102, v6, v23
  v_dot2_f32_bf16 v23, v103, v7, v23
  v_dot2_f32_bf16 v24, v104, v4, 0
  v_dot2_f32_bf16 v24, v105, v5, v24
  v_dot2_f32_bf16 v24, v106, v6, v24
  v_dot2_f32_bf16 v24, v107, v7, v24
  v_dot2_f32_bf16 v25, v108, v4, 0
  v_dot2_f32_bf16 v25, v109, v5, v25
  v_dot2_f32_bf16 v25, v110, v6, v25
  v_dot2_f32_bf16 v25, v111, v7, v25
  v_add_f32_dpp v26, v22, v22 row_ror:8 row_mask:0xf bank_mask:0x3
  v_add_f32_dpp v27, v24, v24 row_ror:8 row_mask:0xf bank_mask:0x3
  s_nop 0
  v_add_f32_dpp v26, v23, v23 row_ror:8 row_mask:0xf bank_mask:0xc
  v_add_f32_dpp v27, v25, v25 row_ror:8 row_mask:0xf bank_mask:0xc
  s_nop 0
  v_add_f32_dpp v28, v26, v26 row_half_mirror row_mask:0xf bank_mask:0x5
  s_nop 1
  v_add_f32_dpp v28, v27, v27 row_half_mirror row_mask:0xf bank_mask:0xa
  s_nop 1
  v_add_f32_dpp v28, v28, v28 quad_perm:[1,0,3,2]
  s_nop 1
  v_add_f32_dpp v194, v28, v28 quad_perm:[2,3,0,1]
  v_max_f32 v20, v20, v194
  v_dot2_f32_bf16 v22, v112, v4, 0
  v_dot2_f32_bf16 v22, v113, v5, v22
  v_dot2_f32_bf16 v22, v114, v6, v22
  v_dot2_f32_bf16 v22, v115, v7, v22
  v_dot2_f32_bf16 v23, v116, v4, 0
  v_dot2_f32_bf16 v23, v117, v5, v23
  v_dot2_f32_bf16 v23, v118, v6, v23
  v_dot2_f32_bf16 v23, v119, v7, v23
  v_dot2_f32_bf16 v24, v120, v4, 0
  v_dot2_f32_bf16 v24, v121, v5, v24
  v_dot2_f32_bf16 v24, v122, v6, v24
  v_dot2_f32_bf16 v24, v123, v7, v24
  v_dot2_f32_bf16 v25, v124, v4, 0
  v_dot2_f32_bf16 v25, v125, v5, v25
  v_dot2_f32_bf16 v25, v126, v6, v25
  v_dot2_f32_bf16 v25, v127, v7, v25
  v_add_f32_dpp v26, v22, v22 row_ror:8 row_mask:0xf bank_mask:0x3
  v_add_f32_dpp v27, v24, v24 row_ror:8 row_mask:0xf bank_mask:0x3
  s_nop 0
  v_add_f32_dpp v26, v23, v23 row_ror:8 row_mask:0xf bank_mask:0xc
  v_add_f32_dpp v27, v25, v25 row_ror:8 row_mask:0xf bank_mask:0xc
  s_nop 0
  v_add_f32_dpp v28, v26, v26 row_half_mirror row_mask:0xf bank_mask:0x5
  s_nop 1
  v_add_f32_dpp v28, v27, v27 row_half_mirror row_mask:0xf bank_mask:0xa
  s_nop 1
  v_add_f32_dpp v28, v28, v28 quad_perm:[1,0,3,2]
  s_nop 1
  v_add_f32_dpp v195, v28, v28 quad_perm:[2,3,0,1]
  v_max_f32 v20, v20, v195
  v_dot2_f32_bf16 v22, v128, v4, 0
  v_dot2_f32_bf16 v22, v129, v5, v22
  v_dot2_f32_bf16 v22, v130, v6, v22
  v_dot2_f32_bf16 v22, v131, v7, v22
  v_dot2_f32_bf16 v23, v132, v4, 0
  v_dot2_f32_bf16 v23, v133, v5, v23
  v_dot2_f32_bf16 v23, v134, v6, v23
  v_dot2_f32_bf16 v23, v135, v7, v23
  v_dot2_f32_bf16 v24, v136, v4, 0
  v_dot2_f32_bf16 v24, v137, v5, v24
  v_dot2_f32_bf16 v24, v138, v6, v24
  v_dot2_f32_bf16 v24, v139, v7, v24
  v_dot2_f32_bf16 v25, v140, v4, 0
  v_dot2_f32_bf16 v25, v141, v5, v25
  v_dot2_f32_bf16 v25, v142, v6, v25
  v_dot2_f32_bf16 v25, v143, v7, v25
  v_add_f32_dpp v26, v22, v22 row_ror:8 row_mask:0xf bank_mask:0x3
  v_add_f32_dpp v27, v24, v24 row_ror:8 row_mask:0xf bank_mask:0x3
  s_nop 0
  v_add_f32_dpp v26, v23, v23 row_ror:8 row_mask:0xf bank_mask:0xc
  v_add_f32_dpp v27, v25, v25 row_ror:8 row_mask:0xf bank_mask:0xc
  s_nop 0
  v_add_f32_dpp v28, v26, v26 row_half_mirror row_mask:0xf bank_mask:0x5
  s_nop 1
  v_add_f32_dpp v28, v27, v27 row_half_mirror row_mask:0xf bank_mask:0xa
  s_nop 1
  v_add_f32_dpp v28, v28, v28 quad_perm:[1,0,3,2]
  s_nop 1
  v_add_f32_dpp v196, v28, v28 quad_perm:[2,3,0,1]
  v_max_f32 v20, v20, v196
  v_dot2_f32_bf16 v22, v144, v4, 0
  v_dot2_f32_bf16 v22, v145, v5, v22
  v_dot2_f32_bf16 v22, v146, v6, v22
  v_dot2_f32_bf16 v22, v147, v7, v22
  v_dot2_f32_bf16 v23, v148, v4, 0
  v_dot2_f32_bf16 v23, v149, v5, v23
  v_dot2_f32_bf16 v23, v150, v6, v23
  v_dot2_f32_bf16 v23, v151, v7, v23
  v_dot2_f32_bf16 v24, v152, v4, 0
  v_dot2_f32_bf16 v24, v153, v5, v24
  v_dot2_f32_bf16 v24, v154, v6, v24
  v_dot2_f32_bf16 v24, v155, v7, v24
  v_dot2_f32_bf16 v25, v156, v4, 0
  v_dot2_f32_bf16 v25, v157, v5, v25
  v_dot2_f32_bf16 v25, v158, v6, v25
  v_dot2_f32_bf16 v25, v159, v7, v25
  v_add_f32_dpp v26, v22, v22 row_ror:8 row_mask:0xf bank_mask:0x3
  v_add_f32_dpp v27, v24, v24 row_ror:8 row_mask:0xf bank_mask:0x3
  s_nop 0
  v_add_f32_dpp v26, v23, v23 row_ror:8 row_mask:0xf bank_mask:0xc
  v_add_f32_dpp v27, v25, v25 row_ror:8 row_mask:0xf bank_mask:0xc
  s_nop 0
  v_add_f32_dpp v28, v26, v26 row_half_mirror row_mask:0xf bank_mask:0x5
  s_nop 1
  v_add_f32_dpp v28, v27, v27 row_half_mirror row_mask:0xf bank_mask:0xa
  s_nop 1
  v_add_f32_dpp v28, v28, v28 quad_perm:[1,0,3,2]
  s_nop 1
  v_add_f32_dpp v197, v28, v28 quad_perm:[2,3,0,1]
  v_max_f32 v20, v20, v197
  v_dot2_f32_bf16 v22, v160, v4, 0
  v_dot2_f32_bf16 v22, v161, v5, v22
  v_dot2_f32_bf16 v22, v162, v6, v22
  v_dot2_f32_bf16 v22, v163, v7, v22
  v_dot2_f32_bf16 v23, v164, v4, 0
  v_dot2_f32_bf16 v23, v165, v5, v23
  v_dot2_f32_bf16 v23, v166, v6, v23
  v_dot2_f32_bf16 v23, v167, v7, v23
  v_dot2_f32_bf16 v24, v168, v4, 0
  v_dot2_f32_bf16 v24, v169, v5, v24
  v_dot2_f32_bf16 v24, v170, v6, v24
  v_dot2_f32_bf16 v24, v171, v7, v24
  v_dot2_f32_bf16 v25, v172, v4, 0
  v_dot2_f32_bf16 v25, v173, v5, v25
  v_dot2_f32_bf16 v25, v174, v6, v25
  v_dot2_f32_bf16 v25, v175, v7, v25
  v_add_f32_dpp v26, v22, v22 row_ror:8 row_mask:0xf bank_mask:0x3
  v_add_f32_dpp v27, v24, v24 row_ror:8 row_mask:0xf bank_mask:0x3
  s_nop 0
  v_add_f32_dpp v26, v23, v23 row_ror:8 row_mask:0xf bank_mask:0xc
  v_add_f32_dpp v27, v25, v25 row_ror:8 row_mask:0xf bank_mask:0xc
  s_nop 0
  v_add_f32_dpp v28, v26, v26 row_half_mirror row_mask:0xf bank_mask:0x5
  s_nop 1
  v_add_f32_dpp v28, v27, v27 row_half_mirror row_mask:0xf bank_mask:0xa
  s_nop 1
  v_add_f32_dpp v28, v28, v28 quad_perm:[1,0,3,2]
  s_nop 1
  v_add_f32_dpp v198, v28, v28 quad_perm:[2,3,0,1]
  v_max_f32 v20, v20, v198
  s_waitcnt vmcnt(18)
  v_dot2_f32_bf16 v22, v176, v4, 0
  v_dot2_f32_bf16 v22, v177, v5, v22
  v_dot2_f32_bf16 v22, v178, v6, v22
  v_dot2_f32_bf16 v22, v179, v7, v22
  s_waitcnt vmcnt(17)
  v_dot2_f32_bf16 v23, v180, v4, 0
  v_dot2_f32_bf16 v23, v181, v5, v23
  v_dot2_f32_bf16 v23, v182, v6, v23
  v_dot2_f32_bf16 v23, v183, v7, v23
  s_waitcnt vmcnt(16)
  v_dot2_f32_bf16 v24, v184, v4, 0
  v_dot2_f32_bf16 v24, v185, v5, v24
  v_dot2_f32_bf16 v24, v186, v6, v24
  v_dot2_f32_bf16 v24, v187, v7, v24
  s_waitcnt vmcnt(15)
  v_dot2_f32_bf16 v25, v188, v4, 0
  v_dot2_f32_bf16 v25, v189, v5, v25
  v_dot2_f32_bf16 v25, v190, v6, v25
  v_dot2_f32_bf16 v25, v191, v7, v25
  v_add_f32_dpp v26, v22, v22 row_ror:8 row_mask:0xf bank_mask:0x3
  v_add_f32_dpp v27, v24, v24 row_ror:8 row_mask:0xf bank_mask:0x3
  s_nop 0
  v_add_f32_dpp v26, v23, v23 row_ror:8 row_mask:0xf bank_mask:0xc
  v_add_f32_dpp v27, v25, v25 row_ror:8 row_mask:0xf bank_mask:0xc
  s_nop 0
  v_add_f32_dpp v28, v26, v26 row_half_mirror row_mask:0xf bank_mask:0x5
  s_nop 1
  v_add_f32_dpp v28, v27, v27 row_half_mirror row_mask:0xf bank_mask:0xa
  s_nop 1
  v_add_f32_dpp v28, v28, v28 quad_perm:[1,0,3,2]
  s_nop 1
  v_add_f32_dpp v199, v28, v28 quad_perm:[2,3,0,1]
  v_max_f32 v20, v20, v199
  s_waitcnt vmcnt(14)
  v_dot2_f32_bf16 v22, v204, v4, 0
  v_dot2_f32_bf16 v22, v205, v5, v22
  v_dot2_f32_bf16 v22, v206, v6, v22
  v_dot2_f32_bf16 v22, v207, v7, v22
  s_xor_b32 s68, s70, 0x80c00
  buffer_load_dwordx4 v[228:231], v63, s[4:7], s68 offen nt
  s_waitcnt vmcnt(14)
  v_dot2_f32_bf16 v23, v208, v4, 0
  v_dot2_f32_bf16 v23, v209, v5, v23
  v_dot2_f32_bf16 v23, v210, v6, v23
  v_dot2_f32_bf16 v23, v211, v7, v23
  s_xor_b32 s68, s70, 0x80d00
  buffer_load_dwordx4 v[232:235], v63, s[4:7], s68 offen nt
  s_waitcnt vmcnt(14)
  v_dot2_f32_bf16 v24, v212, v4, 0
  v_dot2_f32_bf16 v24, v213, v5, v24
  v_dot2_f32_bf16 v24, v214, v6, v24
  v_dot2_f32_bf16 v24, v215, v7, v24
  s_xor_b32 s68, s70, 0x90000
  buffer_load_dwordx4 v[236:239], v63, s[4:7], s68 offen nt
  s_waitcnt vmcnt(14)
  v_dot2_f32_bf16 v25, v216, v4, 0
  v_dot2_f32_bf16 v25, v217, v5, v25
  v_dot2_f32_bf16 v25, v218, v6, v25
  v_dot2_f32_bf16 v25, v219, v7, v25
  s_xor_b32 s68, s70, 0x90100
  buffer_load_dwordx4 v[240:243], v63, s[4:7], s68 offen nt
  v_add_f32_dpp v26, v22, v22 row_ror:8 row_mask:0xf bank_mask:0x3
  v_add_f32_dpp v27, v24, v24 row_ror:8 row_mask:0xf bank_mask:0x3
  s_nop 0
  v_add_f32_dpp v26, v23, v23 row_ror:8 row_mask:0xf bank_mask:0xc
  v_add_f32_dpp v27, v25, v25 row_ror:8 row_mask:0xf bank_mask:0xc
  s_nop 0
  v_add_f32_dpp v28, v26, v26 row_half_mirror row_mask:0xf bank_mask:0x5
  s_nop 1
  v_add_f32_dpp v28, v27, v27 row_half_mirror row_mask:0xf bank_mask:0xa
  s_nop 1
  v_add_f32_dpp v28, v28, v28 quad_perm:[1,0,3,2]
  s_nop 1
  v_add_f32_dpp v200, v28, v28 quad_perm:[2,3,0,1]
  v_max_f32 v20, v20, v200
  s_waitcnt vmcnt(14)
  v_dot2_f32_bf16 v22, v220, v4, 0
  v_dot2_f32_bf16 v22, v221, v5, v22
  v_dot2_f32_bf16 v22, v222, v6, v22
  v_dot2_f32_bf16 v22, v223, v7, v22
  s_xor_b32 s68, s70, 0x90400
  buffer_load_dwordx4 v[244:247], v63, s[4:7], s68 offen nt
  s_waitcnt vmcnt(14)
  v_dot2_f32_bf16 v23, v224, v4, 0
  v_dot2_f32_bf16 v23, v225, v5, v23
  v_dot2_f32_bf16 v23, v226, v6, v23
  v_dot2_f32_bf16 v23, v227, v7, v23
  s_xor_b32 s68, s70, 0x90500
  buffer_load_dwordx4 v[248:251], v63, s[4:7], s68 offen nt
  s_waitcnt vmcnt(5)
  v_dot2_f32_bf16 v24, v228, v4, 0
  v_dot2_f32_bf16 v24, v229, v5, v24
  v_dot2_f32_bf16 v24, v230, v6, v24
  v_dot2_f32_bf16 v24, v231, v7, v24
  s_xor_b32 s68, s70, 0x90800
  buffer_load_dwordx4 v[252:255], v63, s[4:7], s68 offen nt
  s_waitcnt vmcnt(5)
  v_dot2_f32_bf16 v25, v232, v4, 0
  v_dot2_f32_bf16 v25, v233, v5, v25
  v_dot2_f32_bf16 v25, v234, v6, v25
  v_dot2_f32_bf16 v25, v235, v7, v25
  s_xor_b32 s68, s70, 0x90900
  buffer_load_dwordx4 v[116:119], v63, s[4:7], s68 offen nt
  v_add_f32_dpp v26, v22, v22 row_ror:8 row_mask:0xf bank_mask:0x3
  v_add_f32_dpp v27, v24, v24 row_ror:8 row_mask:0xf bank_mask:0x3
  s_nop 0
  v_add_f32_dpp v26, v23, v23 row_ror:8 row_mask:0xf bank_mask:0xc
  v_add_f32_dpp v27, v25, v25 row_ror:8 row_mask:0xf bank_mask:0xc
  s_nop 0
  v_add_f32_dpp v28, v26, v26 row_half_mirror row_mask:0xf bank_mask:0x5
  s_nop 1
  v_add_f32_dpp v28, v27, v27 row_half_mirror row_mask:0xf bank_mask:0xa
  s_nop 1
  v_add_f32_dpp v28, v28, v28 quad_perm:[1,0,3,2]
  s_nop 1
  v_add_f32_dpp v201, v28, v28 quad_perm:[2,3,0,1]
  v_max_f32 v20, v20, v201
  s_waitcnt vmcnt(5)
  v_dot2_f32_bf16 v22, v236, v4, 0
  v_dot2_f32_bf16 v22, v237, v5, v22
  v_dot2_f32_bf16 v22, v238, v6, v22
  v_dot2_f32_bf16 v22, v239, v7, v22
  s_xor_b32 s68, s70, 0x90c00
  buffer_load_dwordx4 v[120:123], v63, s[4:7], s68 offen nt
  s_waitcnt vmcnt(5)
  v_dot2_f32_bf16 v23, v240, v4, 0
  v_dot2_f32_bf16 v23, v241, v5, v23
  v_dot2_f32_bf16 v23, v242, v6, v23
  v_dot2_f32_bf16 v23, v243, v7, v23
  s_xor_b32 s68, s70, 0x90d00
  buffer_load_dwordx4 v[124:127], v63, s[4:7], s68 offen nt
  s_waitcnt vmcnt(5)
  v_dot2_f32_bf16 v24, v244, v4, 0
  v_dot2_f32_bf16 v24, v245, v5, v24
  v_dot2_f32_bf16 v24, v246, v6, v24
  v_dot2_f32_bf16 v24, v247, v7, v24
  s_xor_b32 s68, s70, 0xa0000
  buffer_load_dwordx4 v[64:67], v63, s[4:7], s68 offen nt
  s_lshl_b32 s73, s75, 16
  s_add_u32 s73, s73, s72
  buffer_load_dwordx4 a[32:35], v2, s[24:27], s73 offen
  s_add_u32 s73, s73, 8192
  s_waitcnt vmcnt(6)
  v_dot2_f32_bf16 v25, v248, v4, 0
  v_dot2_f32_bf16 v25, v249, v5, v25
  v_dot2_f32_bf16 v25, v250, v6, v25
  v_dot2_f32_bf16 v25, v251, v7, v25
  s_xor_b32 s68, s70, 0xa0100
  buffer_load_dwordx4 v[68:71], v63, s[4:7], s68 offen nt
  v_add_f32_dpp v26, v22, v22 row_ror:8 row_mask:0xf bank_mask:0x3
  v_add_f32_dpp v27, v24, v24 row_ror:8 row_mask:0xf bank_mask:0x3
  s_nop 0
  v_add_f32_dpp v26, v23, v23 row_ror:8 row_mask:0xf bank_mask:0xc
  v_add_f32_dpp v27, v25, v25 row_ror:8 row_mask:0xf bank_mask:0xc
  s_nop 0
  v_add_f32_dpp v28, v26, v26 row_half_mirror row_mask:0xf bank_mask:0x5
  s_nop 1
  v_add_f32_dpp v28, v27, v27 row_half_mirror row_mask:0xf bank_mask:0xa
  s_nop 1
  v_add_f32_dpp v28, v28, v28 quad_perm:[1,0,3,2]
  s_nop 1
  v_add_f32_dpp v202, v28, v28 quad_perm:[2,3,0,1]
  v_max_f32 v20, v20, v202
  s_waitcnt vmcnt(6)
  v_dot2_f32_bf16 v22, v252, v4, 0
  v_dot2_f32_bf16 v22, v253, v5, v22
  v_dot2_f32_bf16 v22, v254, v6, v22
  v_dot2_f32_bf16 v22, v255, v7, v22
  s_xor_b32 s68, s70, 0xa0400
  buffer_load_dwordx4 v[72:75], v63, s[4:7], s68 offen nt
  s_waitcnt vmcnt(6)
  v_dot2_f32_bf16 v23, v116, v4, 0
  v_dot2_f32_bf16 v23, v117, v5, v23
  v_dot2_f32_bf16 v23, v118, v6, v23
  v_dot2_f32_bf16 v23, v119, v7, v23
  s_xor_b32 s68, s70, 0xa0500
  buffer_load_dwordx4 v[76:79], v63, s[4:7], s68 offen nt
  s_mov_b32 s38, 0x01000100
  s_mov_b32 s39, 0x03020302
  v_perm_b32 v44, v38, v38, s38
  v_perm_b32 v45, v38, v38, s39
  v_perm_b32 v46, v39, v39, s38
  v_perm_b32 v47, v39, v39, s39
  v_and_b32_dpp v48, v44, v40 row_newbcast:0
  v_and_b32_dpp v49, v44, v41 row_newbcast:0
  v_and_b32_dpp v50, v44, v42 row_newbcast:0
  v_and_b32_dpp v51, v44, v43 row_newbcast:0
  s_nop 1
  v_mfma_f32_16x16x32_bf16 v[56:59], v[48:51], a[0:3], 0
  v_and_b32_dpp v52, v45, v40 row_newbcast:0
  v_and_b32_dpp v53, v45, v41 row_newbcast:0
  v_and_b32_dpp v54, v45, v42 row_newbcast:0
  v_and_b32_dpp v55, v45, v43 row_newbcast:0
  s_nop 1
  v_mfma_f32_16x16x32_bf16 v[56:59], v[52:55], a[4:7], v[56:59]
  v_and_b32_dpp v48, v46, v40 row_newbcast:0
  v_and_b32_dpp v49, v46, v41 row_newbcast:0
  v_and_b32_dpp v50, v46, v42 row_newbcast:0
  v_and_b32_dpp v51, v46, v43 row_newbcast:0
  s_nop 1
  v_mfma_f32_16x16x32_bf16 v[56:59], v[48:51], a[8:11], v[56:59]
  v_and_b32_dpp v52, v47, v40 row_newbcast:0
  v_and_b32_dpp v53, v47, v41 row_newbcast:0
  v_and_b32_dpp v54, v47, v42 row_newbcast:0
  v_and_b32_dpp v55, v47, v43 row_newbcast:0
  s_nop 1
  v_mfma_f32_16x16x32_bf16 v[56:59], v[52:55], a[12:15], v[56:59]
  v_and_b32_dpp v48, v44, v40 row_newbcast:1
  v_and_b32_dpp v49, v44, v41 row_newbcast:1
  v_and_b32_dpp v50, v44, v42 row_newbcast:1
  v_and_b32_dpp v51, v44, v43 row_newbcast:1
  s_nop 1
  v_mfma_f32_16x16x32_bf16 v[56:59], v[48:51], a[16:19], v[56:59]
  v_and_b32_dpp v52, v45, v40 row_newbcast:1
  v_and_b32_dpp v53, v45, v41 row_newbcast:1
  v_and_b32_dpp v54, v45, v42 row_newbcast:1
  v_and_b32_dpp v55, v45, v43 row_newbcast:1
  s_nop 1
  v_mfma_f32_16x16x32_bf16 v[56:59], v[52:55], a[20:23], v[56:59]
  v_and_b32_dpp v48, v46, v40 row_newbcast:1
  v_and_b32_dpp v49, v46, v41 row_newbcast:1
  v_and_b32_dpp v50, v46, v42 row_newbcast:1
  v_and_b32_dpp v51, v46, v43 row_newbcast:1
  s_nop 1
  v_mfma_f32_16x16x32_bf16 v[56:59], v[48:51], a[24:27], v[56:59]
  v_and_b32_dpp v52, v47, v40 row_newbcast:1
  v_and_b32_dpp v53, v47, v41 row_newbcast:1
  v_and_b32_dpp v54, v47, v42 row_newbcast:1
  v_and_b32_dpp v55, v47, v43 row_newbcast:1
  s_nop 1
  v_mfma_f32_16x16x32_bf16 v[56:59], v[52:55], a[28:31], v[56:59]
  s_waitcnt vmcnt(6)
  v_dot2_f32_bf16 v24, v120, v4, 0
  v_dot2_f32_bf16 v24, v121, v5, v24
  v_dot2_f32_bf16 v24, v122, v6, v24
  v_dot2_f32_bf16 v24, v123, v7, v24
  s_xor_b32 s68, s70, 0xa0800
  buffer_load_dwordx4 v[80:83], v63, s[4:7], s68 offen nt
  buffer_load_dwordx4 a[36:39], v2, s[24:27], s73 offen
  s_add_u32 s73, s73, 8192
  s_waitcnt vmcnt(7)
  v_dot2_f32_bf16 v25, v124, v4, 0
  v_dot2_f32_bf16 v25, v125, v5, v25
  v_dot2_f32_bf16 v25, v126, v6, v25
  v_dot2_f32_bf16 v25, v127, v7, v25
  s_xor_b32 s68, s70, 0xa0900
  buffer_load_dwordx4 v[84:87], v63, s[4:7], s68 offen nt
  v_add_f32_dpp v26, v22, v22 row_ror:8 row_mask:0xf bank_mask:0x3
  v_add_f32_dpp v27, v24, v24 row_ror:8 row_mask:0xf bank_mask:0x3
  s_nop 0
  v_add_f32_dpp v26, v23, v23 row_ror:8 row_mask:0xf bank_mask:0xc
  v_add_f32_dpp v27, v25, v25 row_ror:8 row_mask:0xf bank_mask:0xc
  s_nop 0
  v_add_f32_dpp v28, v26, v26 row_half_mirror row_mask:0xf bank_mask:0x5
  s_nop 1
  v_add_f32_dpp v28, v27, v27 row_half_mirror row_mask:0xf bank_mask:0xa
  s_nop 1
  v_add_f32_dpp v28, v28, v28 quad_perm:[1,0,3,2]
  s_nop 1
  v_add_f32_dpp v203, v28, v28 quad_perm:[2,3,0,1]
  v_max_f32 v20, v20, v203
  s_waitcnt vmcnt(7)
  v_dot2_f32_bf16 v22, v64, v4, 0
  v_dot2_f32_bf16 v22, v65, v5, v22
  v_dot2_f32_bf16 v22, v66, v6, v22
  v_dot2_f32_bf16 v22, v67, v7, v22
  s_xor_b32 s68, s70, 0xa0c00
  buffer_load_dwordx4 v[88:91], v63, s[4:7], s68 offen nt
  s_waitcnt vmcnt(6)
  v_dot2_f32_bf16 v23, v68, v4, 0
  v_dot2_f32_bf16 v23, v69, v5, v23
  v_dot2_f32_bf16 v23, v70, v6, v23
  v_dot2_f32_bf16 v23, v71, v7, v23
  s_xor_b32 s68, s70, 0xa0d00
  buffer_load_dwordx4 v[92:95], v63, s[4:7], s68 offen nt
  s_waitcnt vmcnt(6)
  v_dot2_f32_bf16 v24, v72, v4, 0
  v_dot2_f32_bf16 v24, v73, v5, v24
  v_dot2_f32_bf16 v24, v74, v6, v24
  v_dot2_f32_bf16 v24, v75, v7, v24
  s_xor_b32 s68, s70, 0xb0000
  buffer_load_dwordx4 v[96:99], v63, s[4:7], s68 offen nt
  buffer_load_dwordx4 a[40:43], v2, s[24:27], s73 offen
  s_add_u32 s73, s73, 8192
  s_waitcnt vmcnt(7)
  v_dot2_f32_bf16 v25, v76, v4, 0
  v_dot2_f32_bf16 v25, v77, v5, v25
  v_dot2_f32_bf16 v25, v78, v6, v25
  v_dot2_f32_bf16 v25, v79, v7, v25
  s_xor_b32 s68, s70, 0xb0100
  buffer_load_dwordx4 v[100:103], v63, s[4:7], s68 offen nt
  v_add_f32_dpp v26, v22, v22 row_ror:8 row_mask:0xf bank_mask:0x3
  v_add_f32_dpp v27, v24, v24 row_ror:8 row_mask:0xf bank_mask:0x3
  s_nop 0
  v_add_f32_dpp v26, v23, v23 row_ror:8 row_mask:0xf bank_mask:0xc
  v_add_f32_dpp v27, v25, v25 row_ror:8 row_mask:0xf bank_mask:0xc
  s_nop 0
  v_add_f32_dpp v28, v26, v26 row_half_mirror row_mask:0xf bank_mask:0x5
  s_nop 1
  v_add_f32_dpp v28, v27, v27 row_half_mirror row_mask:0xf bank_mask:0xa
  s_nop 1
  v_add_f32_dpp v28, v28, v28 quad_perm:[1,0,3,2]
  s_nop 1
  v_add_f32_dpp v204, v28, v28 quad_perm:[2,3,0,1]
  v_max_f32 v20, v20, v204
  s_waitcnt vmcnt(7)
  v_dot2_f32_bf16 v22, v80, v4, 0
  v_dot2_f32_bf16 v22, v81, v5, v22
  v_dot2_f32_bf16 v22, v82, v6, v22
  v_dot2_f32_bf16 v22, v83, v7, v22
  s_xor_b32 s68, s70, 0xb0400
  buffer_load_dwordx4 v[104:107], v63, s[4:7], s68 offen nt
  s_waitcnt vmcnt(6)
  v_dot2_f32_bf16 v23, v84, v4, 0
  v_dot2_f32_bf16 v23, v85, v5, v23
  v_dot2_f32_bf16 v23, v86, v6, v23
  v_dot2_f32_bf16 v23, v87, v7, v23
  s_xor_b32 s68, s70, 0xb0500
  buffer_load_dwordx4 v[108:111], v63, s[4:7], s68 offen nt
  v_and_b32_dpp v48, v44, v40 row_newbcast:2
  v_and_b32_dpp v49, v44, v41 row_newbcast:2
  v_and_b32_dpp v50, v44, v42 row_newbcast:2
  v_and_b32_dpp v51, v44, v43 row_newbcast:2
  s_nop 1
  v_mfma_f32_16x16x32_bf16 v[56:59], v[48:51], a[32:35], v[56:59]
  s_waitcnt vmcnt(6)
  v_dot2_f32_bf16 v24, v88, v4, 0
  v_dot2_f32_bf16 v24, v89, v5, v24
  v_dot2_f32_bf16 v24, v90, v6, v24
  v_dot2_f32_bf16 v24, v91, v7, v24
  s_xor_b32 s68, s70, 0xb0800
  buffer_load_dwordx4 v[112:115], v63, s[4:7], s68 offen nt
  buffer_load_dwordx4 a[44:47], v2, s[24:27], s73 offen
  s_add_u32 s73, s73, 8192
  s_waitcnt vmcnt(7)
  v_dot2_f32_bf16 v25, v92, v4, 0
  v_dot2_f32_bf16 v25, v93, v5, v25
  v_dot2_f32_bf16 v25, v94, v6, v25
  v_dot2_f32_bf16 v25, v95, v7, v25
  s_xor_b32 s68, s70, 0xb0900
  buffer_load_dwordx4 v[116:119], v63, s[4:7], s68 offen nt
  v_add_f32_dpp v26, v22, v22 row_ror:8 row_mask:0xf bank_mask:0x3
  v_add_f32_dpp v27, v24, v24 row_ror:8 row_mask:0xf bank_mask:0x3
  s_nop 0
  v_add_f32_dpp v26, v23, v23 row_ror:8 row_mask:0xf bank_mask:0xc
  v_add_f32_dpp v27, v25, v25 row_ror:8 row_mask:0xf bank_mask:0xc
  s_nop 0
  v_add_f32_dpp v28, v26, v26 row_half_mirror row_mask:0xf bank_mask:0x5
  s_nop 1
  v_add_f32_dpp v28, v27, v27 row_half_mirror row_mask:0xf bank_mask:0xa
  s_nop 1
  v_add_f32_dpp v28, v28, v28 quad_perm:[1,0,3,2]
  s_nop 1
  v_add_f32_dpp v205, v28, v28 quad_perm:[2,3,0,1]
  v_max_f32 v20, v20, v205
L_join:
  s_nop 1
  s_waitcnt vmcnt(7)
  v_dot2_f32_bf16 v22, v96, v4, 0
  v_dot2_f32_bf16 v22, v97, v5, v22
  v_dot2_f32_bf16 v22, v98, v6, v22
  v_dot2_f32_bf16 v22, v99, v7, v22
  s_xor_b32 s68, s70, 0xb0c00
  buffer_load_dwordx4 v[120:123], v63, s[4:7], s68 offen nt
  s_waitcnt vmcnt(6)
  v_dot2_f32_bf16 v23, v100, v4, 0
  v_dot2_f32_bf16 v23, v101, v5, v23
  v_dot2_f32_bf16 v23, v102, v6, v23
  v_dot2_f32_bf16 v23, v103, v7, v23
  s_xor_b32 s68, s70, 0xb0d00
  buffer_load_dwordx4 v[124:127], v63, s[4:7], s68 offen nt
  v_and_b32_dpp v52, v45, v40 row_newbcast:2
  v_and_b32_dpp v53, v45, v41 row_newbcast:2
  v_and_b32_dpp v54, v45, v42 row_newbcast:2
  v_and_b32_dpp v55, v45, v43 row_newbcast:2
  s_nop 1
  v_mfma_f32_16x16x32_bf16 v[56:59], v[52:55], a[36:39], v[56:59]
  s_waitcnt vmcnt(6)
  v_dot2_f32_bf16 v24, v104, v4, 0
  v_dot2_f32_bf16 v24, v105, v5, v24
  v_dot2_f32_bf16 v24, v106, v6, v24
  v_dot2_f32_bf16 v24, v107, v7, v24
  s_xor_b32 s68, s70, 0x40000
  buffer_load_dwordx4 v[64:67], v63, s[4:7], s68 offen nt
  buffer_load_dwordx4 a[48:51], v2, s[24:27], s73 offen
  s_add_u32 s73, s73, 8192
  s_waitcnt vmcnt(7)
  v_dot2_f32_bf16 v25, v108, v4, 0
  v_dot2_f32_bf16 v25, v109, v5, v25
  v_dot2_f32_bf16 v25, v110, v6, v25
  v_dot2_f32_bf16 v25, v111, v7, v25
  s_xor_b32 s68, s70, 0x40100
  buffer_load_dwordx4 v[68:71], v63, s[4:7], s68 offen nt
  v_add_f32_dpp v26, v22, v22 row_ror:8 row_mask:0xf bank_mask:0x3
  v_add_f32_dpp v27, v24, v24 row_ror:8 row_mask:0xf bank_mask:0x3
  s_nop 0
  v_add_f32_dpp v26, v23, v23 row_ror:8 row_mask:0xf bank_mask:0xc
  v_add_f32_dpp v27, v25, v25 row_ror:8 row_mask:0xf bank_mask:0xc
  s_nop 0
  v_add_f32_dpp v28, v26, v26 row_half_mirror row_mask:0xf bank_mask:0x5
  s_nop 1
  v_add_f32_dpp v28, v27, v27 row_half_mirror row_mask:0xf bank_mask:0xa
  s_nop 1
  v_add_f32_dpp v28, v28, v28 quad_perm:[1,0,3,2]
  s_nop 1
  v_add_f32_dpp v206, v28, v28 quad_perm:[2,3,0,1]
  v_max_f32 v20, v20, v206
  s_barrier
  s_cmp_eq_u32 s64, 0
  s_cbranch_scc0 L_wg
  global_load_dword v33, v34, s[82:83] sc1
L_wg:
  s_waitcnt vmcnt(7)
  v_dot2_f32_bf16 v22, v112, v4, 0
  v_dot2_f32_bf16 v22, v113, v5, v22
  v_dot2_f32_bf16 v22, v114, v6, v22
  v_dot2_f32_bf16 v22, v115, v7, v22
  s_xor_b32 s68, s70, 0x40400
  buffer_load_dwordx4 v[72:75], v63, s[4:7], s68 offen nt
  s_waitcnt vmcnt(6)
  v_dot2_f32_bf16 v23, v116, v4, 0
  v_dot2_f32_bf16 v23, v117, v5, v23
  v_dot2_f32_bf16 v23, v118, v6, v23
  v_dot2_f32_bf16 v23, v119, v7, v23
  s_xor_b32 s68, s70, 0x40500
  buffer_load_dwordx4 v[76:79], v63, s[4:7], s68 offen nt
  v_and_b32_dpp v48, v46, v40 row_newbcast:2
  v_and_b32_dpp v49, v46, v41 row_newbcast:2
  v_and_b32_dpp v50, v46, v42 row_newbcast:2
  v_and_b32_dpp v51, v46, v43 row_newbcast:2
  s_nop 1
  v_mfma_f32_16x16x32_bf16 v[56:59], v[48:51], a[40:43], v[56:59]
  s_waitcnt vmcnt(6)
  v_dot2_f32_bf16 v24, v120, v4, 0
  v_dot2_f32_bf16 v24, v121, v5, v24
  v_dot2_f32_bf16 v24, v122, v6, v24
  v_dot2_f32_bf16 v24, v123, v7, v24
  s_xor_b32 s68, s70, 0x40800
  buffer_load_dwordx4 v[80:83], v63, s[4:7], s68 offen nt
  buffer_load_dwordx4 a[52:55], v2, s[24:27], s73 offen
  s_add_u32 s73, s73, 8192
  s_waitcnt vmcnt(7)
  v_dot2_f32_bf16 v25, v124, v4, 0
  v_dot2_f32_bf16 v25, v125, v5, v25
  v_dot2_f32_bf16 v25, v126, v6, v25
  v_dot2_f32_bf16 v25, v127, v7, v25
  s_xor_b32 s68, s70, 0x40900
  buffer_load_dwordx4 v[84:87], v63, s[4:7], s68 offen nt
  v_add_f32_dpp v26, v22, v22 row_ror:8 row_mask:0xf bank_mask:0x3
  v_add_f32_dpp v27, v24, v24 row_ror:8 row_mask:0xf bank_mask:0x3
  s_nop 0
  v_add_f32_dpp v26, v23, v23 row_ror:8 row_mask:0xf bank_mask:0xc
  v_add_f32_dpp v27, v25, v25 row_ror:8 row_mask:0xf bank_mask:0xc
  s_nop 0
  v_add_f32_dpp v28, v26, v26 row_half_mirror row_mask:0xf bank_mask:0x5
  s_nop 1
  v_add_f32_dpp v28, v27, v27 row_half_mirror row_mask:0xf bank_mask:0xa
  s_nop 1
  v_add_f32_dpp v28, v28, v28 quad_perm:[1,0,3,2]
  s_nop 1
  v_add_f32_dpp v207, v28, v28 quad_perm:[2,3,0,1]
  v_max_f32 v20, v20, v207
  s_barrier
  s_waitcnt vmcnt(7)
  v_dot2_f32_bf16 v22, v64, v4, 0
  v_dot2_f32_bf16 v22, v65, v5, v22
  v_dot2_f32_bf16 v22, v66, v6, v22
  v_dot2_f32_bf16 v22, v67, v7, v22
  s_xor_b32 s68, s70, 0x40c00
  buffer_load_dwordx4 v[88:91], v63, s[4:7], s68 offen nt
  s_waitcnt vmcnt(6)
  v_dot2_f32_bf16 v23, v68, v4, 0
  v_dot2_f32_bf16 v23, v69, v5, v23
  v_dot2_f32_bf16 v23, v70, v6, v23
  v_dot2_f32_bf16 v23, v71, v7, v23
  s_xor_b32 s68, s70, 0x40d00
  buffer_load_dwordx4 v[92:95], v63, s[4:7], s68 offen nt
  v_and_b32_dpp v52, v47, v40 row_newbcast:2
  v_and_b32_dpp v53, v47, v41 row_newbcast:2
  v_and_b32_dpp v54, v47, v42 row_newbcast:2
  v_and_b32_dpp v55, v47, v43 row_newbcast:2
  s_nop 1
  v_mfma_f32_16x16x32_bf16 v[56:59], v[52:55], a[44:47], v[56:59]
  s_waitcnt vmcnt(6)
  v_dot2_f32_bf16 v24, v72, v4, 0
  v_dot2_f32_bf16 v24, v73, v5, v24
  v_dot2_f32_bf16 v24, v74, v6, v24
  v_dot2_f32_bf16 v24, v75, v7, v24
  s_xor_b32 s68, s70, 0x50000
  buffer_load_dwordx4 v[96:99], v63, s[4:7], s68 offen nt
  buffer_load_dwordx4 a[56:59], v2, s[24:27], s73 offen
  s_add_u32 s73, s73, 8192
  s_waitcnt vmcnt(7)
  v_dot2_f32_bf16 v25, v76, v4, 0
  v_dot2_f32_bf16 v25, v77, v5, v25
  v_dot2_f32_bf16 v25, v78, v6, v25
  v_dot2_f32_bf16 v25, v79, v7, v25
  s_xor_b32 s68, s70, 0x50100
  buffer_load_dwordx4 v[100:103], v63, s[4:7], s68 offen nt
  v_add_f32_dpp v26, v22, v22 row_ror:8 row_mask:0xf bank_mask:0x3
  v_add_f32_dpp v27, v24, v24 row_ror:8 row_mask:0xf bank_mask:0x3
  s_nop 0
  v_add_f32_dpp v26, v23, v23 row_ror:8 row_mask:0xf bank_mask:0xc
  v_add_f32_dpp v27, v25, v25 row_ror:8 row_mask:0xf bank_mask:0xc
  s_nop 0
  v_add_f32_dpp v28, v26, v26 row_half_mirror row_mask:0xf bank_mask:0x5
  s_nop 1
  v_add_f32_dpp v28, v27, v27 row_half_mirror row_mask:0xf bank_mask:0xa
  s_nop 1
  v_add_f32_dpp v28, v28, v28 quad_perm:[1,0,3,2]
  s_nop 1
  v_add_f32_dpp v208, v28, v28 quad_perm:[2,3,0,1]
  v_max_f32 v20, v20, v208
  s_barrier
  s_waitcnt vmcnt(7)
  v_dot2_f32_bf16 v22, v80, v4, 0
  v_dot2_f32_bf16 v22, v81, v5, v22
  v_dot2_f32_bf16 v22, v82, v6, v22
  v_dot2_f32_bf16 v22, v83, v7, v22
  s_xor_b32 s68, s70, 0x50400
  buffer_load_dwordx4 v[104:107], v63, s[4:7], s68 offen nt
  s_waitcnt vmcnt(6)
  v_dot2_f32_bf16 v23, v84, v4, 0
  v_dot2_f32_bf16 v23, v85, v5, v23
  v_dot2_f32_bf16 v23, v86, v6, v23
  v_dot2_f32_bf16 v23, v87, v7, v23
  s_xor_b32 s68, s70, 0x50500
  buffer_load_dwordx4 v[108:111], v63, s[4:7], s68 offen nt
  v_and_b32_dpp v48, v44, v40 row_newbcast:3
  v_and_b32_dpp v49, v44, v41 row_newbcast:3
  v_and_b32_dpp v50, v44, v42 row_newbcast:3
  v_and_b32_dpp v51, v44, v43 row_newbcast:3
  s_nop 1
  v_mfma_f32_16x16x32_bf16 v[56:59], v[48:51], a[48:51], v[56:59]
  s_waitcnt vmcnt(6)
  v_dot2_f32_bf16 v24, v88, v4, 0
  v_dot2_f32_bf16 v24, v89, v5, v24
  v_dot2_f32_bf16 v24, v90, v6, v24
  v_dot2_f32_bf16 v24, v91, v7, v24
  s_xor_b32 s68, s70, 0x50800
  buffer_load_dwordx4 v[112:115], v63, s[4:7], s68 offen nt
  buffer_load_dwordx4 a[60:63], v2, s[24:27], s73 offen
  s_waitcnt vmcnt(7)
  v_dot2_f32_bf16 v25, v92, v4, 0
  v_dot2_f32_bf16 v25, v93, v5, v25
  v_dot2_f32_bf16 v25, v94, v6, v25
  v_dot2_f32_bf16 v25, v95, v7, v25
  s_xor_b32 s68, s70, 0x50900
  buffer_load_dwordx4 v[116:119], v63, s[4:7], s68 offen nt
  v_add_f32_dpp v26, v22, v22 row_ror:8 row_mask:0xf bank_mask:0x3
  v_add_f32_dpp v27, v24, v24 row_ror:8 row_mask:0xf bank_mask:0x3
  s_nop 0
  v_add_f32_dpp v26, v23, v23 row_ror:8 row_mask:0xf bank_mask:0xc
  v_add_f32_dpp v27, v25, v25 row_ror:8 row_mask:0xf bank_mask:0xc
  s_nop 0
  v_add_f32_dpp v28, v26, v26 row_half_mirror row_mask:0xf bank_mask:0x5
  s_nop 1
  v_add_f32_dpp v28, v27, v27 row_half_mirror row_mask:0xf bank_mask:0xa
  s_nop 1
  v_add_f32_dpp v28, v28, v28 quad_perm:[1,0,3,2]
  s_nop 1
  v_add_f32_dpp v209, v28, v28 quad_perm:[2,3,0,1]
  v_max_f32 v20, v20, v209
  s_barrier
  s_waitcnt vmcnt(7)
  v_dot2_f32_bf16 v22, v96, v4, 0
  v_dot2_f32_bf16 v22, v97, v5, v22
  v_dot2_f32_bf16 v22, v98, v6, v22
  v_dot2_f32_bf16 v22, v99, v7, v22
  s_xor_b32 s68, s70, 0x50c00
  buffer_load_dwordx4 v[120:123], v63, s[4:7], s68 offen nt
  s_waitcnt vmcnt(6)
  v_dot2_f32_bf16 v23, v100, v4, 0
  v_dot2_f32_bf16 v23, v101, v5, v23
  v_dot2_f32_bf16 v23, v102, v6, v23
  v_dot2_f32_bf16 v23, v103, v7, v23
  s_xor_b32 s68, s70, 0x50d00
  buffer_load_dwordx4 v[124:127], v63, s[4:7], s68 offen nt
  v_and_b32_dpp v52, v45, v40 row_newbcast:3
  v_and_b32_dpp v53, v45, v41 row_newbcast:3
  v_and_b32_dpp v54, v45, v42 row_newbcast:3
  v_and_b32_dpp v55, v45, v43 row_newbcast:3
  s_nop 1
  v_mfma_f32_16x16x32_bf16 v[56:59], v[52:55], a[52:55], v[56:59]
  s_waitcnt vmcnt(6)
  v_dot2_f32_bf16 v24, v104, v4, 0
  v_dot2_f32_bf16 v24, v105, v5, v24
  v_dot2_f32_bf16 v24, v106, v6, v24
  v_dot2_f32_bf16 v24, v107, v7, v24
  s_xor_b32 s68, s70, 0x60000
  buffer_load_dwordx4 v[64:67], v63, s[4:7], s68 offen nt
  s_lshl_b32 s73, s76, 16
  s_add_u32 s73, s73, s72
  buffer_load_dwordx4 a[64:67], v2, s[24:27], s73 offen
  s_add_u32 s73, s73, 8192
  s_waitcnt vmcnt(7)
  v_dot2_f32_bf16 v25, v108, v4, 0
  v_dot2_f32_bf16 v25, v109, v5, v25
  v_dot2_f32_bf16 v25, v110, v6, v25
  v_dot2_f32_bf16 v25, v111, v7, v25
  s_xor_b32 s68, s70, 0x60100
  buffer_load_dwordx4 v[68:71], v63, s[4:7], s68 offen nt
  v_add_f32_dpp v26, v22, v22 row_ror:8 row_mask:0xf bank_mask:0x3
  v_add_f32_dpp v27, v24, v24 row_ror:8 row_mask:0xf bank_mask:0x3
  s_nop 0
  v_add_f32_dpp v26, v23, v23 row_ror:8 row_mask:0xf bank_mask:0xc
  v_add_f32_dpp v27, v25, v25 row_ror:8 row_mask:0xf bank_mask:0xc
  s_nop 0
  v_add_f32_dpp v28, v26, v26 row_half_mirror row_mask:0xf bank_mask:0x5
  s_nop 1
  v_add_f32_dpp v28, v27, v27 row_half_mirror row_mask:0xf bank_mask:0xa
  s_nop 1
  v_add_f32_dpp v28, v28, v28 quad_perm:[1,0,3,2]
  s_nop 1
  v_add_f32_dpp v210, v28, v28 quad_perm:[2,3,0,1]
  v_max_f32 v20, v20, v210
  s_barrier
  s_waitcnt vmcnt(7)
  v_dot2_f32_bf16 v22, v112, v4, 0
  v_dot2_f32_bf16 v22, v113, v5, v22
  v_dot2_f32_bf16 v22, v114, v6, v22
  v_dot2_f32_bf16 v22, v115, v7, v22
  s_xor_b32 s68, s70, 0x60400
  buffer_load_dwordx4 v[72:75], v63, s[4:7], s68 offen nt
  s_waitcnt vmcnt(6)
  v_dot2_f32_bf16 v23, v116, v4, 0
  v_dot2_f32_bf16 v23, v117, v5, v23
  v_dot2_f32_bf16 v23, v118, v6, v23
  v_dot2_f32_bf16 v23, v119, v7, v23
  s_xor_b32 s68, s70, 0x60500
  buffer_load_dwordx4 v[76:79], v63, s[4:7], s68 offen nt
  v_and_b32_dpp v48, v46, v40 row_newbcast:3
  v_and_b32_dpp v49, v46, v41 row_newbcast:3
  v_and_b32_dpp v50, v46, v42 row_newbcast:3
  v_and_b32_dpp v51, v46, v43 row_newbcast:3
  s_nop 1
  v_mfma_f32_16x16x32_bf16 v[56:59], v[48:51], a[56:59], v[56:59]
  s_waitcnt vmcnt(6)
  v_dot2_f32_bf16 v24, v120, v4, 0
  v_dot2_f32_bf16 v24, v121, v5, v24
  v_dot2_f32_bf16 v24, v122, v6, v24
  v_dot2_f32_bf16 v24, v123, v7, v24
  s_xor_b32 s68, s70, 0x60800
  buffer_load_dwordx4 v[80:83], v63, s[4:7], s68 offen nt
  buffer_load_dwordx4 a[68:71], v2, s[24:27], s73 offen
  s_add_u32 s73, s73, 8192
  s_waitcnt vmcnt(7)
  v_dot2_f32_bf16 v25, v124, v4, 0
  v_dot2_f32_bf16 v25, v125, v5, v25
  v_dot2_f32_bf16 v25, v126, v6, v25
  v_dot2_f32_bf16 v25, v127, v7, v25
  s_xor_b32 s68, s70, 0x60900
  buffer_load_dwordx4 v[84:87], v63, s[4:7], s68 offen nt
  v_add_f32_dpp v26, v22, v22 row_ror:8 row_mask:0xf bank_mask:0x3
  v_add_f32_dpp v27, v24, v24 row_ror:8 row_mask:0xf bank_mask:0x3
  s_nop 0
  v_add_f32_dpp v26, v23, v23 row_ror:8 row_mask:0xf bank_mask:0xc
  v_add_f32_dpp v27, v25, v25 row_ror:8 row_mask:0xf bank_mask:0xc
  s_nop 0
  v_add_f32_dpp v28, v26, v26 row_half_mirror row_mask:0xf bank_mask:0x5
  s_nop 1
  v_add_f32_dpp v28, v27, v27 row_half_mirror row_mask:0xf bank_mask:0xa
  s_nop 1
  v_add_f32_dpp v28, v28, v28 quad_perm:[1,0,3,2]
  s_nop 1
  v_add_f32_dpp v211, v28, v28 quad_perm:[2,3,0,1]
  v_max_f32 v20, v20, v211
  s_barrier
  s_waitcnt vmcnt(7)
  v_dot2_f32_bf16 v22, v64, v4, 0
  v_dot2_f32_bf16 v22, v65, v5, v22
  v_dot2_f32_bf16 v22, v66, v6, v22
  v_dot2_f32_bf16 v22, v67, v7, v22
  s_xor_b32 s68, s70, 0x60c00
  buffer_load_dwordx4 v[88:91], v63, s[4:7], s68 offen nt
  s_waitcnt vmcnt(6)
  v_dot2_f32_bf16 v23, v68, v4, 0
  v_dot2_f32_bf16 v23, v69, v5, v23
  v_dot2_f32_bf16 v23, v70, v6, v23
  v_dot2_f32_bf16 v23, v71, v7, v23
  s_xor_b32 s68, s70, 0x60d00
  buffer_load_dwordx4 v[92:95], v63, s[4:7], s68 offen nt
  v_and_b32_dpp v52, v47, v40 row_newbcast:3
  v_and_b32_dpp v53, v47, v41 row_newbcast:3
  v_and_b32_dpp v54, v47, v42 row_newbcast:3
  v_and_b32_dpp v55, v47, v43 row_newbcast:3
  s_nop 1
  v_mfma_f32_16x16x32_bf16 v[56:59], v[52:55], a[60:63], v[56:59]
  s_waitcnt vmcnt(6)
  v_dot2_f32_bf16 v24, v72, v4, 0
  v_dot2_f32_bf16 v24, v73, v5, v24
  v_dot2_f32_bf16 v24, v74, v6, v24
  v_dot2_f32_bf16 v24, v75, v7, v24
  s_xor_b32 s68, s70, 0x70000
  buffer_load_dwordx4 v[96:99], v63, s[4:7], s68 offen nt
  buffer_load_dwordx4 a[72:75], v2, s[24:27], s73 offen
  s_add_u32 s73, s73, 8192
  s_waitcnt vmcnt(7)
  v_dot2_f32_bf16 v25, v76, v4, 0
  v_dot2_f32_bf16 v25, v77, v5, v25
  v_dot2_f32_bf16 v25, v78, v6, v25
  v_dot2_f32_bf16 v25, v79, v7, v25
  s_xor_b32 s68, s70, 0x70100
  buffer_load_dwordx4 v[100:103], v63, s[4:7], s68 offen nt
  v_add_f32_dpp v26, v22, v22 row_ror:8 row_mask:0xf bank_mask:0x3
  v_add_f32_dpp v27, v24, v24 row_ror:8 row_mask:0xf bank_mask:0x3
  s_nop 0
  v_add_f32_dpp v26, v23, v23 row_ror:8 row_mask:0xf bank_mask:0xc
  v_add_f32_dpp v27, v25, v25 row_ror:8 row_mask:0xf bank_mask:0xc
  s_nop 0
  v_add_f32_dpp v28, v26, v26 row_half_mirror row_mask:0xf bank_mask:0x5
  s_nop 1
  v_add_f32_dpp v28, v27, v27 row_half_mirror row_mask:0xf bank_mask:0xa
  s_nop 1
  v_add_f32_dpp v28, v28, v28 quad_perm:[1,0,3,2]
  s_nop 1
  v_add_f32_dpp v212, v28, v28 quad_perm:[2,3,0,1]
  v_max_f32 v20, v20, v212
  s_barrier
  s_cmp_eq_u32 s64, 0
  s_cbranch_scc0 L_wh
L_go:
  v_cmp_eq_u32 vcc, 0, v33
  s_nop 1
  s_cbranch_vccz L_gone
  global_load_dword v33, v34, s[82:83] sc1
  s_sub_u32 s87, s87, 1
  s_cmp_eq_u32 s87, 0
  s_cbranch_scc1 L_bail
  s_waitcnt vmcnt(0)
  s_branch L_go
L_gone:
L_wh:
  s_waitcnt vmcnt(7)
  v_dot2_f32_bf16 v22, v80, v4, 0
  v_dot2_f32_bf16 v22, v81, v5, v22
  v_dot2_f32_bf16 v22, v82, v6, v22
  v_dot2_f32_bf16 v22, v83, v7, v22
  s_xor_b32 s68, s70, 0x70400
  buffer_load_dwordx4 v[104:107], v63, s[4:7], s68 offen nt
  s_waitcnt vmcnt(6)
  v_dot2_f32_bf16 v23, v84, v4, 0
  v_dot2_f32_bf16 v23, v85, v5, v23
  v_dot2_f32_bf16 v23, v86, v6, v23
  v_dot2_f32_bf16 v23, v87, v7, v23
  s_xor_b32 s68, s70, 0x70500
  buffer_load_dwordx4 v[108:111], v63, s[4:7], s68 offen nt
  v_and_b32_dpp v48, v44, v40 row_newbcast:4
  v_and_b32_dpp v49, v44, v41 row_newbcast:4
  v_and_b32_dpp v50, v44, v42 row_newbcast:4
  v_and_b32_dpp v51, v44, v43 row_newbcast:4
  s_nop 1
  v_mfma_f32_16x16x32_bf16 v[56:59], v[48:51], a[64:67], v[56:59]
  s_waitcnt vmcnt(6)
  v_dot2_f32_bf16 v24, v88, v4, 0
  v_dot2_f32_bf16 v24, v89, v5, v24
  v_dot2_f32_bf16 v24, v90, v6, v24
  v_dot2_f32_bf16 v24, v91, v7, v24
  s_xor_b32 s68, s70, 0x70800
  buffer_load_dwordx4 v[112:115], v63, s[4:7], s68 offen nt
  buffer_load_dwordx4 a[76:79], v2, s[24:27], s73 offen
  s_add_u32 s73, s73, 8192
  s_waitcnt vmcnt(7)
  v_dot2_f32_bf16 v25, v92, v4, 0
  v_dot2_f32_bf16 v25, v93, v5, v25
  v_dot2_f32_bf16 v25, v94, v6, v25
  v_dot2_f32_bf16 v25, v95, v7, v25
  s_xor_b32 s68, s70, 0x70900
  buffer_load_dwordx4 v[116:119], v63, s[4:7], s68 offen nt
  v_add_f32_dpp v26, v22, v22 row_ror:8 row_mask:0xf bank_mask:0x3
  v_add_f32_dpp v27, v24, v24 row_ror:8 row_mask:0xf bank_mask:0x3
  s_nop 0
  v_add_f32_dpp v26, v23, v23 row_ror:8 row_mask:0xf bank_mask:0xc
  v_add_f32_dpp v27, v25, v25 row_ror:8 row_mask:0xf bank_mask:0xc
  s_nop 0
  v_add_f32_dpp v28, v26, v26 row_half_mirror row_mask:0xf bank_mask:0x5
  s_nop 1
  v_add_f32_dpp v28, v27, v27 row_half_mirror row_mask:0xf bank_mask:0xa
  s_nop 1
  v_add_f32_dpp v28, v28, v28 quad_perm:[1,0,3,2]
  s_nop 1
  v_add_f32_dpp v213, v28, v28 quad_perm:[2,3,0,1]
  v_max_f32 v20, v20, v213
  s_barrier
  s_waitcnt vmcnt(7)
  v_dot2_f32_bf16 v22, v96, v4, 0
  v_dot2_f32_bf16 v22, v97, v5, v22
  v_dot2_f32_bf16 v22, v98, v6, v22
  v_dot2_f32_bf16 v22, v99, v7, v22
  s_xor_b32 s68, s70, 0x70c00
  buffer_load_dwordx4 v[120:123], v63, s[4:7], s68 offen nt
  s_waitcnt vmcnt(6)
  v_dot2_f32_bf16 v23, v100, v4, 0
  v_dot2_f32_bf16 v23, v101, v5, v23
  v_dot2_f32_bf16 v23, v102, v6, v23
  v_dot2_f32_bf16 v23, v103, v7, v23
  s_xor_b32 s68, s70, 0x70d00
  buffer_load_dwordx4 v[124:127], v63, s[4:7], s68 offen nt
  v_and_b32_dpp v52, v45, v40 row_newbcast:4
  v_and_b32_dpp v53, v45, v41 row_newbcast:4
  v_and_b32_dpp v54, v45, v42 row_newbcast:4
  v_and_b32_dpp v55, v45, v43 row_newbcast:4
  s_nop 1
  v_mfma_f32_16x16x32_bf16 v[56:59], v[52:55], a[68:71], v[56:59]
  s_waitcnt vmcnt(6)
  v_dot2_f32_bf16 v24, v104, v4, 0
  v_dot2_f32_bf16 v24, v105, v5, v24
  v_dot2_f32_bf16 v24, v106, v6, v24
  v_dot2_f32_bf16 v24, v107, v7, v24
  s_xor_b32 s68, s70, 0xc0000
  buffer_load_dwordx4 v[64:67], v63, s[4:7], s68 offen nt
  buffer_load_dwordx4 a[80:83], v2, s[24:27], s73 offen
  s_add_u32 s73, s73, 8192
  s_waitcnt vmcnt(7)
  v_dot2_f32_bf16 v25, v108, v4, 0
  v_dot2_f32_bf16 v25, v109, v5, v25
  v_dot2_f32_bf16 v25, v110, v6, v25
  v_dot2_f32_bf16 v25, v111, v7, v25
  s_xor_b32 s68, s70, 0xc0100
  buffer_load_dwordx4 v[68:71], v63, s[4:7], s68 offen nt
  v_add_f32_dpp v26, v22, v22 row_ror:8 row_mask:0xf bank_mask:0x3
  v_add_f32_dpp v27, v24, v24 row_ror:8 row_mask:0xf bank_mask:0x3
  s_nop 0
  v_add_f32_dpp v26, v23, v23 row_ror:8 row_mask:0xf bank_mask:0xc
  v_add_f32_dpp v27, v25, v25 row_ror:8 row_mask:0xf bank_mask:0xc
  s_nop 0
  v_add_f32_dpp v28, v26, v26 row_half_mirror row_mask:0xf bank_mask:0x5
  s_nop 1
  v_add_f32_dpp v28, v27, v27 row_half_mirror row_mask:0xf bank_mask:0xa
  s_nop 1
  v_add_f32_dpp v28, v28, v28 quad_perm:[1,0,3,2]
  s_nop 1
  v_add_f32_dpp v214, v28, v28 quad_perm:[2,3,0,1]
  v_max_f32 v20, v20, v214
  s_barrier
  s_waitcnt vmcnt(7)
  v_dot2_f32_bf16 v22, v112, v4, 0
  v_dot2_f32_bf16 v22, v113, v5, v22
  v_dot2_f32_bf16 v22, v114, v6, v22
  v_dot2_f32_bf16 v22, v115, v7, v22
  s_xor_b32 s68, s70, 0xc0400
  buffer_load_dwordx4 v[72:75], v63, s[4:7], s68 offen nt
  s_waitcnt vmcnt(6)
  v_dot2_f32_bf16 v23, v116, v4, 0
  v_dot2_f32_bf16 v23, v117, v5, v23
  v_dot2_f32_bf16 v23, v118, v6, v23
  v_dot2_f32_bf16 v23, v119, v7, v23
  s_xor_b32 s68, s70, 0xc0500
  buffer_load_dwordx4 v[76:79], v63, s[4:7], s68 offen nt
  v_and_b32_dpp v48, v46, v40 row_newbcast:4
  v_and_b32_dpp v49, v46, v41 row_newbcast:4
  v_and_b32_dpp v50, v46, v42 row_newbcast:4
  v_and_b32_dpp v51, v46, v43 row_newbcast:4
  s_nop 1
  v_mfma_f32_16x16x32_bf16 v[56:59], v[48:51], a[72:75], v[56:59]
  s_waitcnt vmcnt(6)
  v_dot2_f32_bf16 v24, v120, v4, 0
  v_dot2_f32_bf16 v24, v121, v5, v24
  v_dot2_f32_bf16 v24, v122, v6, v24
  v_dot2_f32_bf16 v24, v123, v7, v24
  s_xor_b32 s68, s70, 0xc0800
  buffer_load_dwordx4 v[80:83], v63, s[4:7], s68 offen nt
  buffer_load_dwordx4 a[84:87], v2, s[24:27], s73 offen
  s_add_u32 s73, s73, 8192
  s_waitcnt vmcnt(7)
  v_dot2_f32_bf16 v25, v124, v4, 0
  v_dot2_f32_bf16 v25, v125, v5, v25
  v_dot2_f32_bf16 v25, v126, v6, v25
  v_dot2_f32_bf16 v25, v127, v7, v25
  s_xor_b32 s68, s70, 0xc0900
  buffer_load_dwordx4 v[84:87], v63, s[4:7], s68 offen nt
  v_add_f32_dpp v26, v22, v22 row_ror:8 row_mask:0xf bank_mask:0x3
  v_add_f32_dpp v27, v24, v24 row_ror:8 row_mask:0xf bank_mask:0x3
  s_nop 0
  v_add_f32_dpp v26, v23, v23 row_ror:8 row_mask:0xf bank_mask:0xc
  v_add_f32_dpp v27, v25, v25 row_ror:8 row_mask:0xf bank_mask:0xc
  s_nop 0
  v_add_f32_dpp v28, v26, v26 row_half_mirror row_mask:0xf bank_mask:0x5
  s_nop 1
  v_add_f32_dpp v28, v27, v27 row_half_mirror row_mask:0xf bank_mask:0xa
  s_nop 1
  v_add_f32_dpp v28, v28, v28 quad_perm:[1,0,3,2]
  s_nop 1
  v_add_f32_dpp v215, v28, v28 quad_perm:[2,3,0,1]
  v_max_f32 v20, v20, v215
  s_barrier
  s_waitcnt vmcnt(7)
  v_dot2_f32_bf16 v22, v64, v4, 0
  v_dot2_f32_bf16 v22, v65, v5, v22
  v_dot2_f32_bf16 v22, v66, v6, v22
  v_dot2_f32_bf16 v22, v67, v7, v22
  s_xor_b32 s68, s70, 0xc0c00
  buffer_load_dwordx4 v[88:91], v63, s[4:7], s68 offen nt
  s_waitcnt vmcnt(6)
  v_dot2_f32_bf16 v23, v68, v4, 0
  v_dot2_f32_bf16 v23, v69, v5, v23
  v_dot2_f32_bf16 v23, v70, v6, v23
  v_dot2_f32_bf16 v23, v71, v7, v23
  s_xor_b32 s68, s70, 0xc0d00
  buffer_load_dwordx4 v[92:95], v63, s[4:7], s68 offen nt
  v_and_b32_dpp v52, v47, v40 row_newbcast:4
  v_and_b32_dpp v53, v47, v41 row_newbcast:4
  v_and_b32_dpp v54, v47, v42 row_newbcast:4
  v_and_b32_dpp v55, v47, v43 row_newbcast:4
  s_nop 1
  v_mfma_f32_16x16x32_bf16 v[56:59], v[52:55], a[76:79], v[56:59]
  s_waitcnt vmcnt(6)
  v_dot2_f32_bf16 v24, v72, v4, 0
  v_dot2_f32_bf16 v24, v73, v5, v24
  v_dot2_f32_bf16 v24, v74, v6, v24
  v_dot2_f32_bf16 v24, v75, v7, v24
  s_xor_b32 s68, s70, 0xd0000
  buffer_load_dwordx4 v[96:99], v63, s[4:7], s68 offen nt
  buffer_load_dwordx4 a[88:91], v2, s[24:27], s73 offen
  s_add_u32 s73, s73, 8192
  s_waitcnt vmcnt(7)
  v_dot2_f32_bf16 v25, v76, v4, 0
  v_dot2_f32_bf16 v25, v77, v5, v25
  v_dot2_f32_bf16 v25, v78, v6, v25
  v_dot2_f32_bf16 v25, v79, v7, v25
  s_xor_b32 s68, s70, 0xd0100
  buffer_load_dwordx4 v[100:103], v63, s[4:7], s68 offen nt
  v_add_f32_dpp v26, v22, v22 row_ror:8 row_mask:0xf bank_mask:0x3
  v_add_f32_dpp v27, v24, v24 row_ror:8 row_mask:0xf bank_mask:0x3
  s_nop 0
  v_add_f32_dpp v26, v23, v23 row_ror:8 row_mask:0xf bank_mask:0xc
  v_add_f32_dpp v27, v25, v25 row_ror:8 row_mask:0xf bank_mask:0xc
  s_nop 0
  v_add_f32_dpp v28, v26, v26 row_half_mirror row_mask:0xf bank_mask:0x5
  s_nop 1
  v_add_f32_dpp v28, v27, v27 row_half_mirror row_mask:0xf bank_mask:0xa
  s_nop 1
  v_add_f32_dpp v28, v28, v28 quad_perm:[1,0,3,2]
  s_nop 1
  v_add_f32_dpp v216, v28, v28 quad_perm:[2,3,0,1]
  v_max_f32 v20, v20, v216
  s_barrier
  s_barrier
  s_cmp_eq_u32 s64, 0
  s_cbranch_scc0 L_wi
  s_mov_b32 s100, 1
  s_add_u32 s101, s88, 32768
  s_atomic_umax s100, s[20:21], s101
L_wi:
  s_waitcnt vmcnt(7)
  v_dot2_f32_bf16 v22, v80, v4, 0
  v_dot2_f32_bf16 v22, v81, v5, v22
  v_dot2_f32_bf16 v22, v82, v6, v22
  v_dot2_f32_bf16 v22, v83, v7, v22
  s_xor_b32 s68, s70, 0xd0400
  buffer_load_dwordx4 v[104:107], v63, s[4:7], s68 offen nt
  s_waitcnt vmcnt(6)
  v_dot2_f32_bf16 v23, v84, v4, 0
  v_dot2_f32_bf16 v23, v85, v5, v23
  v_dot2_f32_bf16 v23, v86, v6, v23
  v_dot2_f32_bf16 v23, v87, v7, v23
  s_xor_b32 s68, s70, 0xd0500
  buffer_load_dwordx4 v[108:111], v63, s[4:7], s68 offen nt
  v_and_b32_dpp v48, v44, v40 row_newbcast:5
  v_and_b32_dpp v49, v44, v41 row_newbcast:5
  v_and_b32_dpp v50, v44, v42 row_newbcast:5
  v_and_b32_dpp v51, v44, v43 row_newbcast:5
  s_nop 1
  v_mfma_f32_16x16x32_bf16 v[56:59], v[48:51], a[80:83], v[56:59]
  s_waitcnt vmcnt(6)
  v_dot2_f32_bf16 v24, v88, v4, 0
  v_dot2_f32_bf16 v24, v89, v5, v24
  v_dot2_f32_bf16 v24, v90, v6, v24
  v_dot2_f32_bf16 v24, v91, v7, v24
  s_xor_b32 s68, s70, 0xd0800
  buffer_load_dwordx4 v[112:115], v63, s[4:7], s68 offen nt
  buffer_load_dwordx4 a[92:95], v2, s[24:27], s73 offen
  s_waitcnt vmcnt(7)
  v_dot2_f32_bf16 v25, v92, v4, 0
  v_dot2_f32_bf16 v25, v93, v5, v25
  v_dot2_f32_bf16 v25, v94, v6, v25
  v_dot2_f32_bf16 v25, v95, v7, v25
  s_xor_b32 s68, s70, 0xd0900
  buffer_load_dwordx4 v[116:119], v63, s[4:7], s68 offen nt
  v_add_f32_dpp v26, v22, v22 row_ror:8 row_mask:0xf bank_mask:0x3
  v_add_f32_dpp v27, v24, v24 row_ror:8 row_mask:0xf bank_mask:0x3
  s_nop 0
  v_add_f32_dpp v26, v23, v23 row_ror:8 row_mask:0xf bank_mask:0xc
  v_add_f32_dpp v27, v25, v25 row_ror:8 row_mask:0xf bank_mask:0xc
  s_nop 0
  v_add_f32_dpp v28, v26, v26 row_half_mirror row_mask:0xf bank_mask:0x5
  s_nop 1
  v_add_f32_dpp v28, v27, v27 row_half_mirror row_mask:0xf bank_mask:0xa
  s_nop 1
  v_add_f32_dpp v28, v28, v28 quad_perm:[1,0,3,2]
  s_nop 1
  v_add_f32_dpp v217, v28, v28 quad_perm:[2,3,0,1]
  v_max_f32 v20, v20, v217
  s_barrier
  s_waitcnt vmcnt(7)
  v_dot2_f32_bf16 v22, v96, v4, 0
  v_dot2_f32_bf16 v22, v97, v5, v22
  v_dot2_f32_bf16 v22, v98, v6, v22
  v_dot2_f32_bf16 v22, v99, v7, v22
  s_xor_b32 s68, s70, 0xd0c00
  buffer_load_dwordx4 v[120:123], v63, s[4:7], s68 offen nt
  s_cmp_eq_u32 s64, 2
  s_cbranch_scc0 L_wp26
  s_mov_b32 s100, 2
  s_atomic_umax s100, s[20:21], s88
  s_and_b32 s60, s88, 0xfffffc7f
  s_xor_b32 s61, s60, 8192
  s_add_u32 s38, s60, 0
  s_load_dword s40, s[20:21], s38 glc
  s_add_u32 s38, s61, 128
  s_load_dword s41, s[20:21], s38 glc
  s_add_u32 s38, s61, 256
  s_load_dword s42, s[20:21], s38 glc
  s_add_u32 s38, s60, 384
  s_load_dword s43, s[20:21], s38 glc
  s_add_u32 s38, s60, 512
  s_load_dword s44, s[20:21], s38 glc
  s_add_u32 s38, s61, 640
  s_load_dword s45, s[20:21], s38 glc
  s_add_u32 s38, s61, 768
  s_load_dword s46, s[20:21], s38 glc
  s_add_u32 s38, s60, 896
  s_load_dword s47, s[20:21], s38 glc
L_wp26:
  s_waitcnt vmcnt(6)
  v_dot2_f32_bf16 v23, v100, v4, 0
  v_dot2_f32_bf16 v23, v101, v5, v23
  v_dot2_f32_bf16 v23, v102, v6, v23
  v_dot2_f32_bf16 v23, v103, v7, v23
  s_xor_b32 s68, s70, 0xd0d00
  buffer_load_dwordx4 v[124:127], v63, s[4:7], s68 offen nt
  v_and_b32_dpp v52, v45, v40 row_newbcast:5
  v_and_b32_dpp v53, v45, v41 row_newbcast:5
  v_and_b32_dpp v54, v45, v42 row_newbcast:5
  v_and_b32_dpp v55, v45, v43 row_newbcast:5
  s_nop 1
  v_mfma_f32_16x16x32_bf16 v[56:59], v[52:55], a[84:87], v[56:59]
  s_waitcnt vmcnt(6)
  v_dot2_f32_bf16 v24, v104, v4, 0
  v_dot2_f32_bf16 v24, v105, v5, v24
  v_dot2_f32_bf16 v24, v106, v6, v24
  v_dot2_f32_bf16 v24, v107, v7, v24
  s_xor_b32 s68, s70, 0xe0000
  buffer_load_dwordx4 v[64:67], v63, s[4:7], s68 offen nt
  s_lshl_b32 s73, s77, 16
  s_add_u32 s73, s73, s72
  buffer_load_dwordx4 a[96:99], v2, s[24:27], s73 offen
  s_add_u32 s73, s73, 8192
  s_waitcnt vmcnt(7)
  v_dot2_f32_bf16 v25, v108, v4, 0
  v_dot2_f32_bf16 v25, v109, v5, v25
  v_dot2_f32_bf16 v25, v110, v6, v25
  v_dot2_f32_bf16 v25, v111, v7, v25
  s_xor_b32 s68, s70, 0xe0100
  buffer_load_dwordx4 v[68:71], v63, s[4:7], s68 offen nt
  v_add_f32_dpp v26, v22, v22 row_ror:8 row_mask:0xf bank_mask:0x3
  v_add_f32_dpp v27, v24, v24 row_ror:8 row_mask:0xf bank_mask:0x3
  s_nop 0
  v_add_f32_dpp v26, v23, v23 row_ror:8 row_mask:0xf bank_mask:0xc
  v_add_f32_dpp v27, v25, v25 row_ror:8 row_mask:0xf bank_mask:0xc
  s_nop 0
  v_add_f32_dpp v28, v26, v26 row_half_mirror row_mask:0xf bank_mask:0x5
  s_nop 1
  v_add_f32_dpp v28, v27, v27 row_half_mirror row_mask:0xf bank_mask:0xa
  s_nop 1
  v_add_f32_dpp v28, v28, v28 quad_perm:[1,0,3,2]
  s_nop 1
  v_add_f32_dpp v218, v28, v28 quad_perm:[2,3,0,1]
  v_max_f32 v20, v20, v218
  s_barrier
  s_waitcnt vmcnt(7)
  v_dot2_f32_bf16 v22, v112, v4, 0
  v_dot2_f32_bf16 v22, v113, v5, v22
  v_dot2_f32_bf16 v22, v114, v6, v22
  v_dot2_f32_bf16 v22, v115, v7, v22
  s_xor_b32 s68, s70, 0xe0400
  buffer_load_dwordx4 v[72:75], v63, s[4:7], s68 offen nt
  s_waitcnt vmcnt(6)
  v_dot2_f32_bf16 v23, v116, v4, 0
  v_dot2_f32_bf16 v23, v117, v5, v23
  v_dot2_f32_bf16 v23, v118, v6, v23
  v_dot2_f32_bf16 v23, v119, v7, v23
  s_xor_b32 s68, s70, 0xe0500
  buffer_load_dwordx4 v[76:79], v63, s[4:7], s68 offen nt
  v_and_b32_dpp v48, v46, v40 row_newbcast:5
  v_and_b32_dpp v49, v46, v41 row_newbcast:5
  v_and_b32_dpp v50, v46, v42 row_newbcast:5
  v_and_b32_dpp v51, v46, v43 row_newbcast:5
  s_nop 1
  v_mfma_f32_16x16x32_bf16 v[56:59], v[48:51], a[88:91], v[56:59]
  s_waitcnt vmcnt(6)
  v_dot2_f32_bf16 v24, v120, v4, 0
  v_dot2_f32_bf16 v24, v121, v5, v24
  v_dot2_f32_bf16 v24, v122, v6, v24
  v_dot2_f32_bf16 v24, v123, v7, v24
  s_xor_b32 s68, s70, 0xe0800
  buffer_load_dwordx4 v[80:83], v63, s[4:7], s68 offen nt
  buffer_load_dwordx4 a[100:103], v2, s[24:27], s73 offen
  s_add_u32 s73, s73, 8192
  s_waitcnt vmcnt(7)
  v_dot2_f32_bf16 v25, v124, v4, 0
  v_dot2_f32_bf16 v25, v125, v5, v25
  v_dot2_f32_bf16 v25, v126, v6, v25
  v_dot2_f32_bf16 v25, v127, v7, v25
  s_xor_b32 s68, s70, 0xe0900
  buffer_load_dwordx4 v[84:87], v63, s[4:7], s68 offen nt
  v_add_f32_dpp v26, v22, v22 row_ror:8 row_mask:0xf bank_mask:0x3
  v_add_f32_dpp v27, v24, v24 row_ror:8 row_mask:0xf bank_mask:0x3
  s_nop 0
  v_add_f32_dpp v26, v23, v23 row_ror:8 row_mask:0xf bank_mask:0xc
  v_add_f32_dpp v27, v25, v25 row_ror:8 row_mask:0xf bank_mask:0xc
  s_nop 0
  v_add_f32_dpp v28, v26, v26 row_half_mirror row_mask:0xf bank_mask:0x5
  s_nop 1
  v_add_f32_dpp v28, v27, v27 row_half_mirror row_mask:0xf bank_mask:0xa
  s_nop 1
  v_add_f32_dpp v28, v28, v28 quad_perm:[1,0,3,2]
  s_nop 1
  v_add_f32_dpp v219, v28, v28 quad_perm:[2,3,0,1]
  v_max_f32 v20, v20, v219
  s_barrier
  s_waitcnt vmcnt(7)
  v_dot2_f32_bf16 v22, v64, v4, 0
  v_dot2_f32_bf16 v22, v65, v5, v22
  v_dot2_f32_bf16 v22, v66, v6, v22
  v_dot2_f32_bf16 v22, v67, v7, v22
  s_xor_b32 s68, s70, 0xe0c00
  buffer_load_dwordx4 v[88:91], v63, s[4:7], s68 offen nt
  s_cmp_eq_u32 s64, 2
  s_cbranch_scc0 L_wp28
  s_mov_b32 s101, 0
  s_waitcnt lgkmcnt(0)
  s_cmp_ge_u32 s40, 2
  s_addc_u32 s101, s101, 0
  s_cmp_ge_u32 s41, 2
  s_addc_u32 s101, s101, 0
  s_cmp_ge_u32 s42, 2
  s_addc_u32 s101, s101, 0
  s_cmp_ge_u32 s43, 2
  s_addc_u32 s101, s101, 0
  s_cmp_ge_u32 s44, 2
  s_addc_u32 s101, s101, 0
  s_cmp_ge_u32 s45, 2
  s_addc_u32 s101, s101, 0
  s_cmp_ge_u32 s46, 2
  s_addc_u32 s101, s101, 0
  s_cmp_ge_u32 s47, 2
  s_addc_u32 s101, s101, 0
  s_cmp_lt_u32 s101, 6
  s_cselect_b32 s38, -1, 0
  v_mov_b32 v26, 0
  v_mov_b32 v27, s38
  ds_write_b32 v26, v27 offset:8512
L_wp28:
  s_waitcnt vmcnt(6)
  v_dot2_f32_bf16 v23, v68, v4, 0
  v_dot2_f32_bf16 v23, v69, v5, v23
  v_dot2_f32_bf16 v23, v70, v6, v23
  v_dot2_f32_bf16 v23, v71, v7, v23
  s_xor_b32 s68, s70, 0xe0d00
  buffer_load_dwordx4 v[92:95], v63, s[4:7], s68 offen nt
  v_and_b32_dpp v52, v47, v40 row_newbcast:5
  v_and_b32_dpp v53, v47, v41 row_newbcast:5
  v_and_b32_dpp v54, v47, v42 row_newbcast:5
  v_and_b32_dpp v55, v47, v43 row_newbcast:5
  s_nop 1
  v_mfma_f32_16x16x32_bf16 v[56:59], v[52:55], a[92:95], v[56:59]
  s_waitcnt vmcnt(6)
  v_dot2_f32_bf16 v24, v72, v4, 0
  v_dot2_f32_bf16 v24, v73, v5, v24
  v_dot2_f32_bf16 v24, v74, v6, v24
  v_dot2_f32_bf16 v24, v75, v7, v24
  s_xor_b32 s68, s70, 0xf0000
  buffer_load_dwordx4 v[96:99], v63, s[4:7], s68 offen nt
  buffer_load_dwordx4 a[104:107], v2, s[24:27], s73 offen
  s_add_u32 s73, s73, 8192
  s_waitcnt vmcnt(7)
  v_dot2_f32_bf16 v25, v76, v4, 0
  v_dot2_f32_bf16 v25, v77, v5, v25
  v_dot2_f32_bf16 v25, v78, v6, v25
  v_dot2_f32_bf16 v25, v79, v7, v25
  s_xor_b32 s68, s70, 0xf0100
  buffer_load_dwordx4 v[100:103], v63, s[4:7], s68 offen nt
  v_add_f32_dpp v26, v22, v22 row_ror:8 row_mask:0xf bank_mask:0x3
  v_add_f32_dpp v27, v24, v24 row_ror:8 row_mask:0xf bank_mask:0x3
  s_nop 0
  v_add_f32_dpp v26, v23, v23 row_ror:8 row_mask:0xf bank_mask:0xc
  v_add_f32_dpp v27, v25, v25 row_ror:8 row_mask:0xf bank_mask:0xc
  s_nop 0
  v_add_f32_dpp v28, v26, v26 row_half_mirror row_mask:0xf bank_mask:0x5
  s_nop 1
  v_add_f32_dpp v28, v27, v27 row_half_mirror row_mask:0xf bank_mask:0xa
  s_nop 1
  v_add_f32_dpp v28, v28, v28 quad_perm:[1,0,3,2]
  s_nop 1
  v_add_f32_dpp v220, v28, v28 quad_perm:[2,3,0,1]
  v_max_f32 v20, v20, v220
  s_barrier
  s_waitcnt vmcnt(7)
  v_dot2_f32_bf16 v22, v80, v4, 0
  v_dot2_f32_bf16 v22, v81, v5, v22
  v_dot2_f32_bf16 v22, v82, v6, v22
  v_dot2_f32_bf16 v22, v83, v7, v22
  s_xor_b32 s68, s70, 0xf0400
  buffer_load_dwordx4 v[104:107], v63, s[4:7], s68 offen nt
  v_mov_b32 v26, 0
  ds_read_b32 v35, v26 offset:8512
  s_waitcnt vmcnt(6)
  v_dot2_f32_bf16 v23, v84, v4, 0
  v_dot2_f32_bf16 v23, v85, v5, v23
  v_dot2_f32_bf16 v23, v86, v6, v23
  v_dot2_f32_bf16 v23, v87, v7, v23
  s_xor_b32 s68, s70, 0xf0500
  buffer_load_dwordx4 v[108:111], v63, s[4:7], s68 offen nt
  v_and_b32_dpp v48, v44, v40 row_newbcast:6
  v_and_b32_dpp v49, v44, v41 row_newbcast:6
  v_and_b32_dpp v50, v44, v42 row_newbcast:6
  v_and_b32_dpp v51, v44, v43 row_newbcast:6
  s_nop 1
  v_mfma_f32_16x16x32_bf16 v[56:59], v[48:51], a[96:99], v[56:59]
  s_waitcnt vmcnt(6)
  v_dot2_f32_bf16 v24, v88, v4, 0
  v_dot2_f32_bf16 v24, v89, v5, v24
  v_dot2_f32_bf16 v24, v90, v6, v24
  v_dot2_f32_bf16 v24, v91, v7, v24
  s_xor_b32 s68, s70, 0xf0800
  buffer_load_dwordx4 v[112:115], v63, s[4:7], s68 offen nt
  buffer_load_dwordx4 a[108:111], v2, s[24:27], s73 offen
  s_add_u32 s73, s73, 8192
  s_waitcnt vmcnt(7)
  v_dot2_f32_bf16 v25, v92, v4, 0
  v_dot2_f32_bf16 v25, v93, v5, v25
  v_dot2_f32_bf16 v25, v94, v6, v25
  v_dot2_f32_bf16 v25, v95, v7, v25
  s_xor_b32 s68, s70, 0xf0900
  buffer_load_dwordx4 v[116:119], v63, s[4:7], s68 offen nt
  v_add_f32_dpp v26, v22, v22 row_ror:8 row_mask:0xf bank_mask:0x3
  v_add_f32_dpp v27, v24, v24 row_ror:8 row_mask:0xf bank_mask:0x3
  s_nop 0
  v_add_f32_dpp v26, v23, v23 row_ror:8 row_mask:0xf bank_mask:0xc
  v_add_f32_dpp v27, v25, v25 row_ror:8 row_mask:0xf bank_mask:0xc
  s_nop 0
  v_add_f32_dpp v28, v26, v26 row_half_mirror row_mask:0xf bank_mask:0x5
  s_nop 1
  v_add_f32_dpp v28, v27, v27 row_half_mirror row_mask:0xf bank_mask:0xa
  s_nop 1
  v_add_f32_dpp v28, v28, v28 quad_perm:[1,0,3,2]
  s_nop 1
  v_add_f32_dpp v221, v28, v28 quad_perm:[2,3,0,1]
  v_max_f32 v20, v20, v221
  s_barrier
  s_waitcnt vmcnt(7)
  v_dot2_f32_bf16 v22, v96, v4, 0
  v_dot2_f32_bf16 v22, v97, v5, v22
  v_dot2_f32_bf16 v22, v98, v6, v22
  v_dot2_f32_bf16 v22, v99, v7, v22
  s_cbranch_vccz L_d120
  s_waitcnt vmcnt(5)
L_d120:
  s_xor_b32 s68, s70, 0xf0c00
  buffer_load_dwordx4 v[120:123], v63, s[4:7], s68 offen nt
  s_waitcnt lgkmcnt(0)
  v_cmp_ne_u32 vcc, 0, v35
  s_waitcnt vmcnt(6)
  v_dot2_f32_bf16 v23, v100, v4, 0
  v_dot2_f32_bf16 v23, v101, v5, v23
  v_dot2_f32_bf16 v23, v102, v6, v23
  v_dot2_f32_bf16 v23, v103, v7, v23
  s_cbranch_vccz L_d121
  s_waitcnt vmcnt(5)
L_d121:
  s_xor_b32 s68, s70, 0xf0d00
  buffer_load_dwordx4 v[124:127], v63, s[4:7], s68 offen nt
  v_and_b32_dpp v52, v45, v40 row_newbcast:6
  v_and_b32_dpp v53, v45, v41 row_newbcast:6
  v_and_b32_dpp v54, v45, v42 row_newbcast:6
  v_and_b32_dpp v55, v45, v43 row_newbcast:6
  s_nop 1
  v_mfma_f32_16x16x32_bf16 v[56:59], v[52:55], a[100:103], v[56:59]
  s_waitcnt vmcnt(6)
  v_dot2_f32_bf16 v24, v104, v4, 0
  v_dot2_f32_bf16 v24, v105, v5, v24
  v_dot2_f32_bf16 v24, v106, v6, v24
  v_dot2_f32_bf16 v24, v107, v7, v24
  s_cbranch_vccz L_d122
  s_waitcnt vmcnt(5)
L_d122:
  s_xor_b32 s68, s70, 0x4000
  buffer_load_dwordx4 v[64:67], v63, s[4:7], s68 offen nt
  buffer_load_dwordx4 a[112:115], v2, s[24:27], s73 offen
  s_add_u32 s73, s73, 8192
  s_waitcnt vmcnt(7)
  v_dot2_f32_bf16 v25, v108, v4, 0
  v_dot2_f32_bf16 v25, v109, v5, v25
  v_dot2_f32_bf16 v25, v110, v6, v25
  v_dot2_f32_bf16 v25, v111, v7, v25
  s_cbranch_vccz L_d123
  s_waitcnt vmcnt(6)
L_d123:
  s_xor_b32 s68, s70, 0x4100
  buffer_load_dwordx4 v[68:71], v63, s[4:7], s68 offen nt
  v_add_f32_dpp v26, v22, v22 row_ror:8 row_mask:0xf bank_mask:0x3
  v_add_f32_dpp v27, v24, v24 row_ror:8 row_mask:0xf bank_mask:0x3
  s_nop 0
  v_add_f32_dpp v26, v23, v23 row_ror:8 row_mask:0xf bank_mask:0xc
  v_add_f32_dpp v27, v25, v25 row_ror:8 row_mask:0xf bank_mask:0xc
  s_nop 0
  v_add_f32_dpp v28, v26, v26 row_half_mirror row_mask:0xf bank_mask:0x5
  s_nop 1
  v_add_f32_dpp v28, v27, v27 row_half_mirror row_mask:0xf bank_mask:0xa
  s_nop 1
  v_add_f32_dpp v28, v28, v28 quad_perm:[1,0,3,2]
  s_nop 1
  v_add_f32_dpp v222, v28, v28 quad_perm:[2,3,0,1]
  v_max_f32 v20, v20, v222
  s_barrier
  s_waitcnt vmcnt(7)
  v_dot2_f32_bf16 v22, v112, v4, 0
  v_dot2_f32_bf16 v22, v113, v5, v22
  v_dot2_f32_bf16 v22, v114, v6, v22
  v_dot2_f32_bf16 v22, v115, v7, v22
  s_cbranch_vccz L_d124
  s_waitcnt vmcnt(5)
L_d124:
  s_xor_b32 s68, s70, 0x4400
  buffer_load_dwordx4 v[72:75], v63, s[4:7], s68 offen nt
  s_waitcnt vmcnt(6)
  v_dot2_f32_bf16 v23, v116, v4, 0
  v_dot2_f32_bf16 v23, v117, v5, v23
  v_dot2_f32_bf16 v23, v118, v6, v23
  v_dot2_f32_bf16 v23, v119, v7, v23
  s_cbranch_vccz L_d125
  s_waitcnt vmcnt(5)
L_d125:
  s_xor_b32 s68, s70, 0x4500
  buffer_load_dwordx4 v[76:79], v63, s[4:7], s68 offen nt
  v_and_b32_dpp v48, v46, v40 row_newbcast:6
  v_and_b32_dpp v49, v46, v41 row_newbcast:6
  v_and_b32_dpp v50, v46, v42 row_newbcast:6
  v_and_b32_dpp v51, v46, v43 row_newbcast:6
  s_nop 1
  v_mfma_f32_16x16x32_bf16 v[56:59], v[48:51], a[104:107], v[56:59]
  s_waitcnt vmcnt(6)
  v_dot2_f32_bf16 v24, v120, v4, 0
  v_dot2_f32_bf16 v24, v121, v5, v24
  v_dot2_f32_bf16 v24, v122, v6, v24
  v_dot2_f32_bf16 v24, v123, v7, v24
  s_cbranch_vccz L_d126
  s_waitcnt vmcnt(5)
L_d126:
  s_xor_b32 s68, s70, 0x4800
  buffer_load_dwordx4 v[80:83], v63, s[4:7], s68 offen nt
  buffer_load_dwordx4 a[116:119], v2, s[24:27], s73 offen
  s_add_u32 s73, s73, 8192
  s_waitcnt vmcnt(7)
  v_dot2_f32_bf16 v25, v124, v4, 0
  v_dot2_f32_bf16 v25, v125, v5, v25
  v_dot2_f32_bf16 v25, v126, v6, v25
  v_dot2_f32_bf16 v25, v127, v7, v25
  s_cbranch_vccz L_d127
  s_waitcnt vmcnt(6)
L_d127:
  s_xor_b32 s68, s70, 0x4900
  buffer_load_dwordx4 v[84:87], v63, s[4:7], s68 offen nt
  v_add_f32_dpp v26, v22, v22 row_ror:8 row_mask:0xf bank_mask:0x3
  v_add_f32_dpp v27, v24, v24 row_ror:8 row_mask:0xf bank_mask:0x3
  s_nop 0
  v_add_f32_dpp v26, v23, v23 row_ror:8 row_mask:0xf bank_mask:0xc
  v_add_f32_dpp v27, v25, v25 row_ror:8 row_mask:0xf bank_mask:0xc
  s_nop 0
  v_add_f32_dpp v28, v26, v26 row_half_mirror row_mask:0xf bank_mask:0x5
  s_nop 1
  v_add_f32_dpp v28, v27, v27 row_half_mirror row_mask:0xf bank_mask:0xa
  s_nop 1
  v_add_f32_dpp v28, v28, v28 quad_perm:[1,0,3,2]
  s_nop 1
  v_add_f32_dpp v223, v28, v28 quad_perm:[2,3,0,1]
  v_max_f32 v20, v20, v223
  s_barrier
  s_waitcnt vmcnt(7)
  v_dot2_f32_bf16 v22, v64, v4, 0
  v_dot2_f32_bf16 v22, v65, v5, v22
  v_dot2_f32_bf16 v22, v66, v6, v22
  v_dot2_f32_bf16 v22, v67, v7, v22
  s_cbranch_vccz L_d128
  s_waitcnt vmcnt(5)
L_d128:
  s_xor_b32 s68, s70, 0x4c00
  buffer_load_dwordx4 v[88:91], v63, s[4:7], s68 offen nt
  s_waitcnt vmcnt(6)
  v_dot2_f32_bf16 v23, v68, v4, 0
  v_dot2_f32_bf16 v23, v69, v5, v23
  v_dot2_f32_bf16 v23, v70, v6, v23
  v_dot2_f32_bf16 v23, v71, v7, v23
  s_cbranch_vccz L_d129
  s_waitcnt vmcnt(5)
L_d129:
  s_xor_b32 s68, s70, 0x4d00
  buffer_load_dwordx4 v[92:95], v63, s[4:7], s68 offen nt
  v_and_b32_dpp v52, v47, v40 row_newbcast:6
  v_and_b32_dpp v53, v47, v41 row_newbcast:6
  v_and_b32_dpp v54, v47, v42 row_newbcast:6
  v_and_b32_dpp v55, v47, v43 row_newbcast:6
  s_nop 1
  v_mfma_f32_16x16x32_bf16 v[56:59], v[52:55], a[108:111], v[56:59]
  s_waitcnt vmcnt(6)
  v_dot2_f32_bf16 v24, v72, v4, 0
  v_dot2_f32_bf16 v24, v73, v5, v24
  v_dot2_f32_bf16 v24, v74, v6, v24
  v_dot2_f32_bf16 v24, v75, v7, v24
  s_cbranch_vccz L_d130
  s_waitcnt vmcnt(5)
L_d130:
  s_xor_b32 s68, s70, 0x14000
  buffer_load_dwordx4 v[96:99], v63, s[4:7], s68 offen nt
  buffer_load_dwordx4 a[120:123], v2, s[24:27], s73 offen
  s_add_u32 s73, s73, 8192
  s_waitcnt vmcnt(7)
  v_dot2_f32_bf16 v25, v76, v4, 0
  v_dot2_f32_bf16 v25, v77, v5, v25
  v_dot2_f32_bf16 v25, v78, v6, v25
  v_dot2_f32_bf16 v25, v79, v7, v25
  s_cbranch_vccz L_d131
  s_waitcnt vmcnt(6)
L_d131:
  s_xor_b32 s68, s70, 0x14100
  buffer_load_dwordx4 v[100:103], v63, s[4:7], s68 offen nt
  v_add_f32_dpp v26, v22, v22 row_ror:8 row_mask:0xf bank_mask:0x3
  v_add_f32_dpp v27, v24, v24 row_ror:8 row_mask:0xf bank_mask:0x3
  s_nop 0
  v_add_f32_dpp v26, v23, v23 row_ror:8 row_mask:0xf bank_mask:0xc
  v_add_f32_dpp v27, v25, v25 row_ror:8 row_mask:0xf bank_mask:0xc
  s_nop 0
  v_add_f32_dpp v28, v26, v26 row_half_mirror row_mask:0xf bank_mask:0x5
  s_nop 1
  v_add_f32_dpp v28, v27, v27 row_half_mirror row_mask:0xf bank_mask:0xa
  s_nop 1
  v_add_f32_dpp v28, v28, v28 quad_perm:[1,0,3,2]
  s_nop 1
  v_add_f32_dpp v224, v28, v28 quad_perm:[2,3,0,1]
  v_max_f32 v20, v20, v224
  s_barrier
  s_waitcnt vmcnt(7)
  v_dot2_f32_bf16 v22, v80, v4, 0
  v_dot2_f32_bf16 v22, v81, v5, v22
  v_dot2_f32_bf16 v22, v82, v6, v22
  v_dot2_f32_bf16 v22, v83, v7, v22
  s_cbranch_vccz L_d132
  s_waitcnt vmcnt(5)
L_d132:
  s_xor_b32 s68, s70, 0x14400
  buffer_load_dwordx4 v[104:107], v63, s[4:7], s68 offen nt
  s_waitcnt vmcnt(6)
  v_dot2_f32_bf16 v23, v84, v4, 0
  v_dot2_f32_bf16 v23, v85, v5, v23
  v_dot2_f32_bf16 v23, v86, v6, v23
  v_dot2_f32_bf16 v23, v87, v7, v23
  s_cbranch_vccz L_d133
  s_waitcnt vmcnt(5)
L_d133:
  s_xor_b32 s68, s70, 0x14500
  buffer_load_dwordx4 v[108:111], v63, s[4:7], s68 offen nt
  v_and_b32_dpp v48, v44, v40 row_newbcast:7
  v_and_b32_dpp v49, v44, v41 row_newbcast:7
  v_and_b32_dpp v50, v44, v42 row_newbcast:7
  v_and_b32_dpp v51, v44, v43 row_newbcast:7
  s_nop 1
  v_mfma_f32_16x16x32_bf16 v[56:59], v[48:51], a[112:115], v[56:59]
  s_waitcnt vmcnt(6)
  v_dot2_f32_bf16 v24, v88, v4, 0
  v_dot2_f32_bf16 v24, v89, v5, v24
  v_dot2_f32_bf16 v24, v90, v6, v24
  v_dot2_f32_bf16 v24, v91, v7, v24
  s_cbranch_vccz L_d134
  s_waitcnt vmcnt(5)
L_d134:
  s_xor_b32 s68, s70, 0x14800
  buffer_load_dwordx4 v[112:115], v63, s[4:7], s68 offen nt
  buffer_load_dwordx4 a[124:127], v2, s[24:27], s73 offen
  s_waitcnt vmcnt(7)
  v_dot2_f32_bf16 v25, v92, v4, 0
  v_dot2_f32_bf16 v25, v93, v5, v25
  v_dot2_f32_bf16 v25, v94, v6, v25
  v_dot2_f32_bf16 v25, v95, v7, v25
  s_cbranch_vccz L_d135
  s_waitcnt vmcnt(6)
L_d135:
  s_xor_b32 s68, s70, 0x14900
  buffer_load_dwordx4 v[116:119], v63, s[4:7], s68 offen nt
  v_add_f32_dpp v26, v22, v22 row_ror:8 row_mask:0xf bank_mask:0x3
  v_add_f32_dpp v27, v24, v24 row_ror:8 row_mask:0xf bank_mask:0x3
  s_nop 0
  v_add_f32_dpp v26, v23, v23 row_ror:8 row_mask:0xf bank_mask:0xc
  v_add_f32_dpp v27, v25, v25 row_ror:8 row_mask:0xf bank_mask:0xc
  s_nop 0
  v_add_f32_dpp v28, v26, v26 row_half_mirror row_mask:0xf bank_mask:0x5
  s_nop 1
  v_add_f32_dpp v28, v27, v27 row_half_mirror row_mask:0xf bank_mask:0xa
  s_nop 1
  v_add_f32_dpp v28, v28, v28 quad_perm:[1,0,3,2]
  s_nop 1
  v_add_f32_dpp v225, v28, v28 quad_perm:[2,3,0,1]
  v_max_f32 v20, v20, v225
  s_barrier
  s_waitcnt vmcnt(7)
  v_dot2_f32_bf16 v22, v96, v4, 0
  v_dot2_f32_bf16 v22, v97, v5, v22
  v_dot2_f32_bf16 v22, v98, v6, v22
  v_dot2_f32_bf16 v22, v99, v7, v22
  s_cbranch_vccz L_d136
  s_waitcnt vmcnt(5)
L_d136:
  s_xor_b32 s68, s70, 0x14c00
  buffer_load_dwordx4 v[120:123], v63, s[4:7], s68 offen nt
  s_waitcnt vmcnt(6)
  v_dot2_f32_bf16 v23, v100, v4, 0
  v_dot2_f32_bf16 v23, v101, v5, v23
  v_dot2_f32_bf16 v23, v102, v6, v23
  v_dot2_f32_bf16 v23, v103, v7, v23
  s_cbranch_vccz L_d137
  s_waitcnt vmcnt(5)
L_d137:
  s_xor_b32 s68, s70, 0x14d00
  buffer_load_dwordx4 v[124:127], v63, s[4:7], s68 offen nt
  v_and_b32_dpp v52, v45, v40 row_newbcast:7
  v_and_b32_dpp v53, v45, v41 row_newbcast:7
  v_and_b32_dpp v54, v45, v42 row_newbcast:7
  v_and_b32_dpp v55, v45, v43 row_newbcast:7
  s_nop 1
  v_mfma_f32_16x16x32_bf16 v[56:59], v[52:55], a[116:119], v[56:59]
  s_waitcnt vmcnt(6)
  v_dot2_f32_bf16 v24, v104, v4, 0
  v_dot2_f32_bf16 v24, v105, v5, v24
  v_dot2_f32_bf16 v24, v106, v6, v24
  v_dot2_f32_bf16 v24, v107, v7, v24
  s_cbranch_vccz L_d138
  s_waitcnt vmcnt(5)
L_d138:
  s_xor_b32 s68, s70, 0x24000
  buffer_load_dwordx4 v[64:67], v63, s[4:7], s68 offen nt
  s_lshl_b32 s73, s78, 16
  s_add_u32 s73, s73, s72
  buffer_load_dwordx4 a[128:131], v2, s[24:27], s73 offen
  s_add_u32 s73, s73, 8192
  s_waitcnt vmcnt(7)
  v_dot2_f32_bf16 v25, v108, v4, 0
  v_dot2_f32_bf16 v25, v109, v5, v25
  v_dot2_f32_bf16 v25, v110, v6, v25
  v_dot2_f32_bf16 v25, v111, v7, v25
  s_cbranch_vccz L_d139
  s_waitcnt vmcnt(6)
L_d139:
  s_xor_b32 s68, s70, 0x24100
  buffer_load_dwordx4 v[68:71], v63, s[4:7], s68 offen nt
  v_add_f32_dpp v26, v22, v22 row_ror:8 row_mask:0xf bank_mask:0x3
  v_add_f32_dpp v27, v24, v24 row_ror:8 row_mask:0xf bank_mask:0x3
  s_nop 0
  v_add_f32_dpp v26, v23, v23 row_ror:8 row_mask:0xf bank_mask:0xc
  v_add_f32_dpp v27, v25, v25 row_ror:8 row_mask:0xf bank_mask:0xc
  s_nop 0
  v_add_f32_dpp v28, v26, v26 row_half_mirror row_mask:0xf bank_mask:0x5
  s_nop 1
  v_add_f32_dpp v28, v27, v27 row_half_mirror row_mask:0xf bank_mask:0xa
  s_nop 1
  v_add_f32_dpp v28, v28, v28 quad_perm:[1,0,3,2]
  s_nop 1
  v_add_f32_dpp v226, v28, v28 quad_perm:[2,3,0,1]
  v_max_f32 v20, v20, v226
  s_barrier
  s_waitcnt vmcnt(7)
  v_dot2_f32_bf16 v22, v112, v4, 0
  v_dot2_f32_bf16 v22, v113, v5, v22
  v_dot2_f32_bf16 v22, v114, v6, v22
  v_dot2_f32_bf16 v22, v115, v7, v22
  s_cbranch_vccz L_d140
  s_waitcnt vmcnt(5)
L_d140:
  s_xor_b32 s68, s70, 0x24400
  buffer_load_dwordx4 v[72:75], v63, s[4:7], s68 offen nt
  s_waitcnt vmcnt(6)
  v_dot2_f32_bf16 v23, v116, v4, 0
  v_dot2_f32_bf16 v23, v117, v5, v23
  v_dot2_f32_bf16 v23, v118, v6, v23
  v_dot2_f32_bf16 v23, v119, v7, v23
  s_cbranch_vccz L_d141
  s_waitcnt vmcnt(5)
L_d141:
  s_xor_b32 s68, s70, 0x24500
  buffer_load_dwordx4 v[76:79], v63, s[4:7], s68 offen nt
  v_and_b32_dpp v48, v46, v40 row_newbcast:7
  v_and_b32_dpp v49, v46, v41 row_newbcast:7
  v_and_b32_dpp v50, v46, v42 row_newbcast:7
  v_and_b32_dpp v51, v46, v43 row_newbcast:7
  s_nop 1
  v_mfma_f32_16x16x32_bf16 v[56:59], v[48:51], a[120:123], v[56:59]
  s_waitcnt vmcnt(6)
  v_dot2_f32_bf16 v24, v120, v4, 0
  v_dot2_f32_bf16 v24, v121, v5, v24
  v_dot2_f32_bf16 v24, v122, v6, v24
  v_dot2_f32_bf16 v24, v123, v7, v24
  s_cbranch_vccz L_d142
  s_waitcnt vmcnt(5)
L_d142:
  s_xor_b32 s68, s70, 0x24800
  buffer_load_dwordx4 v[80:83], v63, s[4:7], s68 offen nt
  buffer_load_dwordx4 a[132:135], v2, s[24:27], s73 offen
  s_add_u32 s73, s73, 8192
  s_waitcnt vmcnt(7)
  v_dot2_f32_bf16 v25, v124, v4, 0
  v_dot2_f32_bf16 v25, v125, v5, v25
  v_dot2_f32_bf16 v25, v126, v6, v25
  v_dot2_f32_bf16 v25, v127, v7, v25
  s_cbranch_vccz L_d143
  s_waitcnt vmcnt(6)
L_d143:
  s_xor_b32 s68, s70, 0x24900
  buffer_load_dwordx4 v[84:87], v63, s[4:7], s68 offen nt
  v_add_f32_dpp v26, v22, v22 row_ror:8 row_mask:0xf bank_mask:0x3
  v_add_f32_dpp v27, v24, v24 row_ror:8 row_mask:0xf bank_mask:0x3
  s_nop 0
  v_add_f32_dpp v26, v23, v23 row_ror:8 row_mask:0xf bank_mask:0xc
  v_add_f32_dpp v27, v25, v25 row_ror:8 row_mask:0xf bank_mask:0xc
  s_nop 0
  v_add_f32_dpp v28, v26, v26 row_half_mirror row_mask:0xf bank_mask:0x5
  s_nop 1
  v_add_f32_dpp v28, v27, v27 row_half_mirror row_mask:0xf bank_mask:0xa
  s_nop 1
  v_add_f32_dpp v28, v28, v28 quad_perm:[1,0,3,2]
  s_nop 1
  v_add_f32_dpp v227, v28, v28 quad_perm:[2,3,0,1]
  v_max_f32 v20, v20, v227
  s_barrier
  s_waitcnt vmcnt(7)
  v_dot2_f32_bf16 v22, v64, v4, 0
  v_dot2_f32_bf16 v22, v65, v5, v22
  v_dot2_f32_bf16 v22, v66, v6, v22
  v_dot2_f32_bf16 v22, v67, v7, v22
  s_cbranch_vccz L_d144
  s_waitcnt vmcnt(5)
L_d144:
  s_xor_b32 s68, s70, 0x24c00
  buffer_load_dwordx4 v[88:91], v63, s[4:7], s68 offen nt
  s_waitcnt vmcnt(6)
  v_dot2_f32_bf16 v23, v68, v4, 0
  v_dot2_f32_bf16 v23, v69, v5, v23
  v_dot2_f32_bf16 v23, v70, v6, v23
  v_dot2_f32_bf16 v23, v71, v7, v23
  s_cbranch_vccz L_d145
  s_waitcnt vmcnt(5)
L_d145:
  s_xor_b32 s68, s70, 0x24d00
  buffer_load_dwordx4 v[92:95], v63, s[4:7], s68 offen nt
  v_and_b32_dpp v52, v47, v40 row_newbcast:7
  v_and_b32_dpp v53, v47, v41 row_newbcast:7
  v_and_b32_dpp v54, v47, v42 row_newbcast:7
  v_and_b32_dpp v55, v47, v43 row_newbcast:7
  s_nop 1
  v_mfma_f32_16x16x32_bf16 v[56:59], v[52:55], a[124:127], v[56:59]
  s_waitcnt vmcnt(6)
  v_dot2_f32_bf16 v24, v72, v4, 0
  v_dot2_f32_bf16 v24, v73, v5, v24
  v_dot2_f32_bf16 v24, v74, v6, v24
  v_dot2_f32_bf16 v24, v75, v7, v24
  s_cbranch_vccz L_d146
  s_waitcnt vmcnt(5)
L_d146:
  s_xor_b32 s68, s70, 0x34000
  buffer_load_dwordx4 v[96:99], v63, s[4:7], s68 offen nt
  buffer_load_dwordx4 a[136:139], v2, s[24:27], s73 offen
  s_add_u32 s73, s73, 8192
  s_waitcnt vmcnt(7)
  v_dot2_f32_bf16 v25, v76, v4, 0
  v_dot2_f32_bf16 v25, v77, v5, v25
  v_dot2_f32_bf16 v25, v78, v6, v25
  v_dot2_f32_bf16 v25, v79, v7, v25
  s_cbranch_vccz L_d147
  s_waitcnt vmcnt(6)
L_d147:
  s_xor_b32 s68, s70, 0x34100
  buffer_load_dwordx4 v[100:103], v63, s[4:7], s68 offen nt
  v_add_f32_dpp v26, v22, v22 row_ror:8 row_mask:0xf bank_mask:0x3
  v_add_f32_dpp v27, v24, v24 row_ror:8 row_mask:0xf bank_mask:0x3
  s_nop 0
  v_add_f32_dpp v26, v23, v23 row_ror:8 row_mask:0xf bank_mask:0xc
  v_add_f32_dpp v27, v25, v25 row_ror:8 row_mask:0xf bank_mask:0xc
  s_nop 0
  v_add_f32_dpp v28, v26, v26 row_half_mirror row_mask:0xf bank_mask:0x5
  s_nop 1
  v_add_f32_dpp v28, v27, v27 row_half_mirror row_mask:0xf bank_mask:0xa
  s_nop 1
  v_add_f32_dpp v28, v28, v28 quad_perm:[1,0,3,2]
  s_nop 1
  v_add_f32_dpp v228, v28, v28 quad_perm:[2,3,0,1]
  v_max_f32 v20, v20, v228
  s_barrier
  s_waitcnt vmcnt(7)
  v_dot2_f32_bf16 v22, v80, v4, 0
  v_dot2_f32_bf16 v22, v81, v5, v22
  v_dot2_f32_bf16 v22, v82, v6, v22
  v_dot2_f32_bf16 v22, v83, v7, v22
  s_cbranch_vccz L_d148
  s_waitcnt vmcnt(5)
L_d148:
  s_xor_b32 s68, s70, 0x34400
  buffer_load_dwordx4 v[104:107], v63, s[4:7], s68 offen nt
  s_waitcnt vmcnt(6)
  v_dot2_f32_bf16 v23, v84, v4, 0
  v_dot2_f32_bf16 v23, v85, v5, v23
  v_dot2_f32_bf16 v23, v86, v6, v23
  v_dot2_f32_bf16 v23, v87, v7, v23
  s_cbranch_vccz L_d149
  s_waitcnt vmcnt(5)
L_d149:
  s_xor_b32 s68, s70, 0x34500
  buffer_load_dwordx4 v[108:111], v63, s[4:7], s68 offen nt
  v_and_b32_dpp v48, v44, v40 row_newbcast:8
  v_and_b32_dpp v49, v44, v41 row_newbcast:8
  v_and_b32_dpp v50, v44, v42 row_newbcast:8
  v_and_b32_dpp v51, v44, v43 row_newbcast:8
  s_nop 1
  v_mfma_f32_16x16x32_bf16 v[56:59], v[48:51], a[128:131], v[56:59]
  s_waitcnt vmcnt(6)
  v_dot2_f32_bf16 v24, v88, v4, 0
  v_dot2_f32_bf16 v24, v89, v5, v24
  v_dot2_f32_bf16 v24, v90, v6, v24
  v_dot2_f32_bf16 v24, v91, v7, v24
  s_cbranch_vccz L_d150
  s_waitcnt vmcnt(5)
L_d150:
  s_xor_b32 s68, s70, 0x34800
  buffer_load_dwordx4 v[112:115], v63, s[4:7], s68 offen nt
  buffer_load_dwordx4 a[140:143], v2, s[24:27], s73 offen
  s_add_u32 s73, s73, 8192
  s_waitcnt vmcnt(7)
  v_dot2_f32_bf16 v25, v92, v4, 0
  v_dot2_f32_bf16 v25, v93, v5, v25
  v_dot2_f32_bf16 v25, v94, v6, v25
  v_dot2_f32_bf16 v25, v95, v7, v25
  s_cbranch_vccz L_d151
  s_waitcnt vmcnt(6)
L_d151:
  s_xor_b32 s68, s70, 0x34900
  buffer_load_dwordx4 v[116:119], v63, s[4:7], s68 offen nt
  v_add_f32_dpp v26, v22, v22 row_ror:8 row_mask:0xf bank_mask:0x3
  v_add_f32_dpp v27, v24, v24 row_ror:8 row_mask:0xf bank_mask:0x3
  s_nop 0
  v_add_f32_dpp v26, v23, v23 row_ror:8 row_mask:0xf bank_mask:0xc
  v_add_f32_dpp v27, v25, v25 row_ror:8 row_mask:0xf bank_mask:0xc
  s_nop 0
  v_add_f32_dpp v28, v26, v26 row_half_mirror row_mask:0xf bank_mask:0x5
  s_nop 1
  v_add_f32_dpp v28, v27, v27 row_half_mirror row_mask:0xf bank_mask:0xa
  s_nop 1
  v_add_f32_dpp v28, v28, v28 quad_perm:[1,0,3,2]
  s_nop 1
  v_add_f32_dpp v229, v28, v28 quad_perm:[2,3,0,1]
  v_max_f32 v20, v20, v229
  s_barrier
  s_waitcnt vmcnt(7)
  v_dot2_f32_bf16 v22, v96, v4, 0
  v_dot2_f32_bf16 v22, v97, v5, v22
  v_dot2_f32_bf16 v22, v98, v6, v22
  v_dot2_f32_bf16 v22, v99, v7, v22
  s_cbranch_vccz L_d152
  s_waitcnt vmcnt(5)
L_d152:
  s_xor_b32 s68, s70, 0x34c00
  buffer_load_dwordx4 v[120:123], v63, s[4:7], s68 offen nt
  s_cmp_eq_u32 s64, 3
  s_cbranch_scc0 L_wp38
  s_mov_b32 s100, 3
  s_atomic_umax s100, s[20:21], s88
  s_and_b32 s60, s88, 0xfffffc7f
  s_xor_b32 s61, s60, 16384
  s_add_u32 s38, s61, 0
  s_load_dword s40, s[20:21], s38 glc
  s_add_u32 s38, s60, 128
  s_load_dword s41, s[20:21], s38 glc
  s_add_u32 s38, s60, 256
  s_load_dword s42, s[20:21], s38 glc
  s_add_u32 s38, s61, 384
  s_load_dword s43, s[20:21], s38 glc
  s_add_u32 s38, s61, 512
  s_load_dword s44, s[20:21], s38 glc
  s_add_u32 s38, s60, 640
  s_load_dword s45, s[20:21], s38 glc
  s_add_u32 s38, s60, 768
  s_load_dword s46, s[20:21], s38 glc
  s_add_u32 s38, s61, 896
  s_load_dword s47, s[20:21], s38 glc
L_wp38:
  s_waitcnt vmcnt(6)
  v_dot2_f32_bf16 v23, v100, v4, 0
  v_dot2_f32_bf16 v23, v101, v5, v23
  v_dot2_f32_bf16 v23, v102, v6, v23
  v_dot2_f32_bf16 v23, v103, v7, v23
  s_cbranch_vccz L_d153
  s_waitcnt vmcnt(5)
L_d153:
  s_xor_b32 s68, s70, 0x34d00
  buffer_load_dwordx4 v[124:127], v63, s[4:7], s68 offen nt
  v_and_b32_dpp v52, v45, v40 row_newbcast:8
  v_and_b32_dpp v53, v45, v41 row_newbcast:8
  v_and_b32_dpp v54, v45, v42 row_newbcast:8
  v_and_b32_dpp v55, v45, v43 row_newbcast:8
  s_nop 1
  v_mfma_f32_16x16x32_bf16 v[56:59], v[52:55], a[132:135], v[56:59]
  s_waitcnt vmcnt(6)
  v_dot2_f32_bf16 v24, v104, v4, 0
  v_dot2_f32_bf16 v24, v105, v5, v24
  v_dot2_f32_bf16 v24, v106, v6, v24
  v_dot2_f32_bf16 v24, v107, v7, v24
  s_cbranch_vccz L_d154
  s_waitcnt vmcnt(5)
L_d154:
  s_xor_b32 s68, s70, 0x84000
  buffer_load_dwordx4 v[64:67], v63, s[4:7], s68 offen nt
  buffer_load_dwordx4 a[144:147], v2, s[24:27], s73 offen
  s_add_u32 s73, s73, 8192
  s_waitcnt vmcnt(7)
  v_dot2_f32_bf16 v25, v108, v4, 0
  v_dot2_f32_bf16 v25, v109, v5, v25
  v_dot2_f32_bf16 v25, v110, v6, v25
  v_dot2_f32_bf16 v25, v111, v7, v25
  s_cbranch_vccz L_d155
  s_waitcnt vmcnt(6)
L_d155:
  s_xor_b32 s68, s70, 0x84100
  buffer_load_dwordx4 v[68:71], v63, s[4:7], s68 offen nt
  v_add_f32_dpp v26, v22, v22 row_ror:8 row_mask:0xf bank_mask:0x3
  v_add_f32_dpp v27, v24, v24 row_ror:8 row_mask:0xf bank_mask:0x3
  s_nop 0
  v_add_f32_dpp v26, v23, v23 row_ror:8 row_mask:0xf bank_mask:0xc
  v_add_f32_dpp v27, v25, v25 row_ror:8 row_mask:0xf bank_mask:0xc
  s_nop 0
  v_add_f32_dpp v28, v26, v26 row_half_mirror row_mask:0xf bank_mask:0x5
  s_nop 1
  v_add_f32_dpp v28, v27, v27 row_half_mirror row_mask:0xf bank_mask:0xa
  s_nop 1
  v_add_f32_dpp v28, v28, v28 quad_perm:[1,0,3,2]
  s_nop 1
  v_add_f32_dpp v230, v28, v28 quad_perm:[2,3,0,1]
  v_max_f32 v20, v20, v230
  s_barrier
  s_waitcnt vmcnt(7)
  v_dot2_f32_bf16 v22, v112, v4, 0
  v_dot2_f32_bf16 v22, v113, v5, v22
  v_dot2_f32_bf16 v22, v114, v6, v22
  v_dot2_f32_bf16 v22, v115, v7, v22
  s_cbranch_vccz L_d156
  s_waitcnt vmcnt(5)
L_d156:
  s_xor_b32 s68, s70, 0x84400
  buffer_load_dwordx4 v[72:75], v63, s[4:7], s68 offen nt
  s_waitcnt vmcnt(6)
  v_dot2_f32_bf16 v23, v116, v4, 0
  v_dot2_f32_bf16 v23, v117, v5, v23
  v_dot2_f32_bf16 v23, v118, v6, v23
  v_dot2_f32_bf16 v23, v119, v7, v23
  s_cbranch_vccz L_d157
  s_waitcnt vmcnt(5)
L_d157:
  s_xor_b32 s68, s70, 0x84500
  buffer_load_dwordx4 v[76:79], v63, s[4:7], s68 offen nt
  v_and_b32_dpp v48, v46, v40 row_newbcast:8
  v_and_b32_dpp v49, v46, v41 row_newbcast:8
  v_and_b32_dpp v50, v46, v42 row_newbcast:8
  v_and_b32_dpp v51, v46, v43 row_newbcast:8
  s_nop 1
  v_mfma_f32_16x16x32_bf16 v[56:59], v[48:51], a[136:139], v[56:59]
  s_waitcnt vmcnt(6)
  v_dot2_f32_bf16 v24, v120, v4, 0
  v_dot2_f32_bf16 v24, v121, v5, v24
  v_dot2_f32_bf16 v24, v122, v6, v24
  v_dot2_f32_bf16 v24, v123, v7, v24
  s_cbranch_vccz L_d158
  s_waitcnt vmcnt(5)
L_d158:
  s_xor_b32 s68, s70, 0x84800
  buffer_load_dwordx4 v[80:83], v63, s[4:7], s68 offen nt
  buffer_load_dwordx4 a[148:151], v2, s[24:27], s73 offen
  s_add_u32 s73, s73, 8192
  s_waitcnt vmcnt(7)
  v_dot2_f32_bf16 v25, v124, v4, 0
  v_dot2_f32_bf16 v25, v125, v5, v25
  v_dot2_f32_bf16 v25, v126, v6, v25
  v_dot2_f32_bf16 v25, v127, v7, v25
  s_cbranch_vccz L_d159
  s_waitcnt vmcnt(6)
L_d159:
  s_xor_b32 s68, s70, 0x84900
  buffer_load_dwordx4 v[84:87], v63, s[4:7], s68 offen nt
  v_add_f32_dpp v26, v22, v22 row_ror:8 row_mask:0xf bank_mask:0x3
  v_add_f32_dpp v27, v24, v24 row_ror:8 row_mask:0xf bank_mask:0x3
  s_nop 0
  v_add_f32_dpp v26, v23, v23 row_ror:8 row_mask:0xf bank_mask:0xc
  v_add_f32_dpp v27, v25, v25 row_ror:8 row_mask:0xf bank_mask:0xc
  s_nop 0
  v_add_f32_dpp v28, v26, v26 row_half_mirror row_mask:0xf bank_mask:0x5
  s_nop 1
  v_add_f32_dpp v28, v27, v27 row_half_mirror row_mask:0xf bank_mask:0xa
  s_nop 1
  v_add_f32_dpp v28, v28, v28 quad_perm:[1,0,3,2]
  s_nop 1
  v_add_f32_dpp v231, v28, v28 quad_perm:[2,3,0,1]
  v_max_f32 v20, v20, v231
  s_barrier
  s_waitcnt vmcnt(7)
  v_dot2_f32_bf16 v22, v64, v4, 0
  v_dot2_f32_bf16 v22, v65, v5, v22
  v_dot2_f32_bf16 v22, v66, v6, v22
  v_dot2_f32_bf16 v22, v67, v7, v22
  s_cbranch_vccz L_d160
  s_waitcnt vmcnt(5)
L_d160:
  s_xor_b32 s68, s70, 0x84c00
  buffer_load_dwordx4 v[88:91], v63, s[4:7], s68 offen nt
  s_cmp_eq_u32 s64, 3
  s_cbranch_scc0 L_wp40
  s_mov_b32 s101, 0
  s_waitcnt lgkmcnt(0)
  s_cmp_ge_u32 s40, 3
  s_addc_u32 s101, s101, 0
  s_cmp_ge_u32 s41, 3
  s_addc_u32 s101, s101, 0
  s_cmp_ge_u32 s42, 3
  s_addc_u32 s101, s101, 0
  s_cmp_ge_u32 s43, 3
  s_addc_u32 s101, s101, 0
  s_cmp_ge_u32 s44, 3
  s_addc_u32 s101, s101, 0
  s_cmp_ge_u32 s45, 3
  s_addc_u32 s101, s101, 0
  s_cmp_ge_u32 s46, 3
  s_addc_u32 s101, s101, 0
  s_cmp_ge_u32 s47, 3
  s_addc_u32 s101, s101, 0
  s_cmp_lt_u32 s101, 6
  s_cselect_b32 s38, -1, 0
  v_mov_b32 v26, 0
  v_mov_b32 v27, s38
  ds_write_b32 v26, v27 offset:8512
L_wp40:
  s_waitcnt vmcnt(6)
  v_dot2_f32_bf16 v23, v68, v4, 0
  v_dot2_f32_bf16 v23, v69, v5, v23
  v_dot2_f32_bf16 v23, v70, v6, v23
  v_dot2_f32_bf16 v23, v71, v7, v23
  s_cbranch_vccz L_d161
  s_waitcnt vmcnt(5)
L_d161:
  s_xor_b32 s68, s70, 0x84d00
  buffer_load_dwordx4 v[92:95], v63, s[4:7], s68 offen nt
  v_and_b32_dpp v52, v47, v40 row_newbcast:8
  v_and_b32_dpp v53, v47, v41 row_newbcast:8
  v_and_b32_dpp v54, v47, v42 row_newbcast:8
  v_and_b32_dpp v55, v47, v43 row_newbcast:8
  s_nop 1
  v_mfma_f32_16x16x32_bf16 v[56:59], v[52:55], a[140:143], v[56:59]
  s_waitcnt vmcnt(6)
  v_dot2_f32_bf16 v24, v72, v4, 0
  v_dot2_f32_bf16 v24, v73, v5, v24
  v_dot2_f32_bf16 v24, v74, v6, v24
  v_dot2_f32_bf16 v24, v75, v7, v24
  s_cbranch_vccz L_d162
  s_waitcnt vmcnt(5)
L_d162:
  s_xor_b32 s68, s70, 0x94000
  buffer_load_dwordx4 v[96:99], v63, s[4:7], s68 offen nt
  buffer_load_dwordx4 a[152:155], v2, s[24:27], s73 offen
  s_add_u32 s73, s73, 8192
  s_waitcnt vmcnt(7)
  v_dot2_f32_bf16 v25, v76, v4, 0
  v_dot2_f32_bf16 v25, v77, v5, v25
  v_dot2_f32_bf16 v25, v78, v6, v25
  v_dot2_f32_bf16 v25, v79, v7, v25
  s_cbranch_vccz L_d163
  s_waitcnt vmcnt(6)
L_d163:
  s_xor_b32 s68, s70, 0x94100
  buffer_load_dwordx4 v[100:103], v63, s[4:7], s68 offen nt
  v_add_f32_dpp v26, v22, v22 row_ror:8 row_mask:0xf bank_mask:0x3
  v_add_f32_dpp v27, v24, v24 row_ror:8 row_mask:0xf bank_mask:0x3
  s_nop 0
  v_add_f32_dpp v26, v23, v23 row_ror:8 row_mask:0xf bank_mask:0xc
  v_add_f32_dpp v27, v25, v25 row_ror:8 row_mask:0xf bank_mask:0xc
  s_nop 0
  v_add_f32_dpp v28, v26, v26 row_half_mirror row_mask:0xf bank_mask:0x5
  s_nop 1
  v_add_f32_dpp v28, v27, v27 row_half_mirror row_mask:0xf bank_mask:0xa
  s_nop 1
  v_add_f32_dpp v28, v28, v28 quad_perm:[1,0,3,2]
  s_nop 1
  v_add_f32_dpp v232, v28, v28 quad_perm:[2,3,0,1]
  v_max_f32 v20, v20, v232
  s_barrier
  s_waitcnt vmcnt(7)
  v_dot2_f32_bf16 v22, v80, v4, 0
  v_dot2_f32_bf16 v22, v81, v5, v22
  v_dot2_f32_bf16 v22, v82, v6, v22
  v_dot2_f32_bf16 v22, v83, v7, v22
  s_cbranch_vccz L_d164
  s_waitcnt vmcnt(5)
L_d164:
  s_xor_b32 s68, s70, 0x94400
  buffer_load_dwordx4 v[104:107], v63, s[4:7], s68 offen nt
  v_mov_b32 v26, 0
  ds_read_b32 v35, v26 offset:8512
  s_waitcnt vmcnt(6)
  v_dot2_f32_bf16 v23, v84, v4, 0
  v_dot2_f32_bf16 v23, v85, v5, v23
  v_dot2_f32_bf16 v23, v86, v6, v23
  v_dot2_f32_bf16 v23, v87, v7, v23
  s_cbranch_vccz L_d165
  s_waitcnt vmcnt(5)
L_d165:
  s_xor_b32 s68, s70, 0x94500
  buffer_load_dwordx4 v[108:111], v63, s[4:7], s68 offen nt
  v_and_b32_dpp v48, v44, v40 row_newbcast:9
  v_and_b32_dpp v49, v44, v41 row_newbcast:9
  v_and_b32_dpp v50, v44, v42 row_newbcast:9
  v_and_b32_dpp v51, v44, v43 row_newbcast:9
  s_nop 1
  v_mfma_f32_16x16x32_bf16 v[56:59], v[48:51], a[144:147], v[56:59]
  s_waitcnt vmcnt(6)
  v_dot2_f32_bf16 v24, v88, v4, 0
  v_dot2_f32_bf16 v24, v89, v5, v24
  v_dot2_f32_bf16 v24, v90, v6, v24
  v_dot2_f32_bf16 v24, v91, v7, v24
  s_cbranch_vccz L_d166
  s_waitcnt vmcnt(5)
L_d166:
  s_xor_b32 s68, s70, 0x94800
  buffer_load_dwordx4 v[112:115], v63, s[4:7], s68 offen nt
  buffer_load_dwordx4 a[156:159], v2, s[24:27], s73 offen
  s_waitcnt vmcnt(7)
  v_dot2_f32_bf16 v25, v92, v4, 0
  v_dot2_f32_bf16 v25, v93, v5, v25
  v_dot2_f32_bf16 v25, v94, v6, v25
  v_dot2_f32_bf16 v25, v95, v7, v25
  s_cbranch_vccz L_d167
  s_waitcnt vmcnt(6)
L_d167:
  s_xor_b32 s68, s70, 0x94900
  buffer_load_dwordx4 v[116:119], v63, s[4:7], s68 offen nt
  v_add_f32_dpp v26, v22, v22 row_ror:8 row_mask:0xf bank_mask:0x3
  v_add_f32_dpp v27, v24, v24 row_ror:8 row_mask:0xf bank_mask:0x3
  s_nop 0
  v_add_f32_dpp v26, v23, v23 row_ror:8 row_mask:0xf bank_mask:0xc
  v_add_f32_dpp v27, v25, v25 row_ror:8 row_mask:0xf bank_mask:0xc
  s_nop 0
  v_add_f32_dpp v28, v26, v26 row_half_mirror row_mask:0xf bank_mask:0x5
  s_nop 1
  v_add_f32_dpp v28, v27, v27 row_half_mirror row_mask:0xf bank_mask:0xa
  s_nop 1
  v_add_f32_dpp v28, v28, v28 quad_perm:[1,0,3,2]
  s_nop 1
  v_add_f32_dpp v233, v28, v28 quad_perm:[2,3,0,1]
  v_max_f32 v20, v20, v233
  s_barrier
  s_waitcnt vmcnt(7)
  v_dot2_f32_bf16 v22, v96, v4, 0
  v_dot2_f32_bf16 v22, v97, v5, v22
  v_dot2_f32_bf16 v22, v98, v6, v22
  v_dot2_f32_bf16 v22, v99, v7, v22
  s_cbranch_vccz L_d168
  s_waitcnt vmcnt(5)
L_d168:
  s_xor_b32 s68, s70, 0x94c00
  buffer_load_dwordx4 v[120:123], v63, s[4:7], s68 offen nt
  s_waitcnt lgkmcnt(0)
  v_cmp_ne_u32 vcc, 0, v35
  s_waitcnt vmcnt(6)
  v_dot2_f32_bf16 v23, v100, v4, 0
  v_dot2_f32_bf16 v23, v101, v5, v23
  v_dot2_f32_bf16 v23, v102, v6, v23
  v_dot2_f32_bf16 v23, v103, v7, v23
  s_cbranch_vccz L_d169
  s_waitcnt vmcnt(5)
L_d169:
  s_xor_b32 s68, s70, 0x94d00
  buffer_load_dwordx4 v[124:127], v63, s[4:7], s68 offen nt
  v_and_b32_dpp v52, v45, v40 row_newbcast:9
  v_and_b32_dpp v53, v45, v41 row_newbcast:9
  v_and_b32_dpp v54, v45, v42 row_newbcast:9
  v_and_b32_dpp v55, v45, v43 row_newbcast:9
  s_nop 1
  v_mfma_f32_16x16x32_bf16 v[56:59], v[52:55], a[148:151], v[56:59]
  s_waitcnt vmcnt(6)
  v_dot2_f32_bf16 v24, v104, v4, 0
  v_dot2_f32_bf16 v24, v105, v5, v24
  v_dot2_f32_bf16 v24, v106, v6, v24
  v_dot2_f32_bf16 v24, v107, v7, v24
  s_cbranch_vccz L_d170
  s_waitcnt vmcnt(5)
L_d170:
  s_xor_b32 s68, s70, 0xa4000
  buffer_load_dwordx4 v[64:67], v63, s[4:7], s68 offen nt
  s_lshl_b32 s73, s79, 16
  s_add_u32 s73, s73, s72
  buffer_load_dwordx4 a[160:163], v2, s[24:27], s73 offen
  s_add_u32 s73, s73, 8192
  s_waitcnt vmcnt(7)
  v_dot2_f32_bf16 v25, v108, v4, 0
  v_dot2_f32_bf16 v25, v109, v5, v25
  v_dot2_f32_bf16 v25, v110, v6, v25
  v_dot2_f32_bf16 v25, v111, v7, v25
  s_cbranch_vccz L_d171
  s_waitcnt vmcnt(6)
L_d171:
  s_xor_b32 s68, s70, 0xa4100
  buffer_load_dwordx4 v[68:71], v63, s[4:7], s68 offen nt
  v_add_f32_dpp v26, v22, v22 row_ror:8 row_mask:0xf bank_mask:0x3
  v_add_f32_dpp v27, v24, v24 row_ror:8 row_mask:0xf bank_mask:0x3
  s_nop 0
  v_add_f32_dpp v26, v23, v23 row_ror:8 row_mask:0xf bank_mask:0xc
  v_add_f32_dpp v27, v25, v25 row_ror:8 row_mask:0xf bank_mask:0xc
  s_nop 0
  v_add_f32_dpp v28, v26, v26 row_half_mirror row_mask:0xf bank_mask:0x5
  s_nop 1
  v_add_f32_dpp v28, v27, v27 row_half_mirror row_mask:0xf bank_mask:0xa
  s_nop 1
  v_add_f32_dpp v28, v28, v28 quad_perm:[1,0,3,2]
  s_nop 1
  v_add_f32_dpp v234, v28, v28 quad_perm:[2,3,0,1]
  v_max_f32 v20, v20, v234
  s_barrier
  s_waitcnt vmcnt(7)
  v_dot2_f32_bf16 v22, v112, v4, 0
  v_dot2_f32_bf16 v22, v113, v5, v22
  v_dot2_f32_bf16 v22, v114, v6, v22
  v_dot2_f32_bf16 v22, v115, v7, v22
  s_cbranch_vccz L_d172
  s_waitcnt vmcnt(5)
L_d172:
  s_xor_b32 s68, s70, 0xa4400
  buffer_load_dwordx4 v[72:75], v63, s[4:7], s68 offen nt
  s_waitcnt vmcnt(6)
  v_dot2_f32_bf16 v23, v116, v4, 0
  v_dot2_f32_bf16 v23, v117, v5, v23
  v_dot2_f32_bf16 v23, v118, v6, v23
  v_dot2_f32_bf16 v23, v119, v7, v23
  s_cbranch_vccz L_d173
  s_waitcnt vmcnt(5)
L_d173:
  s_xor_b32 s68, s70, 0xa4500
  buffer_load_dwordx4 v[76:79], v63, s[4:7], s68 offen nt
  v_and_b32_dpp v48, v46, v40 row_newbcast:9
  v_and_b32_dpp v49, v46, v41 row_newbcast:9
  v_and_b32_dpp v50, v46, v42 row_newbcast:9
  v_and_b32_dpp v51, v46, v43 row_newbcast:9
  s_nop 1
  v_mfma_f32_16x16x32_bf16 v[56:59], v[48:51], a[152:155], v[56:59]
  s_waitcnt vmcnt(6)
  v_dot2_f32_bf16 v24, v120, v4, 0
  v_dot2_f32_bf16 v24, v121, v5, v24
  v_dot2_f32_bf16 v24, v122, v6, v24
  v_dot2_f32_bf16 v24, v123, v7, v24
  s_cbranch_vccz L_d174
  s_waitcnt vmcnt(5)
L_d174:
  s_xor_b32 s68, s70, 0xa4800
  buffer_load_dwordx4 v[80:83], v63, s[4:7], s68 offen nt
  buffer_load_dwordx4 a[164:167], v2, s[24:27], s73 offen
  s_add_u32 s73, s73, 8192
  s_waitcnt vmcnt(7)
  v_dot2_f32_bf16 v25, v124, v4, 0
  v_dot2_f32_bf16 v25, v125, v5, v25
  v_dot2_f32_bf16 v25, v126, v6, v25
  v_dot2_f32_bf16 v25, v127, v7, v25
  s_cbranch_vccz L_d175
  s_waitcnt vmcnt(6)
L_d175:
  s_xor_b32 s68, s70, 0xa4900
  buffer_load_dwordx4 v[84:87], v63, s[4:7], s68 offen nt
  v_add_f32_dpp v26, v22, v22 row_ror:8 row_mask:0xf bank_mask:0x3
  v_add_f32_dpp v27, v24, v24 row_ror:8 row_mask:0xf bank_mask:0x3
  s_nop 0
  v_add_f32_dpp v26, v23, v23 row_ror:8 row_mask:0xf bank_mask:0xc
  v_add_f32_dpp v27, v25, v25 row_ror:8 row_mask:0xf bank_mask:0xc
  s_nop 0
  v_add_f32_dpp v28, v26, v26 row_half_mirror row_mask:0xf bank_mask:0x5
  s_nop 1
  v_add_f32_dpp v28, v27, v27 row_half_mirror row_mask:0xf bank_mask:0xa
  s_nop 1
  v_add_f32_dpp v28, v28, v28 quad_perm:[1,0,3,2]
  s_nop 1
  v_add_f32_dpp v235, v28, v28 quad_perm:[2,3,0,1]
  v_max_f32 v20, v20, v235
  s_barrier
  s_waitcnt vmcnt(7)
  v_dot2_f32_bf16 v22, v64, v4, 0
  v_dot2_f32_bf16 v22, v65, v5, v22
  v_dot2_f32_bf16 v22, v66, v6, v22
  v_dot2_f32_bf16 v22, v67, v7, v22
  s_cbranch_vccz L_d176
  s_waitcnt vmcnt(5)
L_d176:
  s_xor_b32 s68, s70, 0xa4c00
  buffer_load_dwordx4 v[88:91], v63, s[4:7], s68 offen nt
  s_waitcnt vmcnt(6)
  v_dot2_f32_bf16 v23, v68, v4, 0
  v_dot2_f32_bf16 v23, v69, v5, v23
  v_dot2_f32_bf16 v23, v70, v6, v23
  v_dot2_f32_bf16 v23, v71, v7, v23
  s_cbranch_vccz L_d177
  s_waitcnt vmcnt(5)
L_d177:
  s_xor_b32 s68, s70, 0xa4d00
  buffer_load_dwordx4 v[92:95], v63, s[4:7], s68 offen nt
  v_and_b32_dpp v52, v47, v40 row_newbcast:9
  v_and_b32_dpp v53, v47, v41 row_newbcast:9
  v_and_b32_dpp v54, v47, v42 row_newbcast:9
  v_and_b32_dpp v55, v47, v43 row_newbcast:9
  s_nop 1
  v_mfma_f32_16x16x32_bf16 v[56:59], v[52:55], a[156:159], v[56:59]
  s_waitcnt vmcnt(6)
  v_dot2_f32_bf16 v24, v72, v4, 0
  v_dot2_f32_bf16 v24, v73, v5, v24
  v_dot2_f32_bf16 v24, v74, v6, v24
  v_dot2_f32_bf16 v24, v75, v7, v24
  s_cbranch_vccz L_d178
  s_waitcnt vmcnt(5)
L_d178:
  s_xor_b32 s68, s70, 0xb4000
  buffer_load_dwordx4 v[96:99], v63, s[4:7], s68 offen nt
  buffer_load_dwordx4 a[168:171], v2, s[24:27], s73 offen
  s_add_u32 s73, s73, 8192
  s_waitcnt vmcnt(7)
  v_dot2_f32_bf16 v25, v76, v4, 0
  v_dot2_f32_bf16 v25, v77, v5, v25
  v_dot2_f32_bf16 v25, v78, v6, v25
  v_dot2_f32_bf16 v25, v79, v7, v25
  s_cbranch_vccz L_d179
  s_waitcnt vmcnt(6)
L_d179:
  s_xor_b32 s68, s70, 0xb4100
  buffer_load_dwordx4 v[100:103], v63, s[4:7], s68 offen nt
  v_add_f32_dpp v26, v22, v22 row_ror:8 row_mask:0xf bank_mask:0x3
  v_add_f32_dpp v27, v24, v24 row_ror:8 row_mask:0xf bank_mask:0x3
  s_nop 0
  v_add_f32_dpp v26, v23, v23 row_ror:8 row_mask:0xf bank_mask:0xc
  v_add_f32_dpp v27, v25, v25 row_ror:8 row_mask:0xf bank_mask:0xc
  s_nop 0
  v_add_f32_dpp v28, v26, v26 row_half_mirror row_mask:0xf bank_mask:0x5
  s_nop 1
  v_add_f32_dpp v28, v27, v27 row_half_mirror row_mask:0xf bank_mask:0xa
  s_nop 1
  v_add_f32_dpp v28, v28, v28 quad_perm:[1,0,3,2]
  s_nop 1
  v_add_f32_dpp v236, v28, v28 quad_perm:[2,3,0,1]
  v_max_f32 v20, v20, v236
  s_barrier
  s_waitcnt vmcnt(7)
  v_dot2_f32_bf16 v22, v80, v4, 0
  v_dot2_f32_bf16 v22, v81, v5, v22
  v_dot2_f32_bf16 v22, v82, v6, v22
  v_dot2_f32_bf16 v22, v83, v7, v22
  s_cbranch_vccz L_d180
  s_waitcnt vmcnt(5)
L_d180:
  s_xor_b32 s68, s70, 0xb4400
  buffer_load_dwordx4 v[104:107], v63, s[4:7], s68 offen nt
  s_waitcnt vmcnt(6)
  v_dot2_f32_bf16 v23, v84, v4, 0
  v_dot2_f32_bf16 v23, v85, v5, v23
  v_dot2_f32_bf16 v23, v86, v6, v23
  v_dot2_f32_bf16 v23, v87, v7, v23
  s_cbranch_vccz L_d181
  s_waitcnt vmcnt(5)
L_d181:
  s_xor_b32 s68, s70, 0xb4500
  buffer_load_dwordx4 v[108:111], v63, s[4:7], s68 offen nt
  v_and_b32_dpp v48, v44, v40 row_newbcast:10
  v_and_b32_dpp v49, v44, v41 row_newbcast:10
  v_and_b32_dpp v50, v44, v42 row_newbcast:10
  v_and_b32_dpp v51, v44, v43 row_newbcast:10
  s_nop 1
  v_mfma_f32_16x16x32_bf16 v[56:59], v[48:51], a[160:163], v[56:59]
  s_waitcnt vmcnt(6)
  v_dot2_f32_bf16 v24, v88, v4, 0
  v_dot2_f32_bf16 v24, v89, v5, v24
  v_dot2_f32_bf16 v24, v90, v6, v24
  v_dot2_f32_bf16 v24, v91, v7, v24
  s_cbranch_vccz L_d182
  s_waitcnt vmcnt(5)
L_d182:
  s_xor_b32 s68, s70, 0xb4800
  buffer_load_dwordx4 v[112:115], v63, s[4:7], s68 offen nt
  buffer_load_dwordx4 a[172:175], v2, s[24:27], s73 offen
  s_add_u32 s73, s73, 8192
  s_waitcnt vmcnt(7)
  v_dot2_f32_bf16 v25, v92, v4, 0
  v_dot2_f32_bf16 v25, v93, v5, v25
  v_dot2_f32_bf16 v25, v94, v6, v25
  v_dot2_f32_bf16 v25, v95, v7, v25
  s_cbranch_vccz L_d183
  s_waitcnt vmcnt(6)
L_d183:
  s_xor_b32 s68, s70, 0xb4900
  buffer_load_dwordx4 v[116:119], v63, s[4:7], s68 offen nt
  v_add_f32_dpp v26, v22, v22 row_ror:8 row_mask:0xf bank_mask:0x3
  v_add_f32_dpp v27, v24, v24 row_ror:8 row_mask:0xf bank_mask:0x3
  s_nop 0
  v_add_f32_dpp v26, v23, v23 row_ror:8 row_mask:0xf bank_mask:0xc
  v_add_f32_dpp v27, v25, v25 row_ror:8 row_mask:0xf bank_mask:0xc
  s_nop 0
  v_add_f32_dpp v28, v26, v26 row_half_mirror row_mask:0xf bank_mask:0x5
  s_nop 1
  v_add_f32_dpp v28, v27, v27 row_half_mirror row_mask:0xf bank_mask:0xa
  s_nop 1
  v_add_f32_dpp v28, v28, v28 quad_perm:[1,0,3,2]
  s_nop 1
  v_add_f32_dpp v237, v28, v28 quad_perm:[2,3,0,1]
  v_max_f32 v20, v20, v237
  s_barrier
  s_waitcnt vmcnt(7)
  v_dot2_f32_bf16 v22, v96, v4, 0
  v_dot2_f32_bf16 v22, v97, v5, v22
  v_dot2_f32_bf16 v22, v98, v6, v22
  v_dot2_f32_bf16 v22, v99, v7, v22
  s_cbranch_vccz L_d184
  s_waitcnt vmcnt(5)
L_d184:
  s_xor_b32 s68, s70, 0xb4c00
  buffer_load_dwordx4 v[120:123], v63, s[4:7], s68 offen nt
  s_waitcnt vmcnt(6)
  v_dot2_f32_bf16 v23, v100, v4, 0
  v_dot2_f32_bf16 v23, v101, v5, v23
  v_dot2_f32_bf16 v23, v102, v6, v23
  v_dot2_f32_bf16 v23, v103, v7, v23
  s_cbranch_vccz L_d185
  s_waitcnt vmcnt(5)
L_d185:
  s_xor_b32 s68, s70, 0xb4d00
  buffer_load_dwordx4 v[124:127], v63, s[4:7], s68 offen nt
  v_and_b32_dpp v52, v45, v40 row_newbcast:10
  v_and_b32_dpp v53, v45, v41 row_newbcast:10
  v_and_b32_dpp v54, v45, v42 row_newbcast:10
  v_and_b32_dpp v55, v45, v43 row_newbcast:10
  s_nop 1
  v_mfma_f32_16x16x32_bf16 v[56:59], v[52:55], a[164:167], v[56:59]
  s_waitcnt vmcnt(6)
  v_dot2_f32_bf16 v24, v104, v4, 0
  v_dot2_f32_bf16 v24, v105, v5, v24
  v_dot2_f32_bf16 v24, v106, v6, v24
  v_dot2_f32_bf16 v24, v107, v7, v24
  s_cbranch_vccz L_d186
  s_waitcnt vmcnt(5)
L_d186:
  s_xor_b32 s68, s70, 0x44000
  buffer_load_dwordx4 v[64:67], v63, s[4:7], s68 offen nt
  buffer_load_dwordx4 a[176:179], v2, s[24:27], s73 offen
  s_add_u32 s73, s73, 8192
  s_waitcnt vmcnt(7)
  v_dot2_f32_bf16 v25, v108, v4, 0
  v_dot2_f32_bf16 v25, v109, v5, v25
  v_dot2_f32_bf16 v25, v110, v6, v25
  v_dot2_f32_bf16 v25, v111, v7, v25
  s_cbranch_vccz L_d187
  s_waitcnt vmcnt(6)
L_d187:
  s_xor_b32 s68, s70, 0x44100
  buffer_load_dwordx4 v[68:71], v63, s[4:7], s68 offen nt
  v_add_f32_dpp v26, v22, v22 row_ror:8 row_mask:0xf bank_mask:0x3
  v_add_f32_dpp v27, v24, v24 row_ror:8 row_mask:0xf bank_mask:0x3
  s_nop 0
  v_add_f32_dpp v26, v23, v23 row_ror:8 row_mask:0xf bank_mask:0xc
  v_add_f32_dpp v27, v25, v25 row_ror:8 row_mask:0xf bank_mask:0xc
  s_nop 0
  v_add_f32_dpp v28, v26, v26 row_half_mirror row_mask:0xf bank_mask:0x5
  s_nop 1
  v_add_f32_dpp v28, v27, v27 row_half_mirror row_mask:0xf bank_mask:0xa
  s_nop 1
  v_add_f32_dpp v28, v28, v28 quad_perm:[1,0,3,2]
  s_nop 1
  v_add_f32_dpp v238, v28, v28 quad_perm:[2,3,0,1]
  v_max_f32 v20, v20, v238
  s_barrier
  s_waitcnt vmcnt(7)
  v_dot2_f32_bf16 v22, v112, v4, 0
  v_dot2_f32_bf16 v22, v113, v5, v22
  v_dot2_f32_bf16 v22, v114, v6, v22
  v_dot2_f32_bf16 v22, v115, v7, v22
  s_cbranch_vccz L_d188
  s_waitcnt vmcnt(5)
L_d188:
  s_xor_b32 s68, s70, 0x44400
  buffer_load_dwordx4 v[72:75], v63, s[4:7], s68 offen nt
  s_waitcnt vmcnt(6)
  v_dot2_f32_bf16 v23, v116, v4, 0
  v_dot2_f32_bf16 v23, v117, v5, v23
  v_dot2_f32_bf16 v23, v118, v6, v23
  v_dot2_f32_bf16 v23, v119, v7, v23
  s_cbranch_vccz L_d189
  s_waitcnt vmcnt(5)
L_d189:
  s_xor_b32 s68, s70, 0x44500
  buffer_load_dwordx4 v[76:79], v63, s[4:7], s68 offen nt
  v_and_b32_dpp v48, v46, v40 row_newbcast:10
  v_and_b32_dpp v49, v46, v41 row_newbcast:10
  v_and_b32_dpp v50, v46, v42 row_newbcast:10
  v_and_b32_dpp v51, v46, v43 row_newbcast:10
  s_nop 1
  v_mfma_f32_16x16x32_bf16 v[56:59], v[48:51], a[168:171], v[56:59]
  s_waitcnt vmcnt(6)
  v_dot2_f32_bf16 v24, v120, v4, 0
  v_dot2_f32_bf16 v24, v121, v5, v24
  v_dot2_f32_bf16 v24, v122, v6, v24
  v_dot2_f32_bf16 v24, v123, v7, v24
  s_cbranch_vccz L_d190
  s_waitcnt vmcnt(5)
L_d190:
  s_xor_b32 s68, s70, 0x44800
  buffer_load_dwordx4 v[80:83], v63, s[4:7], s68 offen nt
  buffer_load_dwordx4 a[180:183], v2, s[24:27], s73 offen
  s_add_u32 s73, s73, 8192
  s_waitcnt vmcnt(7)
  v_dot2_f32_bf16 v25, v124, v4, 0
  v_dot2_f32_bf16 v25, v125, v5, v25
  v_dot2_f32_bf16 v25, v126, v6, v25
  v_dot2_f32_bf16 v25, v127, v7, v25
  s_cbranch_vccz L_d191
  s_waitcnt vmcnt(6)
L_d191:
  s_xor_b32 s68, s70, 0x44900
  buffer_load_dwordx4 v[84:87], v63, s[4:7], s68 offen nt
  v_add_f32_dpp v26, v22, v22 row_ror:8 row_mask:0xf bank_mask:0x3
  v_add_f32_dpp v27, v24, v24 row_ror:8 row_mask:0xf bank_mask:0x3
  s_nop 0
  v_add_f32_dpp v26, v23, v23 row_ror:8 row_mask:0xf bank_mask:0xc
  v_add_f32_dpp v27, v25, v25 row_ror:8 row_mask:0xf bank_mask:0xc
  s_nop 0
  v_add_f32_dpp v28, v26, v26 row_half_mirror row_mask:0xf bank_mask:0x5
  s_nop 1
  v_add_f32_dpp v28, v27, v27 row_half_mirror row_mask:0xf bank_mask:0xa
  s_nop 1
  v_add_f32_dpp v28, v28, v28 quad_perm:[1,0,3,2]
  s_nop 1
  v_add_f32_dpp v239, v28, v28 quad_perm:[2,3,0,1]
  v_max_f32 v20, v20, v239
  s_barrier
  s_waitcnt vmcnt(7)
  v_dot2_f32_bf16 v22, v64, v4, 0
  v_dot2_f32_bf16 v22, v65, v5, v22
  v_dot2_f32_bf16 v22, v66, v6, v22
  v_dot2_f32_bf16 v22, v67, v7, v22
  s_cbranch_vccz L_d192
  s_waitcnt vmcnt(5)
L_d192:
  s_xor_b32 s68, s70, 0x44c00
  buffer_load_dwordx4 v[88:91], v63, s[4:7], s68 offen nt
  s_waitcnt vmcnt(6)
  v_dot2_f32_bf16 v23, v68, v4, 0
  v_dot2_f32_bf16 v23, v69, v5, v23
  v_dot2_f32_bf16 v23, v70, v6, v23
  v_dot2_f32_bf16 v23, v71, v7, v23
  s_cbranch_vccz L_d193
  s_waitcnt vmcnt(5)
L_d193:
  s_xor_b32 s68, s70, 0x44d00
  buffer_load_dwordx4 v[92:95], v63, s[4:7], s68 offen nt
  v_and_b32_dpp v52, v47, v40 row_newbcast:10
  v_and_b32_dpp v53, v47, v41 row_newbcast:10
  v_and_b32_dpp v54, v47, v42 row_newbcast:10
  v_and_b32_dpp v55, v47, v43 row_newbcast:10
  s_nop 1
  v_mfma_f32_16x16x32_bf16 v[56:59], v[52:55], a[172:175], v[56:59]
  s_waitcnt vmcnt(6)
  v_dot2_f32_bf16 v24, v72, v4, 0
  v_dot2_f32_bf16 v24, v73, v5, v24
  v_dot2_f32_bf16 v24, v74, v6, v24
  v_dot2_f32_bf16 v24, v75, v7, v24
  s_cbranch_vccz L_d194
  s_waitcnt vmcnt(5)
L_d194:
  s_xor_b32 s68, s70, 0x54000
  buffer_load_dwordx4 v[96:99], v63, s[4:7], s68 offen nt
  buffer_load_dwordx4 a[184:187], v2, s[24:27], s73 offen
  s_add_u32 s73, s73, 8192
  s_waitcnt vmcnt(7)
  v_dot2_f32_bf16 v25, v76, v4, 0
  v_dot2_f32_bf16 v25, v77, v5, v25
  v_dot2_f32_bf16 v25, v78, v6, v25
  v_dot2_f32_bf16 v25, v79, v7, v25
  s_cbranch_vccz L_d195
  s_waitcnt vmcnt(6)
L_d195:
  s_xor_b32 s68, s70, 0x54100
  buffer_load_dwordx4 v[100:103], v63, s[4:7], s68 offen nt
  v_add_f32_dpp v26, v22, v22 row_ror:8 row_mask:0xf bank_mask:0x3
  v_add_f32_dpp v27, v24, v24 row_ror:8 row_mask:0xf bank_mask:0x3
  s_nop 0
  v_add_f32_dpp v26, v23, v23 row_ror:8 row_mask:0xf bank_mask:0xc
  v_add_f32_dpp v27, v25, v25 row_ror:8 row_mask:0xf bank_mask:0xc
  s_nop 0
  v_add_f32_dpp v28, v26, v26 row_half_mirror row_mask:0xf bank_mask:0x5
  s_nop 1
  v_add_f32_dpp v28, v27, v27 row_half_mirror row_mask:0xf bank_mask:0xa
  s_nop 1
  v_add_f32_dpp v28, v28, v28 quad_perm:[1,0,3,2]
  s_nop 1
  v_add_f32_dpp v240, v28, v28 quad_perm:[2,3,0,1]
  v_max_f32 v20, v20, v240
  s_barrier
  s_waitcnt vmcnt(7)
  v_dot2_f32_bf16 v22, v80, v4, 0
  v_dot2_f32_bf16 v22, v81, v5, v22
  v_dot2_f32_bf16 v22, v82, v6, v22
  v_dot2_f32_bf16 v22, v83, v7, v22
  s_cbranch_vccz L_d196
  s_waitcnt vmcnt(5)
L_d196:
  s_xor_b32 s68, s70, 0x54400
  buffer_load_dwordx4 v[104:107], v63, s[4:7], s68 offen nt
  s_waitcnt vmcnt(6)
  v_dot2_f32_bf16 v23, v84, v4, 0
  v_dot2_f32_bf16 v23, v85, v5, v23
  v_dot2_f32_bf16 v23, v86, v6, v23
  v_dot2_f32_bf16 v23, v87, v7, v23
  s_cbranch_vccz L_d197
  s_waitcnt vmcnt(5)
L_d197:
  s_xor_b32 s68, s70, 0x54500
  buffer_load_dwordx4 v[108:111], v63, s[4:7], s68 offen nt
  v_and_b32_dpp v48, v44, v40 row_newbcast:11
  v_and_b32_dpp v49, v44, v41 row_newbcast:11
  v_and_b32_dpp v50, v44, v42 row_newbcast:11
  v_and_b32_dpp v51, v44, v43 row_newbcast:11
  s_nop 1
  v_mfma_f32_16x16x32_bf16 v[56:59], v[48:51], a[176:179], v[56:59]
  s_waitcnt vmcnt(6)
  v_dot2_f32_bf16 v24, v88, v4, 0
  v_dot2_f32_bf16 v24, v89, v5, v24
  v_dot2_f32_bf16 v24, v90, v6, v24
  v_dot2_f32_bf16 v24, v91, v7, v24
  s_cbranch_vccz L_d198
  s_waitcnt vmcnt(5)
L_d198:
  s_xor_b32 s68, s70, 0x54800
  buffer_load_dwordx4 v[112:115], v63, s[4:7], s68 offen nt
  buffer_load_dwordx4 a[188:191], v2, s[24:27], s73 offen
  s_waitcnt vmcnt(7)
  v_dot2_f32_bf16 v25, v92, v4, 0
  v_dot2_f32_bf16 v25, v93, v5, v25
  v_dot2_f32_bf16 v25, v94, v6, v25
  v_dot2_f32_bf16 v25, v95, v7, v25
  s_cbranch_vccz L_d199
  s_waitcnt vmcnt(6)
L_d199:
  s_xor_b32 s68, s70, 0x54900
  buffer_load_dwordx4 v[116:119], v63, s[4:7], s68 offen nt
  v_add_f32_dpp v26, v22, v22 row_ror:8 row_mask:0xf bank_mask:0x3
  v_add_f32_dpp v27, v24, v24 row_ror:8 row_mask:0xf bank_mask:0x3
  s_nop 0
  v_add_f32_dpp v26, v23, v23 row_ror:8 row_mask:0xf bank_mask:0xc
  v_add_f32_dpp v27, v25, v25 row_ror:8 row_mask:0xf bank_mask:0xc
  s_nop 0
  v_add_f32_dpp v28, v26, v26 row_half_mirror row_mask:0xf bank_mask:0x5
  s_nop 1
  v_add_f32_dpp v28, v27, v27 row_half_mirror row_mask:0xf bank_mask:0xa
  s_nop 1
  v_add_f32_dpp v28, v28, v28 quad_perm:[1,0,3,2]
  s_nop 1
  v_add_f32_dpp v241, v28, v28 quad_perm:[2,3,0,1]
  v_max_f32 v20, v20, v241
  s_barrier
  s_waitcnt vmcnt(7)
  v_dot2_f32_bf16 v22, v96, v4, 0
  v_dot2_f32_bf16 v22, v97, v5, v22
  v_dot2_f32_bf16 v22, v98, v6, v22
  v_dot2_f32_bf16 v22, v99, v7, v22
  s_cbranch_vccz L_d200
  s_waitcnt vmcnt(5)
L_d200:
  s_xor_b32 s68, s70, 0x54c00
  buffer_load_dwordx4 v[120:123], v63, s[4:7], s68 offen nt
  s_cmp_eq_u32 s64, 0
  s_cbranch_scc0 L_wp50
  s_mov_b32 s100, 4
  s_atomic_umax s100, s[20:21], s88
  s_and_b32 s60, s88, 0xfffffc7f
  s_xor_b32 s61, s60, 1024
  s_add_u32 s38, s60, 0
  s_load_dword s40, s[20:21], s38 glc
  s_add_u32 s38, s61, 128
  s_load_dword s41, s[20:21], s38 glc
  s_add_u32 s38, s61, 256
  s_load_dword s42, s[20:21], s38 glc
  s_add_u32 s38, s60, 384
  s_load_dword s43, s[20:21], s38 glc
  s_add_u32 s38, s60, 512
  s_load_dword s44, s[20:21], s38 glc
  s_add_u32 s38, s61, 640
  s_load_dword s45, s[20:21], s38 glc
  s_add_u32 s38, s61, 768
  s_load_dword s46, s[20:21], s38 glc
  s_add_u32 s38, s60, 896
  s_load_dword s47, s[20:21], s38 glc
L_wp50:
  s_waitcnt vmcnt(6)
  v_dot2_f32_bf16 v23, v100, v4, 0
  v_dot2_f32_bf16 v23, v101, v5, v23
  v_dot2_f32_bf16 v23, v102, v6, v23
  v_dot2_f32_bf16 v23, v103, v7, v23
  s_cbranch_vccz L_d201
  s_waitcnt vmcnt(5)
L_d201:
  s_xor_b32 s68, s70, 0x54d00
  buffer_load_dwordx4 v[124:127], v63, s[4:7], s68 offen nt
  v_and_b32_dpp v52, v45, v40 row_newbcast:11
  v_and_b32_dpp v53, v45, v41 row_newbcast:11
  v_and_b32_dpp v54, v45, v42 row_newbcast:11
  v_and_b32_dpp v55, v45, v43 row_newbcast:11
  s_nop 1
  v_mfma_f32_16x16x32_bf16 v[56:59], v[52:55], a[180:183], v[56:59]
  s_waitcnt vmcnt(6)
  v_dot2_f32_bf16 v24, v104, v4, 0
  v_dot2_f32_bf16 v24, v105, v5, v24
  v_dot2_f32_bf16 v24, v106, v6, v24
  v_dot2_f32_bf16 v24, v107, v7, v24
  s_cbranch_vccz L_d202
  s_waitcnt vmcnt(5)
L_d202:
  s_xor_b32 s68, s70, 0x64000
  buffer_load_dwordx4 v[64:67], v63, s[4:7], s68 offen nt
  s_lshl_b32 s73, s80, 16
  s_add_u32 s73, s73, s72
  buffer_load_dwordx4 a[192:195], v2, s[24:27], s73 offen
  s_add_u32 s73, s73, 8192
  s_waitcnt vmcnt(7)
  v_dot2_f32_bf16 v25, v108, v4, 0
  v_dot2_f32_bf16 v25, v109, v5, v25
  v_dot2_f32_bf16 v25, v110, v6, v25
  v_dot2_f32_bf16 v25, v111, v7, v25
  s_cbranch_vccz L_d203
  s_waitcnt vmcnt(6)
L_d203:
  s_xor_b32 s68, s70, 0x64100
  buffer_load_dwordx4 v[68:71], v63, s[4:7], s68 offen nt
  v_add_f32_dpp v26, v22, v22 row_ror:8 row_mask:0xf bank_mask:0x3
  v_add_f32_dpp v27, v24, v24 row_ror:8 row_mask:0xf bank_mask:0x3
  s_nop 0
  v_add_f32_dpp v26, v23, v23 row_ror:8 row_mask:0xf bank_mask:0xc
  v_add_f32_dpp v27, v25, v25 row_ror:8 row_mask:0xf bank_mask:0xc
  s_nop 0
  v_add_f32_dpp v28, v26, v26 row_half_mirror row_mask:0xf bank_mask:0x5
  s_nop 1
  v_add_f32_dpp v28, v27, v27 row_half_mirror row_mask:0xf bank_mask:0xa
  s_nop 1
  v_add_f32_dpp v28, v28, v28 quad_perm:[1,0,3,2]
  s_nop 1
  v_add_f32_dpp v242, v28, v28 quad_perm:[2,3,0,1]
  v_max_f32 v20, v20, v242
  s_barrier
  s_waitcnt vmcnt(7)
  v_dot2_f32_bf16 v22, v112, v4, 0
  v_dot2_f32_bf16 v22, v113, v5, v22
  v_dot2_f32_bf16 v22, v114, v6, v22
  v_dot2_f32_bf16 v22, v115, v7, v22
  s_cbranch_vccz L_d204
  s_waitcnt vmcnt(5)
L_d204:
  s_xor_b32 s68, s70, 0x64400
  buffer_load_dwordx4 v[72:75], v63, s[4:7], s68 offen nt
  s_waitcnt vmcnt(6)
  v_dot2_f32_bf16 v23, v116, v4, 0
  v_dot2_f32_bf16 v23, v117, v5, v23
  v_dot2_f32_bf16 v23, v118, v6, v23
  v_dot2_f32_bf16 v23, v119, v7, v23
  s_cbranch_vccz L_d205
  s_waitcnt vmcnt(5)
L_d205:
  s_xor_b32 s68, s70, 0x64500
  buffer_load_dwordx4 v[76:79], v63, s[4:7], s68 offen nt
  v_and_b32_dpp v48, v46, v40 row_newbcast:11
  v_and_b32_dpp v49, v46, v41 row_newbcast:11
  v_and_b32_dpp v50, v46, v42 row_newbcast:11
  v_and_b32_dpp v51, v46, v43 row_newbcast:11
  s_nop 1
  v_mfma_f32_16x16x32_bf16 v[56:59], v[48:51], a[184:187], v[56:59]
  s_waitcnt vmcnt(6)
  v_dot2_f32_bf16 v24, v120, v4, 0
  v_dot2_f32_bf16 v24, v121, v5, v24
  v_dot2_f32_bf16 v24, v122, v6, v24
  v_dot2_f32_bf16 v24, v123, v7, v24
  s_cbranch_vccz L_d206
  s_waitcnt vmcnt(5)
L_d206:
  s_xor_b32 s68, s70, 0x64800
  buffer_load_dwordx4 v[80:83], v63, s[4:7], s68 offen nt
  buffer_load_dwordx4 a[196:199], v2, s[24:27], s73 offen
  s_add_u32 s73, s73, 8192
  s_waitcnt vmcnt(7)
  v_dot2_f32_bf16 v25, v124, v4, 0
  v_dot2_f32_bf16 v25, v125, v5, v25
  v_dot2_f32_bf16 v25, v126, v6, v25
  v_dot2_f32_bf16 v25, v127, v7, v25
  s_cbranch_vccz L_d207
  s_waitcnt vmcnt(6)
L_d207:
  s_xor_b32 s68, s70, 0x64900
  buffer_load_dwordx4 v[84:87], v63, s[4:7], s68 offen nt
  v_add_f32_dpp v26, v22, v22 row_ror:8 row_mask:0xf bank_mask:0x3
  v_add_f32_dpp v27, v24, v24 row_ror:8 row_mask:0xf bank_mask:0x3
  s_nop 0
  v_add_f32_dpp v26, v23, v23 row_ror:8 row_mask:0xf bank_mask:0xc
  v_add_f32_dpp v27, v25, v25 row_ror:8 row_mask:0xf bank_mask:0xc
  s_nop 0
  v_add_f32_dpp v28, v26, v26 row_half_mirror row_mask:0xf bank_mask:0x5
  s_nop 1
  v_add_f32_dpp v28, v27, v27 row_half_mirror row_mask:0xf bank_mask:0xa
  s_nop 1
  v_add_f32_dpp v28, v28, v28 quad_perm:[1,0,3,2]
  s_nop 1
  v_add_f32_dpp v243, v28, v28 quad_perm:[2,3,0,1]
  v_max_f32 v20, v20, v243
  s_barrier
  s_waitcnt vmcnt(7)
  v_dot2_f32_bf16 v22, v64, v4, 0
  v_dot2_f32_bf16 v22, v65, v5, v22
  v_dot2_f32_bf16 v22, v66, v6, v22
  v_dot2_f32_bf16 v22, v67, v7, v22
  s_cbranch_vccz L_d208
  s_waitcnt vmcnt(5)
L_d208:
  s_xor_b32 s68, s70, 0x64c00
  buffer_load_dwordx4 v[88:91], v63, s[4:7], s68 offen nt
  s_cmp_eq_u32 s64, 0
  s_cbranch_scc0 L_wp52
  s_mov_b32 s101, 0
  s_waitcnt lgkmcnt(0)
  s_cmp_ge_u32 s40, 4
  s_addc_u32 s101, s101, 0
  s_cmp_ge_u32 s41, 4
  s_addc_u32 s101, s101, 0
  s_cmp_ge_u32 s42, 4
  s_addc_u32 s101, s101, 0
  s_cmp_ge_u32 s43, 4
  s_addc_u32 s101, s101, 0
  s_cmp_ge_u32 s44, 4
  s_addc_u32 s101, s101, 0
  s_cmp_ge_u32 s45, 4
  s_addc_u32 s101, s101, 0
  s_cmp_ge_u32 s46, 4
  s_addc_u32 s101, s101, 0
  s_cmp_ge_u32 s47, 4
  s_addc_u32 s101, s101, 0
  s_cmp_lt_u32 s101, 6
  s_cselect_b32 s38, -1, 0
  v_mov_b32 v26, 0
  v_mov_b32 v27, s38
  ds_write_b32 v26, v27 offset:8512
L_wp52:
  s_waitcnt vmcnt(6)
  v_dot2_f32_bf16 v23, v68, v4, 0
  v_dot2_f32_bf16 v23, v69, v5, v23
  v_dot2_f32_bf16 v23, v70, v6, v23
  v_dot2_f32_bf16 v23, v71, v7, v23
  s_cbranch_vccz L_d209
  s_waitcnt vmcnt(5)
L_d209:
  s_xor_b32 s68, s70, 0x64d00
  buffer_load_dwordx4 v[92:95], v63, s[4:7], s68 offen nt
  v_and_b32_dpp v52, v47, v40 row_newbcast:11
  v_and_b32_dpp v53, v47, v41 row_newbcast:11
  v_and_b32_dpp v54, v47, v42 row_newbcast:11
  v_and_b32_dpp v55, v47, v43 row_newbcast:11
  s_nop 1
  v_mfma_f32_16x16x32_bf16 v[56:59], v[52:55], a[188:191], v[56:59]
  s_waitcnt vmcnt(6)
  v_dot2_f32_bf16 v24, v72, v4, 0
  v_dot2_f32_bf16 v24, v73, v5, v24
  v_dot2_f32_bf16 v24, v74, v6, v24
  v_dot2_f32_bf16 v24, v75, v7, v24
  s_cbranch_vccz L_d210
  s_waitcnt vmcnt(5)
L_d210:
  s_xor_b32 s68, s70, 0x74000
  buffer_load_dwordx4 v[96:99], v63, s[4:7], s68 offen nt
  buffer_load_dwordx4 a[200:203], v2, s[24:27], s73 offen
  s_add_u32 s73, s73, 8192
  s_waitcnt vmcnt(7)
  v_dot2_f32_bf16 v25, v76, v4, 0
  v_dot2_f32_bf16 v25, v77, v5, v25
  v_dot2_f32_bf16 v25, v78, v6, v25
  v_dot2_f32_bf16 v25, v79, v7, v25
  s_cbranch_vccz L_d211
  s_waitcnt vmcnt(6)
L_d211:
  s_xor_b32 s68, s70, 0x74100
  buffer_load_dwordx4 v[100:103], v63, s[4:7], s68 offen nt
  v_add_f32_dpp v26, v22, v22 row_ror:8 row_mask:0xf bank_mask:0x3
  v_add_f32_dpp v27, v24, v24 row_ror:8 row_mask:0xf bank_mask:0x3
  s_nop 0
  v_add_f32_dpp v26, v23, v23 row_ror:8 row_mask:0xf bank_mask:0xc
  v_add_f32_dpp v27, v25, v25 row_ror:8 row_mask:0xf bank_mask:0xc
  s_nop 0
  v_add_f32_dpp v28, v26, v26 row_half_mirror row_mask:0xf bank_mask:0x5
  s_nop 1
  v_add_f32_dpp v28, v27, v27 row_half_mirror row_mask:0xf bank_mask:0xa
  s_nop 1
  v_add_f32_dpp v28, v28, v28 quad_perm:[1,0,3,2]
  s_nop 1
  v_add_f32_dpp v244, v28, v28 quad_perm:[2,3,0,1]
  v_max_f32 v20, v20, v244
  s_barrier
  s_waitcnt vmcnt(7)
  v_dot2_f32_bf16 v22, v80, v4, 0
  v_dot2_f32_bf16 v22, v81, v5, v22
  v_dot2_f32_bf16 v22, v82, v6, v22
  v_dot2_f32_bf16 v22, v83, v7, v22
  s_cbranch_vccz L_d212
  s_waitcnt vmcnt(5)
L_d212:
  s_xor_b32 s68, s70, 0x74400
  buffer_load_dwordx4 v[104:107], v63, s[4:7], s68 offen nt
  v_mov_b32 v26, 0
  ds_read_b32 v35, v26 offset:8512
  s_waitcnt vmcnt(6)
  v_dot2_f32_bf16 v23, v84, v4, 0
  v_dot2_f32_bf16 v23, v85, v5, v23
  v_dot2_f32_bf16 v23, v86, v6, v23
  v_dot2_f32_bf16 v23, v87, v7, v23
  s_cbranch_vccz L_d213
  s_waitcnt vmcnt(5)
L_d213:
  s_xor_b32 s68, s70, 0x74500
  buffer_load_dwordx4 v[108:111], v63, s[4:7], s68 offen nt
  v_and_b32_dpp v48, v44, v40 row_newbcast:12
  v_and_b32_dpp v49, v44, v41 row_newbcast:12
  v_and_b32_dpp v50, v44, v42 row_newbcast:12
  v_and_b32_dpp v51, v44, v43 row_newbcast:12
  s_nop 1
  v_mfma_f32_16x16x32_bf16 v[56:59], v[48:51], a[192:195], v[56:59]
  s_waitcnt vmcnt(6)
  v_dot2_f32_bf16 v24, v88, v4, 0
  v_dot2_f32_bf16 v24, v89, v5, v24
  v_dot2_f32_bf16 v24, v90, v6, v24
  v_dot2_f32_bf16 v24, v91, v7, v24
  s_cbranch_vccz L_d214
  s_waitcnt vmcnt(5)
L_d214:
  s_xor_b32 s68, s70, 0x74800
  buffer_load_dwordx4 v[112:115], v63, s[4:7], s68 offen nt
  buffer_load_dwordx4 a[204:207], v2, s[24:27], s73 offen
  s_add_u32 s73, s73, 8192
  s_waitcnt vmcnt(7)
  v_dot2_f32_bf16 v25, v92, v4, 0
  v_dot2_f32_bf16 v25, v93, v5, v25
  v_dot2_f32_bf16 v25, v94, v6, v25
  v_dot2_f32_bf16 v25, v95, v7, v25
  s_cbranch_vccz L_d215
  s_waitcnt vmcnt(6)
L_d215:
  s_xor_b32 s68, s70, 0x74900
  buffer_load_dwordx4 v[116:119], v63, s[4:7], s68 offen nt
  v_add_f32_dpp v26, v22, v22 row_ror:8 row_mask:0xf bank_mask:0x3
  v_add_f32_dpp v27, v24, v24 row_ror:8 row_mask:0xf bank_mask:0x3
  s_nop 0
  v_add_f32_dpp v26, v23, v23 row_ror:8 row_mask:0xf bank_mask:0xc
  v_add_f32_dpp v27, v25, v25 row_ror:8 row_mask:0xf bank_mask:0xc
  s_nop 0
  v_add_f32_dpp v28, v26, v26 row_half_mirror row_mask:0xf bank_mask:0x5
  s_nop 1
  v_add_f32_dpp v28, v27, v27 row_half_mirror row_mask:0xf bank_mask:0xa
  s_nop 1
  v_add_f32_dpp v28, v28, v28 quad_perm:[1,0,3,2]
  s_nop 1
  v_add_f32_dpp v245, v28, v28 quad_perm:[2,3,0,1]
  v_max_f32 v20, v20, v245
  s_barrier
  s_waitcnt vmcnt(7)
  v_dot2_f32_bf16 v22, v96, v4, 0
  v_dot2_f32_bf16 v22, v97, v5, v22
  v_dot2_f32_bf16 v22, v98, v6, v22
  v_dot2_f32_bf16 v22, v99, v7, v22
  s_cbranch_vccz L_d216
  s_waitcnt vmcnt(5)
L_d216:
  s_xor_b32 s68, s70, 0x74c00
  buffer_load_dwordx4 v[120:123], v63, s[4:7], s68 offen nt
  s_waitcnt lgkmcnt(0)
  v_cmp_ne_u32 vcc, 0, v35
  s_waitcnt vmcnt(6)
  v_dot2_f32_bf16 v23, v100, v4, 0
  v_dot2_f32_bf16 v23, v101, v5, v23
  v_dot2_f32_bf16 v23, v102, v6, v23
  v_dot2_f32_bf16 v23, v103, v7, v23
  s_cbranch_vccz L_d217
  s_waitcnt vmcnt(5)
L_d217:
  s_xor_b32 s68, s70, 0x74d00
  buffer_load_dwordx4 v[124:127], v63, s[4:7], s68 offen nt
  v_and_b32_dpp v52, v45, v40 row_newbcast:12
  v_and_b32_dpp v53, v45, v41 row_newbcast:12
  v_and_b32_dpp v54, v45, v42 row_newbcast:12
  v_and_b32_dpp v55, v45, v43 row_newbcast:12
  s_nop 1
  v_mfma_f32_16x16x32_bf16 v[56:59], v[52:55], a[196:199], v[56:59]
  s_waitcnt vmcnt(6)
  v_dot2_f32_bf16 v24, v104, v4, 0
  v_dot2_f32_bf16 v24, v105, v5, v24
  v_dot2_f32_bf16 v24, v106, v6, v24
  v_dot2_f32_bf16 v24, v107, v7, v24
  s_cbranch_vccz L_d218
  s_waitcnt vmcnt(5)
L_d218:
  s_xor_b32 s68, s70, 0xc4000
  buffer_load_dwordx4 v[64:67], v63, s[4:7], s68 offen nt
  buffer_load_dwordx4 a[208:211], v2, s[24:27], s73 offen
  s_add_u32 s73, s73, 8192
  s_waitcnt vmcnt(7)
  v_dot2_f32_bf16 v25, v108, v4, 0
  v_dot2_f32_bf16 v25, v109, v5, v25
  v_dot2_f32_bf16 v25, v110, v6, v25
  v_dot2_f32_bf16 v25, v111, v7, v25
  s_cbranch_vccz L_d219
  s_waitcnt vmcnt(6)
L_d219:
  s_xor_b32 s68, s70, 0xc4100
  buffer_load_dwordx4 v[68:71], v63, s[4:7], s68 offen nt
  v_add_f32_dpp v26, v22, v22 row_ror:8 row_mask:0xf bank_mask:0x3
  v_add_f32_dpp v27, v24, v24 row_ror:8 row_mask:0xf bank_mask:0x3
  s_nop 0
  v_add_f32_dpp v26, v23, v23 row_ror:8 row_mask:0xf bank_mask:0xc
  v_add_f32_dpp v27, v25, v25 row_ror:8 row_mask:0xf bank_mask:0xc
  s_nop 0
  v_add_f32_dpp v28, v26, v26 row_half_mirror row_mask:0xf bank_mask:0x5
  s_nop 1
  v_add_f32_dpp v28, v27, v27 row_half_mirror row_mask:0xf bank_mask:0xa
  s_nop 1
  v_add_f32_dpp v28, v28, v28 quad_perm:[1,0,3,2]
  s_nop 1
  v_add_f32_dpp v246, v28, v28 quad_perm:[2,3,0,1]
  v_max_f32 v20, v20, v246
  s_barrier
  s_waitcnt vmcnt(7)
  v_dot2_f32_bf16 v22, v112, v4, 0
  v_dot2_f32_bf16 v22, v113, v5, v22
  v_dot2_f32_bf16 v22, v114, v6, v22
  v_dot2_f32_bf16 v22, v115, v7, v22
  s_cbranch_vccz L_d220
  s_waitcnt vmcnt(5)
L_d220:
  s_xor_b32 s68, s70, 0xc4400
  buffer_load_dwordx4 v[72:75], v63, s[4:7], s68 offen nt
  s_waitcnt vmcnt(6)
  v_dot2_f32_bf16 v23, v116, v4, 0
  v_dot2_f32_bf16 v23, v117, v5, v23
  v_dot2_f32_bf16 v23, v118, v6, v23
  v_dot2_f32_bf16 v23, v119, v7, v23
  s_cbranch_vccz L_d221
  s_waitcnt vmcnt(5)
L_d221:
  s_xor_b32 s68, s70, 0xc4500
  buffer_load_dwordx4 v[76:79], v63, s[4:7], s68 offen nt
  v_and_b32_dpp v48, v46, v40 row_newbcast:12
  v_and_b32_dpp v49, v46, v41 row_newbcast:12
  v_and_b32_dpp v50, v46, v42 row_newbcast:12
  v_and_b32_dpp v51, v46, v43 row_newbcast:12
  s_nop 1
  v_mfma_f32_16x16x32_bf16 v[56:59], v[48:51], a[200:203], v[56:59]
  s_waitcnt vmcnt(6)
  v_dot2_f32_bf16 v24, v120, v4, 0
  v_dot2_f32_bf16 v24, v121, v5, v24
  v_dot2_f32_bf16 v24, v122, v6, v24
  v_dot2_f32_bf16 v24, v123, v7, v24
  s_cbranch_vccz L_d222
  s_waitcnt vmcnt(5)
L_d222:
  s_xor_b32 s68, s70, 0xc4800
  buffer_load_dwordx4 v[80:83], v63, s[4:7], s68 offen nt
  buffer_load_dwordx4 a[212:215], v2, s[24:27], s73 offen
  s_add_u32 s73, s73, 8192
  s_waitcnt vmcnt(7)
  v_dot2_f32_bf16 v25, v124, v4, 0
  v_dot2_f32_bf16 v25, v125, v5, v25
  v_dot2_f32_bf16 v25, v126, v6, v25
  v_dot2_f32_bf16 v25, v127, v7, v25
  s_cbranch_vccz L_d223
  s_waitcnt vmcnt(6)
L_d223:
  s_xor_b32 s68, s70, 0xc4900
  buffer_load_dwordx4 v[84:87], v63, s[4:7], s68 offen nt
  v_add_f32_dpp v26, v22, v22 row_ror:8 row_mask:0xf bank_mask:0x3
  v_add_f32_dpp v27, v24, v24 row_ror:8 row_mask:0xf bank_mask:0x3
  s_nop 0
  v_add_f32_dpp v26, v23, v23 row_ror:8 row_mask:0xf bank_mask:0xc
  v_add_f32_dpp v27, v25, v25 row_ror:8 row_mask:0xf bank_mask:0xc
  s_nop 0
  v_add_f32_dpp v28, v26, v26 row_half_mirror row_mask:0xf bank_mask:0x5
  s_nop 1
  v_add_f32_dpp v28, v27, v27 row_half_mirror row_mask:0xf bank_mask:0xa
  s_nop 1
  v_add_f32_dpp v28, v28, v28 quad_perm:[1,0,3,2]
  s_nop 1
  v_add_f32_dpp v247, v28, v28 quad_perm:[2,3,0,1]
  v_max_f32 v20, v20, v247
  s_barrier
  s_waitcnt vmcnt(7)
  v_dot2_f32_bf16 v22, v64, v4, 0
  v_dot2_f32_bf16 v22, v65, v5, v22
  v_dot2_f32_bf16 v22, v66, v6, v22
  v_dot2_f32_bf16 v22, v67, v7, v22
  s_cbranch_vccz L_d224
  s_waitcnt vmcnt(5)
L_d224:
  s_xor_b32 s68, s70, 0xc4c00
  buffer_load_dwordx4 v[88:91], v63, s[4:7], s68 offen nt
  s_waitcnt vmcnt(6)
  v_dot2_f32_bf16 v23, v68, v4, 0
  v_dot2_f32_bf16 v23, v69, v5, v23
  v_dot2_f32_bf16 v23, v70, v6, v23
  v_dot2_f32_bf16 v23, v71, v7, v23
  s_cbranch_vccz L_d225
  s_waitcnt vmcnt(5)
L_d225:
  s_xor_b32 s68, s70, 0xc4d00
  buffer_load_dwordx4 v[92:95], v63, s[4:7], s68 offen nt
  v_and_b32_dpp v52, v47, v40 row_newbcast:12
  v_and_b32_dpp v53, v47, v41 row_newbcast:12
  v_and_b32_dpp v54, v47, v42 row_newbcast:12
  v_and_b32_dpp v55, v47, v43 row_newbcast:12
  s_nop 1
  v_mfma_f32_16x16x32_bf16 v[56:59], v[52:55], a[204:207], v[56:59]
  s_waitcnt vmcnt(6)
  v_dot2_f32_bf16 v24, v72, v4, 0
  v_dot2_f32_bf16 v24, v73, v5, v24
  v_dot2_f32_bf16 v24, v74, v6, v24
  v_dot2_f32_bf16 v24, v75, v7, v24
  s_cbranch_vccz L_d226
  s_waitcnt vmcnt(5)
L_d226:
  s_xor_b32 s68, s70, 0xd4000
  buffer_load_dwordx4 v[96:99], v63, s[4:7], s68 offen nt
  buffer_load_dwordx4 a[216:219], v2, s[24:27], s73 offen
  s_add_u32 s73, s73, 8192
  s_waitcnt vmcnt(7)
  v_dot2_f32_bf16 v25, v76, v4, 0
  v_dot2_f32_bf16 v25, v77, v5, v25
  v_dot2_f32_bf16 v25, v78, v6, v25
  v_dot2_f32_bf16 v25, v79, v7, v25
  s_cbranch_vccz L_d227
  s_waitcnt vmcnt(6)
L_d227:
  s_xor_b32 s68, s70, 0xd4100
  buffer_load_dwordx4 v[100:103], v63, s[4:7], s68 offen nt
  v_add_f32_dpp v26, v22, v22 row_ror:8 row_mask:0xf bank_mask:0x3
  v_add_f32_dpp v27, v24, v24 row_ror:8 row_mask:0xf bank_mask:0x3
  s_nop 0
  v_add_f32_dpp v26, v23, v23 row_ror:8 row_mask:0xf bank_mask:0xc
  v_add_f32_dpp v27, v25, v25 row_ror:8 row_mask:0xf bank_mask:0xc
  s_nop 0
  v_add_f32_dpp v28, v26, v26 row_half_mirror row_mask:0xf bank_mask:0x5
  s_nop 1
  v_add_f32_dpp v28, v27, v27 row_half_mirror row_mask:0xf bank_mask:0xa
  s_nop 1
  v_add_f32_dpp v28, v28, v28 quad_perm:[1,0,3,2]
  s_nop 1
  v_add_f32_dpp v248, v28, v28 quad_perm:[2,3,0,1]
  v_max_f32 v20, v20, v248
  s_barrier
  s_waitcnt vmcnt(7)
  v_dot2_f32_bf16 v22, v80, v4, 0
  v_dot2_f32_bf16 v22, v81, v5, v22
  v_dot2_f32_bf16 v22, v82, v6, v22
  v_dot2_f32_bf16 v22, v83, v7, v22
  s_cbranch_vccz L_d228
  s_waitcnt vmcnt(5)
L_d228:
  s_xor_b32 s68, s70, 0xd4400
  buffer_load_dwordx4 v[104:107], v63, s[4:7], s68 offen nt
  s_waitcnt vmcnt(6)
  v_dot2_f32_bf16 v23, v84, v4, 0
  v_dot2_f32_bf16 v23, v85, v5, v23
  v_dot2_f32_bf16 v23, v86, v6, v23
  v_dot2_f32_bf16 v23, v87, v7, v23
  s_cbranch_vccz L_d229
  s_waitcnt vmcnt(5)
L_d229:
  s_xor_b32 s68, s70, 0xd4500
  buffer_load_dwordx4 v[108:111], v63, s[4:7], s68 offen nt
  v_and_b32_dpp v48, v44, v40 row_newbcast:13
  v_and_b32_dpp v49, v44, v41 row_newbcast:13
  v_and_b32_dpp v50, v44, v42 row_newbcast:13
  v_and_b32_dpp v51, v44, v43 row_newbcast:13
  s_nop 1
  v_mfma_f32_16x16x32_bf16 v[56:59], v[48:51], a[208:211], v[56:59]
  s_waitcnt vmcnt(6)
  v_dot2_f32_bf16 v24, v88, v4, 0
  v_dot2_f32_bf16 v24, v89, v5, v24
  v_dot2_f32_bf16 v24, v90, v6, v24
  v_dot2_f32_bf16 v24, v91, v7, v24
  s_cbranch_vccz L_d230
  s_waitcnt vmcnt(5)
L_d230:
  s_xor_b32 s68, s70, 0xd4800
  buffer_load_dwordx4 v[112:115], v63, s[4:7], s68 offen nt
  buffer_load_dwordx4 a[220:223], v2, s[24:27], s73 offen
  s_waitcnt vmcnt(7)
  v_dot2_f32_bf16 v25, v92, v4, 0
  v_dot2_f32_bf16 v25, v93, v5, v25
  v_dot2_f32_bf16 v25, v94, v6, v25
  v_dot2_f32_bf16 v25, v95, v7, v25
  s_cbranch_vccz L_d231
  s_waitcnt vmcnt(6)
L_d231:
  s_xor_b32 s68, s70, 0xd4900
  buffer_load_dwordx4 v[116:119], v63, s[4:7], s68 offen nt
  v_add_f32_dpp v26, v22, v22 row_ror:8 row_mask:0xf bank_mask:0x3
  v_add_f32_dpp v27, v24, v24 row_ror:8 row_mask:0xf bank_mask:0x3
  s_nop 0
  v_add_f32_dpp v26, v23, v23 row_ror:8 row_mask:0xf bank_mask:0xc
  v_add_f32_dpp v27, v25, v25 row_ror:8 row_mask:0xf bank_mask:0xc
  s_nop 0
  v_add_f32_dpp v28, v26, v26 row_half_mirror row_mask:0xf bank_mask:0x5
  s_nop 1
  v_add_f32_dpp v28, v27, v27 row_half_mirror row_mask:0xf bank_mask:0xa
  s_nop 1
  v_add_f32_dpp v28, v28, v28 quad_perm:[1,0,3,2]
  s_nop 1
  v_add_f32_dpp v249, v28, v28 quad_perm:[2,3,0,1]
  v_max_f32 v20, v20, v249
  s_barrier
  s_waitcnt vmcnt(7)
  v_dot2_f32_bf16 v22, v96, v4, 0
  v_dot2_f32_bf16 v22, v97, v5, v22
  v_dot2_f32_bf16 v22, v98, v6, v22
  v_dot2_f32_bf16 v22, v99, v7, v22
  s_cbranch_vccz L_d232
  s_waitcnt vmcnt(5)
L_d232:
  s_xor_b32 s68, s70, 0xd4c00
  buffer_load_dwordx4 v[120:123], v63, s[4:7], s68 offen nt
  s_waitcnt vmcnt(6)
  v_dot2_f32_bf16 v23, v100, v4, 0
  v_dot2_f32_bf16 v23, v101, v5, v23
  v_dot2_f32_bf16 v23, v102, v6, v23
  v_dot2_f32_bf16 v23, v103, v7, v23
  s_cbranch_vccz L_d233
  s_waitcnt vmcnt(5)
L_d233:
  s_xor_b32 s68, s70, 0xd4d00
  buffer_load_dwordx4 v[124:127], v63, s[4:7], s68 offen nt
  v_and_b32_dpp v52, v45, v40 row_newbcast:13
  v_and_b32_dpp v53, v45, v41 row_newbcast:13
  v_and_b32_dpp v54, v45, v42 row_newbcast:13
  v_and_b32_dpp v55, v45, v43 row_newbcast:13
  s_nop 1
  v_mfma_f32_16x16x32_bf16 v[56:59], v[52:55], a[212:215], v[56:59]
  s_waitcnt vmcnt(6)
  v_dot2_f32_bf16 v24, v104, v4, 0
  v_dot2_f32_bf16 v24, v105, v5, v24
  v_dot2_f32_bf16 v24, v106, v6, v24
  v_dot2_f32_bf16 v24, v107, v7, v24
  s_cbranch_vccz L_d234
  s_waitcnt vmcnt(5)
L_d234:
  s_xor_b32 s68, s70, 0xe4000
  buffer_load_dwordx4 v[64:67], v63, s[4:7], s68 offen nt
  s_lshl_b32 s73, s81, 16
  s_add_u32 s73, s73, s72
  buffer_load_dwordx4 a[224:227], v2, s[24:27], s73 offen
  s_add_u32 s73, s73, 8192
  s_waitcnt vmcnt(7)
  v_dot2_f32_bf16 v25, v108, v4, 0
  v_dot2_f32_bf16 v25, v109, v5, v25
  v_dot2_f32_bf16 v25, v110, v6, v25
  v_dot2_f32_bf16 v25, v111, v7, v25
  s_cbranch_vccz L_d235
  s_waitcnt vmcnt(6)
L_d235:
  s_xor_b32 s68, s70, 0xe4100
  buffer_load_dwordx4 v[68:71], v63, s[4:7], s68 offen nt
  v_add_f32_dpp v26, v22, v22 row_ror:8 row_mask:0xf bank_mask:0x3
  v_add_f32_dpp v27, v24, v24 row_ror:8 row_mask:0xf bank_mask:0x3
  s_nop 0
  v_add_f32_dpp v26, v23, v23 row_ror:8 row_mask:0xf bank_mask:0xc
  v_add_f32_dpp v27, v25, v25 row_ror:8 row_mask:0xf bank_mask:0xc
  s_nop 0
  v_add_f32_dpp v28, v26, v26 row_half_mirror row_mask:0xf bank_mask:0x5
  s_nop 1
  v_add_f32_dpp v28, v27, v27 row_half_mirror row_mask:0xf bank_mask:0xa
  s_nop 1
  v_add_f32_dpp v28, v28, v28 quad_perm:[1,0,3,2]
  s_nop 1
  v_add_f32_dpp v250, v28, v28 quad_perm:[2,3,0,1]
  v_max_f32 v20, v20, v250
  s_barrier
  s_waitcnt vmcnt(7)
  v_dot2_f32_bf16 v22, v112, v4, 0
  v_dot2_f32_bf16 v22, v113, v5, v22
  v_dot2_f32_bf16 v22, v114, v6, v22
  v_dot2_f32_bf16 v22, v115, v7, v22
  s_cbranch_vccz L_d236
  s_waitcnt vmcnt(5)
L_d236:
  s_xor_b32 s68, s70, 0xe4400
  buffer_load_dwordx4 v[72:75], v63, s[4:7], s68 offen nt
  s_waitcnt vmcnt(6)
  v_dot2_f32_bf16 v23, v116, v4, 0
  v_dot2_f32_bf16 v23, v117, v5, v23
  v_dot2_f32_bf16 v23, v118, v6, v23
  v_dot2_f32_bf16 v23, v119, v7, v23
  s_cbranch_vccz L_d237
  s_waitcnt vmcnt(5)
L_d237:
  s_xor_b32 s68, s70, 0xe4500
  buffer_load_dwordx4 v[76:79], v63, s[4:7], s68 offen nt
  v_and_b32_dpp v48, v46, v40 row_newbcast:13
  v_and_b32_dpp v49, v46, v41 row_newbcast:13
  v_and_b32_dpp v50, v46, v42 row_newbcast:13
  v_and_b32_dpp v51, v46, v43 row_newbcast:13
  s_nop 1
  v_mfma_f32_16x16x32_bf16 v[56:59], v[48:51], a[216:219], v[56:59]
  s_waitcnt vmcnt(6)
  v_dot2_f32_bf16 v24, v120, v4, 0
  v_dot2_f32_bf16 v24, v121, v5, v24
  v_dot2_f32_bf16 v24, v122, v6, v24
  v_dot2_f32_bf16 v24, v123, v7, v24
  s_cbranch_vccz L_d238
  s_waitcnt vmcnt(5)
L_d238:
  s_xor_b32 s68, s70, 0xe4800
  buffer_load_dwordx4 v[80:83], v63, s[4:7], s68 offen nt
  buffer_load_dwordx4 a[228:231], v2, s[24:27], s73 offen
  s_add_u32 s73, s73, 8192
  s_waitcnt vmcnt(7)
  v_dot2_f32_bf16 v25, v124, v4, 0
  v_dot2_f32_bf16 v25, v125, v5, v25
  v_dot2_f32_bf16 v25, v126, v6, v25
  v_dot2_f32_bf16 v25, v127, v7, v25
  s_cbranch_vccz L_d239
  s_waitcnt vmcnt(6)
L_d239:
  s_xor_b32 s68, s70, 0xe4900
  buffer_load_dwordx4 v[84:87], v63, s[4:7], s68 offen nt
  v_add_f32_dpp v26, v22, v22 row_ror:8 row_mask:0xf bank_mask:0x3
  v_add_f32_dpp v27, v24, v24 row_ror:8 row_mask:0xf bank_mask:0x3
  s_nop 0
  v_add_f32_dpp v26, v23, v23 row_ror:8 row_mask:0xf bank_mask:0xc
  v_add_f32_dpp v27, v25, v25 row_ror:8 row_mask:0xf bank_mask:0xc
  s_nop 0
  v_add_f32_dpp v28, v26, v26 row_half_mirror row_mask:0xf bank_mask:0x5
  s_nop 1
  v_add_f32_dpp v28, v27, v27 row_half_mirror row_mask:0xf bank_mask:0xa
  s_nop 1
  v_add_f32_dpp v28, v28, v28 quad_perm:[1,0,3,2]
  s_nop 1
  v_add_f32_dpp v251, v28, v28 quad_perm:[2,3,0,1]
  v_max_f32 v20, v20, v251
  s_barrier
  s_waitcnt vmcnt(7)
  v_dot2_f32_bf16 v22, v64, v4, 0
  v_dot2_f32_bf16 v22, v65, v5, v22
  v_dot2_f32_bf16 v22, v66, v6, v22
  v_dot2_f32_bf16 v22, v67, v7, v22
  s_cbranch_vccz L_d240
  s_waitcnt vmcnt(5)
L_d240:
  s_xor_b32 s68, s70, 0xe4c00
  buffer_load_dwordx4 v[88:91], v63, s[4:7], s68 offen nt
  s_waitcnt vmcnt(6)
  v_dot2_f32_bf16 v23, v68, v4, 0
  v_dot2_f32_bf16 v23, v69, v5, v23
  v_dot2_f32_bf16 v23, v70, v6, v23
  v_dot2_f32_bf16 v23, v71, v7, v23
  s_cbranch_vccz L_d241
  s_waitcnt vmcnt(5)
L_d241:
  s_xor_b32 s68, s70, 0xe4d00
  buffer_load_dwordx4 v[92:95], v63, s[4:7], s68 offen nt
  v_and_b32_dpp v52, v47, v40 row_newbcast:13
  v_and_b32_dpp v53, v47, v41 row_newbcast:13
  v_and_b32_dpp v54, v47, v42 row_newbcast:13
  v_and_b32_dpp v55, v47, v43 row_newbcast:13
  s_nop 1
  v_mfma_f32_16x16x32_bf16 v[56:59], v[52:55], a[220:223], v[56:59]
  s_waitcnt vmcnt(6)
  v_dot2_f32_bf16 v24, v72, v4, 0
  v_dot2_f32_bf16 v24, v73, v5, v24
  v_dot2_f32_bf16 v24, v74, v6, v24
  v_dot2_f32_bf16 v24, v75, v7, v24
  s_cbranch_vccz L_d242
  s_waitcnt vmcnt(5)
L_d242:
  s_xor_b32 s68, s70, 0xf4000
  buffer_load_dwordx4 v[96:99], v63, s[4:7], s68 offen nt
  buffer_load_dwordx4 a[232:235], v2, s[24:27], s73 offen
  s_add_u32 s73, s73, 8192
  s_waitcnt vmcnt(7)
  v_dot2_f32_bf16 v25, v76, v4, 0
  v_dot2_f32_bf16 v25, v77, v5, v25
  v_dot2_f32_bf16 v25, v78, v6, v25
  v_dot2_f32_bf16 v25, v79, v7, v25
  s_cbranch_vccz L_d243
  s_waitcnt vmcnt(6)
L_d243:
  s_xor_b32 s68, s70, 0xf4100
  buffer_load_dwordx4 v[100:103], v63, s[4:7], s68 offen nt
  v_add_f32_dpp v26, v22, v22 row_ror:8 row_mask:0xf bank_mask:0x3
  v_add_f32_dpp v27, v24, v24 row_ror:8 row_mask:0xf bank_mask:0x3
  s_nop 0
  v_add_f32_dpp v26, v23, v23 row_ror:8 row_mask:0xf bank_mask:0xc
  v_add_f32_dpp v27, v25, v25 row_ror:8 row_mask:0xf bank_mask:0xc
  s_nop 0
  v_add_f32_dpp v28, v26, v26 row_half_mirror row_mask:0xf bank_mask:0x5
  s_nop 1
  v_add_f32_dpp v28, v27, v27 row_half_mirror row_mask:0xf bank_mask:0xa
  s_nop 1
  v_add_f32_dpp v28, v28, v28 quad_perm:[1,0,3,2]
  s_nop 1
  v_add_f32_dpp v252, v28, v28 quad_perm:[2,3,0,1]
  v_max_f32 v20, v20, v252
  s_barrier
  s_waitcnt vmcnt(7)
  v_dot2_f32_bf16 v22, v80, v4, 0
  v_dot2_f32_bf16 v22, v81, v5, v22
  v_dot2_f32_bf16 v22, v82, v6, v22
  v_dot2_f32_bf16 v22, v83, v7, v22
  s_cbranch_vccz L_d244
  s_waitcnt vmcnt(5)
L_d244:
  s_xor_b32 s68, s70, 0xf4400
  buffer_load_dwordx4 v[104:107], v63, s[4:7], s68 offen nt
  s_waitcnt vmcnt(6)
  v_dot2_f32_bf16 v23, v84, v4, 0
  v_dot2_f32_bf16 v23, v85, v5, v23
  v_dot2_f32_bf16 v23, v86, v6, v23
  v_dot2_f32_bf16 v23, v87, v7, v23
  s_cbranch_vccz L_d245
  s_waitcnt vmcnt(5)
L_d245:
  s_xor_b32 s68, s70, 0xf4500
  buffer_load_dwordx4 v[108:111], v63, s[4:7], s68 offen nt
  v_and_b32_dpp v48, v44, v40 row_newbcast:14
  v_and_b32_dpp v49, v44, v41 row_newbcast:14
  v_and_b32_dpp v50, v44, v42 row_newbcast:14
  v_and_b32_dpp v51, v44, v43 row_newbcast:14
  s_nop 1
  v_mfma_f32_16x16x32_bf16 v[56:59], v[48:51], a[224:227], v[56:59]
  s_waitcnt vmcnt(6)
  v_dot2_f32_bf16 v24, v88, v4, 0
  v_dot2_f32_bf16 v24, v89, v5, v24
  v_dot2_f32_bf16 v24, v90, v6, v24
  v_dot2_f32_bf16 v24, v91, v7, v24
  s_cbranch_vccz L_d246
  s_waitcnt vmcnt(5)
L_d246:
  s_xor_b32 s68, s70, 0xf4800
  buffer_load_dwordx4 v[112:115], v63, s[4:7], s68 offen nt
  buffer_load_dwordx4 a[236:239], v2, s[24:27], s73 offen
  s_add_u32 s73, s73, 8192
  s_waitcnt vmcnt(7)
  v_dot2_f32_bf16 v25, v92, v4, 0
  v_dot2_f32_bf16 v25, v93, v5, v25
  v_dot2_f32_bf16 v25, v94, v6, v25
  v_dot2_f32_bf16 v25, v95, v7, v25
  s_cbranch_vccz L_d247
  s_waitcnt vmcnt(6)
L_d247:
  s_xor_b32 s68, s70, 0xf4900
  buffer_load_dwordx4 v[116:119], v63, s[4:7], s68 offen nt
  v_add_f32_dpp v26, v22, v22 row_ror:8 row_mask:0xf bank_mask:0x3
  v_add_f32_dpp v27, v24, v24 row_ror:8 row_mask:0xf bank_mask:0x3
  s_nop 0
  v_add_f32_dpp v26, v23, v23 row_ror:8 row_mask:0xf bank_mask:0xc
  v_add_f32_dpp v27, v25, v25 row_ror:8 row_mask:0xf bank_mask:0xc
  s_nop 0
  v_add_f32_dpp v28, v26, v26 row_half_mirror row_mask:0xf bank_mask:0x5
  s_nop 1
  v_add_f32_dpp v28, v27, v27 row_half_mirror row_mask:0xf bank_mask:0xa
  s_nop 1
  v_add_f32_dpp v28, v28, v28 quad_perm:[1,0,3,2]
  s_nop 1
  v_add_f32_dpp v253, v28, v28 quad_perm:[2,3,0,1]
  v_max_f32 v20, v20, v253
  s_barrier
  s_waitcnt vmcnt(7)
  v_dot2_f32_bf16 v22, v96, v4, 0
  v_dot2_f32_bf16 v22, v97, v5, v22
  v_dot2_f32_bf16 v22, v98, v6, v22
  v_dot2_f32_bf16 v22, v99, v7, v22
  s_cbranch_vccz L_d248
  s_waitcnt vmcnt(5)
L_d248:
  s_xor_b32 s68, s70, 0xf4c00
  buffer_load_dwordx4 v[120:123], v63, s[4:7], s68 offen nt
  s_cmp_eq_u32 s64, 1
  s_cbranch_scc0 L_wp62
  s_mov_b32 s100, 5
  s_atomic_umax s100, s[20:21], s88
  s_and_b32 s60, s88, 0xfffffc7f
  s_xor_b32 s61, s60, 2048
  s_add_u32 s38, s61, 0
  s_load_dword s40, s[20:21], s38 glc
  s_add_u32 s38, s60, 128
  s_load_dword s41, s[20:21], s38 glc
  s_add_u32 s38, s60, 256
  s_load_dword s42, s[20:21], s38 glc
  s_add_u32 s38, s61, 384
  s_load_dword s43, s[20:21], s38 glc
  s_add_u32 s38, s61, 512
  s_load_dword s44, s[20:21], s38 glc
  s_add_u32 s38, s60, 640
  s_load_dword s45, s[20:21], s38 glc
  s_add_u32 s38, s60, 768
  s_load_dword s46, s[20:21], s38 glc
  s_add_u32 s38, s61, 896
  s_load_dword s47, s[20:21], s38 glc
L_wp62:
  s_waitcnt vmcnt(6)
  v_dot2_f32_bf16 v23, v100, v4, 0
  v_dot2_f32_bf16 v23, v101, v5, v23
  v_dot2_f32_bf16 v23, v102, v6, v23
  v_dot2_f32_bf16 v23, v103, v7, v23
  s_cbranch_vccz L_d249
  s_waitcnt vmcnt(5)
L_d249:
  s_xor_b32 s68, s70, 0xf4d00
  buffer_load_dwordx4 v[124:127], v63, s[4:7], s68 offen nt
  v_and_b32_dpp v52, v45, v40 row_newbcast:14
  v_and_b32_dpp v53, v45, v41 row_newbcast:14
  v_and_b32_dpp v54, v45, v42 row_newbcast:14
  v_and_b32_dpp v55, v45, v43 row_newbcast:14
  s_nop 1
  v_mfma_f32_16x16x32_bf16 v[56:59], v[52:55], a[228:231], v[56:59]
  s_waitcnt vmcnt(6)
  v_dot2_f32_bf16 v24, v104, v4, 0
  v_dot2_f32_bf16 v24, v105, v5, v24
  v_dot2_f32_bf16 v24, v106, v6, v24
  v_dot2_f32_bf16 v24, v107, v7, v24
  s_cbranch_vccz L_d250
  s_waitcnt vmcnt(5)
L_d250:
  s_xor_b32 s68, s70, 0x0
  buffer_load_dwordx4 v[64:67], v63, s[8:11], s68 offen nt
  buffer_load_dwordx4 a[240:243], v2, s[24:27], s73 offen
  s_add_u32 s73, s73, 8192
  s_waitcnt vmcnt(7)
  v_dot2_f32_bf16 v25, v108, v4, 0
  v_dot2_f32_bf16 v25, v109, v5, v25
  v_dot2_f32_bf16 v25, v110, v6, v25
  v_dot2_f32_bf16 v25, v111, v7, v25
  s_cbranch_vccz L_d251
  s_waitcnt vmcnt(6)
L_d251:
  s_xor_b32 s68, s70, 0x100
  buffer_load_dwordx4 v[68:71], v63, s[8:11], s68 offen nt
  v_add_f32_dpp v26, v22, v22 row_ror:8 row_mask:0xf bank_mask:0x3
  v_add_f32_dpp v27, v24, v24 row_ror:8 row_mask:0xf bank_mask:0x3
  s_nop 0
  v_add_f32_dpp v26, v23, v23 row_ror:8 row_mask:0xf bank_mask:0xc
  v_add_f32_dpp v27, v25, v25 row_ror:8 row_mask:0xf bank_mask:0xc
  s_nop 0
  v_add_f32_dpp v28, v26, v26 row_half_mirror row_mask:0xf bank_mask:0x5
  s_nop 1
  v_add_f32_dpp v28, v27, v27 row_half_mirror row_mask:0xf bank_mask:0xa
  s_nop 1
  v_add_f32_dpp v28, v28, v28 quad_perm:[1,0,3,2]
  s_nop 1
  v_add_f32_dpp v254, v28, v28 quad_perm:[2,3,0,1]
  v_max_f32 v20, v20, v254
  s_barrier
  s_waitcnt vmcnt(7)
  v_dot2_f32_bf16 v22, v112, v4, 0
  v_dot2_f32_bf16 v22, v113, v5, v22
  v_dot2_f32_bf16 v22, v114, v6, v22
  v_dot2_f32_bf16 v22, v115, v7, v22
  s_cbranch_vccz L_d252
  s_waitcnt vmcnt(5)
L_d252:
  s_xor_b32 s68, s70, 0x400
  buffer_load_dwordx4 v[72:75], v63, s[8:11], s68 offen nt
  s_waitcnt vmcnt(6)
  v_dot2_f32_bf16 v23, v116, v4, 0
  v_dot2_f32_bf16 v23, v117, v5, v23
  v_dot2_f32_bf16 v23, v118, v6, v23
  v_dot2_f32_bf16 v23, v119, v7, v23
  s_cbranch_vccz L_d253
  s_waitcnt vmcnt(5)
L_d253:
  s_xor_b32 s68, s70, 0x500
  buffer_load_dwordx4 v[76:79], v63, s[8:11], s68 offen nt
  v_and_b32_dpp v48, v46, v40 row_newbcast:14
  v_and_b32_dpp v49, v46, v41 row_newbcast:14
  v_and_b32_dpp v50, v46, v42 row_newbcast:14
  v_and_b32_dpp v51, v46, v43 row_newbcast:14
  s_nop 1
  v_mfma_f32_16x16x32_bf16 v[56:59], v[48:51], a[232:235], v[56:59]
  s_waitcnt vmcnt(6)
  v_dot2_f32_bf16 v24, v120, v4, 0
  v_dot2_f32_bf16 v24, v121, v5, v24
  v_dot2_f32_bf16 v24, v122, v6, v24
  v_dot2_f32_bf16 v24, v123, v7, v24
  s_cbranch_vccz L_d254
  s_waitcnt vmcnt(5)
L_d254:
  s_xor_b32 s68, s70, 0x800
  buffer_load_dwordx4 v[80:83], v63, s[8:11], s68 offen nt
  buffer_load_dwordx4 a[244:247], v2, s[24:27], s73 offen
  s_add_u32 s73, s73, 8192
  s_waitcnt vmcnt(7)
  v_dot2_f32_bf16 v25, v124, v4, 0
  v_dot2_f32_bf16 v25, v125, v5, v25
  v_dot2_f32_bf16 v25, v126, v6, v25
  v_dot2_f32_bf16 v25, v127, v7, v25
  s_cbranch_vccz L_d255
  s_waitcnt vmcnt(6)
L_d255:
  s_xor_b32 s68, s70, 0x900
  buffer_load_dwordx4 v[84:87], v63, s[8:11], s68 offen nt
  v_add_f32_dpp v26, v22, v22 row_ror:8 row_mask:0xf bank_mask:0x3
  v_add_f32_dpp v27, v24, v24 row_ror:8 row_mask:0xf bank_mask:0x3
  s_nop 0
  v_add_f32_dpp v26, v23, v23 row_ror:8 row_mask:0xf bank_mask:0xc
  v_add_f32_dpp v27, v25, v25 row_ror:8 row_mask:0xf bank_mask:0xc
  s_nop 0
  v_add_f32_dpp v28, v26, v26 row_half_mirror row_mask:0xf bank_mask:0x5
  s_nop 1
  v_add_f32_dpp v28, v27, v27 row_half_mirror row_mask:0xf bank_mask:0xa
  s_nop 1
  v_add_f32_dpp v28, v28, v28 quad_perm:[1,0,3,2]
  s_nop 1
  v_add_f32_dpp v255, v28, v28 quad_perm:[2,3,0,1]
  v_max_f32 v20, v20, v255
  s_barrier
  s_nop 0
  v_max_f32_dpp v20, v20, v20 row_ror:4
  s_nop 1
  v_max_f32_dpp v20, v20, v20 row_ror:8
  v_mov_b32 v26, v20
  s_nop 1
  v_permlane32_swap_b32 v20, v26
  v_max_f32 v20, v20, v26
  v_mov_b32 v26, v20
  s_nop 1
  v_permlane16_swap_b32 v20, v26
  v_max_f32 v20, v20, v26
  v_mul_f32 v29, s71, v20
  v_mov_b32 v21, 0
  v_mov_b32 v12, 0
  v_mov_b32 v13, 0
  v_mov_b32 v14, 0
  v_mov_b32 v15, 0
  v_mov_b32 v16, 0
  v_mov_b32 v17, 0
  v_mov_b32 v18, 0
  v_mov_b32 v19, 0
  v_fma_f32 v28, v192, s71, -v29
  v_exp_f32 v28, v28
  s_nop 0
  v_cvt_pk_bf16_f32 v30, v28, 0
  v_cvt_pk_bf16_f32 v31, 0, v28
  v_add_f32 v21, v21, v28
  s_waitcnt vmcnt(7)
  v_dot2c_f32_bf16_dpp v12, v30, v64 row_newbcast:0
  v_dot2c_f32_bf16_dpp v13, v31, v64 row_newbcast:0
  v_dot2c_f32_bf16_dpp v14, v30, v65 row_newbcast:0
  v_dot2c_f32_bf16_dpp v15, v31, v65 row_newbcast:0
  v_dot2c_f32_bf16_dpp v16, v30, v66 row_newbcast:0
  v_dot2c_f32_bf16_dpp v17, v31, v66 row_newbcast:0
  v_dot2c_f32_bf16_dpp v18, v30, v67 row_newbcast:0
  v_dot2c_f32_bf16_dpp v19, v31, v67 row_newbcast:0
  s_cbranch_vccz L_d256
  s_waitcnt vmcnt(5)
L_d256:
  s_xor_b32 s68, s70, 0xc00
  buffer_load_dwordx4 v[88:91], v63, s[8:11], s68 offen nt
  s_cmp_eq_u32 s64, 1
  s_cbranch_scc0 L_wp64
  s_mov_b32 s101, 0
  s_waitcnt lgkmcnt(0)
  s_cmp_ge_u32 s40, 5
  s_addc_u32 s101, s101, 0
  s_cmp_ge_u32 s41, 5
  s_addc_u32 s101, s101, 0
  s_cmp_ge_u32 s42, 5
  s_addc_u32 s101, s101, 0
  s_cmp_ge_u32 s43, 5
  s_addc_u32 s101, s101, 0
  s_cmp_ge_u32 s44, 5
  s_addc_u32 s101, s101, 0
  s_cmp_ge_u32 s45, 5
  s_addc_u32 s101, s101, 0
  s_cmp_ge_u32 s46, 5
  s_addc_u32 s101, s101, 0
  s_cmp_ge_u32 s47, 5
  s_addc_u32 s101, s101, 0
  s_cmp_lt_u32 s101, 6
  s_cselect_b32 s38, -1, 0
  v_mov_b32 v26, 0
  v_mov_b32 v27, s38
  ds_write_b32 v26, v27 offset:8512
L_wp64:
  s_waitcnt vmcnt(6)
  v_dot2c_f32_bf16_dpp v12, v30, v68 row_newbcast:8
  v_dot2c_f32_bf16_dpp v13, v31, v68 row_newbcast:8
  v_dot2c_f32_bf16_dpp v14, v30, v69 row_newbcast:8
  v_dot2c_f32_bf16_dpp v15, v31, v69 row_newbcast:8
  v_dot2c_f32_bf16_dpp v16, v30, v70 row_newbcast:8
  v_dot2c_f32_bf16_dpp v17, v31, v70 row_newbcast:8
  v_dot2c_f32_bf16_dpp v18, v30, v71 row_newbcast:8
  v_dot2c_f32_bf16_dpp v19, v31, v71 row_newbcast:8
  s_cbranch_vccz L_d257
  s_waitcnt vmcnt(5)
L_d257:
  s_xor_b32 s68, s70, 0xd00
  buffer_load_dwordx4 v[92:95], v63, s[8:11], s68 offen nt
  v_and_b32_dpp v52, v47, v40 row_newbcast:14
  v_and_b32_dpp v53, v47, v41 row_newbcast:14
  v_and_b32_dpp v54, v47, v42 row_newbcast:14
  v_and_b32_dpp v55, v47, v43 row_newbcast:14
  s_nop 1
  v_mfma_f32_16x16x32_bf16 v[56:59], v[52:55], a[236:239], v[56:59]
  s_waitcnt vmcnt(6)
  v_dot2c_f32_bf16_dpp v12, v30, v72 row_newbcast:4
  v_dot2c_f32_bf16_dpp v13, v31, v72 row_newbcast:4
  v_dot2c_f32_bf16_dpp v14, v30, v73 row_newbcast:4
  v_dot2c_f32_bf16_dpp v15, v31, v73 row_newbcast:4
  v_dot2c_f32_bf16_dpp v16, v30, v74 row_newbcast:4
  v_dot2c_f32_bf16_dpp v17, v31, v74 row_newbcast:4
  v_dot2c_f32_bf16_dpp v18, v30, v75 row_newbcast:4
  v_dot2c_f32_bf16_dpp v19, v31, v75 row_newbcast:4
  s_cbranch_vccz L_d258
  s_waitcnt vmcnt(5)
L_d258:
  s_xor_b32 s68, s70, 0x10000
  buffer_load_dwordx4 v[96:99], v63, s[8:11], s68 offen nt
  buffer_load_dwordx4 a[248:251], v2, s[24:27], s73 offen
  s_add_u32 s73, s73, 8192
  s_waitcnt vmcnt(7)
  v_dot2c_f32_bf16_dpp v12, v30, v76 row_newbcast:12
  v_dot2c_f32_bf16_dpp v13, v31, v76 row_newbcast:12
  v_dot2c_f32_bf16_dpp v14, v30, v77 row_newbcast:12
  v_dot2c_f32_bf16_dpp v15, v31, v77 row_newbcast:12
  v_dot2c_f32_bf16_dpp v16, v30, v78 row_newbcast:12
  v_dot2c_f32_bf16_dpp v17, v31, v78 row_newbcast:12
  v_dot2c_f32_bf16_dpp v18, v30, v79 row_newbcast:12
  v_dot2c_f32_bf16_dpp v19, v31, v79 row_newbcast:12
  s_cbranch_vccz L_d259
  s_waitcnt vmcnt(6)
L_d259:
  s_xor_b32 s68, s70, 0x10100
  buffer_load_dwordx4 v[100:103], v63, s[8:11], s68 offen nt
  s_barrier
  v_fma_f32 v28, v193, s71, -v29
  v_exp_f32 v28, v28
  s_nop 0
  v_cvt_pk_bf16_f32 v30, v28, 0
  v_cvt_pk_bf16_f32 v31, 0, v28
  v_add_f32 v21, v21, v28
  s_waitcnt vmcnt(7)
  v_dot2c_f32_bf16_dpp v12, v30, v80 row_newbcast:0
  v_dot2c_f32_bf16_dpp v13, v31, v80 row_newbcast:0
  v_dot2c_f32_bf16_dpp v14, v30, v81 row_newbcast:0
  v_dot2c_f32_bf16_dpp v15, v31, v81 row_newbcast:0
  v_dot2c_f32_bf16_dpp v16, v30, v82 row_newbcast:0
  v_dot2c_f32_bf16_dpp v17, v31, v82 row_newbcast:0
  v_dot2c_f32_bf16_dpp v18, v30, v83 row_newbcast:0
  v_dot2c_f32_bf16_dpp v19, v31, v83 row_newbcast:0
  s_cbranch_vccz L_d260
  s_waitcnt vmcnt(5)
L_d260:
  s_xor_b32 s68, s70, 0x10400
  buffer_load_dwordx4 v[104:107], v63, s[8:11], s68 offen nt
  v_mov_b32 v26, 0
  ds_read_b32 v35, v26 offset:8512
  s_waitcnt vmcnt(6)
  v_dot2c_f32_bf16_dpp v12, v30, v84 row_newbcast:8
  v_dot2c_f32_bf16_dpp v13, v31, v84 row_newbcast:8
  v_dot2c_f32_bf16_dpp v14, v30, v85 row_newbcast:8
  v_dot2c_f32_bf16_dpp v15, v31, v85 row_newbcast:8
  v_dot2c_f32_bf16_dpp v16, v30, v86 row_newbcast:8
  v_dot2c_f32_bf16_dpp v17, v31, v86 row_newbcast:8
  v_dot2c_f32_bf16_dpp v18, v30, v87 row_newbcast:8
  v_dot2c_f32_bf16_dpp v19, v31, v87 row_newbcast:8
  s_cbranch_vccz L_d261
  s_waitcnt vmcnt(5)
L_d261:
  s_xor_b32 s68, s70, 0x10500
  buffer_load_dwordx4 v[108:111], v63, s[8:11], s68 offen nt
  v_and_b32_dpp v48, v44, v40 row_newbcast:15
  v_and_b32_dpp v49, v44, v41 row_newbcast:15
  v_and_b32_dpp v50, v44, v42 row_newbcast:15
  v_and_b32_dpp v51, v44, v43 row_newbcast:15
  s_nop 1
  v_mfma_f32_16x16x32_bf16 v[56:59], v[48:51], a[240:243], v[56:59]
  s_waitcnt vmcnt(6)
  v_dot2c_f32_bf16_dpp v12, v30, v88 row_newbcast:4
  v_dot2c_f32_bf16_dpp v13, v31, v88 row_newbcast:4
  v_dot2c_f32_bf16_dpp v14, v30, v89 row_newbcast:4
  v_dot2c_f32_bf16_dpp v15, v31, v89 row_newbcast:4
  v_dot2c_f32_bf16_dpp v16, v30, v90 row_newbcast:4
  v_dot2c_f32_bf16_dpp v17, v31, v90 row_newbcast:4
  v_dot2c_f32_bf16_dpp v18, v30, v91 row_newbcast:4
  v_dot2c_f32_bf16_dpp v19, v31, v91 row_newbcast:4
  s_cbranch_vccz L_d262
  s_waitcnt vmcnt(5)
L_d262:
  s_xor_b32 s68, s70, 0x10800
  buffer_load_dwordx4 v[112:115], v63, s[8:11], s68 offen nt
  buffer_load_dwordx4 a[252:255], v2, s[24:27], s73 offen
  s_waitcnt vmcnt(7)
  v_dot2c_f32_bf16_dpp v12, v30, v92 row_newbcast:12
  v_dot2c_f32_bf16_dpp v13, v31, v92 row_newbcast:12
  v_dot2c_f32_bf16_dpp v14, v30, v93 row_newbcast:12
  v_dot2c_f32_bf16_dpp v15, v31, v93 row_newbcast:12
  v_dot2c_f32_bf16_dpp v16, v30, v94 row_newbcast:12
  v_dot2c_f32_bf16_dpp v17, v31, v94 row_newbcast:12
  v_dot2c_f32_bf16_dpp v18, v30, v95 row_newbcast:12
  v_dot2c_f32_bf16_dpp v19, v31, v95 row_newbcast:12
  s_cbranch_vccz L_d263
  s_waitcnt vmcnt(6)
L_d263:
  s_xor_b32 s68, s70, 0x10900
  buffer_load_dwordx4 v[116:119], v63, s[8:11], s68 offen nt
  s_barrier
  v_fma_f32 v28, v194, s71, -v29
  v_exp_f32 v28, v28
  s_nop 0
  v_cvt_pk_bf16_f32 v30, v28, 0
  v_cvt_pk_bf16_f32 v31, 0, v28
  v_add_f32 v21, v21, v28
  s_waitcnt vmcnt(7)
  v_dot2c_f32_bf16_dpp v12, v30, v96 row_newbcast:0
  v_dot2c_f32_bf16_dpp v13, v31, v96 row_newbcast:0
  v_dot2c_f32_bf16_dpp v14, v30, v97 row_newbcast:0
  v_dot2c_f32_bf16_dpp v15, v31, v97 row_newbcast:0
  v_dot2c_f32_bf16_dpp v16, v30, v98 row_newbcast:0
  v_dot2c_f32_bf16_dpp v17, v31, v98 row_newbcast:0
  v_dot2c_f32_bf16_dpp v18, v30, v99 row_newbcast:0
  v_dot2c_f32_bf16_dpp v19, v31, v99 row_newbcast:0
  s_cbranch_vccz L_d264
  s_waitcnt vmcnt(5)
L_d264:
  s_xor_b32 s68, s70, 0x10c00
  buffer_load_dwordx4 v[120:123], v63, s[8:11], s68 offen nt
  s_waitcnt lgkmcnt(0)
  v_cmp_ne_u32 vcc, 0, v35
  s_waitcnt vmcnt(6)
  v_dot2c_f32_bf16_dpp v12, v30, v100 row_newbcast:8
  v_dot2c_f32_bf16_dpp v13, v31, v100 row_newbcast:8
  v_dot2c_f32_bf16_dpp v14, v30, v101 row_newbcast:8
  v_dot2c_f32_bf16_dpp v15, v31, v101 row_newbcast:8
  v_dot2c_f32_bf16_dpp v16, v30, v102 row_newbcast:8
  v_dot2c_f32_bf16_dpp v17, v31, v102 row_newbcast:8
  v_dot2c_f32_bf16_dpp v18, v30, v103 row_newbcast:8
  v_dot2c_f32_bf16_dpp v19, v31, v103 row_newbcast:8
  s_cbranch_vccz L_d265
  s_waitcnt vmcnt(5)
L_d265:
  s_xor_b32 s68, s70, 0x10d00
  buffer_load_dwordx4 v[124:127], v63, s[8:11], s68 offen nt
  v_and_b32_dpp v52, v45, v40 row_newbcast:15
  v_and_b32_dpp v53, v45, v41 row_newbcast:15
  v_and_b32_dpp v54, v45, v42 row_newbcast:15
  v_and_b32_dpp v55, v45, v43 row_newbcast:15
  s_nop 1
  v_mfma_f32_16x16x32_bf16 v[56:59], v[52:55], a[244:247], v[56:59]
  s_waitcnt vmcnt(6)
  v_dot2c_f32_bf16_dpp v12, v30, v104 row_newbcast:4
  v_dot2c_f32_bf16_dpp v13, v31, v104 row_newbcast:4
  v_dot2c_f32_bf16_dpp v14, v30, v105 row_newbcast:4
  v_dot2c_f32_bf16_dpp v15, v31, v105 row_newbcast:4
  v_dot2c_f32_bf16_dpp v16, v30, v106 row_newbcast:4
  v_dot2c_f32_bf16_dpp v17, v31, v106 row_newbcast:4
  v_dot2c_f32_bf16_dpp v18, v30, v107 row_newbcast:4
  v_dot2c_f32_bf16_dpp v19, v31, v107 row_newbcast:4
  s_cbranch_vccz L_d266
  s_waitcnt vmcnt(5)
L_d266:
  s_xor_b32 s68, s70, 0x20000
  buffer_load_dwordx4 v[64:67], v63, s[8:11], s68 offen nt
  s_mov_b32 s24, s48
  s_mov_b32 s25, s49
  s_lshl_b32 s38, s65, 18
  s_lshl_b32 s84, s64, 9
  s_add_u32 s84, s84, s38
  s_lshl_b32 s73, s74, 13
  s_add_u32 s73, s73, s84
  buffer_load_dwordx4 a[0:3], v3, s[24:27], s73 offen offset:0
  buffer_load_dwordx4 a[8:11], v3, s[24:27], s73 offen offset:256
  buffer_load_dwordx4 a[4:7], v3, s[24:27], s73 offen offset:2048
  buffer_load_dwordx4 a[12:15], v3, s[24:27], s73 offen offset:2304
  s_add_u32 s73, s73, 4096
  buffer_load_dwordx4 a[16:19], v3, s[24:27], s73 offen offset:0
  buffer_load_dwordx4 a[24:27], v3, s[24:27], s73 offen offset:256
  buffer_load_dwordx4 a[20:23], v3, s[24:27], s73 offen offset:2048
  buffer_load_dwordx4 a[28:31], v3, s[24:27], s73 offen offset:2304
  s_add_u32 s73, s73, 4096
  s_waitcnt vmcnt(14)
  v_dot2c_f32_bf16_dpp v12, v30, v108 row_newbcast:12
  v_dot2c_f32_bf16_dpp v13, v31, v108 row_newbcast:12
  v_dot2c_f32_bf16_dpp v14, v30, v109 row_newbcast:12
  v_dot2c_f32_bf16_dpp v15, v31, v109 row_newbcast:12
  v_dot2c_f32_bf16_dpp v16, v30, v110 row_newbcast:12
  v_dot2c_f32_bf16_dpp v17, v31, v110 row_newbcast:12
  v_dot2c_f32_bf16_dpp v18, v30, v111 row_newbcast:12
  v_dot2c_f32_bf16_dpp v19, v31, v111 row_newbcast:12
  s_cbranch_vccz L_d267
  s_waitcnt vmcnt(13)
L_d267:
  s_xor_b32 s68, s70, 0x20100
  buffer_load_dwordx4 v[68:71], v63, s[8:11], s68 offen nt
  s_barrier
  v_fma_f32 v28, v195, s71, -v29
  v_exp_f32 v28, v28
  s_nop 0
  v_cvt_pk_bf16_f32 v30, v28, 0
  v_cvt_pk_bf16_f32 v31, 0, v28
  v_add_f32 v21, v21, v28
  s_waitcnt vmcnt(14)
  v_dot2c_f32_bf16_dpp v12, v30, v112 row_newbcast:0
  v_dot2c_f32_bf16_dpp v13, v31, v112 row_newbcast:0
  v_dot2c_f32_bf16_dpp v14, v30, v113 row_newbcast:0
  v_dot2c_f32_bf16_dpp v15, v31, v113 row_newbcast:0
  v_dot2c_f32_bf16_dpp v16, v30, v114 row_newbcast:0
  v_dot2c_f32_bf16_dpp v17, v31, v114 row_newbcast:0
  v_dot2c_f32_bf16_dpp v18, v30, v115 row_newbcast:0
  v_dot2c_f32_bf16_dpp v19, v31, v115 row_newbcast:0
  s_cbranch_vccz L_d268
  s_waitcnt vmcnt(12)
L_d268:
  s_xor_b32 s68, s70, 0x20400
  buffer_load_dwordx4 v[72:75], v63, s[8:11], s68 offen nt
  s_waitcnt vmcnt(13)
  v_dot2c_f32_bf16_dpp v12, v30, v116 row_newbcast:8
  v_dot2c_f32_bf16_dpp v13, v31, v116 row_newbcast:8
  v_dot2c_f32_bf16_dpp v14, v30, v117 row_newbcast:8
  v_dot2c_f32_bf16_dpp v15, v31, v117 row_newbcast:8
  v_dot2c_f32_bf16_dpp v16, v30, v118 row_newbcast:8
  v_dot2c_f32_bf16_dpp v17, v31, v118 row_newbcast:8
  v_dot2c_f32_bf16_dpp v18, v30, v119 row_newbcast:8
  v_dot2c_f32_bf16_dpp v19, v31, v119 row_newbcast:8
  s_cbranch_vccz L_d269
  s_waitcnt vmcnt(12)
L_d269:
  s_xor_b32 s68, s70, 0x20500
  buffer_load_dwordx4 v[76:79], v63, s[8:11], s68 offen nt
  v_and_b32_dpp v48, v46, v40 row_newbcast:15
  v_and_b32_dpp v49, v46, v41 row_newbcast:15
  v_and_b32_dpp v50, v46, v42 row_newbcast:15
  v_and_b32_dpp v51, v46, v43 row_newbcast:15
  s_nop 1
  v_mfma_f32_16x16x32_bf16 v[56:59], v[48:51], a[248:251], v[56:59]
  s_waitcnt vmcnt(13)
  v_dot2c_f32_bf16_dpp v12, v30, v120 row_newbcast:4
  v_dot2c_f32_bf16_dpp v13, v31, v120 row_newbcast:4
  v_dot2c_f32_bf16_dpp v14, v30, v121 row_newbcast:4
  v_dot2c_f32_bf16_dpp v15, v31, v121 row_newbcast:4
  v_dot2c_f32_bf16_dpp v16, v30, v122 row_newbcast:4
  v_dot2c_f32_bf16_dpp v17, v31, v122 row_newbcast:4
  v_dot2c_f32_bf16_dpp v18, v30, v123 row_newbcast:4
  v_dot2c_f32_bf16_dpp v19, v31, v123 row_newbcast:4
  s_cbranch_vccz L_d270
  s_waitcnt vmcnt(12)
L_d270:
  s_xor_b32 s68, s70, 0x20800
  buffer_load_dwordx4 v[80:83], v63, s[8:11], s68 offen nt
  s_waitcnt vmcnt(13)
  v_dot2c_f32_bf16_dpp v12, v30, v124 row_newbcast:12
  v_dot2c_f32_bf16_dpp v13, v31, v124 row_newbcast:12
  v_dot2c_f32_bf16_dpp v14, v30, v125 row_newbcast:12
  v_dot2c_f32_bf16_dpp v15, v31, v125 row_newbcast:12
  v_dot2c_f32_bf16_dpp v16, v30, v126 row_newbcast:12
  v_dot2c_f32_bf16_dpp v17, v31, v126 row_newbcast:12
  v_dot2c_f32_bf16_dpp v18, v30, v127 row_newbcast:12
  v_dot2c_f32_bf16_dpp v19, v31, v127 row_newbcast:12
  s_cbranch_vccz L_d271
  s_waitcnt vmcnt(12)
L_d271:
  s_xor_b32 s68, s70, 0x20900
  buffer_load_dwordx4 v[84:87], v63, s[8:11], s68 offen nt
  s_barrier
  v_fma_f32 v28, v196, s71, -v29
  v_exp_f32 v28, v28
  s_nop 0
  v_cvt_pk_bf16_f32 v30, v28, 0
  v_cvt_pk_bf16_f32 v31, 0, v28
  v_add_f32 v21, v21, v28
  s_waitcnt vmcnt(13)
  v_dot2c_f32_bf16_dpp v12, v30, v64 row_newbcast:0
  v_dot2c_f32_bf16_dpp v13, v31, v64 row_newbcast:0
  v_dot2c_f32_bf16_dpp v14, v30, v65 row_newbcast:0
  v_dot2c_f32_bf16_dpp v15, v31, v65 row_newbcast:0
  v_dot2c_f32_bf16_dpp v16, v30, v66 row_newbcast:0
  v_dot2c_f32_bf16_dpp v17, v31, v66 row_newbcast:0
  v_dot2c_f32_bf16_dpp v18, v30, v67 row_newbcast:0
  v_dot2c_f32_bf16_dpp v19, v31, v67 row_newbcast:0
  s_cbranch_vccz L_d272
  s_waitcnt vmcnt(4)
L_d272:
  s_xor_b32 s68, s70, 0x20c00
  buffer_load_dwordx4 v[88:91], v63, s[8:11], s68 offen nt
  s_waitcnt vmcnt(5)
  v_dot2c_f32_bf16_dpp v12, v30, v68 row_newbcast:8
  v_dot2c_f32_bf16_dpp v13, v31, v68 row_newbcast:8
  v_dot2c_f32_bf16_dpp v14, v30, v69 row_newbcast:8
  v_dot2c_f32_bf16_dpp v15, v31, v69 row_newbcast:8
  v_dot2c_f32_bf16_dpp v16, v30, v70 row_newbcast:8
  v_dot2c_f32_bf16_dpp v17, v31, v70 row_newbcast:8
  v_dot2c_f32_bf16_dpp v18, v30, v71 row_newbcast:8
  v_dot2c_f32_bf16_dpp v19, v31, v71 row_newbcast:8
  s_cbranch_vccz L_d273
  s_waitcnt vmcnt(4)
L_d273:
  s_xor_b32 s68, s70, 0x20d00
  buffer_load_dwordx4 v[92:95], v63, s[8:11], s68 offen nt
  v_and_b32_dpp v52, v47, v40 row_newbcast:15
  v_and_b32_dpp v53, v47, v41 row_newbcast:15
  v_and_b32_dpp v54, v47, v42 row_newbcast:15
  v_and_b32_dpp v55, v47, v43 row_newbcast:15
  s_nop 1
  v_mfma_f32_16x16x32_bf16 v[56:59], v[52:55], a[252:255], v[56:59]
  s_waitcnt vmcnt(5)
  v_dot2c_f32_bf16_dpp v12, v30, v72 row_newbcast:4
  v_dot2c_f32_bf16_dpp v13, v31, v72 row_newbcast:4
  v_dot2c_f32_bf16_dpp v14, v30, v73 row_newbcast:4
  v_dot2c_f32_bf16_dpp v15, v31, v73 row_newbcast:4
  v_dot2c_f32_bf16_dpp v16, v30, v74 row_newbcast:4
  v_dot2c_f32_bf16_dpp v17, v31, v74 row_newbcast:4
  v_dot2c_f32_bf16_dpp v18, v30, v75 row_newbcast:4
  v_dot2c_f32_bf16_dpp v19, v31, v75 row_newbcast:4
  s_cbranch_vccz L_d274
  s_waitcnt vmcnt(4)
L_d274:
  s_xor_b32 s68, s70, 0x30000
  buffer_load_dwordx4 v[96:99], v63, s[8:11], s68 offen nt
  s_waitcnt vmcnt(5)
  v_dot2c_f32_bf16_dpp v12, v30, v76 row_newbcast:12
  v_dot2c_f32_bf16_dpp v13, v31, v76 row_newbcast:12
  v_dot2c_f32_bf16_dpp v14, v30, v77 row_newbcast:12
  v_dot2c_f32_bf16_dpp v15, v31, v77 row_newbcast:12
  v_dot2c_f32_bf16_dpp v16, v30, v78 row_newbcast:12
  v_dot2c_f32_bf16_dpp v17, v31, v78 row_newbcast:12
  v_dot2c_f32_bf16_dpp v18, v30, v79 row_newbcast:12
  v_dot2c_f32_bf16_dpp v19, v31, v79 row_newbcast:12
  s_cbranch_vccz L_d275
  s_waitcnt vmcnt(4)
L_d275:
  s_xor_b32 s68, s70, 0x30100
  buffer_load_dwordx4 v[100:103], v63, s[8:11], s68 offen nt
  s_barrier
  v_fma_f32 v28, v197, s71, -v29
  v_exp_f32 v28, v28
  s_nop 0
  v_cvt_pk_bf16_f32 v30, v28, 0
  v_cvt_pk_bf16_f32 v31, 0, v28
  v_add_f32 v21, v21, v28
  s_waitcnt vmcnt(5)
  v_dot2c_f32_bf16_dpp v12, v30, v80 row_newbcast:0
  v_dot2c_f32_bf16_dpp v13, v31, v80 row_newbcast:0
  v_dot2c_f32_bf16_dpp v14, v30, v81 row_newbcast:0
  v_dot2c_f32_bf16_dpp v15, v31, v81 row_newbcast:0
  v_dot2c_f32_bf16_dpp v16, v30, v82 row_newbcast:0
  v_dot2c_f32_bf16_dpp v17, v31, v82 row_newbcast:0
  v_dot2c_f32_bf16_dpp v18, v30, v83 row_newbcast:0
  v_dot2c_f32_bf16_dpp v19, v31, v83 row_newbcast:0
  s_cbranch_vccz L_d276
  s_waitcnt vmcnt(4)
L_d276:
  s_xor_b32 s68, s70, 0x30400
  buffer_load_dwordx4 v[104:107], v63, s[8:11], s68 offen nt
  s_waitcnt vmcnt(5)
  v_dot2c_f32_bf16_dpp v12, v30, v84 row_newbcast:8
  v_dot2c_f32_bf16_dpp v13, v31, v84 row_newbcast:8
  v_dot2c_f32_bf16_dpp v14, v30, v85 row_newbcast:8
  v_dot2c_f32_bf16_dpp v15, v31, v85 row_newbcast:8
  v_dot2c_f32_bf16_dpp v16, v30, v86 row_newbcast:8
  v_dot2c_f32_bf16_dpp v17, v31, v86 row_newbcast:8
  v_dot2c_f32_bf16_dpp v18, v30, v87 row_newbcast:8
  v_dot2c_f32_bf16_dpp v19, v31, v87 row_newbcast:8
  s_cbranch_vccz L_d277
  s_waitcnt vmcnt(4)
L_d277:
  s_xor_b32 s68, s70, 0x30500
  buffer_load_dwordx4 v[108:111], v63, s[8:11], s68 offen nt
  s_waitcnt vmcnt(5)
  v_dot2c_f32_bf16_dpp v12, v30, v88 row_newbcast:4
  v_dot2c_f32_bf16_dpp v13, v31, v88 row_newbcast:4
  v_dot2c_f32_bf16_dpp v14, v30, v89 row_newbcast:4
  v_dot2c_f32_bf16_dpp v15, v31, v89 row_newbcast:4
  v_dot2c_f32_bf16_dpp v16, v30, v90 row_newbcast:4
  v_dot2c_f32_bf16_dpp v17, v31, v90 row_newbcast:4
  v_dot2c_f32_bf16_dpp v18, v30, v91 row_newbcast:4
  v_dot2c_f32_bf16_dpp v19, v31, v91 row_newbcast:4
  s_cbranch_vccz L_d278
  s_waitcnt vmcnt(4)
L_d278:
  s_xor_b32 s68, s70, 0x30800
  buffer_load_dwordx4 v[112:115], v63, s[8:11], s68 offen nt
  s_waitcnt vmcnt(5)
  v_dot2c_f32_bf16_dpp v12, v30, v92 row_newbcast:12
  v_dot2c_f32_bf16_dpp v13, v31, v92 row_newbcast:12
  v_dot2c_f32_bf16_dpp v14, v30, v93 row_newbcast:12
  v_dot2c_f32_bf16_dpp v15, v31, v93 row_newbcast:12
  v_dot2c_f32_bf16_dpp v16, v30, v94 row_newbcast:12
  v_dot2c_f32_bf16_dpp v17, v31, v94 row_newbcast:12
  v_dot2c_f32_bf16_dpp v18, v30, v95 row_newbcast:12
  v_dot2c_f32_bf16_dpp v19, v31, v95 row_newbcast:12
  s_cbranch_vccz L_d279
  s_waitcnt vmcnt(4)
L_d279:
  s_xor_b32 s68, s70, 0x30900
  buffer_load_dwordx4 v[116:119], v63, s[8:11], s68 offen nt
  s_barrier
  v_lshrrev_b32 v26, 8, v1
  v_and_b32 v27, 0xf0, v1
  v_lshlrev_b32 v26, 4, v26
  v_lshl_add_u32 v26, v27, 1, v26
  s_lshl_b32 s38, s64, 9
  v_add_u32 v26, s38, v26
  s_mov_b64 exec, 0xffffffff
  ds_write_b128 v26, v[56:59] offset:2048
  s_mov_b64 exec, -1
  v_fma_f32 v28, v198, s71, -v29
  v_exp_f32 v28, v28
  s_nop 0
  v_cvt_pk_bf16_f32 v30, v28, 0
  v_cvt_pk_bf16_f32 v31, 0, v28
  v_add_f32 v21, v21, v28
  s_waitcnt vmcnt(5)
  v_dot2c_f32_bf16_dpp v12, v30, v96 row_newbcast:0
  v_dot2c_f32_bf16_dpp v13, v31, v96 row_newbcast:0
  v_dot2c_f32_bf16_dpp v14, v30, v97 row_newbcast:0
  v_dot2c_f32_bf16_dpp v15, v31, v97 row_newbcast:0
  v_dot2c_f32_bf16_dpp v16, v30, v98 row_newbcast:0
  v_dot2c_f32_bf16_dpp v17, v31, v98 row_newbcast:0
  v_dot2c_f32_bf16_dpp v18, v30, v99 row_newbcast:0
  v_dot2c_f32_bf16_dpp v19, v31, v99 row_newbcast:0
  s_cbranch_vccz L_d280
  s_waitcnt vmcnt(4)
L_d280:
  s_xor_b32 s68, s70, 0x30c00
  buffer_load_dwordx4 v[120:123], v63, s[8:11], s68 offen nt
  s_waitcnt vmcnt(5)
  v_dot2c_f32_bf16_dpp v12, v30, v100 row_newbcast:8
  v_dot2c_f32_bf16_dpp v13, v31, v100 row_newbcast:8
  v_dot2c_f32_bf16_dpp v14, v30, v101 row_newbcast:8
  v_dot2c_f32_bf16_dpp v15, v31, v101 row_newbcast:8
  v_dot2c_f32_bf16_dpp v16, v30, v102 row_newbcast:8
  v_dot2c_f32_bf16_dpp v17, v31, v102 row_newbcast:8
  v_dot2c_f32_bf16_dpp v18, v30, v103 row_newbcast:8
  v_dot2c_f32_bf16_dpp v19, v31, v103 row_newbcast:8
  s_cbranch_vccz L_d281
  s_waitcnt vmcnt(4)
L_d281:
  s_xor_b32 s68, s70, 0x30d00
  buffer_load_dwordx4 v[124:127], v63, s[8:11], s68 offen nt
  s_waitcnt vmcnt(5)
  v_dot2c_f32_bf16_dpp v12, v30, v104 row_newbcast:4
  v_dot2c_f32_bf16_dpp v13, v31, v104 row_newbcast:4
  v_dot2c_f32_bf16_dpp v14, v30, v105 row_newbcast:4
  v_dot2c_f32_bf16_dpp v15, v31, v105 row_newbcast:4
  v_dot2c_f32_bf16_dpp v16, v30, v106 row_newbcast:4
  v_dot2c_f32_bf16_dpp v17, v31, v106 row_newbcast:4
  v_dot2c_f32_bf16_dpp v18, v30, v107 row_newbcast:4
  v_dot2c_f32_bf16_dpp v19, v31, v107 row_newbcast:4
  s_cbranch_vccz L_d282
  s_waitcnt vmcnt(4)
L_d282:
  s_xor_b32 s68, s70, 0x80000
  buffer_load_dwordx4 v[64:67], v63, s[8:11], s68 offen nt
  s_lshl_b32 s73, s75, 13
  s_add_u32 s73, s73, s84
  buffer_load_dwordx4 a[32:35], v3, s[24:27], s73 offen offset:0
  s_waitcnt vmcnt(6)
  v_dot2c_f32_bf16_dpp v12, v30, v108 row_newbcast:12
  v_dot2c_f32_bf16_dpp v13, v31, v108 row_newbcast:12
  v_dot2c_f32_bf16_dpp v14, v30, v109 row_newbcast:12
  v_dot2c_f32_bf16_dpp v15, v31, v109 row_newbcast:12
  v_dot2c_f32_bf16_dpp v16, v30, v110 row_newbcast:12
  v_dot2c_f32_bf16_dpp v17, v31, v110 row_newbcast:12
  v_dot2c_f32_bf16_dpp v18, v30, v111 row_newbcast:12
  v_dot2c_f32_bf16_dpp v19, v31, v111 row_newbcast:12
  s_cbranch_vccz L_d283
  s_waitcnt vmcnt(5)
L_d283:
  s_xor_b32 s68, s70, 0x80100
  buffer_load_dwordx4 v[68:71], v63, s[8:11], s68 offen nt
  s_barrier
  v_fma_f32 v28, v199, s71, -v29
  v_exp_f32 v28, v28
  s_nop 0
  v_cvt_pk_bf16_f32 v30, v28, 0
  v_cvt_pk_bf16_f32 v31, 0, v28
  v_add_f32 v21, v21, v28
  s_waitcnt vmcnt(6)
  v_dot2c_f32_bf16_dpp v12, v30, v112 row_newbcast:0
  v_dot2c_f32_bf16_dpp v13, v31, v112 row_newbcast:0
  v_dot2c_f32_bf16_dpp v14, v30, v113 row_newbcast:0
  v_dot2c_f32_bf16_dpp v15, v31, v113 row_newbcast:0
  v_dot2c_f32_bf16_dpp v16, v30, v114 row_newbcast:0
  v_dot2c_f32_bf16_dpp v17, v31, v114 row_newbcast:0
  v_dot2c_f32_bf16_dpp v18, v30, v115 row_newbcast:0
  v_dot2c_f32_bf16_dpp v19, v31, v115 row_newbcast:0
  s_cbranch_vccz L_d284
  s_waitcnt vmcnt(5)
L_d284:
  s_xor_b32 s68, s70, 0x80400
  buffer_load_dwordx4 v[72:75], v63, s[8:11], s68 offen nt
  s_waitcnt vmcnt(6)
  v_dot2c_f32_bf16_dpp v12, v30, v116 row_newbcast:8
  v_dot2c_f32_bf16_dpp v13, v31, v116 row_newbcast:8
  v_dot2c_f32_bf16_dpp v14, v30, v117 row_newbcast:8
  v_dot2c_f32_bf16_dpp v15, v31, v117 row_newbcast:8
  v_dot2c_f32_bf16_dpp v16, v30, v118 row_newbcast:8
  v_dot2c_f32_bf16_dpp v17, v31, v118 row_newbcast:8
  v_dot2c_f32_bf16_dpp v18, v30, v119 row_newbcast:8
  v_dot2c_f32_bf16_dpp v19, v31, v119 row_newbcast:8
  s_cbranch_vccz L_d285
  s_waitcnt vmcnt(5)
L_d285:
  s_xor_b32 s68, s70, 0x80500
  buffer_load_dwordx4 v[76:79], v63, s[8:11], s68 offen nt
  s_waitcnt vmcnt(6)
  v_dot2c_f32_bf16_dpp v12, v30, v120 row_newbcast:4
  v_dot2c_f32_bf16_dpp v13, v31, v120 row_newbcast:4
  v_dot2c_f32_bf16_dpp v14, v30, v121 row_newbcast:4
  v_dot2c_f32_bf16_dpp v15, v31, v121 row_newbcast:4
  v_dot2c_f32_bf16_dpp v16, v30, v122 row_newbcast:4
  v_dot2c_f32_bf16_dpp v17, v31, v122 row_newbcast:4
  v_dot2c_f32_bf16_dpp v18, v30, v123 row_newbcast:4
  v_dot2c_f32_bf16_dpp v19, v31, v123 row_newbcast:4
  s_cbranch_vccz L_d286
  s_waitcnt vmcnt(5)
L_d286:
  s_xor_b32 s68, s70, 0x80800
  buffer_load_dwordx4 v[80:83], v63, s[8:11], s68 offen nt
  buffer_load_dwordx4 a[40:43], v3, s[24:27], s73 offen offset:256
  s_waitcnt vmcnt(7)
  v_dot2c_f32_bf16_dpp v12, v30, v124 row_newbcast:12
  v_dot2c_f32_bf16_dpp v13, v31, v124 row_newbcast:12
  v_dot2c_f32_bf16_dpp v14, v30, v125 row_newbcast:12
  v_dot2c_f32_bf16_dpp v15, v31, v125 row_newbcast:12
  v_dot2c_f32_bf16_dpp v16, v30, v126 row_newbcast:12
  v_dot2c_f32_bf16_dpp v17, v31, v126 row_newbcast:12
  v_dot2c_f32_bf16_dpp v18, v30, v127 row_newbcast:12
  v_dot2c_f32_bf16_dpp v19, v31, v127 row_newbcast:12
  s_cbranch_vccz L_d287
  s_waitcnt vmcnt(6)
L_d287:
  s_xor_b32 s68, s70, 0x80900
  buffer_load_dwordx4 v[84:87], v63, s[8:11], s68 offen nt
  s_barrier
  v_fma_f32 v28, v200, s71, -v29
  v_exp_f32 v28, v28
  s_nop 0
  v_cvt_pk_bf16_f32 v30, v28, 0
  v_cvt_pk_bf16_f32 v31, 0, v28
  v_add_f32 v21, v21, v28
  s_waitcnt vmcnt(7)
  v_dot2c_f32_bf16_dpp v12, v30, v64 row_newbcast:0
  v_dot2c_f32_bf16_dpp v13, v31, v64 row_newbcast:0
  v_dot2c_f32_bf16_dpp v14, v30, v65 row_newbcast:0
  v_dot2c_f32_bf16_dpp v15, v31, v65 row_newbcast:0
  v_dot2c_f32_bf16_dpp v16, v30, v66 row_newbcast:0
  v_dot2c_f32_bf16_dpp v17, v31, v66 row_newbcast:0
  v_dot2c_f32_bf16_dpp v18, v30, v67 row_newbcast:0
  v_dot2c_f32_bf16_dpp v19, v31, v67 row_newbcast:0
  s_cbranch_vccz L_d288
  s_waitcnt vmcnt(5)
L_d288:
  s_xor_b32 s68, s70, 0x80c00
  buffer_load_dwordx4 v[88:91], v63, s[8:11], s68 offen nt
  s_waitcnt vmcnt(6)
  v_dot2c_f32_bf16_dpp v12, v30, v68 row_newbcast:8
  v_dot2c_f32_bf16_dpp v13, v31, v68 row_newbcast:8
  v_dot2c_f32_bf16_dpp v14, v30, v69 row_newbcast:8
  v_dot2c_f32_bf16_dpp v15, v31, v69 row_newbcast:8
  v_dot2c_f32_bf16_dpp v16, v30, v70 row_newbcast:8
  v_dot2c_f32_bf16_dpp v17, v31, v70 row_newbcast:8
  v_dot2c_f32_bf16_dpp v18, v30, v71 row_newbcast:8
  v_dot2c_f32_bf16_dpp v19, v31, v71 row_newbcast:8
  s_cbranch_vccz L_d289
  s_waitcnt vmcnt(5)
L_d289:
  s_xor_b32 s68, s70, 0x80d00
  buffer_load_dwordx4 v[92:95], v63, s[8:11], s68 offen nt
  s_waitcnt vmcnt(6)
  v_dot2c_f32_bf16_dpp v12, v30, v72 row_newbcast:4
  v_dot2c_f32_bf16_dpp v13, v31, v72 row_newbcast:4
  v_dot2c_f32_bf16_dpp v14, v30, v73 row_newbcast:4
  v_dot2c_f32_bf16_dpp v15, v31, v73 row_newbcast:4
  v_dot2c_f32_bf16_dpp v16, v30, v74 row_newbcast:4
  v_dot2c_f32_bf16_dpp v17, v31, v74 row_newbcast:4
  v_dot2c_f32_bf16_dpp v18, v30, v75 row_newbcast:4
  v_dot2c_f32_bf16_dpp v19, v31, v75 row_newbcast:4
  s_cbranch_vccz L_d290
  s_waitcnt vmcnt(5)
L_d290:
  s_xor_b32 s68, s70, 0x90000
  buffer_load_dwordx4 v[96:99], v63, s[8:11], s68 offen nt
  buffer_load_dwordx4 a[36:39], v3, s[24:27], s73 offen offset:2048
  s_waitcnt vmcnt(7)
  v_dot2c_f32_bf16_dpp v12, v30, v76 row_newbcast:12
  v_dot2c_f32_bf16_dpp v13, v31, v76 row_newbcast:12
  v_dot2c_f32_bf16_dpp v14, v30, v77 row_newbcast:12
  v_dot2c_f32_bf16_dpp v15, v31, v77 row_newbcast:12
  v_dot2c_f32_bf16_dpp v16, v30, v78 row_newbcast:12
  v_dot2c_f32_bf16_dpp v17, v31, v78 row_newbcast:12
  v_dot2c_f32_bf16_dpp v18, v30, v79 row_newbcast:12
  v_dot2c_f32_bf16_dpp v19, v31, v79 row_newbcast:12
  s_cbranch_vccz L_d291
  s_waitcnt vmcnt(6)
L_d291:
  s_xor_b32 s68, s70, 0x90100
  buffer_load_dwordx4 v[100:103], v63, s[8:11], s68 offen nt
  s_barrier
  v_fma_f32 v28, v201, s71, -v29
  v_exp_f32 v28, v28
  s_nop 0
  v_cvt_pk_bf16_f32 v30, v28, 0
  v_cvt_pk_bf16_f32 v31, 0, v28
  v_add_f32 v21, v21, v28
  s_waitcnt vmcnt(7)
  v_dot2c_f32_bf16_dpp v12, v30, v80 row_newbcast:0
  v_dot2c_f32_bf16_dpp v13, v31, v80 row_newbcast:0
  v_dot2c_f32_bf16_dpp v14, v30, v81 row_newbcast:0
  v_dot2c_f32_bf16_dpp v15, v31, v81 row_newbcast:0
  v_dot2c_f32_bf16_dpp v16, v30, v82 row_newbcast:0
  v_dot2c_f32_bf16_dpp v17, v31, v82 row_newbcast:0
  v_dot2c_f32_bf16_dpp v18, v30, v83 row_newbcast:0
  v_dot2c_f32_bf16_dpp v19, v31, v83 row_newbcast:0
  s_cbranch_vccz L_d292
  s_waitcnt vmcnt(5)
L_d292:
  s_xor_b32 s68, s70, 0x90400
  buffer_load_dwordx4 v[104:107], v63, s[8:11], s68 offen nt
  s_waitcnt vmcnt(6)
  v_dot2c_f32_bf16_dpp v12, v30, v84 row_newbcast:8
  v_dot2c_f32_bf16_dpp v13, v31, v84 row_newbcast:8
  v_dot2c_f32_bf16_dpp v14, v30, v85 row_newbcast:8
  v_dot2c_f32_bf16_dpp v15, v31, v85 row_newbcast:8
  v_dot2c_f32_bf16_dpp v16, v30, v86 row_newbcast:8
  v_dot2c_f32_bf16_dpp v17, v31, v86 row_newbcast:8
  v_dot2c_f32_bf16_dpp v18, v30, v87 row_newbcast:8
  v_dot2c_f32_bf16_dpp v19, v31, v87 row_newbcast:8
  s_cbranch_vccz L_d293
  s_waitcnt vmcnt(5)
L_d293:
  s_xor_b32 s68, s70, 0x90500
  buffer_load_dwordx4 v[108:111], v63, s[8:11], s68 offen nt
  s_waitcnt vmcnt(6)
  v_dot2c_f32_bf16_dpp v12, v30, v88 row_newbcast:4
  v_dot2c_f32_bf16_dpp v13, v31, v88 row_newbcast:4
  v_dot2c_f32_bf16_dpp v14, v30, v89 row_newbcast:4
  v_dot2c_f32_bf16_dpp v15, v31, v89 row_newbcast:4
  v_dot2c_f32_bf16_dpp v16, v30, v90 row_newbcast:4
  v_dot2c_f32_bf16_dpp v17, v31, v90 row_newbcast:4
  v_dot2c_f32_bf16_dpp v18, v30, v91 row_newbcast:4
  v_dot2c_f32_bf16_dpp v19, v31, v91 row_newbcast:4
  s_cbranch_vccz L_d294
  s_waitcnt vmcnt(5)
L_d294:
  s_xor_b32 s68, s70, 0x90800
  buffer_load_dwordx4 v[112:115], v63, s[8:11], s68 offen nt
  buffer_load_dwordx4 a[44:47], v3, s[24:27], s73 offen offset:2304
  s_add_u32 s73, s73, 4096
  s_waitcnt vmcnt(7)
  v_dot2c_f32_bf16_dpp v12, v30, v92 row_newbcast:12
  v_dot2c_f32_bf16_dpp v13, v31, v92 row_newbcast:12
  v_dot2c_f32_bf16_dpp v14, v30, v93 row_newbcast:12
  v_dot2c_f32_bf16_dpp v15, v31, v93 row_newbcast:12
  v_dot2c_f32_bf16_dpp v16, v30, v94 row_newbcast:12
  v_dot2c_f32_bf16_dpp v17, v31, v94 row_newbcast:12
  v_dot2c_f32_bf16_dpp v18, v30, v95 row_newbcast:12
  v_dot2c_f32_bf16_dpp v19, v31, v95 row_newbcast:12
  s_cbranch_vccz L_d295
  s_waitcnt vmcnt(6)
L_d295:
  s_xor_b32 s68, s70, 0x90900
  buffer_load_dwordx4 v[116:119], v63, s[8:11], s68 offen nt
  s_barrier
  s_waitcnt lgkmcnt(0)
  s_barrier
  v_and_b32 v26, 0xf0, v1
  v_lshlrev_b32 v26, 1, v26
  ds_read_b128 v[160:163], v26 offset:2048
  ds_read_b128 v[164:167], v26 offset:2560
  ds_read_b128 v[168:171], v26 offset:3072
  ds_read_b128 v[172:175], v26 offset:3584
  ds_read_b128 v[176:179], v26 offset:2064
  ds_read_b128 v[180:183], v26 offset:2576
  ds_read_b128 v[184:187], v26 offset:3088
  ds_read_b128 v[188:191], v26 offset:3600
  s_waitcnt lgkmcnt(4)
  v_pk_add_f32 v[160:161], v[160:161], v[164:165]
  v_pk_add_f32 v[168:169], v[168:169], v[172:173]
  v_pk_add_f32 v[162:163], v[162:163], v[166:167]
  v_pk_add_f32 v[170:171], v[170:171], v[174:175]
  v_pk_add_f32 v[160:161], v[160:161], v[168:169]
  v_pk_add_f32 v[162:163], v[162:163], v[170:171]
  v_cvt_pk_bf16_f32 v8, v160, v161
  v_cvt_pk_bf16_f32 v9, v162, v163
  s_waitcnt lgkmcnt(0)
  v_pk_add_f32 v[176:177], v[176:177], v[180:181]
  v_pk_add_f32 v[184:185], v[184:185], v[188:189]
  v_pk_add_f32 v[178:179], v[178:179], v[182:183]
  v_pk_add_f32 v[186:187], v[186:187], v[190:191]
  v_pk_add_f32 v[176:177], v[176:177], v[184:185]
  v_pk_add_f32 v[178:179], v[178:179], v[186:187]
  v_cvt_pk_bf16_f32 v10, v176, v177
  v_cvt_pk_bf16_f32 v11, v178, v179
  v_fma_f32 v28, v202, s71, -v29
  v_exp_f32 v28, v28
  s_nop 0
  v_cvt_pk_bf16_f32 v30, v28, 0
  v_cvt_pk_bf16_f32 v31, 0, v28
  v_add_f32 v21, v21, v28
  s_waitcnt vmcnt(7)
  v_dot2c_f32_bf16_dpp v12, v30, v96 row_newbcast:0
  v_dot2c_f32_bf16_dpp v13, v31, v96 row_newbcast:0
  v_dot2c_f32_bf16_dpp v14, v30, v97 row_newbcast:0
  v_dot2c_f32_bf16_dpp v15, v31, v97 row_newbcast:0
  v_dot2c_f32_bf16_dpp v16, v30, v98 row_newbcast:0
  v_dot2c_f32_bf16_dpp v17, v31, v98 row_newbcast:0
  v_dot2c_f32_bf16_dpp v18, v30, v99 row_newbcast:0
  v_dot2c_f32_bf16_dpp v19, v31, v99 row_newbcast:0
  s_cbranch_vccz L_d296
  s_waitcnt vmcnt(5)
L_d296:
  s_xor_b32 s68, s70, 0x90c00
  buffer_load_dwordx4 v[120:123], v63, s[8:11], s68 offen nt
  s_cmp_eq_u32 s64, 2
  s_cbranch_scc0 L_wp74
  s_mov_b32 s100, 6
  s_atomic_umax s100, s[20:21], s88
  s_and_b32 s60, s88, 0xfffffc7f
  s_xor_b32 s61, s60, 4096
  s_add_u32 s38, s60, 0
  s_load_dword s40, s[20:21], s38 glc
  s_add_u32 s38, s61, 128
  s_load_dword s41, s[20:21], s38 glc
  s_add_u32 s38, s61, 256
  s_load_dword s42, s[20:21], s38 glc
  s_add_u32 s38, s60, 384
  s_load_dword s43, s[20:21], s38 glc
  s_add_u32 s38, s60, 512
  s_load_dword s44, s[20:21], s38 glc
  s_add_u32 s38, s61, 640
  s_load_dword s45, s[20:21], s38 glc
  s_add_u32 s38, s61, 768
  s_load_dword s46, s[20:21], s38 glc
  s_add_u32 s38, s60, 896
  s_load_dword s47, s[20:21], s38 glc
L_wp74:
  s_waitcnt vmcnt(6)
  v_dot2c_f32_bf16_dpp v12, v30, v100 row_newbcast:8
  v_dot2c_f32_bf16_dpp v13, v31, v100 row_newbcast:8
  v_dot2c_f32_bf16_dpp v14, v30, v101 row_newbcast:8
  v_dot2c_f32_bf16_dpp v15, v31, v101 row_newbcast:8
  v_dot2c_f32_bf16_dpp v16, v30, v102 row_newbcast:8
  v_dot2c_f32_bf16_dpp v17, v31, v102 row_newbcast:8
  v_dot2c_f32_bf16_dpp v18, v30, v103 row_newbcast:8
  v_dot2c_f32_bf16_dpp v19, v31, v103 row_newbcast:8
  s_cbranch_vccz L_d297
  s_waitcnt vmcnt(5)
L_d297:
  s_xor_b32 s68, s70, 0x90d00
  buffer_load_dwordx4 v[124:127], v63, s[8:11], s68 offen nt
  s_waitcnt vmcnt(6)
  v_dot2c_f32_bf16_dpp v12, v30, v104 row_newbcast:4
  v_dot2c_f32_bf16_dpp v13, v31, v104 row_newbcast:4
  v_dot2c_f32_bf16_dpp v14, v30, v105 row_newbcast:4
  v_dot2c_f32_bf16_dpp v15, v31, v105 row_newbcast:4
  v_dot2c_f32_bf16_dpp v16, v30, v106 row_newbcast:4
  v_dot2c_f32_bf16_dpp v17, v31, v106 row_newbcast:4
  v_dot2c_f32_bf16_dpp v18, v30, v107 row_newbcast:4
  v_dot2c_f32_bf16_dpp v19, v31, v107 row_newbcast:4
  s_cbranch_vccz L_d298
  s_waitcnt vmcnt(5)
L_d298:
  s_xor_b32 s68, s70, 0xa0000
  buffer_load_dwordx4 v[64:67], v63, s[8:11], s68 offen nt
  buffer_load_dwordx4 a[48:51], v3, s[24:27], s73 offen offset:0
  s_waitcnt vmcnt(7)
  v_dot2c_f32_bf16_dpp v12, v30, v108 row_newbcast:12
  v_dot2c_f32_bf16_dpp v13, v31, v108 row_newbcast:12
  v_dot2c_f32_bf16_dpp v14, v30, v109 row_newbcast:12
  v_dot2c_f32_bf16_dpp v15, v31, v109 row_newbcast:12
  v_dot2c_f32_bf16_dpp v16, v30, v110 row_newbcast:12
  v_dot2c_f32_bf16_dpp v17, v31, v110 row_newbcast:12
  v_dot2c_f32_bf16_dpp v18, v30, v111 row_newbcast:12
  v_dot2c_f32_bf16_dpp v19, v31, v111 row_newbcast:12
  s_cbranch_vccz L_d299
  s_waitcnt vmcnt(6)
L_d299:
  s_xor_b32 s68, s70, 0xa0100
  buffer_load_dwordx4 v[68:71], v63, s[8:11], s68 offen nt
  s_barrier
  v_fma_f32 v28, v203, s71, -v29
  v_exp_f32 v28, v28
  s_nop 0
  v_cvt_pk_bf16_f32 v30, v28, 0
  v_cvt_pk_bf16_f32 v31, 0, v28
  v_add_f32 v21, v21, v28
  s_waitcnt vmcnt(7)
  v_dot2c_f32_bf16_dpp v12, v30, v112 row_newbcast:0
  v_dot2c_f32_bf16_dpp v13, v31, v112 row_newbcast:0
  v_dot2c_f32_bf16_dpp v14, v30, v113 row_newbcast:0
  v_dot2c_f32_bf16_dpp v15, v31, v113 row_newbcast:0
  v_dot2c_f32_bf16_dpp v16, v30, v114 row_newbcast:0
  v_dot2c_f32_bf16_dpp v17, v31, v114 row_newbcast:0
  v_dot2c_f32_bf16_dpp v18, v30, v115 row_newbcast:0
  v_dot2c_f32_bf16_dpp v19, v31, v115 row_newbcast:0
  s_cbranch_vccz L_d300
  s_waitcnt vmcnt(5)
L_d300:
  s_xor_b32 s68, s70, 0xa0400
  buffer_load_dwordx4 v[72:75], v63, s[8:11], s68 offen nt
  s_waitcnt vmcnt(6)
  v_dot2c_f32_bf16_dpp v12, v30, v116 row_newbcast:8
  v_dot2c_f32_bf16_dpp v13, v31, v116 row_newbcast:8
  v_dot2c_f32_bf16_dpp v14, v30, v117 row_newbcast:8
  v_dot2c_f32_bf16_dpp v15, v31, v117 row_newbcast:8
  v_dot2c_f32_bf16_dpp v16, v30, v118 row_newbcast:8
  v_dot2c_f32_bf16_dpp v17, v31, v118 row_newbcast:8
  v_dot2c_f32_bf16_dpp v18, v30, v119 row_newbcast:8
  v_dot2c_f32_bf16_dpp v19, v31, v119 row_newbcast:8
  s_cbranch_vccz L_d301
  s_waitcnt vmcnt(5)
L_d301:
  s_xor_b32 s68, s70, 0xa0500
  buffer_load_dwordx4 v[76:79], v63, s[8:11], s68 offen nt
  s_waitcnt vmcnt(6)
  v_dot2c_f32_bf16_dpp v12, v30, v120 row_newbcast:4
  v_dot2c_f32_bf16_dpp v13, v31, v120 row_newbcast:4
  v_dot2c_f32_bf16_dpp v14, v30, v121 row_newbcast:4
  v_dot2c_f32_bf16_dpp v15, v31, v121 row_newbcast:4
  v_dot2c_f32_bf16_dpp v16, v30, v122 row_newbcast:4
  v_dot2c_f32_bf16_dpp v17, v31, v122 row_newbcast:4
  v_dot2c_f32_bf16_dpp v18, v30, v123 row_newbcast:4
  v_dot2c_f32_bf16_dpp v19, v31, v123 row_newbcast:4
  s_cbranch_vccz L_d302
  s_waitcnt vmcnt(5)
L_d302:
  s_xor_b32 s68, s70, 0xa0800
  buffer_load_dwordx4 v[80:83], v63, s[8:11], s68 offen nt
  buffer_load_dwordx4 a[56:59], v3, s[24:27], s73 offen offset:256
  s_waitcnt vmcnt(7)
  v_dot2c_f32_bf16_dpp v12, v30, v124 row_newbcast:12
  v_dot2c_f32_bf16_dpp v13, v31, v124 row_newbcast:12
  v_dot2c_f32_bf16_dpp v14, v30, v125 row_newbcast:12
  v_dot2c_f32_bf16_dpp v15, v31, v125 row_newbcast:12
  v_dot2c_f32_bf16_dpp v16, v30, v126 row_newbcast:12
  v_dot2c_f32_bf16_dpp v17, v31, v126 row_newbcast:12
  v_dot2c_f32_bf16_dpp v18, v30, v127 row_newbcast:12
  v_dot2c_f32_bf16_dpp v19, v31, v127 row_newbcast:12
  s_cbranch_vccz L_d303
  s_waitcnt vmcnt(6)
L_d303:
  s_xor_b32 s68, s70, 0xa0900
  buffer_load_dwordx4 v[84:87], v63, s[8:11], s68 offen nt
  s_barrier
  v_fma_f32 v28, v204, s71, -v29
  v_exp_f32 v28, v28
  s_nop 0
  v_cvt_pk_bf16_f32 v30, v28, 0
  v_cvt_pk_bf16_f32 v31, 0, v28
  v_add_f32 v21, v21, v28
  s_waitcnt vmcnt(7)
  v_dot2c_f32_bf16_dpp v12, v30, v64 row_newbcast:0
  v_dot2c_f32_bf16_dpp v13, v31, v64 row_newbcast:0
  v_dot2c_f32_bf16_dpp v14, v30, v65 row_newbcast:0
  v_dot2c_f32_bf16_dpp v15, v31, v65 row_newbcast:0
  v_dot2c_f32_bf16_dpp v16, v30, v66 row_newbcast:0
  v_dot2c_f32_bf16_dpp v17, v31, v66 row_newbcast:0
  v_dot2c_f32_bf16_dpp v18, v30, v67 row_newbcast:0
  v_dot2c_f32_bf16_dpp v19, v31, v67 row_newbcast:0
  s_cbranch_vccz L_d304
  s_waitcnt vmcnt(5)
L_d304:
  s_xor_b32 s68, s70, 0xa0c00
  buffer_load_dwordx4 v[88:91], v63, s[8:11], s68 offen nt
  s_cmp_eq_u32 s64, 2
  s_cbranch_scc0 L_wp76
  s_mov_b32 s101, 0
  s_waitcnt lgkmcnt(0)
  s_cmp_ge_u32 s40, 6
  s_addc_u32 s101, s101, 0
  s_cmp_ge_u32 s41, 6
  s_addc_u32 s101, s101, 0
  s_cmp_ge_u32 s42, 6
  s_addc_u32 s101, s101, 0
  s_cmp_ge_u32 s43, 6
  s_addc_u32 s101, s101, 0
  s_cmp_ge_u32 s44, 6
  s_addc_u32 s101, s101, 0
  s_cmp_ge_u32 s45, 6
  s_addc_u32 s101, s101, 0
  s_cmp_ge_u32 s46, 6
  s_addc_u32 s101, s101, 0
  s_cmp_ge_u32 s47, 6
  s_addc_u32 s101, s101, 0
  s_cmp_lt_u32 s101, 6
  s_cselect_b32 s38, -1, 0
  v_mov_b32 v26, 0
  v_mov_b32 v27, s38
  ds_write_b32 v26, v27 offset:8512
L_wp76:
  s_waitcnt vmcnt(6)
  v_dot2c_f32_bf16_dpp v12, v30, v68 row_newbcast:8
  v_dot2c_f32_bf16_dpp v13, v31, v68 row_newbcast:8
  v_dot2c_f32_bf16_dpp v14, v30, v69 row_newbcast:8
  v_dot2c_f32_bf16_dpp v15, v31, v69 row_newbcast:8
  v_dot2c_f32_bf16_dpp v16, v30, v70 row_newbcast:8
  v_dot2c_f32_bf16_dpp v17, v31, v70 row_newbcast:8
  v_dot2c_f32_bf16_dpp v18, v30, v71 row_newbcast:8
  v_dot2c_f32_bf16_dpp v19, v31, v71 row_newbcast:8
  s_cbranch_vccz L_d305
  s_waitcnt vmcnt(5)
L_d305:
  s_xor_b32 s68, s70, 0xa0d00
  buffer_load_dwordx4 v[92:95], v63, s[8:11], s68 offen nt
  s_waitcnt vmcnt(6)
  v_dot2c_f32_bf16_dpp v12, v30, v72 row_newbcast:4
  v_dot2c_f32_bf16_dpp v13, v31, v72 row_newbcast:4
  v_dot2c_f32_bf16_dpp v14, v30, v73 row_newbcast:4
  v_dot2c_f32_bf16_dpp v15, v31, v73 row_newbcast:4
  v_dot2c_f32_bf16_dpp v16, v30, v74 row_newbcast:4
  v_dot2c_f32_bf16_dpp v17, v31, v74 row_newbcast:4
  v_dot2c_f32_bf16_dpp v18, v30, v75 row_newbcast:4
  v_dot2c_f32_bf16_dpp v19, v31, v75 row_newbcast:4
  s_cbranch_vccz L_d306
  s_waitcnt vmcnt(5)
L_d306:
  s_xor_b32 s68, s70, 0xb0000
  buffer_load_dwordx4 v[96:99], v63, s[8:11], s68 offen nt
  buffer_load_dwordx4 a[52:55], v3, s[24:27], s73 offen offset:2048
  s_waitcnt vmcnt(7)
  v_dot2c_f32_bf16_dpp v12, v30, v76 row_newbcast:12
  v_dot2c_f32_bf16_dpp v13, v31, v76 row_newbcast:12
  v_dot2c_f32_bf16_dpp v14, v30, v77 row_newbcast:12
  v_dot2c_f32_bf16_dpp v15, v31, v77 row_newbcast:12
  v_dot2c_f32_bf16_dpp v16, v30, v78 row_newbcast:12
  v_dot2c_f32_bf16_dpp v17, v31, v78 row_newbcast:12
  v_dot2c_f32_bf16_dpp v18, v30, v79 row_newbcast:12
  v_dot2c_f32_bf16_dpp v19, v31, v79 row_newbcast:12
  s_cbranch_vccz L_d307
  s_waitcnt vmcnt(6)
L_d307:
  s_xor_b32 s68, s70, 0xb0100
  buffer_load_dwordx4 v[100:103], v63, s[8:11], s68 offen nt
  s_barrier
  v_fma_f32 v28, v205, s71, -v29
  v_exp_f32 v28, v28
  s_nop 0
  v_cvt_pk_bf16_f32 v30, v28, 0
  v_cvt_pk_bf16_f32 v31, 0, v28
  v_add_f32 v21, v21, v28
  s_waitcnt vmcnt(7)
  v_dot2c_f32_bf16_dpp v12, v30, v80 row_newbcast:0
  v_dot2c_f32_bf16_dpp v13, v31, v80 row_newbcast:0
  v_dot2c_f32_bf16_dpp v14, v30, v81 row_newbcast:0
  v_dot2c_f32_bf16_dpp v15, v31, v81 row_newbcast:0
  v_dot2c_f32_bf16_dpp v16, v30, v82 row_newbcast:0
  v_dot2c_f32_bf16_dpp v17, v31, v82 row_newbcast:0
  v_dot2c_f32_bf16_dpp v18, v30, v83 row_newbcast:0
  v_dot2c_f32_bf16_dpp v19, v31, v83 row_newbcast:0
  s_cbranch_vccz L_d308
  s_waitcnt vmcnt(5)
L_d308:
  s_xor_b32 s68, s70, 0xb0400
  buffer_load_dwordx4 v[104:107], v63, s[8:11], s68 offen nt
  v_mov_b32 v26, 0
  ds_read_b32 v35, v26 offset:8512
  s_waitcnt vmcnt(6)
  v_dot2c_f32_bf16_dpp v12, v30, v84 row_newbcast:8
  v_dot2c_f32_bf16_dpp v13, v31, v84 row_newbcast:8
  v_dot2c_f32_bf16_dpp v14, v30, v85 row_newbcast:8
  v_dot2c_f32_bf16_dpp v15, v31, v85 row_newbcast:8
  v_dot2c_f32_bf16_dpp v16, v30, v86 row_newbcast:8
  v_dot2c_f32_bf16_dpp v17, v31, v86 row_newbcast:8
  v_dot2c_f32_bf16_dpp v18, v30, v87 row_newbcast:8
  v_dot2c_f32_bf16_dpp v19, v31, v87 row_newbcast:8
  s_cbranch_vccz L_d309
  s_waitcnt vmcnt(5)
L_d309:
  s_xor_b32 s68, s70, 0xb0500
  buffer_load_dwordx4 v[108:111], v63, s[8:11], s68 offen nt
  s_waitcnt vmcnt(6)
  v_dot2c_f32_bf16_dpp v12, v30, v88 row_newbcast:4
  v_dot2c_f32_bf16_dpp v13, v31, v88 row_newbcast:4
  v_dot2c_f32_bf16_dpp v14, v30, v89 row_newbcast:4
  v_dot2c_f32_bf16_dpp v15, v31, v89 row_newbcast:4
  v_dot2c_f32_bf16_dpp v16, v30, v90 row_newbcast:4
  v_dot2c_f32_bf16_dpp v17, v31, v90 row_newbcast:4
  v_dot2c_f32_bf16_dpp v18, v30, v91 row_newbcast:4
  v_dot2c_f32_bf16_dpp v19, v31, v91 row_newbcast:4
  s_cbranch_vccz L_d310
  s_waitcnt vmcnt(5)
L_d310:
  s_xor_b32 s68, s70, 0xb0800
  buffer_load_dwordx4 v[112:115], v63, s[8:11], s68 offen nt
  buffer_load_dwordx4 a[60:63], v3, s[24:27], s73 offen offset:2304
  s_add_u32 s73, s73, 4096
  s_waitcnt vmcnt(7)
  v_dot2c_f32_bf16_dpp v12, v30, v92 row_newbcast:12
  v_dot2c_f32_bf16_dpp v13, v31, v92 row_newbcast:12
  v_dot2c_f32_bf16_dpp v14, v30, v93 row_newbcast:12
  v_dot2c_f32_bf16_dpp v15, v31, v93 row_newbcast:12
  v_dot2c_f32_bf16_dpp v16, v30, v94 row_newbcast:12
  v_dot2c_f32_bf16_dpp v17, v31, v94 row_newbcast:12
  v_dot2c_f32_bf16_dpp v18, v30, v95 row_newbcast:12
  v_dot2c_f32_bf16_dpp v19, v31, v95 row_newbcast:12
  s_cbranch_vccz L_d311
  s_waitcnt vmcnt(6)
L_d311:
  s_xor_b32 s68, s70, 0xb0900
  buffer_load_dwordx4 v[116:119], v63, s[8:11], s68 offen nt
  s_barrier
  v_fma_f32 v28, v206, s71, -v29
  v_exp_f32 v28, v28
  s_nop 0
  v_cvt_pk_bf16_f32 v30, v28, 0
  v_cvt_pk_bf16_f32 v31, 0, v28
  v_add_f32 v21, v21, v28
  s_waitcnt vmcnt(7)
  v_dot2c_f32_bf16_dpp v12, v30, v96 row_newbcast:0
  v_dot2c_f32_bf16_dpp v13, v31, v96 row_newbcast:0
  v_dot2c_f32_bf16_dpp v14, v30, v97 row_newbcast:0
  v_dot2c_f32_bf16_dpp v15, v31, v97 row_newbcast:0
  v_dot2c_f32_bf16_dpp v16, v30, v98 row_newbcast:0
  v_dot2c_f32_bf16_dpp v17, v31, v98 row_newbcast:0
  v_dot2c_f32_bf16_dpp v18, v30, v99 row_newbcast:0
  v_dot2c_f32_bf16_dpp v19, v31, v99 row_newbcast:0
  s_cbranch_vccz L_d312
  s_waitcnt vmcnt(5)
L_d312:
  s_xor_b32 s68, s70, 0xb0c00
  buffer_load_dwordx4 v[120:123], v63, s[8:11], s68 offen nt
  s_waitcnt lgkmcnt(0)
  v_cmp_ne_u32 vcc, 0, v35
  s_waitcnt vmcnt(6)
  v_dot2c_f32_bf16_dpp v12, v30, v100 row_newbcast:8
  v_dot2c_f32_bf16_dpp v13, v31, v100 row_newbcast:8
  v_dot2c_f32_bf16_dpp v14, v30, v101 row_newbcast:8
  v_dot2c_f32_bf16_dpp v15, v31, v101 row_newbcast:8
  v_dot2c_f32_bf16_dpp v16, v30, v102 row_newbcast:8
  v_dot2c_f32_bf16_dpp v17, v31, v102 row_newbcast:8
  v_dot2c_f32_bf16_dpp v18, v30, v103 row_newbcast:8
  v_dot2c_f32_bf16_dpp v19, v31, v103 row_newbcast:8
  s_cbranch_vccz L_d313
  s_waitcnt vmcnt(5)
L_d313:
  s_xor_b32 s68, s70, 0xb0d00
  buffer_load_dwordx4 v[124:127], v63, s[8:11], s68 offen nt
  s_waitcnt vmcnt(6)
  v_dot2c_f32_bf16_dpp v12, v30, v104 row_newbcast:4
  v_dot2c_f32_bf16_dpp v13, v31, v104 row_newbcast:4
  v_dot2c_f32_bf16_dpp v14, v30, v105 row_newbcast:4
  v_dot2c_f32_bf16_dpp v15, v31, v105 row_newbcast:4
  v_dot2c_f32_bf16_dpp v16, v30, v106 row_newbcast:4
  v_dot2c_f32_bf16_dpp v17, v31, v106 row_newbcast:4
  v_dot2c_f32_bf16_dpp v18, v30, v107 row_newbcast:4
  v_dot2c_f32_bf16_dpp v19, v31, v107 row_newbcast:4
  s_cbranch_vccz L_d314
  s_waitcnt vmcnt(5)
L_d314:
  s_xor_b32 s68, s70, 0x40000
  buffer_load_dwordx4 v[64:67], v63, s[8:11], s68 offen nt
  s_lshl_b32 s73, s76, 13
  s_add_u32 s73, s73, s84
  buffer_load_dwordx4 a[64:67], v3, s[24:27], s73 offen offset:0
  s_waitcnt vmcnt(7)
  v_dot2c_f32_bf16_dpp v12, v30, v108 row_newbcast:12
  v_dot2c_f32_bf16_dpp v13, v31, v108 row_newbcast:12
  v_dot2c_f32_bf16_dpp v14, v30, v109 row_newbcast:12
  v_dot2c_f32_bf16_dpp v15, v31, v109 row_newbcast:12
  v_dot2c_f32_bf16_dpp v16, v30, v110 row_newbcast:12
  v_dot2c_f32_bf16_dpp v17, v31, v110 row_newbcast:12
  v_dot2c_f32_bf16_dpp v18, v30, v111 row_newbcast:12
  v_dot2c_f32_bf16_dpp v19, v31, v111 row_newbcast:12
  s_cbranch_vccz L_d315
  s_waitcnt vmcnt(6)
L_d315:
  s_xor_b32 s68, s70, 0x40100
  buffer_load_dwordx4 v[68:71], v63, s[8:11], s68 offen nt
  s_barrier
  v_fma_f32 v28, v207, s71, -v29
  v_exp_f32 v28, v28
  s_nop 0
  v_cvt_pk_bf16_f32 v30, v28, 0
  v_cvt_pk_bf16_f32 v31, 0, v28
  v_add_f32 v21, v21, v28
  s_waitcnt vmcnt(7)
  v_dot2c_f32_bf16_dpp v12, v30, v112 row_newbcast:0
  v_dot2c_f32_bf16_dpp v13, v31, v112 row_newbcast:0
  v_dot2c_f32_bf16_dpp v14, v30, v113 row_newbcast:0
  v_dot2c_f32_bf16_dpp v15, v31, v113 row_newbcast:0
  v_dot2c_f32_bf16_dpp v16, v30, v114 row_newbcast:0
  v_dot2c_f32_bf16_dpp v17, v31, v114 row_newbcast:0
  v_dot2c_f32_bf16_dpp v18, v30, v115 row_newbcast:0
  v_dot2c_f32_bf16_dpp v19, v31, v115 row_newbcast:0
  s_cbranch_vccz L_d316
  s_waitcnt vmcnt(5)
L_d316:
  s_xor_b32 s68, s70, 0x40400
  buffer_load_dwordx4 v[72:75], v63, s[8:11], s68 offen nt
  s_waitcnt vmcnt(6)
  v_dot2c_f32_bf16_dpp v12, v30, v116 row_newbcast:8
  v_dot2c_f32_bf16_dpp v13, v31, v116 row_newbcast:8
  v_dot2c_f32_bf16_dpp v14, v30, v117 row_newbcast:8
  v_dot2c_f32_bf16_dpp v15, v31, v117 row_newbcast:8
  v_dot2c_f32_bf16_dpp v16, v30, v118 row_newbcast:8
  v_dot2c_f32_bf16_dpp v17, v31, v118 row_newbcast:8
  v_dot2c_f32_bf16_dpp v18, v30, v119 row_newbcast:8
  v_dot2c_f32_bf16_dpp v19, v31, v119 row_newbcast:8
  s_cbranch_vccz L_d317
  s_waitcnt vmcnt(5)
L_d317:
  s_xor_b32 s68, s70, 0x40500
  buffer_load_dwordx4 v[76:79], v63, s[8:11], s68 offen nt
  s_waitcnt vmcnt(6)
  v_dot2c_f32_bf16_dpp v12, v30, v120 row_newbcast:4
  v_dot2c_f32_bf16_dpp v13, v31, v120 row_newbcast:4
  v_dot2c_f32_bf16_dpp v14, v30, v121 row_newbcast:4
  v_dot2c_f32_bf16_dpp v15, v31, v121 row_newbcast:4
  v_dot2c_f32_bf16_dpp v16, v30, v122 row_newbcast:4
  v_dot2c_f32_bf16_dpp v17, v31, v122 row_newbcast:4
  v_dot2c_f32_bf16_dpp v18, v30, v123 row_newbcast:4
  v_dot2c_f32_bf16_dpp v19, v31, v123 row_newbcast:4
  s_cbranch_vccz L_d318
  s_waitcnt vmcnt(5)
L_d318:
  s_xor_b32 s68, s70, 0x40800
  buffer_load_dwordx4 v[80:83], v63, s[8:11], s68 offen nt
  buffer_load_dwordx4 a[72:75], v3, s[24:27], s73 offen offset:256
  s_waitcnt vmcnt(7)
  v_dot2c_f32_bf16_dpp v12, v30, v124 row_newbcast:12
  v_dot2c_f32_bf16_dpp v13, v31, v124 row_newbcast:12
  v_dot2c_f32_bf16_dpp v14, v30, v125 row_newbcast:12
  v_dot2c_f32_bf16_dpp v15, v31, v125 row_newbcast:12
  v_dot2c_f32_bf16_dpp v16, v30, v126 row_newbcast:12
  v_dot2c_f32_bf16_dpp v17, v31, v126 row_newbcast:12
  v_dot2c_f32_bf16_dpp v18, v30, v127 row_newbcast:12
  v_dot2c_f32_bf16_dpp v19, v31, v127 row_newbcast:12
  s_cbranch_vccz L_d319
  s_waitcnt vmcnt(6)
L_d319:
  s_xor_b32 s68, s70, 0x40900
  buffer_load_dwordx4 v[84:87], v63, s[8:11], s68 offen nt
  s_barrier
  v_fma_f32 v28, v208, s71, -v29
  v_exp_f32 v28, v28
  s_nop 0
  v_cvt_pk_bf16_f32 v30, v28, 0
  v_cvt_pk_bf16_f32 v31, 0, v28
  v_add_f32 v21, v21, v28
  s_waitcnt vmcnt(7)
  v_dot2c_f32_bf16_dpp v12, v30, v64 row_newbcast:0
  v_dot2c_f32_bf16_dpp v13, v31, v64 row_newbcast:0
  v_dot2c_f32_bf16_dpp v14, v30, v65 row_newbcast:0
  v_dot2c_f32_bf16_dpp v15, v31, v65 row_newbcast:0
  v_dot2c_f32_bf16_dpp v16, v30, v66 row_newbcast:0
  v_dot2c_f32_bf16_dpp v17, v31, v66 row_newbcast:0
  v_dot2c_f32_bf16_dpp v18, v30, v67 row_newbcast:0
  v_dot2c_f32_bf16_dpp v19, v31, v67 row_newbcast:0
  s_cbranch_vccz L_d320
  s_waitcnt vmcnt(5)
L_d320:
  s_xor_b32 s68, s70, 0x40c00
  buffer_load_dwordx4 v[88:91], v63, s[8:11], s68 offen nt
  s_waitcnt vmcnt(6)
  v_dot2c_f32_bf16_dpp v12, v30, v68 row_newbcast:8
  v_dot2c_f32_bf16_dpp v13, v31, v68 row_newbcast:8
  v_dot2c_f32_bf16_dpp v14, v30, v69 row_newbcast:8
  v_dot2c_f32_bf16_dpp v15, v31, v69 row_newbcast:8
  v_dot2c_f32_bf16_dpp v16, v30, v70 row_newbcast:8
  v_dot2c_f32_bf16_dpp v17, v31, v70 row_newbcast:8
  v_dot2c_f32_bf16_dpp v18, v30, v71 row_newbcast:8
  v_dot2c_f32_bf16_dpp v19, v31, v71 row_newbcast:8
  s_cbranch_vccz L_d321
  s_waitcnt vmcnt(5)
L_d321:
  s_xor_b32 s68, s70, 0x40d00
  buffer_load_dwordx4 v[92:95], v63, s[8:11], s68 offen nt
  s_waitcnt vmcnt(6)
  v_dot2c_f32_bf16_dpp v12, v30, v72 row_newbcast:4
  v_dot2c_f32_bf16_dpp v13, v31, v72 row_newbcast:4
  v_dot2c_f32_bf16_dpp v14, v30, v73 row_newbcast:4
  v_dot2c_f32_bf16_dpp v15, v31, v73 row_newbcast:4
  v_dot2c_f32_bf16_dpp v16, v30, v74 row_newbcast:4
  v_dot2c_f32_bf16_dpp v17, v31, v74 row_newbcast:4
  v_dot2c_f32_bf16_dpp v18, v30, v75 row_newbcast:4
  v_dot2c_f32_bf16_dpp v19, v31, v75 row_newbcast:4
  s_cbranch_vccz L_d322
  s_waitcnt vmcnt(5)
L_d322:
  s_xor_b32 s68, s70, 0x50000
  buffer_load_dwordx4 v[96:99], v63, s[8:11], s68 offen nt
  buffer_load_dwordx4 a[68:71], v3, s[24:27], s73 offen offset:2048
  s_waitcnt vmcnt(7)
  v_dot2c_f32_bf16_dpp v12, v30, v76 row_newbcast:12
  v_dot2c_f32_bf16_dpp v13, v31, v76 row_newbcast:12
  v_dot2c_f32_bf16_dpp v14, v30, v77 row_newbcast:12
  v_dot2c_f32_bf16_dpp v15, v31, v77 row_newbcast:12
  v_dot2c_f32_bf16_dpp v16, v30, v78 row_newbcast:12
  v_dot2c_f32_bf16_dpp v17, v31, v78 row_newbcast:12
  v_dot2c_f32_bf16_dpp v18, v30, v79 row_newbcast:12
  v_dot2c_f32_bf16_dpp v19, v31, v79 row_newbcast:12
  s_cbranch_vccz L_d323
  s_waitcnt vmcnt(6)
L_d323:
  s_xor_b32 s68, s70, 0x50100
  buffer_load_dwordx4 v[100:103], v63, s[8:11], s68 offen nt
  s_barrier
  v_fma_f32 v28, v209, s71, -v29
  v_exp_f32 v28, v28
  s_nop 0
  v_cvt_pk_bf16_f32 v30, v28, 0
  v_cvt_pk_bf16_f32 v31, 0, v28
  v_add_f32 v21, v21, v28
  s_waitcnt vmcnt(7)
  v_dot2c_f32_bf16_dpp v12, v30, v80 row_newbcast:0
  v_dot2c_f32_bf16_dpp v13, v31, v80 row_newbcast:0
  v_dot2c_f32_bf16_dpp v14, v30, v81 row_newbcast:0
  v_dot2c_f32_bf16_dpp v15, v31, v81 row_newbcast:0
  v_dot2c_f32_bf16_dpp v16, v30, v82 row_newbcast:0
  v_dot2c_f32_bf16_dpp v17, v31, v82 row_newbcast:0
  v_dot2c_f32_bf16_dpp v18, v30, v83 row_newbcast:0
  v_dot2c_f32_bf16_dpp v19, v31, v83 row_newbcast:0
  s_cbranch_vccz L_d324
  s_waitcnt vmcnt(5)
L_d324:
  s_xor_b32 s68, s70, 0x50400
  buffer_load_dwordx4 v[104:107], v63, s[8:11], s68 offen nt
  s_waitcnt vmcnt(6)
  v_dot2c_f32_bf16_dpp v12, v30, v84 row_newbcast:8
  v_dot2c_f32_bf16_dpp v13, v31, v84 row_newbcast:8
  v_dot2c_f32_bf16_dpp v14, v30, v85 row_newbcast:8
  v_dot2c_f32_bf16_dpp v15, v31, v85 row_newbcast:8
  v_dot2c_f32_bf16_dpp v16, v30, v86 row_newbcast:8
  v_dot2c_f32_bf16_dpp v17, v31, v86 row_newbcast:8
  v_dot2c_f32_bf16_dpp v18, v30, v87 row_newbcast:8
  v_dot2c_f32_bf16_dpp v19, v31, v87 row_newbcast:8
  s_cbranch_vccz L_d325
  s_waitcnt vmcnt(5)
L_d325:
  s_xor_b32 s68, s70, 0x50500
  buffer_load_dwordx4 v[108:111], v63, s[8:11], s68 offen nt
  s_waitcnt vmcnt(6)
  v_dot2c_f32_bf16_dpp v12, v30, v88 row_newbcast:4
  v_dot2c_f32_bf16_dpp v13, v31, v88 row_newbcast:4
  v_dot2c_f32_bf16_dpp v14, v30, v89 row_newbcast:4
  v_dot2c_f32_bf16_dpp v15, v31, v89 row_newbcast:4
  v_dot2c_f32_bf16_dpp v16, v30, v90 row_newbcast:4
  v_dot2c_f32_bf16_dpp v17, v31, v90 row_newbcast:4
  v_dot2c_f32_bf16_dpp v18, v30, v91 row_newbcast:4
  v_dot2c_f32_bf16_dpp v19, v31, v91 row_newbcast:4
  s_cbranch_vccz L_d326
  s_waitcnt vmcnt(5)
L_d326:
  s_xor_b32 s68, s70, 0x50800
  buffer_load_dwordx4 v[112:115], v63, s[8:11], s68 offen nt
  buffer_load_dwordx4 a[76:79], v3, s[24:27], s73 offen offset:2304
  s_add_u32 s73, s73, 4096
  s_waitcnt vmcnt(7)
  v_dot2c_f32_bf16_dpp v12, v30, v92 row_newbcast:12
  v_dot2c_f32_bf16_dpp v13, v31, v92 row_newbcast:12
  v_dot2c_f32_bf16_dpp v14, v30, v93 row_newbcast:12
  v_dot2c_f32_bf16_dpp v15, v31, v93 row_newbcast:12
  v_dot2c_f32_bf16_dpp v16, v30, v94 row_newbcast:12
  v_dot2c_f32_bf16_dpp v17, v31, v94 row_newbcast:12
  v_dot2c_f32_bf16_dpp v18, v30, v95 row_newbcast:12
  v_dot2c_f32_bf16_dpp v19, v31, v95 row_newbcast:12
  s_cbranch_vccz L_d327
  s_waitcnt vmcnt(6)
L_d327:
  s_xor_b32 s68, s70, 0x50900
  buffer_load_dwordx4 v[116:119], v63, s[8:11], s68 offen nt
  s_barrier
  v_fma_f32 v28, v210, s71, -v29
  v_exp_f32 v28, v28
  s_nop 0
  v_cvt_pk_bf16_f32 v30, v28, 0
  v_cvt_pk_bf16_f32 v31, 0, v28
  v_add_f32 v21, v21, v28
  s_waitcnt vmcnt(7)
  v_dot2c_f32_bf16_dpp v12, v30, v96 row_newbcast:0
  v_dot2c_f32_bf16_dpp v13, v31, v96 row_newbcast:0
  v_dot2c_f32_bf16_dpp v14, v30, v97 row_newbcast:0
  v_dot2c_f32_bf16_dpp v15, v31, v97 row_newbcast:0
  v_dot2c_f32_bf16_dpp v16, v30, v98 row_newbcast:0
  v_dot2c_f32_bf16_dpp v17, v31, v98 row_newbcast:0
  v_dot2c_f32_bf16_dpp v18, v30, v99 row_newbcast:0
  v_dot2c_f32_bf16_dpp v19, v31, v99 row_newbcast:0
  s_cbranch_vccz L_d328
  s_waitcnt vmcnt(5)
L_d328:
  s_xor_b32 s68, s70, 0x50c00
  buffer_load_dwordx4 v[120:123], v63, s[8:11], s68 offen nt
  s_waitcnt vmcnt(6)
  v_dot2c_f32_bf16_dpp v12, v30, v100 row_newbcast:8
  v_dot2c_f32_bf16_dpp v13, v31, v100 row_newbcast:8
  v_dot2c_f32_bf16_dpp v14, v30, v101 row_newbcast:8
  v_dot2c_f32_bf16_dpp v15, v31, v101 row_newbcast:8
  v_dot2c_f32_bf16_dpp v16, v30, v102 row_newbcast:8
  v_dot2c_f32_bf16_dpp v17, v31, v102 row_newbcast:8
  v_dot2c_f32_bf16_dpp v18, v30, v103 row_newbcast:8
  v_dot2c_f32_bf16_dpp v19, v31, v103 row_newbcast:8
  s_cbranch_vccz L_d329
  s_waitcnt vmcnt(5)
L_d329:
  s_xor_b32 s68, s70, 0x50d00
  buffer_load_dwordx4 v[124:127], v63, s[8:11], s68 offen nt
  s_waitcnt vmcnt(6)
  v_dot2c_f32_bf16_dpp v12, v30, v104 row_newbcast:4
  v_dot2c_f32_bf16_dpp v13, v31, v104 row_newbcast:4
  v_dot2c_f32_bf16_dpp v14, v30, v105 row_newbcast:4
  v_dot2c_f32_bf16_dpp v15, v31, v105 row_newbcast:4
  v_dot2c_f32_bf16_dpp v16, v30, v106 row_newbcast:4
  v_dot2c_f32_bf16_dpp v17, v31, v106 row_newbcast:4
  v_dot2c_f32_bf16_dpp v18, v30, v107 row_newbcast:4
  v_dot2c_f32_bf16_dpp v19, v31, v107 row_newbcast:4
  s_cbranch_vccz L_d330
  s_waitcnt vmcnt(5)
L_d330:
  s_xor_b32 s68, s70, 0x60000
  buffer_load_dwordx4 v[64:67], v63, s[8:11], s68 offen nt
  buffer_load_dwordx4 a[80:83], v3, s[24:27], s73 offen offset:0
  s_waitcnt vmcnt(7)
  v_dot2c_f32_bf16_dpp v12, v30, v108 row_newbcast:12
  v_dot2c_f32_bf16_dpp v13, v31, v108 row_newbcast:12
  v_dot2c_f32_bf16_dpp v14, v30, v109 row_newbcast:12
  v_dot2c_f32_bf16_dpp v15, v31, v109 row_newbcast:12
  v_dot2c_f32_bf16_dpp v16, v30, v110 row_newbcast:12
  v_dot2c_f32_bf16_dpp v17, v31, v110 row_newbcast:12
  v_dot2c_f32_bf16_dpp v18, v30, v111 row_newbcast:12
  v_dot2c_f32_bf16_dpp v19, v31, v111 row_newbcast:12
  s_cbranch_vccz L_d331
  s_waitcnt vmcnt(6)
L_d331:
  s_xor_b32 s68, s70, 0x60100
  buffer_load_dwordx4 v[68:71], v63, s[8:11], s68 offen nt
  s_barrier
  v_fma_f32 v28, v211, s71, -v29
  v_exp_f32 v28, v28
  s_nop 0
  v_cvt_pk_bf16_f32 v30, v28, 0
  v_cvt_pk_bf16_f32 v31, 0, v28
  v_add_f32 v21, v21, v28
  s_waitcnt vmcnt(7)
  v_dot2c_f32_bf16_dpp v12, v30, v112 row_newbcast:0
  v_dot2c_f32_bf16_dpp v13, v31, v112 row_newbcast:0
  v_dot2c_f32_bf16_dpp v14, v30, v113 row_newbcast:0
  v_dot2c_f32_bf16_dpp v15, v31, v113 row_newbcast:0
  v_dot2c_f32_bf16_dpp v16, v30, v114 row_newbcast:0
  v_dot2c_f32_bf16_dpp v17, v31, v114 row_newbcast:0
  v_dot2c_f32_bf16_dpp v18, v30, v115 row_newbcast:0
  v_dot2c_f32_bf16_dpp v19, v31, v115 row_newbcast:0
  s_cbranch_vccz L_d332
  s_waitcnt vmcnt(5)
L_d332:
  s_xor_b32 s68, s70, 0x60400
  buffer_load_dwordx4 v[72:75], v63, s[8:11], s68 offen nt
  s_waitcnt vmcnt(6)
  v_dot2c_f32_bf16_dpp v12, v30, v116 row_newbcast:8
  v_dot2c_f32_bf16_dpp v13, v31, v116 row_newbcast:8
  v_dot2c_f32_bf16_dpp v14, v30, v117 row_newbcast:8
  v_dot2c_f32_bf16_dpp v15, v31, v117 row_newbcast:8
  v_dot2c_f32_bf16_dpp v16, v30, v118 row_newbcast:8
  v_dot2c_f32_bf16_dpp v17, v31, v118 row_newbcast:8
  v_dot2c_f32_bf16_dpp v18, v30, v119 row_newbcast:8
  v_dot2c_f32_bf16_dpp v19, v31, v119 row_newbcast:8
  s_cbranch_vccz L_d333
  s_waitcnt vmcnt(5)
L_d333:
  s_xor_b32 s68, s70, 0x60500
  buffer_load_dwordx4 v[76:79], v63, s[8:11], s68 offen nt
  s_waitcnt vmcnt(6)
  v_dot2c_f32_bf16_dpp v12, v30, v120 row_newbcast:4
  v_dot2c_f32_bf16_dpp v13, v31, v120 row_newbcast:4
  v_dot2c_f32_bf16_dpp v14, v30, v121 row_newbcast:4
  v_dot2c_f32_bf16_dpp v15, v31, v121 row_newbcast:4
  v_dot2c_f32_bf16_dpp v16, v30, v122 row_newbcast:4
  v_dot2c_f32_bf16_dpp v17, v31, v122 row_newbcast:4
  v_dot2c_f32_bf16_dpp v18, v30, v123 row_newbcast:4
  v_dot2c_f32_bf16_dpp v19, v31, v123 row_newbcast:4
  s_cbranch_vccz L_d334
  s_waitcnt vmcnt(5)
L_d334:
  s_xor_b32 s68, s70, 0x60800
  buffer_load_dwordx4 v[80:83], v63, s[8:11], s68 offen nt
  buffer_load_dwordx4 a[88:91], v3, s[24:27], s73 offen offset:256
  s_waitcnt vmcnt(7)
  v_dot2c_f32_bf16_dpp v12, v30, v124 row_newbcast:12
  v_dot2c_f32_bf16_dpp v13, v31, v124 row_newbcast:12
  v_dot2c_f32_bf16_dpp v14, v30, v125 row_newbcast:12
  v_dot2c_f32_bf16_dpp v15, v31, v125 row_newbcast:12
  v_dot2c_f32_bf16_dpp v16, v30, v126 row_newbcast:12
  v_dot2c_f32_bf16_dpp v17, v31, v126 row_newbcast:12
  v_dot2c_f32_bf16_dpp v18, v30, v127 row_newbcast:12
  v_dot2c_f32_bf16_dpp v19, v31, v127 row_newbcast:12
  s_cbranch_vccz L_d335
  s_waitcnt vmcnt(6)
L_d335:
  s_xor_b32 s68, s70, 0x60900
  buffer_load_dwordx4 v[84:87], v63, s[8:11], s68 offen nt
  s_barrier
  v_fma_f32 v28, v212, s71, -v29
  v_exp_f32 v28, v28
  s_nop 0
  v_cvt_pk_bf16_f32 v30, v28, 0
  v_cvt_pk_bf16_f32 v31, 0, v28
  v_add_f32 v21, v21, v28
  s_waitcnt vmcnt(7)
  v_dot2c_f32_bf16_dpp v12, v30, v64 row_newbcast:0
  v_dot2c_f32_bf16_dpp v13, v31, v64 row_newbcast:0
  v_dot2c_f32_bf16_dpp v14, v30, v65 row_newbcast:0
  v_dot2c_f32_bf16_dpp v15, v31, v65 row_newbcast:0
  v_dot2c_f32_bf16_dpp v16, v30, v66 row_newbcast:0
  v_dot2c_f32_bf16_dpp v17, v31, v66 row_newbcast:0
  v_dot2c_f32_bf16_dpp v18, v30, v67 row_newbcast:0
  v_dot2c_f32_bf16_dpp v19, v31, v67 row_newbcast:0
  s_cbranch_vccz L_d336
  s_waitcnt vmcnt(5)
L_d336:
  s_xor_b32 s68, s70, 0x60c00
  buffer_load_dwordx4 v[88:91], v63, s[8:11], s68 offen nt
  s_waitcnt vmcnt(6)
  v_dot2c_f32_bf16_dpp v12, v30, v68 row_newbcast:8
  v_dot2c_f32_bf16_dpp v13, v31, v68 row_newbcast:8
  v_dot2c_f32_bf16_dpp v14, v30, v69 row_newbcast:8
  v_dot2c_f32_bf16_dpp v15, v31, v69 row_newbcast:8
  v_dot2c_f32_bf16_dpp v16, v30, v70 row_newbcast:8
  v_dot2c_f32_bf16_dpp v17, v31, v70 row_newbcast:8
  v_dot2c_f32_bf16_dpp v18, v30, v71 row_newbcast:8
  v_dot2c_f32_bf16_dpp v19, v31, v71 row_newbcast:8
  s_cbranch_vccz L_d337
  s_waitcnt vmcnt(5)
L_d337:
  s_xor_b32 s68, s70, 0x60d00
  buffer_load_dwordx4 v[92:95], v63, s[8:11], s68 offen nt
  s_waitcnt vmcnt(6)
  v_dot2c_f32_bf16_dpp v12, v30, v72 row_newbcast:4
  v_dot2c_f32_bf16_dpp v13, v31, v72 row_newbcast:4
  v_dot2c_f32_bf16_dpp v14, v30, v73 row_newbcast:4
  v_dot2c_f32_bf16_dpp v15, v31, v73 row_newbcast:4
  v_dot2c_f32_bf16_dpp v16, v30, v74 row_newbcast:4
  v_dot2c_f32_bf16_dpp v17, v31, v74 row_newbcast:4
  v_dot2c_f32_bf16_dpp v18, v30, v75 row_newbcast:4
  v_dot2c_f32_bf16_dpp v19, v31, v75 row_newbcast:4
  s_cbranch_vccz L_d338
  s_waitcnt vmcnt(5)
L_d338:
  s_xor_b32 s68, s70, 0x70000
  buffer_load_dwordx4 v[96:99], v63, s[8:11], s68 offen nt
  buffer_load_dwordx4 a[84:87], v3, s[24:27], s73 offen offset:2048
  s_waitcnt vmcnt(7)
  v_dot2c_f32_bf16_dpp v12, v30, v76 row_newbcast:12
  v_dot2c_f32_bf16_dpp v13, v31, v76 row_newbcast:12
  v_dot2c_f32_bf16_dpp v14, v30, v77 row_newbcast:12
  v_dot2c_f32_bf16_dpp v15, v31, v77 row_newbcast:12
  v_dot2c_f32_bf16_dpp v16, v30, v78 row_newbcast:12
  v_dot2c_f32_bf16_dpp v17, v31, v78 row_newbcast:12
  v_dot2c_f32_bf16_dpp v18, v30, v79 row_newbcast:12
  v_dot2c_f32_bf16_dpp v19, v31, v79 row_newbcast:12
  s_cbranch_vccz L_d339
  s_waitcnt vmcnt(6)
L_d339:
  s_xor_b32 s68, s70, 0x70100
  buffer_load_dwordx4 v[100:103], v63, s[8:11], s68 offen nt
  s_barrier
  v_fma_f32 v28, v213, s71, -v29
  v_exp_f32 v28, v28
  s_nop 0
  v_cvt_pk_bf16_f32 v30, v28, 0
  v_cvt_pk_bf16_f32 v31, 0, v28
  v_add_f32 v21, v21, v28
  s_waitcnt vmcnt(7)
  v_dot2c_f32_bf16_dpp v12, v30, v80 row_newbcast:0
  v_dot2c_f32_bf16_dpp v13, v31, v80 row_newbcast:0
  v_dot2c_f32_bf16_dpp v14, v30, v81 row_newbcast:0
  v_dot2c_f32_bf16_dpp v15, v31, v81 row_newbcast:0
  v_dot2c_f32_bf16_dpp v16, v30, v82 row_newbcast:0
  v_dot2c_f32_bf16_dpp v17, v31, v82 row_newbcast:0
  v_dot2c_f32_bf16_dpp v18, v30, v83 row_newbcast:0
  v_dot2c_f32_bf16_dpp v19, v31, v83 row_newbcast:0
  s_cbranch_vccz L_d340
  s_waitcnt vmcnt(5)
L_d340:
  s_xor_b32 s68, s70, 0x70400
  buffer_load_dwordx4 v[104:107], v63, s[8:11], s68 offen nt
  s_waitcnt vmcnt(6)
  v_dot2c_f32_bf16_dpp v12, v30, v84 row_newbcast:8
  v_dot2c_f32_bf16_dpp v13, v31, v84 row_newbcast:8
  v_dot2c_f32_bf16_dpp v14, v30, v85 row_newbcast:8
  v_dot2c_f32_bf16_dpp v15, v31, v85 row_newbcast:8
  v_dot2c_f32_bf16_dpp v16, v30, v86 row_newbcast:8
  v_dot2c_f32_bf16_dpp v17, v31, v86 row_newbcast:8
  v_dot2c_f32_bf16_dpp v18, v30, v87 row_newbcast:8
  v_dot2c_f32_bf16_dpp v19, v31, v87 row_newbcast:8
  s_cbranch_vccz L_d341
  s_waitcnt vmcnt(5)
L_d341:
  s_xor_b32 s68, s70, 0x70500
  buffer_load_dwordx4 v[108:111], v63, s[8:11], s68 offen nt
  s_waitcnt vmcnt(6)
  v_dot2c_f32_bf16_dpp v12, v30, v88 row_newbcast:4
  v_dot2c_f32_bf16_dpp v13, v31, v88 row_newbcast:4
  v_dot2c_f32_bf16_dpp v14, v30, v89 row_newbcast:4
  v_dot2c_f32_bf16_dpp v15, v31, v89 row_newbcast:4
  v_dot2c_f32_bf16_dpp v16, v30, v90 row_newbcast:4
  v_dot2c_f32_bf16_dpp v17, v31, v90 row_newbcast:4
  v_dot2c_f32_bf16_dpp v18, v30, v91 row_newbcast:4
  v_dot2c_f32_bf16_dpp v19, v31, v91 row_newbcast:4
  s_cbranch_vccz L_d342
  s_waitcnt vmcnt(5)
L_d342:
  s_xor_b32 s68, s70, 0x70800
  buffer_load_dwordx4 v[112:115], v63, s[8:11], s68 offen nt
  buffer_load_dwordx4 a[92:95], v3, s[24:27], s73 offen offset:2304
  s_add_u32 s73, s73, 4096
  s_waitcnt vmcnt(7)
  v_dot2c_f32_bf16_dpp v12, v30, v92 row_newbcast:12
  v_dot2c_f32_bf16_dpp v13, v31, v92 row_newbcast:12
  v_dot2c_f32_bf16_dpp v14, v30, v93 row_newbcast:12
  v_dot2c_f32_bf16_dpp v15, v31, v93 row_newbcast:12
  v_dot2c_f32_bf16_dpp v16, v30, v94 row_newbcast:12
  v_dot2c_f32_bf16_dpp v17, v31, v94 row_newbcast:12
  v_dot2c_f32_bf16_dpp v18, v30, v95 row_newbcast:12
  v_dot2c_f32_bf16_dpp v19, v31, v95 row_newbcast:12
  s_cbranch_vccz L_d343
  s_waitcnt vmcnt(6)
L_d343:
  s_xor_b32 s68, s70, 0x70900
  buffer_load_dwordx4 v[116:119], v63, s[8:11], s68 offen nt
  s_barrier
  v_fma_f32 v28, v214, s71, -v29
  v_exp_f32 v28, v28
  s_nop 0
  v_cvt_pk_bf16_f32 v30, v28, 0
  v_cvt_pk_bf16_f32 v31, 0, v28
  v_add_f32 v21, v21, v28
  s_waitcnt vmcnt(7)
  v_dot2c_f32_bf16_dpp v12, v30, v96 row_newbcast:0
  v_dot2c_f32_bf16_dpp v13, v31, v96 row_newbcast:0
  v_dot2c_f32_bf16_dpp v14, v30, v97 row_newbcast:0
  v_dot2c_f32_bf16_dpp v15, v31, v97 row_newbcast:0
  v_dot2c_f32_bf16_dpp v16, v30, v98 row_newbcast:0
  v_dot2c_f32_bf16_dpp v17, v31, v98 row_newbcast:0
  v_dot2c_f32_bf16_dpp v18, v30, v99 row_newbcast:0
  v_dot2c_f32_bf16_dpp v19, v31, v99 row_newbcast:0
  s_cbranch_vccz L_d344
  s_waitcnt vmcnt(5)
L_d344:
  s_xor_b32 s68, s70, 0x70c00
  buffer_load_dwordx4 v[120:123], v63, s[8:11], s68 offen nt
  s_cmp_eq_u32 s64, 3
  s_cbranch_scc0 L_wp86
  s_mov_b32 s100, 7
  s_atomic_umax s100, s[20:21], s88
  s_and_b32 s60, s88, 0xfffffc7f
  s_xor_b32 s61, s60, 8192
  s_add_u32 s38, s61, 0
  s_load_dword s40, s[20:21], s38 glc
  s_add_u32 s38, s60, 128
  s_load_dword s41, s[20:21], s38 glc
  s_add_u32 s38, s60, 256
  s_load_dword s42, s[20:21], s38 glc
  s_add_u32 s38, s61, 384
  s_load_dword s43, s[20:21], s38 glc
  s_add_u32 s38, s61, 512
  s_load_dword s44, s[20:21], s38 glc
  s_add_u32 s38, s60, 640
  s_load_dword s45, s[20:21], s38 glc
  s_add_u32 s38, s60, 768
  s_load_dword s46, s[20:21], s38 glc
  s_add_u32 s38, s61, 896
  s_load_dword s47, s[20:21], s38 glc
L_wp86:
  s_waitcnt vmcnt(6)
  v_dot2c_f32_bf16_dpp v12, v30, v100 row_newbcast:8
  v_dot2c_f32_bf16_dpp v13, v31, v100 row_newbcast:8
  v_dot2c_f32_bf16_dpp v14, v30, v101 row_newbcast:8
  v_dot2c_f32_bf16_dpp v15, v31, v101 row_newbcast:8
  v_dot2c_f32_bf16_dpp v16, v30, v102 row_newbcast:8
  v_dot2c_f32_bf16_dpp v17, v31, v102 row_newbcast:8
  v_dot2c_f32_bf16_dpp v18, v30, v103 row_newbcast:8
  v_dot2c_f32_bf16_dpp v19, v31, v103 row_newbcast:8
  s_cbranch_vccz L_d345
  s_waitcnt vmcnt(5)
L_d345:
  s_xor_b32 s68, s70, 0x70d00
  buffer_load_dwordx4 v[124:127], v63, s[8:11], s68 offen nt
  s_waitcnt vmcnt(6)
  v_dot2c_f32_bf16_dpp v12, v30, v104 row_newbcast:4
  v_dot2c_f32_bf16_dpp v13, v31, v104 row_newbcast:4
  v_dot2c_f32_bf16_dpp v14, v30, v105 row_newbcast:4
  v_dot2c_f32_bf16_dpp v15, v31, v105 row_newbcast:4
  v_dot2c_f32_bf16_dpp v16, v30, v106 row_newbcast:4
  v_dot2c_f32_bf16_dpp v17, v31, v106 row_newbcast:4
  v_dot2c_f32_bf16_dpp v18, v30, v107 row_newbcast:4
  v_dot2c_f32_bf16_dpp v19, v31, v107 row_newbcast:4
  s_cbranch_vccz L_d346
  s_waitcnt vmcnt(5)
L_d346:
  s_xor_b32 s68, s70, 0xc0000
  buffer_load_dwordx4 v[64:67], v63, s[8:11], s68 offen nt
  s_lshl_b32 s73, s77, 13
  s_add_u32 s73, s73, s84
  buffer_load_dwordx4 a[96:99], v3, s[24:27], s73 offen offset:0
  s_waitcnt vmcnt(7)
  v_dot2c_f32_bf16_dpp v12, v30, v108 row_newbcast:12
  v_dot2c_f32_bf16_dpp v13, v31, v108 row_newbcast:12
  v_dot2c_f32_bf16_dpp v14, v30, v109 row_newbcast:12
  v_dot2c_f32_bf16_dpp v15, v31, v109 row_newbcast:12
  v_dot2c_f32_bf16_dpp v16, v30, v110 row_newbcast:12
  v_dot2c_f32_bf16_dpp v17, v31, v110 row_newbcast:12
  v_dot2c_f32_bf16_dpp v18, v30, v111 row_newbcast:12
  v_dot2c_f32_bf16_dpp v19, v31, v111 row_newbcast:12
  s_cbranch_vccz L_d347
  s_waitcnt vmcnt(6)
L_d347:
  s_xor_b32 s68, s70, 0xc0100
  buffer_load_dwordx4 v[68:71], v63, s[8:11], s68 offen nt
  s_barrier
  v_fma_f32 v28, v215, s71, -v29
  v_exp_f32 v28, v28
  s_nop 0
  v_cvt_pk_bf16_f32 v30, v28, 0
  v_cvt_pk_bf16_f32 v31, 0, v28
  v_add_f32 v21, v21, v28
  s_waitcnt vmcnt(7)
  v_dot2c_f32_bf16_dpp v12, v30, v112 row_newbcast:0
  v_dot2c_f32_bf16_dpp v13, v31, v112 row_newbcast:0
  v_dot2c_f32_bf16_dpp v14, v30, v113 row_newbcast:0
  v_dot2c_f32_bf16_dpp v15, v31, v113 row_newbcast:0
  v_dot2c_f32_bf16_dpp v16, v30, v114 row_newbcast:0
  v_dot2c_f32_bf16_dpp v17, v31, v114 row_newbcast:0
  v_dot2c_f32_bf16_dpp v18, v30, v115 row_newbcast:0
  v_dot2c_f32_bf16_dpp v19, v31, v115 row_newbcast:0
  s_cbranch_vccz L_d348
  s_waitcnt vmcnt(5)
L_d348:
  s_xor_b32 s68, s70, 0xc0400
  buffer_load_dwordx4 v[72:75], v63, s[8:11], s68 offen nt
  s_waitcnt vmcnt(6)
  v_dot2c_f32_bf16_dpp v12, v30, v116 row_newbcast:8
  v_dot2c_f32_bf16_dpp v13, v31, v116 row_newbcast:8
  v_dot2c_f32_bf16_dpp v14, v30, v117 row_newbcast:8
  v_dot2c_f32_bf16_dpp v15, v31, v117 row_newbcast:8
  v_dot2c_f32_bf16_dpp v16, v30, v118 row_newbcast:8
  v_dot2c_f32_bf16_dpp v17, v31, v118 row_newbcast:8
  v_dot2c_f32_bf16_dpp v18, v30, v119 row_newbcast:8
  v_dot2c_f32_bf16_dpp v19, v31, v119 row_newbcast:8
  s_cbranch_vccz L_d349
  s_waitcnt vmcnt(5)
L_d349:
  s_xor_b32 s68, s70, 0xc0500
  buffer_load_dwordx4 v[76:79], v63, s[8:11], s68 offen nt
  s_waitcnt vmcnt(6)
  v_dot2c_f32_bf16_dpp v12, v30, v120 row_newbcast:4
  v_dot2c_f32_bf16_dpp v13, v31, v120 row_newbcast:4
  v_dot2c_f32_bf16_dpp v14, v30, v121 row_newbcast:4
  v_dot2c_f32_bf16_dpp v15, v31, v121 row_newbcast:4
  v_dot2c_f32_bf16_dpp v16, v30, v122 row_newbcast:4
  v_dot2c_f32_bf16_dpp v17, v31, v122 row_newbcast:4
  v_dot2c_f32_bf16_dpp v18, v30, v123 row_newbcast:4
  v_dot2c_f32_bf16_dpp v19, v31, v123 row_newbcast:4
  s_cbranch_vccz L_d350
  s_waitcnt vmcnt(5)
L_d350:
  s_xor_b32 s68, s70, 0xc0800
  buffer_load_dwordx4 v[80:83], v63, s[8:11], s68 offen nt
  buffer_load_dwordx4 a[104:107], v3, s[24:27], s73 offen offset:256
  s_waitcnt vmcnt(7)
  v_dot2c_f32_bf16_dpp v12, v30, v124 row_newbcast:12
  v_dot2c_f32_bf16_dpp v13, v31, v124 row_newbcast:12
  v_dot2c_f32_bf16_dpp v14, v30, v125 row_newbcast:12
  v_dot2c_f32_bf16_dpp v15, v31, v125 row_newbcast:12
  v_dot2c_f32_bf16_dpp v16, v30, v126 row_newbcast:12
  v_dot2c_f32_bf16_dpp v17, v31, v126 row_newbcast:12
  v_dot2c_f32_bf16_dpp v18, v30, v127 row_newbcast:12
  v_dot2c_f32_bf16_dpp v19, v31, v127 row_newbcast:12
  s_cbranch_vccz L_d351
  s_waitcnt vmcnt(6)
L_d351:
  s_xor_b32 s68, s70, 0xc0900
  buffer_load_dwordx4 v[84:87], v63, s[8:11], s68 offen nt
  s_barrier
  v_fma_f32 v28, v216, s71, -v29
  v_exp_f32 v28, v28
  s_nop 0
  v_cvt_pk_bf16_f32 v30, v28, 0
  v_cvt_pk_bf16_f32 v31, 0, v28
  v_add_f32 v21, v21, v28
  s_waitcnt vmcnt(7)
  v_dot2c_f32_bf16_dpp v12, v30, v64 row_newbcast:0
  v_dot2c_f32_bf16_dpp v13, v31, v64 row_newbcast:0
  v_dot2c_f32_bf16_dpp v14, v30, v65 row_newbcast:0
  v_dot2c_f32_bf16_dpp v15, v31, v65 row_newbcast:0
  v_dot2c_f32_bf16_dpp v16, v30, v66 row_newbcast:0
  v_dot2c_f32_bf16_dpp v17, v31, v66 row_newbcast:0
  v_dot2c_f32_bf16_dpp v18, v30, v67 row_newbcast:0
  v_dot2c_f32_bf16_dpp v19, v31, v67 row_newbcast:0
  s_cbranch_vccz L_d352
  s_waitcnt vmcnt(5)
L_d352:
  s_xor_b32 s68, s70, 0xc0c00
  buffer_load_dwordx4 v[88:91], v63, s[8:11], s68 offen nt
  s_cmp_eq_u32 s64, 3
  s_cbranch_scc0 L_wp88
  s_mov_b32 s101, 0
  s_waitcnt lgkmcnt(0)
  s_cmp_ge_u32 s40, 7
  s_addc_u32 s101, s101, 0
  s_cmp_ge_u32 s41, 7
  s_addc_u32 s101, s101, 0
  s_cmp_ge_u32 s42, 7
  s_addc_u32 s101, s101, 0
  s_cmp_ge_u32 s43, 7
  s_addc_u32 s101, s101, 0
  s_cmp_ge_u32 s44, 7
  s_addc_u32 s101, s101, 0
  s_cmp_ge_u32 s45, 7
  s_addc_u32 s101, s101, 0
  s_cmp_ge_u32 s46, 7
  s_addc_u32 s101, s101, 0
  s_cmp_ge_u32 s47, 7
  s_addc_u32 s101, s101, 0
  s_cmp_lt_u32 s101, 6
  s_cselect_b32 s38, -1, 0
  v_mov_b32 v26, 0
  v_mov_b32 v27, s38
  ds_write_b32 v26, v27 offset:8512
L_wp88:
  s_waitcnt vmcnt(6)
  v_dot2c_f32_bf16_dpp v12, v30, v68 row_newbcast:8
  v_dot2c_f32_bf16_dpp v13, v31, v68 row_newbcast:8
  v_dot2c_f32_bf16_dpp v14, v30, v69 row_newbcast:8
  v_dot2c_f32_bf16_dpp v15, v31, v69 row_newbcast:8
  v_dot2c_f32_bf16_dpp v16, v30, v70 row_newbcast:8
  v_dot2c_f32_bf16_dpp v17, v31, v70 row_newbcast:8
  v_dot2c_f32_bf16_dpp v18, v30, v71 row_newbcast:8
  v_dot2c_f32_bf16_dpp v19, v31, v71 row_newbcast:8
  s_cbranch_vccz L_d353
  s_waitcnt vmcnt(5)
L_d353:
  s_xor_b32 s68, s70, 0xc0d00
  buffer_load_dwordx4 v[92:95], v63, s[8:11], s68 offen nt
  s_waitcnt vmcnt(6)
  v_dot2c_f32_bf16_dpp v12, v30, v72 row_newbcast:4
  v_dot2c_f32_bf16_dpp v13, v31, v72 row_newbcast:4
  v_dot2c_f32_bf16_dpp v14, v30, v73 row_newbcast:4
  v_dot2c_f32_bf16_dpp v15, v31, v73 row_newbcast:4
  v_dot2c_f32_bf16_dpp v16, v30, v74 row_newbcast:4
  v_dot2c_f32_bf16_dpp v17, v31, v74 row_newbcast:4
  v_dot2c_f32_bf16_dpp v18, v30, v75 row_newbcast:4
  v_dot2c_f32_bf16_dpp v19, v31, v75 row_newbcast:4
  s_cbranch_vccz L_d354
  s_waitcnt vmcnt(5)
L_d354:
  s_xor_b32 s68, s70, 0xd0000
  buffer_load_dwordx4 v[96:99], v63, s[8:11], s68 offen nt
  buffer_load_dwordx4 a[100:103], v3, s[24:27], s73 offen offset:2048
  s_waitcnt vmcnt(7)
  v_dot2c_f32_bf16_dpp v12, v30, v76 row_newbcast:12
  v_dot2c_f32_bf16_dpp v13, v31, v76 row_newbcast:12
  v_dot2c_f32_bf16_dpp v14, v30, v77 row_newbcast:12
  v_dot2c_f32_bf16_dpp v15, v31, v77 row_newbcast:12
  v_dot2c_f32_bf16_dpp v16, v30, v78 row_newbcast:12
  v_dot2c_f32_bf16_dpp v17, v31, v78 row_newbcast:12
  v_dot2c_f32_bf16_dpp v18, v30, v79 row_newbcast:12
  v_dot2c_f32_bf16_dpp v19, v31, v79 row_newbcast:12
  s_cbranch_vccz L_d355
  s_waitcnt vmcnt(6)
L_d355:
  s_xor_b32 s68, s70, 0xd0100
  buffer_load_dwordx4 v[100:103], v63, s[8:11], s68 offen nt
  s_barrier
  v_fma_f32 v28, v217, s71, -v29
  v_exp_f32 v28, v28
  s_nop 0
  v_cvt_pk_bf16_f32 v30, v28, 0
  v_cvt_pk_bf16_f32 v31, 0, v28
  v_add_f32 v21, v21, v28
  s_waitcnt vmcnt(7)
  v_dot2c_f32_bf16_dpp v12, v30, v80 row_newbcast:0
  v_dot2c_f32_bf16_dpp v13, v31, v80 row_newbcast:0
  v_dot2c_f32_bf16_dpp v14, v30, v81 row_newbcast:0
  v_dot2c_f32_bf16_dpp v15, v31, v81 row_newbcast:0
  v_dot2c_f32_bf16_dpp v16, v30, v82 row_newbcast:0
  v_dot2c_f32_bf16_dpp v17, v31, v82 row_newbcast:0
  v_dot2c_f32_bf16_dpp v18, v30, v83 row_newbcast:0
  v_dot2c_f32_bf16_dpp v19, v31, v83 row_newbcast:0
  s_cbranch_vccz L_d356
  s_waitcnt vmcnt(5)
L_d356:
  s_xor_b32 s68, s70, 0xd0400
  buffer_load_dwordx4 v[104:107], v63, s[8:11], s68 offen nt
  v_mov_b32 v26, 0
  ds_read_b32 v35, v26 offset:8512
  s_waitcnt vmcnt(6)
  v_dot2c_f32_bf16_dpp v12, v30, v84 row_newbcast:8
  v_dot2c_f32_bf16_dpp v13, v31, v84 row_newbcast:8
  v_dot2c_f32_bf16_dpp v14, v30, v85 row_newbcast:8
  v_dot2c_f32_bf16_dpp v15, v31, v85 row_newbcast:8
  v_dot2c_f32_bf16_dpp v16, v30, v86 row_newbcast:8
  v_dot2c_f32_bf16_dpp v17, v31, v86 row_newbcast:8
  v_dot2c_f32_bf16_dpp v18, v30, v87 row_newbcast:8
  v_dot2c_f32_bf16_dpp v19, v31, v87 row_newbcast:8
  s_cbranch_vccz L_d357
  s_waitcnt vmcnt(5)
L_d357:
  s_xor_b32 s68, s70, 0xd0500
  buffer_load_dwordx4 v[108:111], v63, s[8:11], s68 offen nt
  s_waitcnt vmcnt(6)
  v_dot2c_f32_bf16_dpp v12, v30, v88 row_newbcast:4
  v_dot2c_f32_bf16_dpp v13, v31, v88 row_newbcast:4
  v_dot2c_f32_bf16_dpp v14, v30, v89 row_newbcast:4
  v_dot2c_f32_bf16_dpp v15, v31, v89 row_newbcast:4
  v_dot2c_f32_bf16_dpp v16, v30, v90 row_newbcast:4
  v_dot2c_f32_bf16_dpp v17, v31, v90 row_newbcast:4
  v_dot2c_f32_bf16_dpp v18, v30, v91 row_newbcast:4
  v_dot2c_f32_bf16_dpp v19, v31, v91 row_newbcast:4
  s_cbranch_vccz L_d358
  s_waitcnt vmcnt(5)
L_d358:
  s_xor_b32 s68, s70, 0xd0800
  buffer_load_dwordx4 v[112:115], v63, s[8:11], s68 offen nt
  buffer_load_dwordx4 a[108:111], v3, s[24:27], s73 offen offset:2304
  s_add_u32 s73, s73, 4096
  s_waitcnt vmcnt(7)
  v_dot2c_f32_bf16_dpp v12, v30, v92 row_newbcast:12
  v_dot2c_f32_bf16_dpp v13, v31, v92 row_newbcast:12
  v_dot2c_f32_bf16_dpp v14, v30, v93 row_newbcast:12
  v_dot2c_f32_bf16_dpp v15, v31, v93 row_newbcast:12
  v_dot2c_f32_bf16_dpp v16, v30, v94 row_newbcast:12
  v_dot2c_f32_bf16_dpp v17, v31, v94 row_newbcast:12
  v_dot2c_f32_bf16_dpp v18, v30, v95 row_newbcast:12
  v_dot2c_f32_bf16_dpp v19, v31, v95 row_newbcast:12
  s_cbranch_vccz L_d359
  s_waitcnt vmcnt(6)
L_d359:
  s_xor_b32 s68, s70, 0xd0900
  buffer_load_dwordx4 v[116:119], v63, s[8:11], s68 offen nt
  s_barrier
  v_fma_f32 v28, v218, s71, -v29
  v_exp_f32 v28, v28
  s_nop 0
  v_cvt_pk_bf16_f32 v30, v28, 0
  v_cvt_pk_bf16_f32 v31, 0, v28
  v_add_f32 v21, v21, v28
  s_waitcnt vmcnt(7)
  v_dot2c_f32_bf16_dpp v12, v30, v96 row_newbcast:0
  v_dot2c_f32_bf16_dpp v13, v31, v96 row_newbcast:0
  v_dot2c_f32_bf16_dpp v14, v30, v97 row_newbcast:0
  v_dot2c_f32_bf16_dpp v15, v31, v97 row_newbcast:0
  v_dot2c_f32_bf16_dpp v16, v30, v98 row_newbcast:0
  v_dot2c_f32_bf16_dpp v17, v31, v98 row_newbcast:0
  v_dot2c_f32_bf16_dpp v18, v30, v99 row_newbcast:0
  v_dot2c_f32_bf16_dpp v19, v31, v99 row_newbcast:0
  s_cbranch_vccz L_d360
  s_waitcnt vmcnt(5)
L_d360:
  s_xor_b32 s68, s70, 0xd0c00
  buffer_load_dwordx4 v[120:123], v63, s[8:11], s68 offen nt
  s_waitcnt lgkmcnt(0)
  v_cmp_ne_u32 vcc, 0, v35
  s_waitcnt vmcnt(6)
  v_dot2c_f32_bf16_dpp v12, v30, v100 row_newbcast:8
  v_dot2c_f32_bf16_dpp v13, v31, v100 row_newbcast:8
  v_dot2c_f32_bf16_dpp v14, v30, v101 row_newbcast:8
  v_dot2c_f32_bf16_dpp v15, v31, v101 row_newbcast:8
  v_dot2c_f32_bf16_dpp v16, v30, v102 row_newbcast:8
  v_dot2c_f32_bf16_dpp v17, v31, v102 row_newbcast:8
  v_dot2c_f32_bf16_dpp v18, v30, v103 row_newbcast:8
  v_dot2c_f32_bf16_dpp v19, v31, v103 row_newbcast:8
  s_cbranch_vccz L_d361
  s_waitcnt vmcnt(5)
L_d361:
  s_xor_b32 s68, s70, 0xd0d00
  buffer_load_dwordx4 v[124:127], v63, s[8:11], s68 offen nt
  s_waitcnt vmcnt(6)
  v_dot2c_f32_bf16_dpp v12, v30, v104 row_newbcast:4
  v_dot2c_f32_bf16_dpp v13, v31, v104 row_newbcast:4
  v_dot2c_f32_bf16_dpp v14, v30, v105 row_newbcast:4
  v_dot2c_f32_bf16_dpp v15, v31, v105 row_newbcast:4
  v_dot2c_f32_bf16_dpp v16, v30, v106 row_newbcast:4
  v_dot2c_f32_bf16_dpp v17, v31, v106 row_newbcast:4
  v_dot2c_f32_bf16_dpp v18, v30, v107 row_newbcast:4
  v_dot2c_f32_bf16_dpp v19, v31, v107 row_newbcast:4
  s_cbranch_vccz L_d362
  s_waitcnt vmcnt(5)
L_d362:
  s_xor_b32 s68, s70, 0xe0000
  buffer_load_dwordx4 v[64:67], v63, s[8:11], s68 offen nt
  buffer_load_dwordx4 a[112:115], v3, s[24:27], s73 offen offset:0
  s_waitcnt vmcnt(7)
  v_dot2c_f32_bf16_dpp v12, v30, v108 row_newbcast:12
  v_dot2c_f32_bf16_dpp v13, v31, v108 row_newbcast:12
  v_dot2c_f32_bf16_dpp v14, v30, v109 row_newbcast:12
  v_dot2c_f32_bf16_dpp v15, v31, v109 row_newbcast:12
  v_dot2c_f32_bf16_dpp v16, v30, v110 row_newbcast:12
  v_dot2c_f32_bf16_dpp v17, v31, v110 row_newbcast:12
  v_dot2c_f32_bf16_dpp v18, v30, v111 row_newbcast:12
  v_dot2c_f32_bf16_dpp v19, v31, v111 row_newbcast:12
  s_cbranch_vccz L_d363
  s_waitcnt vmcnt(6)
L_d363:
  s_xor_b32 s68, s70, 0xe0100
  buffer_load_dwordx4 v[68:71], v63, s[8:11], s68 offen nt
  s_barrier
  v_fma_f32 v28, v219, s71, -v29
  v_exp_f32 v28, v28
  s_nop 0
  v_cvt_pk_bf16_f32 v30, v28, 0
  v_cvt_pk_bf16_f32 v31, 0, v28
  v_add_f32 v21, v21, v28
  s_waitcnt vmcnt(7)
  v_dot2c_f32_bf16_dpp v12, v30, v112 row_newbcast:0
  v_dot2c_f32_bf16_dpp v13, v31, v112 row_newbcast:0
  v_dot2c_f32_bf16_dpp v14, v30, v113 row_newbcast:0
  v_dot2c_f32_bf16_dpp v15, v31, v113 row_newbcast:0
  v_dot2c_f32_bf16_dpp v16, v30, v114 row_newbcast:0
  v_dot2c_f32_bf16_dpp v17, v31, v114 row_newbcast:0
  v_dot2c_f32_bf16_dpp v18, v30, v115 row_newbcast:0
  v_dot2c_f32_bf16_dpp v19, v31, v115 row_newbcast:0
  s_cbranch_vccz L_d364
  s_waitcnt vmcnt(5)
L_d364:
  s_xor_b32 s68, s70, 0xe0400
  buffer_load_dwordx4 v[72:75], v63, s[8:11], s68 offen nt
  s_waitcnt vmcnt(6)
  v_dot2c_f32_bf16_dpp v12, v30, v116 row_newbcast:8
  v_dot2c_f32_bf16_dpp v13, v31, v116 row_newbcast:8
  v_dot2c_f32_bf16_dpp v14, v30, v117 row_newbcast:8
  v_dot2c_f32_bf16_dpp v15, v31, v117 row_newbcast:8
  v_dot2c_f32_bf16_dpp v16, v30, v118 row_newbcast:8
  v_dot2c_f32_bf16_dpp v17, v31, v118 row_newbcast:8
  v_dot2c_f32_bf16_dpp v18, v30, v119 row_newbcast:8
  v_dot2c_f32_bf16_dpp v19, v31, v119 row_newbcast:8
  s_cbranch_vccz L_d365
  s_waitcnt vmcnt(5)
L_d365:
  s_xor_b32 s68, s70, 0xe0500
  buffer_load_dwordx4 v[76:79], v63, s[8:11], s68 offen nt
  s_waitcnt vmcnt(6)
  v_dot2c_f32_bf16_dpp v12, v30, v120 row_newbcast:4
  v_dot2c_f32_bf16_dpp v13, v31, v120 row_newbcast:4
  v_dot2c_f32_bf16_dpp v14, v30, v121 row_newbcast:4
  v_dot2c_f32_bf16_dpp v15, v31, v121 row_newbcast:4
  v_dot2c_f32_bf16_dpp v16, v30, v122 row_newbcast:4
  v_dot2c_f32_bf16_dpp v17, v31, v122 row_newbcast:4
  v_dot2c_f32_bf16_dpp v18, v30, v123 row_newbcast:4
  v_dot2c_f32_bf16_dpp v19, v31, v123 row_newbcast:4
  s_cbranch_vccz L_d366
  s_waitcnt vmcnt(5)
L_d366:
  s_xor_b32 s68, s70, 0xe0800
  buffer_load_dwordx4 v[80:83], v63, s[8:11], s68 offen nt
  buffer_load_dwordx4 a[120:123], v3, s[24:27], s73 offen offset:256
  s_waitcnt vmcnt(7)
  v_dot2c_f32_bf16_dpp v12, v30, v124 row_newbcast:12
  v_dot2c_f32_bf16_dpp v13, v31, v124 row_newbcast:12
  v_dot2c_f32_bf16_dpp v14, v30, v125 row_newbcast:12
  v_dot2c_f32_bf16_dpp v15, v31, v125 row_newbcast:12
  v_dot2c_f32_bf16_dpp v16, v30, v126 row_newbcast:12
  v_dot2c_f32_bf16_dpp v17, v31, v126 row_newbcast:12
  v_dot2c_f32_bf16_dpp v18, v30, v127 row_newbcast:12
  v_dot2c_f32_bf16_dpp v19, v31, v127 row_newbcast:12
  s_cbranch_vccz L_d367
  s_waitcnt vmcnt(6)
L_d367:
  s_xor_b32 s68, s70, 0xe0900
  buffer_load_dwordx4 v[84:87], v63, s[8:11], s68 offen nt
  s_barrier
  v_fma_f32 v28, v220, s71, -v29
  v_exp_f32 v28, v28
  s_nop 0
  v_cvt_pk_bf16_f32 v30, v28, 0
  v_cvt_pk_bf16_f32 v31, 0, v28
  v_add_f32 v21, v21, v28
  s_waitcnt vmcnt(7)
  v_dot2c_f32_bf16_dpp v12, v30, v64 row_newbcast:0
  v_dot2c_f32_bf16_dpp v13, v31, v64 row_newbcast:0
  v_dot2c_f32_bf16_dpp v14, v30, v65 row_newbcast:0
  v_dot2c_f32_bf16_dpp v15, v31, v65 row_newbcast:0
  v_dot2c_f32_bf16_dpp v16, v30, v66 row_newbcast:0
  v_dot2c_f32_bf16_dpp v17, v31, v66 row_newbcast:0
  v_dot2c_f32_bf16_dpp v18, v30, v67 row_newbcast:0
  v_dot2c_f32_bf16_dpp v19, v31, v67 row_newbcast:0
  s_cbranch_vccz L_d368
  s_waitcnt vmcnt(5)
L_d368:
  s_xor_b32 s68, s70, 0xe0c00
  buffer_load_dwordx4 v[88:91], v63, s[8:11], s68 offen nt
  s_waitcnt vmcnt(6)
  v_dot2c_f32_bf16_dpp v12, v30, v68 row_newbcast:8
  v_dot2c_f32_bf16_dpp v13, v31, v68 row_newbcast:8
  v_dot2c_f32_bf16_dpp v14, v30, v69 row_newbcast:8
  v_dot2c_f32_bf16_dpp v15, v31, v69 row_newbcast:8
  v_dot2c_f32_bf16_dpp v16, v30, v70 row_newbcast:8
  v_dot2c_f32_bf16_dpp v17, v31, v70 row_newbcast:8
  v_dot2c_f32_bf16_dpp v18, v30, v71 row_newbcast:8
  v_dot2c_f32_bf16_dpp v19, v31, v71 row_newbcast:8
  s_cbranch_vccz L_d369
  s_waitcnt vmcnt(5)
L_d369:
  s_xor_b32 s68, s70, 0xe0d00
  buffer_load_dwordx4 v[92:95], v63, s[8:11], s68 offen nt
  s_waitcnt vmcnt(6)
  v_dot2c_f32_bf16_dpp v12, v30, v72 row_newbcast:4
  v_dot2c_f32_bf16_dpp v13, v31, v72 row_newbcast:4
  v_dot2c_f32_bf16_dpp v14, v30, v73 row_newbcast:4
  v_dot2c_f32_bf16_dpp v15, v31, v73 row_newbcast:4
  v_dot2c_f32_bf16_dpp v16, v30, v74 row_newbcast:4
  v_dot2c_f32_bf16_dpp v17, v31, v74 row_newbcast:4
  v_dot2c_f32_bf16_dpp v18, v30, v75 row_newbcast:4
  v_dot2c_f32_bf16_dpp v19, v31, v75 row_newbcast:4
  s_cbranch_vccz L_d370
  s_waitcnt vmcnt(5)
L_d370:
  s_xor_b32 s68, s70, 0xf0000
  buffer_load_dwordx4 v[96:99], v63, s[8:11], s68 offen nt
  buffer_load_dwordx4 a[116:119], v3, s[24:27], s73 offen offset:2048
  s_waitcnt vmcnt(7)
  v_dot2c_f32_bf16_dpp v12, v30, v76 row_newbcast:12
  v_dot2c_f32_bf16_dpp v13, v31, v76 row_newbcast:12
  v_dot2c_f32_bf16_dpp v14, v30, v77 row_newbcast:12
  v_dot2c_f32_bf16_dpp v15, v31, v77 row_newbcast:12
  v_dot2c_f32_bf16_dpp v16, v30, v78 row_newbcast:12
  v_dot2c_f32_bf16_dpp v17, v31, v78 row_newbcast:12
  v_dot2c_f32_bf16_dpp v18, v30, v79 row_newbcast:12
  v_dot2c_f32_bf16_dpp v19, v31, v79 row_newbcast:12
  s_cbranch_vccz L_d371
  s_waitcnt vmcnt(6)
L_d371:
  s_xor_b32 s68, s70, 0xf0100
  buffer_load_dwordx4 v[100:103], v63, s[8:11], s68 offen nt
  s_barrier
  v_fma_f32 v28, v221, s71, -v29
  v_exp_f32 v28, v28
  s_nop 0
  v_cvt_pk_bf16_f32 v30, v28, 0
  v_cvt_pk_bf16_f32 v31, 0, v28
  v_add_f32 v21, v21, v28
  s_waitcnt vmcnt(7)
  v_dot2c_f32_bf16_dpp v12, v30, v80 row_newbcast:0
  v_dot2c_f32_bf16_dpp v13, v31, v80 row_newbcast:0
  v_dot2c_f32_bf16_dpp v14, v30, v81 row_newbcast:0
  v_dot2c_f32_bf16_dpp v15, v31, v81 row_newbcast:0
  v_dot2c_f32_bf16_dpp v16, v30, v82 row_newbcast:0
  v_dot2c_f32_bf16_dpp v17, v31, v82 row_newbcast:0
  v_dot2c_f32_bf16_dpp v18, v30, v83 row_newbcast:0
  v_dot2c_f32_bf16_dpp v19, v31, v83 row_newbcast:0
  s_cbranch_vccz L_d372
  s_waitcnt vmcnt(5)
L_d372:
  s_xor_b32 s68, s70, 0xf0400
  buffer_load_dwordx4 v[104:107], v63, s[8:11], s68 offen nt
  s_waitcnt vmcnt(6)
  v_dot2c_f32_bf16_dpp v12, v30, v84 row_newbcast:8
  v_dot2c_f32_bf16_dpp v13, v31, v84 row_newbcast:8
  v_dot2c_f32_bf16_dpp v14, v30, v85 row_newbcast:8
  v_dot2c_f32_bf16_dpp v15, v31, v85 row_newbcast:8
  v_dot2c_f32_bf16_dpp v16, v30, v86 row_newbcast:8
  v_dot2c_f32_bf16_dpp v17, v31, v86 row_newbcast:8
  v_dot2c_f32_bf16_dpp v18, v30, v87 row_newbcast:8
  v_dot2c_f32_bf16_dpp v19, v31, v87 row_newbcast:8
  s_cbranch_vccz L_d373
  s_waitcnt vmcnt(5)
L_d373:
  s_xor_b32 s68, s70, 0xf0500
  buffer_load_dwordx4 v[108:111], v63, s[8:11], s68 offen nt
  s_waitcnt vmcnt(6)
  v_dot2c_f32_bf16_dpp v12, v30, v88 row_newbcast:4
  v_dot2c_f32_bf16_dpp v13, v31, v88 row_newbcast:4
  v_dot2c_f32_bf16_dpp v14, v30, v89 row_newbcast:4
  v_dot2c_f32_bf16_dpp v15, v31, v89 row_newbcast:4
  v_dot2c_f32_bf16_dpp v16, v30, v90 row_newbcast:4
  v_dot2c_f32_bf16_dpp v17, v31, v90 row_newbcast:4
  v_dot2c_f32_bf16_dpp v18, v30, v91 row_newbcast:4
  v_dot2c_f32_bf16_dpp v19, v31, v91 row_newbcast:4
  s_cbranch_vccz L_d374
  s_waitcnt vmcnt(5)
L_d374:
  s_xor_b32 s68, s70, 0xf0800
  buffer_load_dwordx4 v[112:115], v63, s[8:11], s68 offen nt
  buffer_load_dwordx4 a[124:127], v3, s[24:27], s73 offen offset:2304
  s_add_u32 s73, s73, 4096
  s_waitcnt vmcnt(7)
  v_dot2c_f32_bf16_dpp v12, v30, v92 row_newbcast:12
  v_dot2c_f32_bf16_dpp v13, v31, v92 row_newbcast:12
  v_dot2c_f32_bf16_dpp v14, v30, v93 row_newbcast:12
  v_dot2c_f32_bf16_dpp v15, v31, v93 row_newbcast:12
  v_dot2c_f32_bf16_dpp v16, v30, v94 row_newbcast:12
  v_dot2c_f32_bf16_dpp v17, v31, v94 row_newbcast:12
  v_dot2c_f32_bf16_dpp v18, v30, v95 row_newbcast:12
  v_dot2c_f32_bf16_dpp v19, v31, v95 row_newbcast:12
  s_cbranch_vccz L_d375
  s_waitcnt vmcnt(6)
L_d375:
  s_xor_b32 s68, s70, 0xf0900
  buffer_load_dwordx4 v[116:119], v63, s[8:11], s68 offen nt
  s_barrier
  v_fma_f32 v28, v222, s71, -v29
  v_exp_f32 v28, v28
  s_nop 0
  v_cvt_pk_bf16_f32 v30, v28, 0
  v_cvt_pk_bf16_f32 v31, 0, v28
  v_add_f32 v21, v21, v28
  s_waitcnt vmcnt(7)
  v_dot2c_f32_bf16_dpp v12, v30, v96 row_newbcast:0
  v_dot2c_f32_bf16_dpp v13, v31, v96 row_newbcast:0
  v_dot2c_f32_bf16_dpp v14, v30, v97 row_newbcast:0
  v_dot2c_f32_bf16_dpp v15, v31, v97 row_newbcast:0
  v_dot2c_f32_bf16_dpp v16, v30, v98 row_newbcast:0
  v_dot2c_f32_bf16_dpp v17, v31, v98 row_newbcast:0
  v_dot2c_f32_bf16_dpp v18, v30, v99 row_newbcast:0
  v_dot2c_f32_bf16_dpp v19, v31, v99 row_newbcast:0
  s_cbranch_vccz L_d376
  s_waitcnt vmcnt(5)
L_d376:
  s_xor_b32 s68, s70, 0xf0c00
  buffer_load_dwordx4 v[120:123], v63, s[8:11], s68 offen nt
  s_waitcnt vmcnt(6)
  v_dot2c_f32_bf16_dpp v12, v30, v100 row_newbcast:8
  v_dot2c_f32_bf16_dpp v13, v31, v100 row_newbcast:8
  v_dot2c_f32_bf16_dpp v14, v30, v101 row_newbcast:8
  v_dot2c_f32_bf16_dpp v15, v31, v101 row_newbcast:8
  v_dot2c_f32_bf16_dpp v16, v30, v102 row_newbcast:8
  v_dot2c_f32_bf16_dpp v17, v31, v102 row_newbcast:8
  v_dot2c_f32_bf16_dpp v18, v30, v103 row_newbcast:8
  v_dot2c_f32_bf16_dpp v19, v31, v103 row_newbcast:8
  s_cbranch_vccz L_d377
  s_waitcnt vmcnt(5)
L_d377:
  s_xor_b32 s68, s70, 0xf0d00
  buffer_load_dwordx4 v[124:127], v63, s[8:11], s68 offen nt
  s_waitcnt vmcnt(6)
  v_dot2c_f32_bf16_dpp v12, v30, v104 row_newbcast:4
  v_dot2c_f32_bf16_dpp v13, v31, v104 row_newbcast:4
  v_dot2c_f32_bf16_dpp v14, v30, v105 row_newbcast:4
  v_dot2c_f32_bf16_dpp v15, v31, v105 row_newbcast:4
  v_dot2c_f32_bf16_dpp v16, v30, v106 row_newbcast:4
  v_dot2c_f32_bf16_dpp v17, v31, v106 row_newbcast:4
  v_dot2c_f32_bf16_dpp v18, v30, v107 row_newbcast:4
  v_dot2c_f32_bf16_dpp v19, v31, v107 row_newbcast:4
  s_cbranch_vccz L_d378
  s_waitcnt vmcnt(5)
L_d378:
  s_xor_b32 s68, s70, 0x4000
  buffer_load_dwordx4 v[64:67], v63, s[8:11], s68 offen nt
  s_lshl_b32 s73, s78, 13
  s_add_u32 s73, s73, s84
  buffer_load_dwordx4 a[128:131], v3, s[24:27], s73 offen offset:0
  s_waitcnt vmcnt(7)
  v_dot2c_f32_bf16_dpp v12, v30, v108 row_newbcast:12
  v_dot2c_f32_bf16_dpp v13, v31, v108 row_newbcast:12
  v_dot2c_f32_bf16_dpp v14, v30, v109 row_newbcast:12
  v_dot2c_f32_bf16_dpp v15, v31, v109 row_newbcast:12
  v_dot2c_f32_bf16_dpp v16, v30, v110 row_newbcast:12
  v_dot2c_f32_bf16_dpp v17, v31, v110 row_newbcast:12
  v_dot2c_f32_bf16_dpp v18, v30, v111 row_newbcast:12
  v_dot2c_f32_bf16_dpp v19, v31, v111 row_newbcast:12
  s_cbranch_vccz L_d379
  s_waitcnt vmcnt(6)
L_d379:
  s_xor_b32 s68, s70, 0x4100
  buffer_load_dwordx4 v[68:71], v63, s[8:11], s68 offen nt
  s_barrier
  v_fma_f32 v28, v223, s71, -v29
  v_exp_f32 v28, v28
  s_nop 0
  v_cvt_pk_bf16_f32 v30, v28, 0
  v_cvt_pk_bf16_f32 v31, 0, v28
  v_add_f32 v21, v21, v28
  s_waitcnt vmcnt(7)
  v_dot2c_f32_bf16_dpp v12, v30, v112 row_newbcast:0
  v_dot2c_f32_bf16_dpp v13, v31, v112 row_newbcast:0
  v_dot2c_f32_bf16_dpp v14, v30, v113 row_newbcast:0
  v_dot2c_f32_bf16_dpp v15, v31, v113 row_newbcast:0
  v_dot2c_f32_bf16_dpp v16, v30, v114 row_newbcast:0
  v_dot2c_f32_bf16_dpp v17, v31, v114 row_newbcast:0
  v_dot2c_f32_bf16_dpp v18, v30, v115 row_newbcast:0
  v_dot2c_f32_bf16_dpp v19, v31, v115 row_newbcast:0
  s_cbranch_vccz L_d380
  s_waitcnt vmcnt(5)
L_d380:
  s_xor_b32 s68, s70, 0x4400
  buffer_load_dwordx4 v[72:75], v63, s[8:11], s68 offen nt
  s_waitcnt vmcnt(6)
  v_dot2c_f32_bf16_dpp v12, v30, v116 row_newbcast:8
  v_dot2c_f32_bf16_dpp v13, v31, v116 row_newbcast:8
  v_dot2c_f32_bf16_dpp v14, v30, v117 row_newbcast:8
  v_dot2c_f32_bf16_dpp v15, v31, v117 row_newbcast:8
  v_dot2c_f32_bf16_dpp v16, v30, v118 row_newbcast:8
  v_dot2c_f32_bf16_dpp v17, v31, v118 row_newbcast:8
  v_dot2c_f32_bf16_dpp v18, v30, v119 row_newbcast:8
  v_dot2c_f32_bf16_dpp v19, v31, v119 row_newbcast:8
  s_cbranch_vccz L_d381
  s_waitcnt vmcnt(5)
L_d381:
  s_xor_b32 s68, s70, 0x4500
  buffer_load_dwordx4 v[76:79], v63, s[8:11], s68 offen nt
  s_waitcnt vmcnt(6)
  v_dot2c_f32_bf16_dpp v12, v30, v120 row_newbcast:4
  v_dot2c_f32_bf16_dpp v13, v31, v120 row_newbcast:4
  v_dot2c_f32_bf16_dpp v14, v30, v121 row_newbcast:4
  v_dot2c_f32_bf16_dpp v15, v31, v121 row_newbcast:4
  v_dot2c_f32_bf16_dpp v16, v30, v122 row_newbcast:4
  v_dot2c_f32_bf16_dpp v17, v31, v122 row_newbcast:4
  v_dot2c_f32_bf16_dpp v18, v30, v123 row_newbcast:4
  v_dot2c_f32_bf16_dpp v19, v31, v123 row_newbcast:4
  s_cbranch_vccz L_d382
  s_waitcnt vmcnt(5)
L_d382:
  s_xor_b32 s68, s70, 0x4800
  buffer_load_dwordx4 v[80:83], v63, s[8:11], s68 offen nt
  buffer_load_dwordx4 a[136:139], v3, s[24:27], s73 offen offset:256
  s_waitcnt vmcnt(7)
  v_dot2c_f32_bf16_dpp v12, v30, v124 row_newbcast:12
  v_dot2c_f32_bf16_dpp v13, v31, v124 row_newbcast:12
  v_dot2c_f32_bf16_dpp v14, v30, v125 row_newbcast:12
  v_dot2c_f32_bf16_dpp v15, v31, v125 row_newbcast:12
  v_dot2c_f32_bf16_dpp v16, v30, v126 row_newbcast:12
  v_dot2c_f32_bf16_dpp v17, v31, v126 row_newbcast:12
  v_dot2c_f32_bf16_dpp v18, v30, v127 row_newbcast:12
  v_dot2c_f32_bf16_dpp v19, v31, v127 row_newbcast:12
  s_cbranch_vccz L_d383
  s_waitcnt vmcnt(6)
L_d383:
  s_xor_b32 s68, s70, 0x4900
  buffer_load_dwordx4 v[84:87], v63, s[8:11], s68 offen nt
  s_barrier
  v_fma_f32 v28, v224, s71, -v29
  v_exp_f32 v28, v28
  s_nop 0
  v_cvt_pk_bf16_f32 v30, v28, 0
  v_cvt_pk_bf16_f32 v31, 0, v28
  v_add_f32 v21, v21, v28
  s_waitcnt vmcnt(7)
  v_dot2c_f32_bf16_dpp v12, v30, v64 row_newbcast:0
  v_dot2c_f32_bf16_dpp v13, v31, v64 row_newbcast:0
  v_dot2c_f32_bf16_dpp v14, v30, v65 row_newbcast:0
  v_dot2c_f32_bf16_dpp v15, v31, v65 row_newbcast:0
  v_dot2c_f32_bf16_dpp v16, v30, v66 row_newbcast:0
  v_dot2c_f32_bf16_dpp v17, v31, v66 row_newbcast:0
  v_dot2c_f32_bf16_dpp v18, v30, v67 row_newbcast:0
  v_dot2c_f32_bf16_dpp v19, v31, v67 row_newbcast:0
  s_cbranch_vccz L_d384
  s_waitcnt vmcnt(5)
L_d384:
  s_xor_b32 s68, s70, 0x4c00
  buffer_load_dwordx4 v[88:91], v63, s[8:11], s68 offen nt
  s_waitcnt vmcnt(6)
  v_dot2c_f32_bf16_dpp v12, v30, v68 row_newbcast:8
  v_dot2c_f32_bf16_dpp v13, v31, v68 row_newbcast:8
  v_dot2c_f32_bf16_dpp v14, v30, v69 row_newbcast:8
  v_dot2c_f32_bf16_dpp v15, v31, v69 row_newbcast:8
  v_dot2c_f32_bf16_dpp v16, v30, v70 row_newbcast:8
  v_dot2c_f32_bf16_dpp v17, v31, v70 row_newbcast:8
  v_dot2c_f32_bf16_dpp v18, v30, v71 row_newbcast:8
  v_dot2c_f32_bf16_dpp v19, v31, v71 row_newbcast:8
  s_cbranch_vccz L_d385
  s_waitcnt vmcnt(5)
L_d385:
  s_xor_b32 s68, s70, 0x4d00
  buffer_load_dwordx4 v[92:95], v63, s[8:11], s68 offen nt
  s_waitcnt vmcnt(6)
  v_dot2c_f32_bf16_dpp v12, v30, v72 row_newbcast:4
  v_dot2c_f32_bf16_dpp v13, v31, v72 row_newbcast:4
  v_dot2c_f32_bf16_dpp v14, v30, v73 row_newbcast:4
  v_dot2c_f32_bf16_dpp v15, v31, v73 row_newbcast:4
  v_dot2c_f32_bf16_dpp v16, v30, v74 row_newbcast:4
  v_dot2c_f32_bf16_dpp v17, v31, v74 row_newbcast:4
  v_dot2c_f32_bf16_dpp v18, v30, v75 row_newbcast:4
  v_dot2c_f32_bf16_dpp v19, v31, v75 row_newbcast:4
  s_cbranch_vccz L_d386
  s_waitcnt vmcnt(5)
L_d386:
  s_xor_b32 s68, s70, 0x14000
  buffer_load_dwordx4 v[96:99], v63, s[8:11], s68 offen nt
  buffer_load_dwordx4 a[132:135], v3, s[24:27], s73 offen offset:2048
  s_waitcnt vmcnt(7)
  v_dot2c_f32_bf16_dpp v12, v30, v76 row_newbcast:12
  v_dot2c_f32_bf16_dpp v13, v31, v76 row_newbcast:12
  v_dot2c_f32_bf16_dpp v14, v30, v77 row_newbcast:12
  v_dot2c_f32_bf16_dpp v15, v31, v77 row_newbcast:12
  v_dot2c_f32_bf16_dpp v16, v30, v78 row_newbcast:12
  v_dot2c_f32_bf16_dpp v17, v31, v78 row_newbcast:12
  v_dot2c_f32_bf16_dpp v18, v30, v79 row_newbcast:12
  v_dot2c_f32_bf16_dpp v19, v31, v79 row_newbcast:12
  s_cbranch_vccz L_d387
  s_waitcnt vmcnt(6)
L_d387:
  s_xor_b32 s68, s70, 0x14100
  buffer_load_dwordx4 v[100:103], v63, s[8:11], s68 offen nt
  s_barrier
  v_fma_f32 v28, v225, s71, -v29
  v_exp_f32 v28, v28
  s_nop 0
  v_cvt_pk_bf16_f32 v30, v28, 0
  v_cvt_pk_bf16_f32 v31, 0, v28
  v_add_f32 v21, v21, v28
  s_waitcnt vmcnt(7)
  v_dot2c_f32_bf16_dpp v12, v30, v80 row_newbcast:0
  v_dot2c_f32_bf16_dpp v13, v31, v80 row_newbcast:0
  v_dot2c_f32_bf16_dpp v14, v30, v81 row_newbcast:0
  v_dot2c_f32_bf16_dpp v15, v31, v81 row_newbcast:0
  v_dot2c_f32_bf16_dpp v16, v30, v82 row_newbcast:0
  v_dot2c_f32_bf16_dpp v17, v31, v82 row_newbcast:0
  v_dot2c_f32_bf16_dpp v18, v30, v83 row_newbcast:0
  v_dot2c_f32_bf16_dpp v19, v31, v83 row_newbcast:0
  s_cbranch_vccz L_d388
  s_waitcnt vmcnt(5)
L_d388:
  s_xor_b32 s68, s70, 0x14400
  buffer_load_dwordx4 v[104:107], v63, s[8:11], s68 offen nt
  s_waitcnt vmcnt(6)
  v_dot2c_f32_bf16_dpp v12, v30, v84 row_newbcast:8
  v_dot2c_f32_bf16_dpp v13, v31, v84 row_newbcast:8
  v_dot2c_f32_bf16_dpp v14, v30, v85 row_newbcast:8
  v_dot2c_f32_bf16_dpp v15, v31, v85 row_newbcast:8
  v_dot2c_f32_bf16_dpp v16, v30, v86 row_newbcast:8
  v_dot2c_f32_bf16_dpp v17, v31, v86 row_newbcast:8
  v_dot2c_f32_bf16_dpp v18, v30, v87 row_newbcast:8
  v_dot2c_f32_bf16_dpp v19, v31, v87 row_newbcast:8
  s_cbranch_vccz L_d389
  s_waitcnt vmcnt(5)
L_d389:
  s_xor_b32 s68, s70, 0x14500
  buffer_load_dwordx4 v[108:111], v63, s[8:11], s68 offen nt
  s_waitcnt vmcnt(6)
  v_dot2c_f32_bf16_dpp v12, v30, v88 row_newbcast:4
  v_dot2c_f32_bf16_dpp v13, v31, v88 row_newbcast:4
  v_dot2c_f32_bf16_dpp v14, v30, v89 row_newbcast:4
  v_dot2c_f32_bf16_dpp v15, v31, v89 row_newbcast:4
  v_dot2c_f32_bf16_dpp v16, v30, v90 row_newbcast:4
  v_dot2c_f32_bf16_dpp v17, v31, v90 row_newbcast:4
  v_dot2c_f32_bf16_dpp v18, v30, v91 row_newbcast:4
  v_dot2c_f32_bf16_dpp v19, v31, v91 row_newbcast:4
  s_cbranch_vccz L_d390
  s_waitcnt vmcnt(5)
L_d390:
  s_xor_b32 s68, s70, 0x14800
  buffer_load_dwordx4 v[112:115], v63, s[8:11], s68 offen nt
  buffer_load_dwordx4 a[140:143], v3, s[24:27], s73 offen offset:2304
  s_add_u32 s73, s73, 4096
  s_waitcnt vmcnt(7)
  v_dot2c_f32_bf16_dpp v12, v30, v92 row_newbcast:12
  v_dot2c_f32_bf16_dpp v13, v31, v92 row_newbcast:12
  v_dot2c_f32_bf16_dpp v14, v30, v93 row_newbcast:12
  v_dot2c_f32_bf16_dpp v15, v31, v93 row_newbcast:12
  v_dot2c_f32_bf16_dpp v16, v30, v94 row_newbcast:12
  v_dot2c_f32_bf16_dpp v17, v31, v94 row_newbcast:12
  v_dot2c_f32_bf16_dpp v18, v30, v95 row_newbcast:12
  v_dot2c_f32_bf16_dpp v19, v31, v95 row_newbcast:12
  s_cbranch_vccz L_d391
  s_waitcnt vmcnt(6)
L_d391:
  s_xor_b32 s68, s70, 0x14900
  buffer_load_dwordx4 v[116:119], v63, s[8:11], s68 offen nt
  s_barrier
  v_fma_f32 v28, v226, s71, -v29
  v_exp_f32 v28, v28
  s_nop 0
  v_cvt_pk_bf16_f32 v30, v28, 0
  v_cvt_pk_bf16_f32 v31, 0, v28
  v_add_f32 v21, v21, v28
  s_waitcnt vmcnt(7)
  v_dot2c_f32_bf16_dpp v12, v30, v96 row_newbcast:0
  v_dot2c_f32_bf16_dpp v13, v31, v96 row_newbcast:0
  v_dot2c_f32_bf16_dpp v14, v30, v97 row_newbcast:0
  v_dot2c_f32_bf16_dpp v15, v31, v97 row_newbcast:0
  v_dot2c_f32_bf16_dpp v16, v30, v98 row_newbcast:0
  v_dot2c_f32_bf16_dpp v17, v31, v98 row_newbcast:0
  v_dot2c_f32_bf16_dpp v18, v30, v99 row_newbcast:0
  v_dot2c_f32_bf16_dpp v19, v31, v99 row_newbcast:0
  s_cbranch_vccz L_d392
  s_waitcnt vmcnt(5)
L_d392:
  s_xor_b32 s68, s70, 0x14c00
  buffer_load_dwordx4 v[120:123], v63, s[8:11], s68 offen nt
  s_cmp_eq_u32 s64, 0
  s_cbranch_scc0 L_wp98
  s_mov_b32 s100, 8
  s_atomic_umax s100, s[20:21], s88
  s_and_b32 s60, s88, 0xfffffc7f
  s_xor_b32 s61, s60, 16384
  s_add_u32 s38, s60, 0
  s_load_dword s40, s[20:21], s38 glc
  s_add_u32 s38, s61, 128
  s_load_dword s41, s[20:21], s38 glc
  s_add_u32 s38, s61, 256
  s_load_dword s42, s[20:21], s38 glc
  s_add_u32 s38, s60, 384
  s_load_dword s43, s[20:21], s38 glc
  s_add_u32 s38, s60, 512
  s_load_dword s44, s[20:21], s38 glc
  s_add_u32 s38, s61, 640
  s_load_dword s45, s[20:21], s38 glc
  s_add_u32 s38, s61, 768
  s_load_dword s46, s[20:21], s38 glc
  s_add_u32 s38, s60, 896
  s_load_dword s47, s[20:21], s38 glc
L_wp98:
  s_waitcnt vmcnt(6)
  v_dot2c_f32_bf16_dpp v12, v30, v100 row_newbcast:8
  v_dot2c_f32_bf16_dpp v13, v31, v100 row_newbcast:8
  v_dot2c_f32_bf16_dpp v14, v30, v101 row_newbcast:8
  v_dot2c_f32_bf16_dpp v15, v31, v101 row_newbcast:8
  v_dot2c_f32_bf16_dpp v16, v30, v102 row_newbcast:8
  v_dot2c_f32_bf16_dpp v17, v31, v102 row_newbcast:8
  v_dot2c_f32_bf16_dpp v18, v30, v103 row_newbcast:8
  v_dot2c_f32_bf16_dpp v19, v31, v103 row_newbcast:8
  s_cbranch_vccz L_d393
  s_waitcnt vmcnt(5)
L_d393:
  s_xor_b32 s68, s70, 0x14d00
  buffer_load_dwordx4 v[124:127], v63, s[8:11], s68 offen nt
  s_waitcnt vmcnt(6)
  v_dot2c_f32_bf16_dpp v12, v30, v104 row_newbcast:4
  v_dot2c_f32_bf16_dpp v13, v31, v104 row_newbcast:4
  v_dot2c_f32_bf16_dpp v14, v30, v105 row_newbcast:4
  v_dot2c_f32_bf16_dpp v15, v31, v105 row_newbcast:4
  v_dot2c_f32_bf16_dpp v16, v30, v106 row_newbcast:4
  v_dot2c_f32_bf16_dpp v17, v31, v106 row_newbcast:4
  v_dot2c_f32_bf16_dpp v18, v30, v107 row_newbcast:4
  v_dot2c_f32_bf16_dpp v19, v31, v107 row_newbcast:4
  s_cbranch_vccz L_d394
  s_waitcnt vmcnt(5)
L_d394:
  s_xor_b32 s68, s70, 0x24000
  buffer_load_dwordx4 v[64:67], v63, s[8:11], s68 offen nt
  buffer_load_dwordx4 a[144:147], v3, s[24:27], s73 offen offset:0
  s_waitcnt vmcnt(7)
  v_dot2c_f32_bf16_dpp v12, v30, v108 row_newbcast:12
  v_dot2c_f32_bf16_dpp v13, v31, v108 row_newbcast:12
  v_dot2c_f32_bf16_dpp v14, v30, v109 row_newbcast:12
  v_dot2c_f32_bf16_dpp v15, v31, v109 row_newbcast:12
  v_dot2c_f32_bf16_dpp v16, v30, v110 row_newbcast:12
  v_dot2c_f32_bf16_dpp v17, v31, v110 row_newbcast:12
  v_dot2c_f32_bf16_dpp v18, v30, v111 row_newbcast:12
  v_dot2c_f32_bf16_dpp v19, v31, v111 row_newbcast:12
  s_cbranch_vccz L_d395
  s_waitcnt vmcnt(6)
L_d395:
  s_xor_b32 s68, s70, 0x24100
  buffer_load_dwordx4 v[68:71], v63, s[8:11], s68 offen nt
  s_barrier
  v_fma_f32 v28, v227, s71, -v29
  v_exp_f32 v28, v28
  s_nop 0
  v_cvt_pk_bf16_f32 v30, v28, 0
  v_cvt_pk_bf16_f32 v31, 0, v28
  v_add_f32 v21, v21, v28
  s_waitcnt vmcnt(7)
  v_dot2c_f32_bf16_dpp v12, v30, v112 row_newbcast:0
  v_dot2c_f32_bf16_dpp v13, v31, v112 row_newbcast:0
  v_dot2c_f32_bf16_dpp v14, v30, v113 row_newbcast:0
  v_dot2c_f32_bf16_dpp v15, v31, v113 row_newbcast:0
  v_dot2c_f32_bf16_dpp v16, v30, v114 row_newbcast:0
  v_dot2c_f32_bf16_dpp v17, v31, v114 row_newbcast:0
  v_dot2c_f32_bf16_dpp v18, v30, v115 row_newbcast:0
  v_dot2c_f32_bf16_dpp v19, v31, v115 row_newbcast:0
  s_cbranch_vccz L_d396
  s_waitcnt vmcnt(5)
L_d396:
  s_xor_b32 s68, s70, 0x24400
  buffer_load_dwordx4 v[72:75], v63, s[8:11], s68 offen nt
  s_waitcnt vmcnt(6)
  v_dot2c_f32_bf16_dpp v12, v30, v116 row_newbcast:8
  v_dot2c_f32_bf16_dpp v13, v31, v116 row_newbcast:8
  v_dot2c_f32_bf16_dpp v14, v30, v117 row_newbcast:8
  v_dot2c_f32_bf16_dpp v15, v31, v117 row_newbcast:8
  v_dot2c_f32_bf16_dpp v16, v30, v118 row_newbcast:8
  v_dot2c_f32_bf16_dpp v17, v31, v118 row_newbcast:8
  v_dot2c_f32_bf16_dpp v18, v30, v119 row_newbcast:8
  v_dot2c_f32_bf16_dpp v19, v31, v119 row_newbcast:8
  s_cbranch_vccz L_d397
  s_waitcnt vmcnt(5)
L_d397:
  s_xor_b32 s68, s70, 0x24500
  buffer_load_dwordx4 v[76:79], v63, s[8:11], s68 offen nt
  s_waitcnt vmcnt(6)
  v_dot2c_f32_bf16_dpp v12, v30, v120 row_newbcast:4
  v_dot2c_f32_bf16_dpp v13, v31, v120 row_newbcast:4
  v_dot2c_f32_bf16_dpp v14, v30, v121 row_newbcast:4
  v_dot2c_f32_bf16_dpp v15, v31, v121 row_newbcast:4
  v_dot2c_f32_bf16_dpp v16, v30, v122 row_newbcast:4
  v_dot2c_f32_bf16_dpp v17, v31, v122 row_newbcast:4
  v_dot2c_f32_bf16_dpp v18, v30, v123 row_newbcast:4
  v_dot2c_f32_bf16_dpp v19, v31, v123 row_newbcast:4
  s_cbranch_vccz L_d398
  s_waitcnt vmcnt(5)
L_d398:
  s_xor_b32 s68, s70, 0x24800
  buffer_load_dwordx4 v[80:83], v63, s[8:11], s68 offen nt
  buffer_load_dwordx4 a[152:155], v3, s[24:27], s73 offen offset:256
  s_waitcnt vmcnt(7)
  v_dot2c_f32_bf16_dpp v12, v30, v124 row_newbcast:12
  v_dot2c_f32_bf16_dpp v13, v31, v124 row_newbcast:12
  v_dot2c_f32_bf16_dpp v14, v30, v125 row_newbcast:12
  v_dot2c_f32_bf16_dpp v15, v31, v125 row_newbcast:12
  v_dot2c_f32_bf16_dpp v16, v30, v126 row_newbcast:12
  v_dot2c_f32_bf16_dpp v17, v31, v126 row_newbcast:12
  v_dot2c_f32_bf16_dpp v18, v30, v127 row_newbcast:12
  v_dot2c_f32_bf16_dpp v19, v31, v127 row_newbcast:12
  s_cbranch_vccz L_d399
  s_waitcnt vmcnt(6)
L_d399:
  s_xor_b32 s68, s70, 0x24900
  buffer_load_dwordx4 v[84:87], v63, s[8:11], s68 offen nt
  s_barrier
  v_fma_f32 v28, v228, s71, -v29
  v_exp_f32 v28, v28
  s_nop 0
  v_cvt_pk_bf16_f32 v30, v28, 0
  v_cvt_pk_bf16_f32 v31, 0, v28
  v_add_f32 v21, v21, v28
  s_waitcnt vmcnt(7)
  v_dot2c_f32_bf16_dpp v12, v30, v64 row_newbcast:0
  v_dot2c_f32_bf16_dpp v13, v31, v64 row_newbcast:0
  v_dot2c_f32_bf16_dpp v14, v30, v65 row_newbcast:0
  v_dot2c_f32_bf16_dpp v15, v31, v65 row_newbcast:0
  v_dot2c_f32_bf16_dpp v16, v30, v66 row_newbcast:0
  v_dot2c_f32_bf16_dpp v17, v31, v66 row_newbcast:0
  v_dot2c_f32_bf16_dpp v18, v30, v67 row_newbcast:0
  v_dot2c_f32_bf16_dpp v19, v31, v67 row_newbcast:0
  s_cbranch_vccz L_d400
  s_waitcnt vmcnt(5)
L_d400:
  s_xor_b32 s68, s70, 0x24c00
  buffer_load_dwordx4 v[88:91], v63, s[8:11], s68 offen nt
  s_cmp_eq_u32 s64, 0
  s_cbranch_scc0 L_wp100
  s_mov_b32 s101, 0
  s_waitcnt lgkmcnt(0)
  s_cmp_ge_u32 s40, 8
  s_addc_u32 s101, s101, 0
  s_cmp_ge_u32 s41, 8
  s_addc_u32 s101, s101, 0
  s_cmp_ge_u32 s42, 8
  s_addc_u32 s101, s101, 0
  s_cmp_ge_u32 s43, 8
  s_addc_u32 s101, s101, 0
  s_cmp_ge_u32 s44, 8
  s_addc_u32 s101, s101, 0
  s_cmp_ge_u32 s45, 8
  s_addc_u32 s101, s101, 0
  s_cmp_ge_u32 s46, 8
  s_addc_u32 s101, s101, 0
  s_cmp_ge_u32 s47, 8
  s_addc_u32 s101, s101, 0
  s_cmp_lt_u32 s101, 6
  s_cselect_b32 s38, -1, 0
  v_mov_b32 v26, 0
  v_mov_b32 v27, s38
  ds_write_b32 v26, v27 offset:8512
L_wp100:
  s_waitcnt vmcnt(6)
  v_dot2c_f32_bf16_dpp v12, v30, v68 row_newbcast:8
  v_dot2c_f32_bf16_dpp v13, v31, v68 row_newbcast:8
  v_dot2c_f32_bf16_dpp v14, v30, v69 row_newbcast:8
  v_dot2c_f32_bf16_dpp v15, v31, v69 row_newbcast:8
  v_dot2c_f32_bf16_dpp v16, v30, v70 row_newbcast:8
  v_dot2c_f32_bf16_dpp v17, v31, v70 row_newbcast:8
  v_dot2c_f32_bf16_dpp v18, v30, v71 row_newbcast:8
  v_dot2c_f32_bf16_dpp v19, v31, v71 row_newbcast:8
  s_cbranch_vccz L_d401
  s_waitcnt vmcnt(5)
L_d401:
  s_xor_b32 s68, s70, 0x24d00
  buffer_load_dwordx4 v[92:95], v63, s[8:11], s68 offen nt
  s_waitcnt vmcnt(6)
  v_dot2c_f32_bf16_dpp v12, v30, v72 row_newbcast:4
  v_dot2c_f32_bf16_dpp v13, v31, v72 row_newbcast:4
  v_dot2c_f32_bf16_dpp v14, v30, v73 row_newbcast:4
  v_dot2c_f32_bf16_dpp v15, v31, v73 row_newbcast:4
  v_dot2c_f32_bf16_dpp v16, v30, v74 row_newbcast:4
  v_dot2c_f32_bf16_dpp v17, v31, v74 row_newbcast:4
  v_dot2c_f32_bf16_dpp v18, v30, v75 row_newbcast:4
  v_dot2c_f32_bf16_dpp v19, v31, v75 row_newbcast:4
  s_cbranch_vccz L_d402
  s_waitcnt vmcnt(5)
L_d402:
  s_xor_b32 s68, s70, 0x34000
  buffer_load_dwordx4 v[96:99], v63, s[8:11], s68 offen nt
  buffer_load_dwordx4 a[148:151], v3, s[24:27], s73 offen offset:2048
  s_waitcnt vmcnt(7)
  v_dot2c_f32_bf16_dpp v12, v30, v76 row_newbcast:12
  v_dot2c_f32_bf16_dpp v13, v31, v76 row_newbcast:12
  v_dot2c_f32_bf16_dpp v14, v30, v77 row_newbcast:12
  v_dot2c_f32_bf16_dpp v15, v31, v77 row_newbcast:12
  v_dot2c_f32_bf16_dpp v16, v30, v78 row_newbcast:12
  v_dot2c_f32_bf16_dpp v17, v31, v78 row_newbcast:12
  v_dot2c_f32_bf16_dpp v18, v30, v79 row_newbcast:12
  v_dot2c_f32_bf16_dpp v19, v31, v79 row_newbcast:12
  s_cbranch_vccz L_d403
  s_waitcnt vmcnt(6)
L_d403:
  s_xor_b32 s68, s70, 0x34100
  buffer_load_dwordx4 v[100:103], v63, s[8:11], s68 offen nt
  s_barrier
  v_fma_f32 v28, v229, s71, -v29
  v_exp_f32 v28, v28
  s_nop 0
  v_cvt_pk_bf16_f32 v30, v28, 0
  v_cvt_pk_bf16_f32 v31, 0, v28
  v_add_f32 v21, v21, v28
  s_waitcnt vmcnt(7)
  v_dot2c_f32_bf16_dpp v12, v30, v80 row_newbcast:0
  v_dot2c_f32_bf16_dpp v13, v31, v80 row_newbcast:0
  v_dot2c_f32_bf16_dpp v14, v30, v81 row_newbcast:0
  v_dot2c_f32_bf16_dpp v15, v31, v81 row_newbcast:0
  v_dot2c_f32_bf16_dpp v16, v30, v82 row_newbcast:0
  v_dot2c_f32_bf16_dpp v17, v31, v82 row_newbcast:0
  v_dot2c_f32_bf16_dpp v18, v30, v83 row_newbcast:0
  v_dot2c_f32_bf16_dpp v19, v31, v83 row_newbcast:0
  s_cbranch_vccz L_d404
  s_waitcnt vmcnt(5)
L_d404:
  s_xor_b32 s68, s70, 0x34400
  buffer_load_dwordx4 v[104:107], v63, s[8:11], s68 offen nt
  v_mov_b32 v26, 0
  ds_read_b32 v35, v26 offset:8512
  s_waitcnt vmcnt(6)
  v_dot2c_f32_bf16_dpp v12, v30, v84 row_newbcast:8
  v_dot2c_f32_bf16_dpp v13, v31, v84 row_newbcast:8
  v_dot2c_f32_bf16_dpp v14, v30, v85 row_newbcast:8
  v_dot2c_f32_bf16_dpp v15, v31, v85 row_newbcast:8
  v_dot2c_f32_bf16_dpp v16, v30, v86 row_newbcast:8
  v_dot2c_f32_bf16_dpp v17, v31, v86 row_newbcast:8
  v_dot2c_f32_bf16_dpp v18, v30, v87 row_newbcast:8
  v_dot2c_f32_bf16_dpp v19, v31, v87 row_newbcast:8
  s_cbranch_vccz L_d405
  s_waitcnt vmcnt(5)
L_d405:
  s_xor_b32 s68, s70, 0x34500
  buffer_load_dwordx4 v[108:111], v63, s[8:11], s68 offen nt
  s_waitcnt vmcnt(6)
  v_dot2c_f32_bf16_dpp v12, v30, v88 row_newbcast:4
  v_dot2c_f32_bf16_dpp v13, v31, v88 row_newbcast:4
  v_dot2c_f32_bf16_dpp v14, v30, v89 row_newbcast:4
  v_dot2c_f32_bf16_dpp v15, v31, v89 row_newbcast:4
  v_dot2c_f32_bf16_dpp v16, v30, v90 row_newbcast:4
  v_dot2c_f32_bf16_dpp v17, v31, v90 row_newbcast:4
  v_dot2c_f32_bf16_dpp v18, v30, v91 row_newbcast:4
  v_dot2c_f32_bf16_dpp v19, v31, v91 row_newbcast:4
  s_cbranch_vccz L_d406
  s_waitcnt vmcnt(5)
L_d406:
  s_xor_b32 s68, s70, 0x34800
  buffer_load_dwordx4 v[112:115], v63, s[8:11], s68 offen nt
  buffer_load_dwordx4 a[156:159], v3, s[24:27], s73 offen offset:2304
  s_add_u32 s73, s73, 4096
  s_waitcnt vmcnt(7)
  v_dot2c_f32_bf16_dpp v12, v30, v92 row_newbcast:12
  v_dot2c_f32_bf16_dpp v13, v31, v92 row_newbcast:12
  v_dot2c_f32_bf16_dpp v14, v30, v93 row_newbcast:12
  v_dot2c_f32_bf16_dpp v15, v31, v93 row_newbcast:12
  v_dot2c_f32_bf16_dpp v16, v30, v94 row_newbcast:12
  v_dot2c_f32_bf16_dpp v17, v31, v94 row_newbcast:12
  v_dot2c_f32_bf16_dpp v18, v30, v95 row_newbcast:12
  v_dot2c_f32_bf16_dpp v19, v31, v95 row_newbcast:12
  s_cbranch_vccz L_d407
  s_waitcnt vmcnt(6)
L_d407:
  s_xor_b32 s68, s70, 0x34900
  buffer_load_dwordx4 v[116:119], v63, s[8:11], s68 offen nt
  s_barrier
  v_fma_f32 v28, v230, s71, -v29
  v_exp_f32 v28, v28
  s_nop 0
  v_cvt_pk_bf16_f32 v30, v28, 0
  v_cvt_pk_bf16_f32 v31, 0, v28
  v_add_f32 v21, v21, v28
  s_waitcnt vmcnt(7)
  v_dot2c_f32_bf16_dpp v12, v30, v96 row_newbcast:0
  v_dot2c_f32_bf16_dpp v13, v31, v96 row_newbcast:0
  v_dot2c_f32_bf16_dpp v14, v30, v97 row_newbcast:0
  v_dot2c_f32_bf16_dpp v15, v31, v97 row_newbcast:0
  v_dot2c_f32_bf16_dpp v16, v30, v98 row_newbcast:0
  v_dot2c_f32_bf16_dpp v17, v31, v98 row_newbcast:0
  v_dot2c_f32_bf16_dpp v18, v30, v99 row_newbcast:0
  v_dot2c_f32_bf16_dpp v19, v31, v99 row_newbcast:0
  s_cbranch_vccz L_d408
  s_waitcnt vmcnt(5)
L_d408:
  s_xor_b32 s68, s70, 0x34c00
  buffer_load_dwordx4 v[120:123], v63, s[8:11], s68 offen nt
  s_waitcnt lgkmcnt(0)
  v_cmp_ne_u32 vcc, 0, v35
  s_waitcnt vmcnt(6)
  v_dot2c_f32_bf16_dpp v12, v30, v100 row_newbcast:8
  v_dot2c_f32_bf16_dpp v13, v31, v100 row_newbcast:8
  v_dot2c_f32_bf16_dpp v14, v30, v101 row_newbcast:8
  v_dot2c_f32_bf16_dpp v15, v31, v101 row_newbcast:8
  v_dot2c_f32_bf16_dpp v16, v30, v102 row_newbcast:8
  v_dot2c_f32_bf16_dpp v17, v31, v102 row_newbcast:8
  v_dot2c_f32_bf16_dpp v18, v30, v103 row_newbcast:8
  v_dot2c_f32_bf16_dpp v19, v31, v103 row_newbcast:8
  s_cbranch_vccz L_d409
  s_waitcnt vmcnt(5)
L_d409:
  s_xor_b32 s68, s70, 0x34d00
  buffer_load_dwordx4 v[124:127], v63, s[8:11], s68 offen nt
  s_waitcnt vmcnt(6)
  v_dot2c_f32_bf16_dpp v12, v30, v104 row_newbcast:4
  v_dot2c_f32_bf16_dpp v13, v31, v104 row_newbcast:4
  v_dot2c_f32_bf16_dpp v14, v30, v105 row_newbcast:4
  v_dot2c_f32_bf16_dpp v15, v31, v105 row_newbcast:4
  v_dot2c_f32_bf16_dpp v16, v30, v106 row_newbcast:4
  v_dot2c_f32_bf16_dpp v17, v31, v106 row_newbcast:4
  v_dot2c_f32_bf16_dpp v18, v30, v107 row_newbcast:4
  v_dot2c_f32_bf16_dpp v19, v31, v107 row_newbcast:4
  s_cbranch_vccz L_d410
  s_waitcnt vmcnt(5)
L_d410:
  s_xor_b32 s68, s70, 0x84000
  buffer_load_dwordx4 v[64:67], v63, s[8:11], s68 offen nt
  s_lshl_b32 s73, s79, 13
  s_add_u32 s73, s73, s84
  buffer_load_dwordx4 a[160:163], v3, s[24:27], s73 offen offset:0
  s_waitcnt vmcnt(7)
  v_dot2c_f32_bf16_dpp v12, v30, v108 row_newbcast:12
  v_dot2c_f32_bf16_dpp v13, v31, v108 row_newbcast:12
  v_dot2c_f32_bf16_dpp v14, v30, v109 row_newbcast:12
  v_dot2c_f32_bf16_dpp v15, v31, v109 row_newbcast:12
  v_dot2c_f32_bf16_dpp v16, v30, v110 row_newbcast:12
  v_dot2c_f32_bf16_dpp v17, v31, v110 row_newbcast:12
  v_dot2c_f32_bf16_dpp v18, v30, v111 row_newbcast:12
  v_dot2c_f32_bf16_dpp v19, v31, v111 row_newbcast:12
  s_cbranch_vccz L_d411
  s_waitcnt vmcnt(6)
L_d411:
  s_xor_b32 s68, s70, 0x84100
  buffer_load_dwordx4 v[68:71], v63, s[8:11], s68 offen nt
  s_barrier
  v_fma_f32 v28, v231, s71, -v29
  v_exp_f32 v28, v28
  s_nop 0
  v_cvt_pk_bf16_f32 v30, v28, 0
  v_cvt_pk_bf16_f32 v31, 0, v28
  v_add_f32 v21, v21, v28
  s_waitcnt vmcnt(7)
  v_dot2c_f32_bf16_dpp v12, v30, v112 row_newbcast:0
  v_dot2c_f32_bf16_dpp v13, v31, v112 row_newbcast:0
  v_dot2c_f32_bf16_dpp v14, v30, v113 row_newbcast:0
  v_dot2c_f32_bf16_dpp v15, v31, v113 row_newbcast:0
  v_dot2c_f32_bf16_dpp v16, v30, v114 row_newbcast:0
  v_dot2c_f32_bf16_dpp v17, v31, v114 row_newbcast:0
  v_dot2c_f32_bf16_dpp v18, v30, v115 row_newbcast:0
  v_dot2c_f32_bf16_dpp v19, v31, v115 row_newbcast:0
  s_cbranch_vccz L_d412
  s_waitcnt vmcnt(5)
L_d412:
  s_xor_b32 s68, s70, 0x84400
  buffer_load_dwordx4 v[72:75], v63, s[8:11], s68 offen nt
  s_waitcnt vmcnt(6)
  v_dot2c_f32_bf16_dpp v12, v30, v116 row_newbcast:8
  v_dot2c_f32_bf16_dpp v13, v31, v116 row_newbcast:8
  v_dot2c_f32_bf16_dpp v14, v30, v117 row_newbcast:8
  v_dot2c_f32_bf16_dpp v15, v31, v117 row_newbcast:8
  v_dot2c_f32_bf16_dpp v16, v30, v118 row_newbcast:8
  v_dot2c_f32_bf16_dpp v17, v31, v118 row_newbcast:8
  v_dot2c_f32_bf16_dpp v18, v30, v119 row_newbcast:8
  v_dot2c_f32_bf16_dpp v19, v31, v119 row_newbcast:8
  s_cbranch_vccz L_d413
  s_waitcnt vmcnt(5)
L_d413:
  s_xor_b32 s68, s70, 0x84500
  buffer_load_dwordx4 v[76:79], v63, s[8:11], s68 offen nt
  s_waitcnt vmcnt(6)
  v_dot2c_f32_bf16_dpp v12, v30, v120 row_newbcast:4
  v_dot2c_f32_bf16_dpp v13, v31, v120 row_newbcast:4
  v_dot2c_f32_bf16_dpp v14, v30, v121 row_newbcast:4
  v_dot2c_f32_bf16_dpp v15, v31, v121 row_newbcast:4
  v_dot2c_f32_bf16_dpp v16, v30, v122 row_newbcast:4
  v_dot2c_f32_bf16_dpp v17, v31, v122 row_newbcast:4
  v_dot2c_f32_bf16_dpp v18, v30, v123 row_newbcast:4
  v_dot2c_f32_bf16_dpp v19, v31, v123 row_newbcast:4
  s_cbranch_vccz L_d414
  s_waitcnt vmcnt(5)
L_d414:
  s_xor_b32 s68, s70, 0x84800
  buffer_load_dwordx4 v[80:83], v63, s[8:11], s68 offen nt
  buffer_load_dwordx4 a[168:171], v3, s[24:27], s73 offen offset:256
  s_waitcnt vmcnt(7)
  v_dot2c_f32_bf16_dpp v12, v30, v124 row_newbcast:12
  v_dot2c_f32_bf16_dpp v13, v31, v124 row_newbcast:12
  v_dot2c_f32_bf16_dpp v14, v30, v125 row_newbcast:12
  v_dot2c_f32_bf16_dpp v15, v31, v125 row_newbcast:12
  v_dot2c_f32_bf16_dpp v16, v30, v126 row_newbcast:12
  v_dot2c_f32_bf16_dpp v17, v31, v126 row_newbcast:12
  v_dot2c_f32_bf16_dpp v18, v30, v127 row_newbcast:12
  v_dot2c_f32_bf16_dpp v19, v31, v127 row_newbcast:12
  s_cbranch_vccz L_d415
  s_waitcnt vmcnt(6)
L_d415:
  s_xor_b32 s68, s70, 0x84900
  buffer_load_dwordx4 v[84:87], v63, s[8:11], s68 offen nt
  s_barrier
  v_fma_f32 v28, v232, s71, -v29
  v_exp_f32 v28, v28
  s_nop 0
  v_cvt_pk_bf16_f32 v30, v28, 0
  v_cvt_pk_bf16_f32 v31, 0, v28
  v_add_f32 v21, v21, v28
  s_waitcnt vmcnt(7)
  v_dot2c_f32_bf16_dpp v12, v30, v64 row_newbcast:0
  v_dot2c_f32_bf16_dpp v13, v31, v64 row_newbcast:0
  v_dot2c_f32_bf16_dpp v14, v30, v65 row_newbcast:0
  v_dot2c_f32_bf16_dpp v15, v31, v65 row_newbcast:0
  v_dot2c_f32_bf16_dpp v16, v30, v66 row_newbcast:0
  v_dot2c_f32_bf16_dpp v17, v31, v66 row_newbcast:0
  v_dot2c_f32_bf16_dpp v18, v30, v67 row_newbcast:0
  v_dot2c_f32_bf16_dpp v19, v31, v67 row_newbcast:0
  s_cbranch_vccz L_d416
  s_waitcnt vmcnt(5)
L_d416:
  s_xor_b32 s68, s70, 0x84c00
  buffer_load_dwordx4 v[88:91], v63, s[8:11], s68 offen nt
  s_waitcnt vmcnt(6)
  v_dot2c_f32_bf16_dpp v12, v30, v68 row_newbcast:8
  v_dot2c_f32_bf16_dpp v13, v31, v68 row_newbcast:8
  v_dot2c_f32_bf16_dpp v14, v30, v69 row_newbcast:8
  v_dot2c_f32_bf16_dpp v15, v31, v69 row_newbcast:8
  v_dot2c_f32_bf16_dpp v16, v30, v70 row_newbcast:8
  v_dot2c_f32_bf16_dpp v17, v31, v70 row_newbcast:8
  v_dot2c_f32_bf16_dpp v18, v30, v71 row_newbcast:8
  v_dot2c_f32_bf16_dpp v19, v31, v71 row_newbcast:8
  s_cbranch_vccz L_d417
  s_waitcnt vmcnt(5)
L_d417:
  s_xor_b32 s68, s70, 0x84d00
  buffer_load_dwordx4 v[92:95], v63, s[8:11], s68 offen nt
  s_waitcnt vmcnt(6)
  v_dot2c_f32_bf16_dpp v12, v30, v72 row_newbcast:4
  v_dot2c_f32_bf16_dpp v13, v31, v72 row_newbcast:4
  v_dot2c_f32_bf16_dpp v14, v30, v73 row_newbcast:4
  v_dot2c_f32_bf16_dpp v15, v31, v73 row_newbcast:4
  v_dot2c_f32_bf16_dpp v16, v30, v74 row_newbcast:4
  v_dot2c_f32_bf16_dpp v17, v31, v74 row_newbcast:4
  v_dot2c_f32_bf16_dpp v18, v30, v75 row_newbcast:4
  v_dot2c_f32_bf16_dpp v19, v31, v75 row_newbcast:4
  s_cbranch_vccz L_d418
  s_waitcnt vmcnt(5)
L_d418:
  s_xor_b32 s68, s70, 0x94000
  buffer_load_dwordx4 v[96:99], v63, s[8:11], s68 offen nt
  buffer_load_dwordx4 a[164:167], v3, s[24:27], s73 offen offset:2048
  s_waitcnt vmcnt(7)
  v_dot2c_f32_bf16_dpp v12, v30, v76 row_newbcast:12
  v_dot2c_f32_bf16_dpp v13, v31, v76 row_newbcast:12
  v_dot2c_f32_bf16_dpp v14, v30, v77 row_newbcast:12
  v_dot2c_f32_bf16_dpp v15, v31, v77 row_newbcast:12
  v_dot2c_f32_bf16_dpp v16, v30, v78 row_newbcast:12
  v_dot2c_f32_bf16_dpp v17, v31, v78 row_newbcast:12
  v_dot2c_f32_bf16_dpp v18, v30, v79 row_newbcast:12
  v_dot2c_f32_bf16_dpp v19, v31, v79 row_newbcast:12
  s_cbranch_vccz L_d419
  s_waitcnt vmcnt(6)
L_d419:
  s_xor_b32 s68, s70, 0x94100
  buffer_load_dwordx4 v[100:103], v63, s[8:11], s68 offen nt
  s_barrier
  v_fma_f32 v28, v233, s71, -v29
  v_exp_f32 v28, v28
  s_nop 0
  v_cvt_pk_bf16_f32 v30, v28, 0
  v_cvt_pk_bf16_f32 v31, 0, v28
  v_add_f32 v21, v21, v28
  s_waitcnt vmcnt(7)
  v_dot2c_f32_bf16_dpp v12, v30, v80 row_newbcast:0
  v_dot2c_f32_bf16_dpp v13, v31, v80 row_newbcast:0
  v_dot2c_f32_bf16_dpp v14, v30, v81 row_newbcast:0
  v_dot2c_f32_bf16_dpp v15, v31, v81 row_newbcast:0
  v_dot2c_f32_bf16_dpp v16, v30, v82 row_newbcast:0
  v_dot2c_f32_bf16_dpp v17, v31, v82 row_newbcast:0
  v_dot2c_f32_bf16_dpp v18, v30, v83 row_newbcast:0
  v_dot2c_f32_bf16_dpp v19, v31, v83 row_newbcast:0
  s_cbranch_vccz L_d420
  s_waitcnt vmcnt(5)
L_d420:
  s_xor_b32 s68, s70, 0x94400
  buffer_load_dwordx4 v[104:107], v63, s[8:11], s68 offen nt
  s_waitcnt vmcnt(6)
  v_dot2c_f32_bf16_dpp v12, v30, v84 row_newbcast:8
  v_dot2c_f32_bf16_dpp v13, v31, v84 row_newbcast:8
  v_dot2c_f32_bf16_dpp v14, v30, v85 row_newbcast:8
  v_dot2c_f32_bf16_dpp v15, v31, v85 row_newbcast:8
  v_dot2c_f32_bf16_dpp v16, v30, v86 row_newbcast:8
  v_dot2c_f32_bf16_dpp v17, v31, v86 row_newbcast:8
  v_dot2c_f32_bf16_dpp v18, v30, v87 row_newbcast:8
  v_dot2c_f32_bf16_dpp v19, v31, v87 row_newbcast:8
  s_cbranch_vccz L_d421
  s_waitcnt vmcnt(5)
L_d421:
  s_xor_b32 s68, s70, 0x94500
  buffer_load_dwordx4 v[108:111], v63, s[8:11], s68 offen nt
  s_waitcnt vmcnt(6)
  v_dot2c_f32_bf16_dpp v12, v30, v88 row_newbcast:4
  v_dot2c_f32_bf16_dpp v13, v31, v88 row_newbcast:4
  v_dot2c_f32_bf16_dpp v14, v30, v89 row_newbcast:4
  v_dot2c_f32_bf16_dpp v15, v31, v89 row_newbcast:4
  v_dot2c_f32_bf16_dpp v16, v30, v90 row_newbcast:4
  v_dot2c_f32_bf16_dpp v17, v31, v90 row_newbcast:4
  v_dot2c_f32_bf16_dpp v18, v30, v91 row_newbcast:4
  v_dot2c_f32_bf16_dpp v19, v31, v91 row_newbcast:4
  s_cbranch_vccz L_d422
  s_waitcnt vmcnt(5)
L_d422:
  s_xor_b32 s68, s70, 0x94800
  buffer_load_dwordx4 v[112:115], v63, s[8:11], s68 offen nt
  buffer_load_dwordx4 a[172:175], v3, s[24:27], s73 offen offset:2304
  s_add_u32 s73, s73, 4096
  s_waitcnt vmcnt(7)
  v_dot2c_f32_bf16_dpp v12, v30, v92 row_newbcast:12
  v_dot2c_f32_bf16_dpp v13, v31, v92 row_newbcast:12
  v_dot2c_f32_bf16_dpp v14, v30, v93 row_newbcast:12
  v_dot2c_f32_bf16_dpp v15, v31, v93 row_newbcast:12
  v_dot2c_f32_bf16_dpp v16, v30, v94 row_newbcast:12
  v_dot2c_f32_bf16_dpp v17, v31, v94 row_newbcast:12
  v_dot2c_f32_bf16_dpp v18, v30, v95 row_newbcast:12
  v_dot2c_f32_bf16_dpp v19, v31, v95 row_newbcast:12
  s_cbranch_vccz L_d423
  s_waitcnt vmcnt(6)
L_d423:
  s_xor_b32 s68, s70, 0x94900
  buffer_load_dwordx4 v[116:119], v63, s[8:11], s68 offen nt
  s_barrier
  v_fma_f32 v28, v234, s71, -v29
  v_exp_f32 v28, v28
  s_nop 0
  v_cvt_pk_bf16_f32 v30, v28, 0
  v_cvt_pk_bf16_f32 v31, 0, v28
  v_add_f32 v21, v21, v28
  s_waitcnt vmcnt(7)
  v_dot2c_f32_bf16_dpp v12, v30, v96 row_newbcast:0
  v_dot2c_f32_bf16_dpp v13, v31, v96 row_newbcast:0
  v_dot2c_f32_bf16_dpp v14, v30, v97 row_newbcast:0
  v_dot2c_f32_bf16_dpp v15, v31, v97 row_newbcast:0
  v_dot2c_f32_bf16_dpp v16, v30, v98 row_newbcast:0
  v_dot2c_f32_bf16_dpp v17, v31, v98 row_newbcast:0
  v_dot2c_f32_bf16_dpp v18, v30, v99 row_newbcast:0
  v_dot2c_f32_bf16_dpp v19, v31, v99 row_newbcast:0
  s_cbranch_vccz L_d424
  s_waitcnt vmcnt(5)
L_d424:
  s_xor_b32 s68, s70, 0x94c00
  buffer_load_dwordx4 v[120:123], v63, s[8:11], s68 offen nt
  s_waitcnt vmcnt(6)
  v_dot2c_f32_bf16_dpp v12, v30, v100 row_newbcast:8
  v_dot2c_f32_bf16_dpp v13, v31, v100 row_newbcast:8
  v_dot2c_f32_bf16_dpp v14, v30, v101 row_newbcast:8
  v_dot2c_f32_bf16_dpp v15, v31, v101 row_newbcast:8
  v_dot2c_f32_bf16_dpp v16, v30, v102 row_newbcast:8
  v_dot2c_f32_bf16_dpp v17, v31, v102 row_newbcast:8
  v_dot2c_f32_bf16_dpp v18, v30, v103 row_newbcast:8
  v_dot2c_f32_bf16_dpp v19, v31, v103 row_newbcast:8
  s_cbranch_vccz L_d425
  s_waitcnt vmcnt(5)
L_d425:
  s_xor_b32 s68, s70, 0x94d00
  buffer_load_dwordx4 v[124:127], v63, s[8:11], s68 offen nt
  s_waitcnt vmcnt(6)
  v_dot2c_f32_bf16_dpp v12, v30, v104 row_newbcast:4
  v_dot2c_f32_bf16_dpp v13, v31, v104 row_newbcast:4
  v_dot2c_f32_bf16_dpp v14, v30, v105 row_newbcast:4
  v_dot2c_f32_bf16_dpp v15, v31, v105 row_newbcast:4
  v_dot2c_f32_bf16_dpp v16, v30, v106 row_newbcast:4
  v_dot2c_f32_bf16_dpp v17, v31, v106 row_newbcast:4
  v_dot2c_f32_bf16_dpp v18, v30, v107 row_newbcast:4
  v_dot2c_f32_bf16_dpp v19, v31, v107 row_newbcast:4
  s_cbranch_vccz L_d426
  s_waitcnt vmcnt(5)
L_d426:
  s_xor_b32 s68, s70, 0xa4000
  buffer_load_dwordx4 v[64:67], v63, s[8:11], s68 offen nt
  buffer_load_dwordx4 a[176:179], v3, s[24:27], s73 offen offset:0
  s_waitcnt vmcnt(7)
  v_dot2c_f32_bf16_dpp v12, v30, v108 row_newbcast:12
  v_dot2c_f32_bf16_dpp v13, v31, v108 row_newbcast:12
  v_dot2c_f32_bf16_dpp v14, v30, v109 row_newbcast:12
  v_dot2c_f32_bf16_dpp v15, v31, v109 row_newbcast:12
  v_dot2c_f32_bf16_dpp v16, v30, v110 row_newbcast:12
  v_dot2c_f32_bf16_dpp v17, v31, v110 row_newbcast:12
  v_dot2c_f32_bf16_dpp v18, v30, v111 row_newbcast:12
  v_dot2c_f32_bf16_dpp v19, v31, v111 row_newbcast:12
  s_cbranch_vccz L_d427
  s_waitcnt vmcnt(6)
L_d427:
  s_xor_b32 s68, s70, 0xa4100
  buffer_load_dwordx4 v[68:71], v63, s[8:11], s68 offen nt
  s_barrier
  v_fma_f32 v28, v235, s71, -v29
  v_exp_f32 v28, v28
  s_nop 0
  v_cvt_pk_bf16_f32 v30, v28, 0
  v_cvt_pk_bf16_f32 v31, 0, v28
  v_add_f32 v21, v21, v28
  s_waitcnt vmcnt(7)
  v_dot2c_f32_bf16_dpp v12, v30, v112 row_newbcast:0
  v_dot2c_f32_bf16_dpp v13, v31, v112 row_newbcast:0
  v_dot2c_f32_bf16_dpp v14, v30, v113 row_newbcast:0
  v_dot2c_f32_bf16_dpp v15, v31, v113 row_newbcast:0
  v_dot2c_f32_bf16_dpp v16, v30, v114 row_newbcast:0
  v_dot2c_f32_bf16_dpp v17, v31, v114 row_newbcast:0
  v_dot2c_f32_bf16_dpp v18, v30, v115 row_newbcast:0
  v_dot2c_f32_bf16_dpp v19, v31, v115 row_newbcast:0
  s_cbranch_vccz L_d428
  s_waitcnt vmcnt(5)
L_d428:
  s_xor_b32 s68, s70, 0xa4400
  buffer_load_dwordx4 v[72:75], v63, s[8:11], s68 offen nt
  s_waitcnt vmcnt(6)
  v_dot2c_f32_bf16_dpp v12, v30, v116 row_newbcast:8
  v_dot2c_f32_bf16_dpp v13, v31, v116 row_newbcast:8
  v_dot2c_f32_bf16_dpp v14, v30, v117 row_newbcast:8
  v_dot2c_f32_bf16_dpp v15, v31, v117 row_newbcast:8
  v_dot2c_f32_bf16_dpp v16, v30, v118 row_newbcast:8
  v_dot2c_f32_bf16_dpp v17, v31, v118 row_newbcast:8
  v_dot2c_f32_bf16_dpp v18, v30, v119 row_newbcast:8
  v_dot2c_f32_bf16_dpp v19, v31, v119 row_newbcast:8
  s_cbranch_vccz L_d429
  s_waitcnt vmcnt(5)
L_d429:
  s_xor_b32 s68, s70, 0xa4500
  buffer_load_dwordx4 v[76:79], v63, s[8:11], s68 offen nt
  s_waitcnt vmcnt(6)
  v_dot2c_f32_bf16_dpp v12, v30, v120 row_newbcast:4
  v_dot2c_f32_bf16_dpp v13, v31, v120 row_newbcast:4
  v_dot2c_f32_bf16_dpp v14, v30, v121 row_newbcast:4
  v_dot2c_f32_bf16_dpp v15, v31, v121 row_newbcast:4
  v_dot2c_f32_bf16_dpp v16, v30, v122 row_newbcast:4
  v_dot2c_f32_bf16_dpp v17, v31, v122 row_newbcast:4
  v_dot2c_f32_bf16_dpp v18, v30, v123 row_newbcast:4
  v_dot2c_f32_bf16_dpp v19, v31, v123 row_newbcast:4
  s_cbranch_vccz L_d430
  s_waitcnt vmcnt(5)
L_d430:
  s_xor_b32 s68, s70, 0xa4800
  buffer_load_dwordx4 v[80:83], v63, s[8:11], s68 offen nt
  buffer_load_dwordx4 a[184:187], v3, s[24:27], s73 offen offset:256
  s_waitcnt vmcnt(7)
  v_dot2c_f32_bf16_dpp v12, v30, v124 row_newbcast:12
  v_dot2c_f32_bf16_dpp v13, v31, v124 row_newbcast:12
  v_dot2c_f32_bf16_dpp v14, v30, v125 row_newbcast:12
  v_dot2c_f32_bf16_dpp v15, v31, v125 row_newbcast:12
  v_dot2c_f32_bf16_dpp v16, v30, v126 row_newbcast:12
  v_dot2c_f32_bf16_dpp v17, v31, v126 row_newbcast:12
  v_dot2c_f32_bf16_dpp v18, v30, v127 row_newbcast:12
  v_dot2c_f32_bf16_dpp v19, v31, v127 row_newbcast:12
  s_cbranch_vccz L_d431
  s_waitcnt vmcnt(6)
L_d431:
  s_xor_b32 s68, s70, 0xa4900
  buffer_load_dwordx4 v[84:87], v63, s[8:11], s68 offen nt
  s_barrier
  v_fma_f32 v28, v236, s71, -v29
  v_exp_f32 v28, v28
  s_nop 0
  v_cvt_pk_bf16_f32 v30, v28, 0
  v_cvt_pk_bf16_f32 v31, 0, v28
  v_add_f32 v21, v21, v28
  s_waitcnt vmcnt(7)
  v_dot2c_f32_bf16_dpp v12, v30, v64 row_newbcast:0
  v_dot2c_f32_bf16_dpp v13, v31, v64 row_newbcast:0
  v_dot2c_f32_bf16_dpp v14, v30, v65 row_newbcast:0
  v_dot2c_f32_bf16_dpp v15, v31, v65 row_newbcast:0
  v_dot2c_f32_bf16_dpp v16, v30, v66 row_newbcast:0
  v_dot2c_f32_bf16_dpp v17, v31, v66 row_newbcast:0
  v_dot2c_f32_bf16_dpp v18, v30, v67 row_newbcast:0
  v_dot2c_f32_bf16_dpp v19, v31, v67 row_newbcast:0
  s_cbranch_vccz L_d432
  s_waitcnt vmcnt(5)
L_d432:
  s_xor_b32 s68, s70, 0xa4c00
  buffer_load_dwordx4 v[88:91], v63, s[8:11], s68 offen nt
  s_waitcnt vmcnt(6)
  v_dot2c_f32_bf16_dpp v12, v30, v68 row_newbcast:8
  v_dot2c_f32_bf16_dpp v13, v31, v68 row_newbcast:8
  v_dot2c_f32_bf16_dpp v14, v30, v69 row_newbcast:8
  v_dot2c_f32_bf16_dpp v15, v31, v69 row_newbcast:8
  v_dot2c_f32_bf16_dpp v16, v30, v70 row_newbcast:8
  v_dot2c_f32_bf16_dpp v17, v31, v70 row_newbcast:8
  v_dot2c_f32_bf16_dpp v18, v30, v71 row_newbcast:8
  v_dot2c_f32_bf16_dpp v19, v31, v71 row_newbcast:8
  s_cbranch_vccz L_d433
  s_waitcnt vmcnt(5)
L_d433:
  s_xor_b32 s68, s70, 0xa4d00
  buffer_load_dwordx4 v[92:95], v63, s[8:11], s68 offen nt
  s_waitcnt vmcnt(6)
  v_dot2c_f32_bf16_dpp v12, v30, v72 row_newbcast:4
  v_dot2c_f32_bf16_dpp v13, v31, v72 row_newbcast:4
  v_dot2c_f32_bf16_dpp v14, v30, v73 row_newbcast:4
  v_dot2c_f32_bf16_dpp v15, v31, v73 row_newbcast:4
  v_dot2c_f32_bf16_dpp v16, v30, v74 row_newbcast:4
  v_dot2c_f32_bf16_dpp v17, v31, v74 row_newbcast:4
  v_dot2c_f32_bf16_dpp v18, v30, v75 row_newbcast:4
  v_dot2c_f32_bf16_dpp v19, v31, v75 row_newbcast:4
  s_cbranch_vccz L_d434
  s_waitcnt vmcnt(5)
L_d434:
  s_xor_b32 s68, s70, 0xb4000
  buffer_load_dwordx4 v[96:99], v63, s[8:11], s68 offen nt
  buffer_load_dwordx4 a[180:183], v3, s[24:27], s73 offen offset:2048
  s_waitcnt vmcnt(7)
  v_dot2c_f32_bf16_dpp v12, v30, v76 row_newbcast:12
  v_dot2c_f32_bf16_dpp v13, v31, v76 row_newbcast:12
  v_dot2c_f32_bf16_dpp v14, v30, v77 row_newbcast:12
  v_dot2c_f32_bf16_dpp v15, v31, v77 row_newbcast:12
  v_dot2c_f32_bf16_dpp v16, v30, v78 row_newbcast:12
  v_dot2c_f32_bf16_dpp v17, v31, v78 row_newbcast:12
  v_dot2c_f32_bf16_dpp v18, v30, v79 row_newbcast:12
  v_dot2c_f32_bf16_dpp v19, v31, v79 row_newbcast:12
  s_cbranch_vccz L_d435
  s_waitcnt vmcnt(6)
L_d435:
  s_xor_b32 s68, s70, 0xb4100
  buffer_load_dwordx4 v[100:103], v63, s[8:11], s68 offen nt
  s_barrier
  v_fma_f32 v28, v237, s71, -v29
  v_exp_f32 v28, v28
  s_nop 0
  v_cvt_pk_bf16_f32 v30, v28, 0
  v_cvt_pk_bf16_f32 v31, 0, v28
  v_add_f32 v21, v21, v28
  s_waitcnt vmcnt(7)
  v_dot2c_f32_bf16_dpp v12, v30, v80 row_newbcast:0
  v_dot2c_f32_bf16_dpp v13, v31, v80 row_newbcast:0
  v_dot2c_f32_bf16_dpp v14, v30, v81 row_newbcast:0
  v_dot2c_f32_bf16_dpp v15, v31, v81 row_newbcast:0
  v_dot2c_f32_bf16_dpp v16, v30, v82 row_newbcast:0
  v_dot2c_f32_bf16_dpp v17, v31, v82 row_newbcast:0
  v_dot2c_f32_bf16_dpp v18, v30, v83 row_newbcast:0
  v_dot2c_f32_bf16_dpp v19, v31, v83 row_newbcast:0
  s_cbranch_vccz L_d436
  s_waitcnt vmcnt(5)
L_d436:
  s_xor_b32 s68, s70, 0xb4400
  buffer_load_dwordx4 v[104:107], v63, s[8:11], s68 offen nt
  s_waitcnt vmcnt(6)
  v_dot2c_f32_bf16_dpp v12, v30, v84 row_newbcast:8
  v_dot2c_f32_bf16_dpp v13, v31, v84 row_newbcast:8
  v_dot2c_f32_bf16_dpp v14, v30, v85 row_newbcast:8
  v_dot2c_f32_bf16_dpp v15, v31, v85 row_newbcast:8
  v_dot2c_f32_bf16_dpp v16, v30, v86 row_newbcast:8
  v_dot2c_f32_bf16_dpp v17, v31, v86 row_newbcast:8
  v_dot2c_f32_bf16_dpp v18, v30, v87 row_newbcast:8
  v_dot2c_f32_bf16_dpp v19, v31, v87 row_newbcast:8
  s_cbranch_vccz L_d437
  s_waitcnt vmcnt(5)
L_d437:
  s_xor_b32 s68, s70, 0xb4500
  buffer_load_dwordx4 v[108:111], v63, s[8:11], s68 offen nt
  s_waitcnt vmcnt(6)
  v_dot2c_f32_bf16_dpp v12, v30, v88 row_newbcast:4
  v_dot2c_f32_bf16_dpp v13, v31, v88 row_newbcast:4
  v_dot2c_f32_bf16_dpp v14, v30, v89 row_newbcast:4
  v_dot2c_f32_bf16_dpp v15, v31, v89 row_newbcast:4
  v_dot2c_f32_bf16_dpp v16, v30, v90 row_newbcast:4
  v_dot2c_f32_bf16_dpp v17, v31, v90 row_newbcast:4
  v_dot2c_f32_bf16_dpp v18, v30, v91 row_newbcast:4
  v_dot2c_f32_bf16_dpp v19, v31, v91 row_newbcast:4
  s_cbranch_vccz L_d438
  s_waitcnt vmcnt(5)
L_d438:
  s_xor_b32 s68, s70, 0xb4800
  buffer_load_dwordx4 v[112:115], v63, s[8:11], s68 offen nt
  buffer_load_dwordx4 a[188:191], v3, s[24:27], s73 offen offset:2304
  s_add_u32 s73, s73, 4096
  s_waitcnt vmcnt(7)
  v_dot2c_f32_bf16_dpp v12, v30, v92 row_newbcast:12
  v_dot2c_f32_bf16_dpp v13, v31, v92 row_newbcast:12
  v_dot2c_f32_bf16_dpp v14, v30, v93 row_newbcast:12
  v_dot2c_f32_bf16_dpp v15, v31, v93 row_newbcast:12
  v_dot2c_f32_bf16_dpp v16, v30, v94 row_newbcast:12
  v_dot2c_f32_bf16_dpp v17, v31, v94 row_newbcast:12
  v_dot2c_f32_bf16_dpp v18, v30, v95 row_newbcast:12
  v_dot2c_f32_bf16_dpp v19, v31, v95 row_newbcast:12
  s_cbranch_vccz L_d439
  s_waitcnt vmcnt(6)
L_d439:
  s_xor_b32 s68, s70, 0xb4900
  buffer_load_dwordx4 v[116:119], v63, s[8:11], s68 offen nt
  s_barrier
  v_fma_f32 v28, v238, s71, -v29
  v_exp_f32 v28, v28
  s_nop 0
  v_cvt_pk_bf16_f32 v30, v28, 0
  v_cvt_pk_bf16_f32 v31, 0, v28
  v_add_f32 v21, v21, v28
  s_waitcnt vmcnt(7)
  v_dot2c_f32_bf16_dpp v12, v30, v96 row_newbcast:0
  v_dot2c_f32_bf16_dpp v13, v31, v96 row_newbcast:0
  v_dot2c_f32_bf16_dpp v14, v30, v97 row_newbcast:0
  v_dot2c_f32_bf16_dpp v15, v31, v97 row_newbcast:0
  v_dot2c_f32_bf16_dpp v16, v30, v98 row_newbcast:0
  v_dot2c_f32_bf16_dpp v17, v31, v98 row_newbcast:0
  v_dot2c_f32_bf16_dpp v18, v30, v99 row_newbcast:0
  v_dot2c_f32_bf16_dpp v19, v31, v99 row_newbcast:0
  s_cbranch_vccz L_d440
  s_waitcnt vmcnt(5)
L_d440:
  s_xor_b32 s68, s70, 0xb4c00
  buffer_load_dwordx4 v[120:123], v63, s[8:11], s68 offen nt
  s_cmp_eq_u32 s64, 1
  s_cbranch_scc0 L_wp110
  s_mov_b32 s100, 9
  s_atomic_umax s100, s[20:21], s88
  s_and_b32 s60, s88, 0xfffffc7f
  s_xor_b32 s61, s60, 1024
  s_add_u32 s38, s61, 0
  s_load_dword s40, s[20:21], s38 glc
  s_add_u32 s38, s60, 128
  s_load_dword s41, s[20:21], s38 glc
  s_add_u32 s38, s60, 256
  s_load_dword s42, s[20:21], s38 glc
  s_add_u32 s38, s61, 384
  s_load_dword s43, s[20:21], s38 glc
  s_add_u32 s38, s61, 512
  s_load_dword s44, s[20:21], s38 glc
  s_add_u32 s38, s60, 640
  s_load_dword s45, s[20:21], s38 glc
  s_add_u32 s38, s60, 768
  s_load_dword s46, s[20:21], s38 glc
  s_add_u32 s38, s61, 896
  s_load_dword s47, s[20:21], s38 glc
L_wp110:
  s_waitcnt vmcnt(6)
  v_dot2c_f32_bf16_dpp v12, v30, v100 row_newbcast:8
  v_dot2c_f32_bf16_dpp v13, v31, v100 row_newbcast:8
  v_dot2c_f32_bf16_dpp v14, v30, v101 row_newbcast:8
  v_dot2c_f32_bf16_dpp v15, v31, v101 row_newbcast:8
  v_dot2c_f32_bf16_dpp v16, v30, v102 row_newbcast:8
  v_dot2c_f32_bf16_dpp v17, v31, v102 row_newbcast:8
  v_dot2c_f32_bf16_dpp v18, v30, v103 row_newbcast:8
  v_dot2c_f32_bf16_dpp v19, v31, v103 row_newbcast:8
  s_cbranch_vccz L_d441
  s_waitcnt vmcnt(5)
L_d441:
  s_xor_b32 s68, s70, 0xb4d00
  buffer_load_dwordx4 v[124:127], v63, s[8:11], s68 offen nt
  s_waitcnt vmcnt(6)
  v_dot2c_f32_bf16_dpp v12, v30, v104 row_newbcast:4
  v_dot2c_f32_bf16_dpp v13, v31, v104 row_newbcast:4
  v_dot2c_f32_bf16_dpp v14, v30, v105 row_newbcast:4
  v_dot2c_f32_bf16_dpp v15, v31, v105 row_newbcast:4
  v_dot2c_f32_bf16_dpp v16, v30, v106 row_newbcast:4
  v_dot2c_f32_bf16_dpp v17, v31, v106 row_newbcast:4
  v_dot2c_f32_bf16_dpp v18, v30, v107 row_newbcast:4
  v_dot2c_f32_bf16_dpp v19, v31, v107 row_newbcast:4
  s_cbranch_vccz L_d442
  s_waitcnt vmcnt(5)
L_d442:
  s_xor_b32 s68, s70, 0x44000
  buffer_load_dwordx4 v[64:67], v63, s[8:11], s68 offen nt
  s_lshl_b32 s73, s80, 13
  s_add_u32 s73, s73, s84
  buffer_load_dwordx4 a[192:195], v3, s[24:27], s73 offen offset:0
  s_waitcnt vmcnt(7)
  v_dot2c_f32_bf16_dpp v12, v30, v108 row_newbcast:12
  v_dot2c_f32_bf16_dpp v13, v31, v108 row_newbcast:12
  v_dot2c_f32_bf16_dpp v14, v30, v109 row_newbcast:12
  v_dot2c_f32_bf16_dpp v15, v31, v109 row_newbcast:12
  v_dot2c_f32_bf16_dpp v16, v30, v110 row_newbcast:12
  v_dot2c_f32_bf16_dpp v17, v31, v110 row_newbcast:12
  v_dot2c_f32_bf16_dpp v18, v30, v111 row_newbcast:12
  v_dot2c_f32_bf16_dpp v19, v31, v111 row_newbcast:12
  s_cbranch_vccz L_d443
  s_waitcnt vmcnt(6)
L_d443:
  s_xor_b32 s68, s70, 0x44100
  buffer_load_dwordx4 v[68:71], v63, s[8:11], s68 offen nt
  s_barrier
  v_fma_f32 v28, v239, s71, -v29
  v_exp_f32 v28, v28
  s_nop 0
  v_cvt_pk_bf16_f32 v30, v28, 0
  v_cvt_pk_bf16_f32 v31, 0, v28
  v_add_f32 v21, v21, v28
  s_waitcnt vmcnt(7)
  v_dot2c_f32_bf16_dpp v12, v30, v112 row_newbcast:0
  v_dot2c_f32_bf16_dpp v13, v31, v112 row_newbcast:0
  v_dot2c_f32_bf16_dpp v14, v30, v113 row_newbcast:0
  v_dot2c_f32_bf16_dpp v15, v31, v113 row_newbcast:0
  v_dot2c_f32_bf16_dpp v16, v30, v114 row_newbcast:0
  v_dot2c_f32_bf16_dpp v17, v31, v114 row_newbcast:0
  v_dot2c_f32_bf16_dpp v18, v30, v115 row_newbcast:0
  v_dot2c_f32_bf16_dpp v19, v31, v115 row_newbcast:0
  s_cbranch_vccz L_d444
  s_waitcnt vmcnt(5)
L_d444:
  s_xor_b32 s68, s70, 0x44400
  buffer_load_dwordx4 v[72:75], v63, s[8:11], s68 offen nt
  s_waitcnt vmcnt(6)
  v_dot2c_f32_bf16_dpp v12, v30, v116 row_newbcast:8
  v_dot2c_f32_bf16_dpp v13, v31, v116 row_newbcast:8
  v_dot2c_f32_bf16_dpp v14, v30, v117 row_newbcast:8
  v_dot2c_f32_bf16_dpp v15, v31, v117 row_newbcast:8
  v_dot2c_f32_bf16_dpp v16, v30, v118 row_newbcast:8
  v_dot2c_f32_bf16_dpp v17, v31, v118 row_newbcast:8
  v_dot2c_f32_bf16_dpp v18, v30, v119 row_newbcast:8
  v_dot2c_f32_bf16_dpp v19, v31, v119 row_newbcast:8
  s_cbranch_vccz L_d445
  s_waitcnt vmcnt(5)
L_d445:
  s_xor_b32 s68, s70, 0x44500
  buffer_load_dwordx4 v[76:79], v63, s[8:11], s68 offen nt
  s_waitcnt vmcnt(6)
  v_dot2c_f32_bf16_dpp v12, v30, v120 row_newbcast:4
  v_dot2c_f32_bf16_dpp v13, v31, v120 row_newbcast:4
  v_dot2c_f32_bf16_dpp v14, v30, v121 row_newbcast:4
  v_dot2c_f32_bf16_dpp v15, v31, v121 row_newbcast:4
  v_dot2c_f32_bf16_dpp v16, v30, v122 row_newbcast:4
  v_dot2c_f32_bf16_dpp v17, v31, v122 row_newbcast:4
  v_dot2c_f32_bf16_dpp v18, v30, v123 row_newbcast:4
  v_dot2c_f32_bf16_dpp v19, v31, v123 row_newbcast:4
  s_cbranch_vccz L_d446
  s_waitcnt vmcnt(5)
L_d446:
  s_xor_b32 s68, s70, 0x44800
  buffer_load_dwordx4 v[80:83], v63, s[8:11], s68 offen nt
  buffer_load_dwordx4 a[200:203], v3, s[24:27], s73 offen offset:256
  s_waitcnt vmcnt(7)
  v_dot2c_f32_bf16_dpp v12, v30, v124 row_newbcast:12
  v_dot2c_f32_bf16_dpp v13, v31, v124 row_newbcast:12
  v_dot2c_f32_bf16_dpp v14, v30, v125 row_newbcast:12
  v_dot2c_f32_bf16_dpp v15, v31, v125 row_newbcast:12
  v_dot2c_f32_bf16_dpp v16, v30, v126 row_newbcast:12
  v_dot2c_f32_bf16_dpp v17, v31, v126 row_newbcast:12
  v_dot2c_f32_bf16_dpp v18, v30, v127 row_newbcast:12
  v_dot2c_f32_bf16_dpp v19, v31, v127 row_newbcast:12
  s_cbranch_vccz L_d447
  s_waitcnt vmcnt(6)
L_d447:
  s_xor_b32 s68, s70, 0x44900
  buffer_load_dwordx4 v[84:87], v63, s[8:11], s68 offen nt
  s_barrier
  v_fma_f32 v28, v240, s71, -v29
  v_exp_f32 v28, v28
  s_nop 0
  v_cvt_pk_bf16_f32 v30, v28, 0
  v_cvt_pk_bf16_f32 v31, 0, v28
  v_add_f32 v21, v21, v28
  s_waitcnt vmcnt(7)
  v_dot2c_f32_bf16_dpp v12, v30, v64 row_newbcast:0
  v_dot2c_f32_bf16_dpp v13, v31, v64 row_newbcast:0
  v_dot2c_f32_bf16_dpp v14, v30, v65 row_newbcast:0
  v_dot2c_f32_bf16_dpp v15, v31, v65 row_newbcast:0
  v_dot2c_f32_bf16_dpp v16, v30, v66 row_newbcast:0
  v_dot2c_f32_bf16_dpp v17, v31, v66 row_newbcast:0
  v_dot2c_f32_bf16_dpp v18, v30, v67 row_newbcast:0
  v_dot2c_f32_bf16_dpp v19, v31, v67 row_newbcast:0
  s_cbranch_vccz L_d448
  s_waitcnt vmcnt(5)
L_d448:
  s_xor_b32 s68, s70, 0x44c00
  buffer_load_dwordx4 v[88:91], v63, s[8:11], s68 offen nt
  s_cmp_eq_u32 s64, 1
  s_cbranch_scc0 L_wp112
  s_mov_b32 s101, 0
  s_waitcnt lgkmcnt(0)
  s_cmp_ge_u32 s40, 9
  s_addc_u32 s101, s101, 0
  s_cmp_ge_u32 s41, 9
  s_addc_u32 s101, s101, 0
  s_cmp_ge_u32 s42, 9
  s_addc_u32 s101, s101, 0
  s_cmp_ge_u32 s43, 9
  s_addc_u32 s101, s101, 0
  s_cmp_ge_u32 s44, 9
  s_addc_u32 s101, s101, 0
  s_cmp_ge_u32 s45, 9
  s_addc_u32 s101, s101, 0
  s_cmp_ge_u32 s46, 9
  s_addc_u32 s101, s101, 0
  s_cmp_ge_u32 s47, 9
  s_addc_u32 s101, s101, 0
  s_cmp_lt_u32 s101, 6
  s_cselect_b32 s38, -1, 0
  v_mov_b32 v26, 0
  v_mov_b32 v27, s38
  ds_write_b32 v26, v27 offset:8512
L_wp112:
  s_waitcnt vmcnt(6)
  v_dot2c_f32_bf16_dpp v12, v30, v68 row_newbcast:8
  v_dot2c_f32_bf16_dpp v13, v31, v68 row_newbcast:8
  v_dot2c_f32_bf16_dpp v14, v30, v69 row_newbcast:8
  v_dot2c_f32_bf16_dpp v15, v31, v69 row_newbcast:8
  v_dot2c_f32_bf16_dpp v16, v30, v70 row_newbcast:8
  v_dot2c_f32_bf16_dpp v17, v31, v70 row_newbcast:8
  v_dot2c_f32_bf16_dpp v18, v30, v71 row_newbcast:8
  v_dot2c_f32_bf16_dpp v19, v31, v71 row_newbcast:8
  s_cbranch_vccz L_d449
  s_waitcnt vmcnt(5)
L_d449:
  s_xor_b32 s68, s70, 0x44d00
  buffer_load_dwordx4 v[92:95], v63, s[8:11], s68 offen nt
  s_waitcnt vmcnt(6)
  v_dot2c_f32_bf16_dpp v12, v30, v72 row_newbcast:4
  v_dot2c_f32_bf16_dpp v13, v31, v72 row_newbcast:4
  v_dot2c_f32_bf16_dpp v14, v30, v73 row_newbcast:4
  v_dot2c_f32_bf16_dpp v15, v31, v73 row_newbcast:4
  v_dot2c_f32_bf16_dpp v16, v30, v74 row_newbcast:4
  v_dot2c_f32_bf16_dpp v17, v31, v74 row_newbcast:4
  v_dot2c_f32_bf16_dpp v18, v30, v75 row_newbcast:4
  v_dot2c_f32_bf16_dpp v19, v31, v75 row_newbcast:4
  s_cbranch_vccz L_d450
  s_waitcnt vmcnt(5)
L_d450:
  s_xor_b32 s68, s70, 0x54000
  buffer_load_dwordx4 v[96:99], v63, s[8:11], s68 offen nt
  buffer_load_dwordx4 a[196:199], v3, s[24:27], s73 offen offset:2048
  s_waitcnt vmcnt(7)
  v_dot2c_f32_bf16_dpp v12, v30, v76 row_newbcast:12
  v_dot2c_f32_bf16_dpp v13, v31, v76 row_newbcast:12
  v_dot2c_f32_bf16_dpp v14, v30, v77 row_newbcast:12
  v_dot2c_f32_bf16_dpp v15, v31, v77 row_newbcast:12
  v_dot2c_f32_bf16_dpp v16, v30, v78 row_newbcast:12
  v_dot2c_f32_bf16_dpp v17, v31, v78 row_newbcast:12
  v_dot2c_f32_bf16_dpp v18, v30, v79 row_newbcast:12
  v_dot2c_f32_bf16_dpp v19, v31, v79 row_newbcast:12
  s_cbranch_vccz L_d451
  s_waitcnt vmcnt(6)
L_d451:
  s_xor_b32 s68, s70, 0x54100
  buffer_load_dwordx4 v[100:103], v63, s[8:11], s68 offen nt
  s_barrier
  v_fma_f32 v28, v241, s71, -v29
  v_exp_f32 v28, v28
  s_nop 0
  v_cvt_pk_bf16_f32 v30, v28, 0
  v_cvt_pk_bf16_f32 v31, 0, v28
  v_add_f32 v21, v21, v28
  s_waitcnt vmcnt(7)
  v_dot2c_f32_bf16_dpp v12, v30, v80 row_newbcast:0
  v_dot2c_f32_bf16_dpp v13, v31, v80 row_newbcast:0
  v_dot2c_f32_bf16_dpp v14, v30, v81 row_newbcast:0
  v_dot2c_f32_bf16_dpp v15, v31, v81 row_newbcast:0
  v_dot2c_f32_bf16_dpp v16, v30, v82 row_newbcast:0
  v_dot2c_f32_bf16_dpp v17, v31, v82 row_newbcast:0
  v_dot2c_f32_bf16_dpp v18, v30, v83 row_newbcast:0
  v_dot2c_f32_bf16_dpp v19, v31, v83 row_newbcast:0
  s_cbranch_vccz L_d452
  s_waitcnt vmcnt(5)
L_d452:
  s_xor_b32 s68, s70, 0x54400
  buffer_load_dwordx4 v[104:107], v63, s[8:11], s68 offen nt
  v_mov_b32 v26, 0
  ds_read_b32 v35, v26 offset:8512
  s_waitcnt vmcnt(6)
  v_dot2c_f32_bf16_dpp v12, v30, v84 row_newbcast:8
  v_dot2c_f32_bf16_dpp v13, v31, v84 row_newbcast:8
  v_dot2c_f32_bf16_dpp v14, v30, v85 row_newbcast:8
  v_dot2c_f32_bf16_dpp v15, v31, v85 row_newbcast:8
  v_dot2c_f32_bf16_dpp v16, v30, v86 row_newbcast:8
  v_dot2c_f32_bf16_dpp v17, v31, v86 row_newbcast:8
  v_dot2c_f32_bf16_dpp v18, v30, v87 row_newbcast:8
  v_dot2c_f32_bf16_dpp v19, v31, v87 row_newbcast:8
  s_cbranch_vccz L_d453
  s_waitcnt vmcnt(5)
L_d453:
  s_xor_b32 s68, s70, 0x54500
  buffer_load_dwordx4 v[108:111], v63, s[8:11], s68 offen nt
  s_waitcnt vmcnt(6)
  v_dot2c_f32_bf16_dpp v12, v30, v88 row_newbcast:4
  v_dot2c_f32_bf16_dpp v13, v31, v88 row_newbcast:4
  v_dot2c_f32_bf16_dpp v14, v30, v89 row_newbcast:4
  v_dot2c_f32_bf16_dpp v15, v31, v89 row_newbcast:4
  v_dot2c_f32_bf16_dpp v16, v30, v90 row_newbcast:4
  v_dot2c_f32_bf16_dpp v17, v31, v90 row_newbcast:4
  v_dot2c_f32_bf16_dpp v18, v30, v91 row_newbcast:4
  v_dot2c_f32_bf16_dpp v19, v31, v91 row_newbcast:4
  s_cbranch_vccz L_d454
  s_waitcnt vmcnt(5)
L_d454:
  s_xor_b32 s68, s70, 0x54800
  buffer_load_dwordx4 v[112:115], v63, s[8:11], s68 offen nt
  buffer_load_dwordx4 a[204:207], v3, s[24:27], s73 offen offset:2304
  s_add_u32 s73, s73, 4096
  s_waitcnt vmcnt(7)
  v_dot2c_f32_bf16_dpp v12, v30, v92 row_newbcast:12
  v_dot2c_f32_bf16_dpp v13, v31, v92 row_newbcast:12
  v_dot2c_f32_bf16_dpp v14, v30, v93 row_newbcast:12
  v_dot2c_f32_bf16_dpp v15, v31, v93 row_newbcast:12
  v_dot2c_f32_bf16_dpp v16, v30, v94 row_newbcast:12
  v_dot2c_f32_bf16_dpp v17, v31, v94 row_newbcast:12
  v_dot2c_f32_bf16_dpp v18, v30, v95 row_newbcast:12
  v_dot2c_f32_bf16_dpp v19, v31, v95 row_newbcast:12
  s_cbranch_vccz L_d455
  s_waitcnt vmcnt(6)
L_d455:
  s_xor_b32 s68, s70, 0x54900
  buffer_load_dwordx4 v[116:119], v63, s[8:11], s68 offen nt
  s_barrier
  v_fma_f32 v28, v242, s71, -v29
  v_exp_f32 v28, v28
  s_nop 0
  v_cvt_pk_bf16_f32 v30, v28, 0
  v_cvt_pk_bf16_f32 v31, 0, v28
  v_add_f32 v21, v21, v28
  s_waitcnt vmcnt(7)
  v_dot2c_f32_bf16_dpp v12, v30, v96 row_newbcast:0
  v_dot2c_f32_bf16_dpp v13, v31, v96 row_newbcast:0
  v_dot2c_f32_bf16_dpp v14, v30, v97 row_newbcast:0
  v_dot2c_f32_bf16_dpp v15, v31, v97 row_newbcast:0
  v_dot2c_f32_bf16_dpp v16, v30, v98 row_newbcast:0
  v_dot2c_f32_bf16_dpp v17, v31, v98 row_newbcast:0
  v_dot2c_f32_bf16_dpp v18, v30, v99 row_newbcast:0
  v_dot2c_f32_bf16_dpp v19, v31, v99 row_newbcast:0
  s_cbranch_vccz L_d456
  s_waitcnt vmcnt(5)
L_d456:
  s_xor_b32 s68, s70, 0x54c00
  buffer_load_dwordx4 v[120:123], v63, s[8:11], s68 offen nt
  s_waitcnt lgkmcnt(0)
  v_cmp_ne_u32 vcc, 0, v35
  s_waitcnt vmcnt(6)
  v_dot2c_f32_bf16_dpp v12, v30, v100 row_newbcast:8
  v_dot2c_f32_bf16_dpp v13, v31, v100 row_newbcast:8
  v_dot2c_f32_bf16_dpp v14, v30, v101 row_newbcast:8
  v_dot2c_f32_bf16_dpp v15, v31, v101 row_newbcast:8
  v_dot2c_f32_bf16_dpp v16, v30, v102 row_newbcast:8
  v_dot2c_f32_bf16_dpp v17, v31, v102 row_newbcast:8
  v_dot2c_f32_bf16_dpp v18, v30, v103 row_newbcast:8
  v_dot2c_f32_bf16_dpp v19, v31, v103 row_newbcast:8
  s_cbranch_vccz L_d457
  s_waitcnt vmcnt(5)
L_d457:
  s_xor_b32 s68, s70, 0x54d00
  buffer_load_dwordx4 v[124:127], v63, s[8:11], s68 offen nt
  s_waitcnt vmcnt(6)
  v_dot2c_f32_bf16_dpp v12, v30, v104 row_newbcast:4
  v_dot2c_f32_bf16_dpp v13, v31, v104 row_newbcast:4
  v_dot2c_f32_bf16_dpp v14, v30, v105 row_newbcast:4
  v_dot2c_f32_bf16_dpp v15, v31, v105 row_newbcast:4
  v_dot2c_f32_bf16_dpp v16, v30, v106 row_newbcast:4
  v_dot2c_f32_bf16_dpp v17, v31, v106 row_newbcast:4
  v_dot2c_f32_bf16_dpp v18, v30, v107 row_newbcast:4
  v_dot2c_f32_bf16_dpp v19, v31, v107 row_newbcast:4
  s_cbranch_vccz L_d458
  s_waitcnt vmcnt(5)
L_d458:
  s_xor_b32 s68, s70, 0x64000
  buffer_load_dwordx4 v[64:67], v63, s[8:11], s68 offen nt
  buffer_load_dwordx4 a[208:211], v3, s[24:27], s73 offen offset:0
  s_waitcnt vmcnt(7)
  v_dot2c_f32_bf16_dpp v12, v30, v108 row_newbcast:12
  v_dot2c_f32_bf16_dpp v13, v31, v108 row_newbcast:12
  v_dot2c_f32_bf16_dpp v14, v30, v109 row_newbcast:12
  v_dot2c_f32_bf16_dpp v15, v31, v109 row_newbcast:12
  v_dot2c_f32_bf16_dpp v16, v30, v110 row_newbcast:12
  v_dot2c_f32_bf16_dpp v17, v31, v110 row_newbcast:12
  v_dot2c_f32_bf16_dpp v18, v30, v111 row_newbcast:12
  v_dot2c_f32_bf16_dpp v19, v31, v111 row_newbcast:12
  s_cbranch_vccz L_d459
  s_waitcnt vmcnt(6)
L_d459:
  s_xor_b32 s68, s70, 0x64100
  buffer_load_dwordx4 v[68:71], v63, s[8:11], s68 offen nt
  s_barrier
  v_fma_f32 v28, v243, s71, -v29
  v_exp_f32 v28, v28
  s_nop 0
  v_cvt_pk_bf16_f32 v30, v28, 0
  v_cvt_pk_bf16_f32 v31, 0, v28
  v_add_f32 v21, v21, v28
  s_waitcnt vmcnt(7)
  v_dot2c_f32_bf16_dpp v12, v30, v112 row_newbcast:0
  v_dot2c_f32_bf16_dpp v13, v31, v112 row_newbcast:0
  v_dot2c_f32_bf16_dpp v14, v30, v113 row_newbcast:0
  v_dot2c_f32_bf16_dpp v15, v31, v113 row_newbcast:0
  v_dot2c_f32_bf16_dpp v16, v30, v114 row_newbcast:0
  v_dot2c_f32_bf16_dpp v17, v31, v114 row_newbcast:0
  v_dot2c_f32_bf16_dpp v18, v30, v115 row_newbcast:0
  v_dot2c_f32_bf16_dpp v19, v31, v115 row_newbcast:0
  s_cbranch_vccz L_d460
  s_waitcnt vmcnt(5)
L_d460:
  s_xor_b32 s68, s70, 0x64400
  buffer_load_dwordx4 v[72:75], v63, s[8:11], s68 offen nt
  s_waitcnt vmcnt(6)
  v_dot2c_f32_bf16_dpp v12, v30, v116 row_newbcast:8
  v_dot2c_f32_bf16_dpp v13, v31, v116 row_newbcast:8
  v_dot2c_f32_bf16_dpp v14, v30, v117 row_newbcast:8
  v_dot2c_f32_bf16_dpp v15, v31, v117 row_newbcast:8
  v_dot2c_f32_bf16_dpp v16, v30, v118 row_newbcast:8
  v_dot2c_f32_bf16_dpp v17, v31, v118 row_newbcast:8
  v_dot2c_f32_bf16_dpp v18, v30, v119 row_newbcast:8
  v_dot2c_f32_bf16_dpp v19, v31, v119 row_newbcast:8
  s_cbranch_vccz L_d461
  s_waitcnt vmcnt(5)
L_d461:
  s_xor_b32 s68, s70, 0x64500
  buffer_load_dwordx4 v[76:79], v63, s[8:11], s68 offen nt
  s_waitcnt vmcnt(6)
  v_dot2c_f32_bf16_dpp v12, v30, v120 row_newbcast:4
  v_dot2c_f32_bf16_dpp v13, v31, v120 row_newbcast:4
  v_dot2c_f32_bf16_dpp v14, v30, v121 row_newbcast:4
  v_dot2c_f32_bf16_dpp v15, v31, v121 row_newbcast:4
  v_dot2c_f32_bf16_dpp v16, v30, v122 row_newbcast:4
  v_dot2c_f32_bf16_dpp v17, v31, v122 row_newbcast:4
  v_dot2c_f32_bf16_dpp v18, v30, v123 row_newbcast:4
  v_dot2c_f32_bf16_dpp v19, v31, v123 row_newbcast:4
  s_cbranch_vccz L_d462
  s_waitcnt vmcnt(5)
L_d462:
  s_xor_b32 s68, s70, 0x64800
  buffer_load_dwordx4 v[80:83], v63, s[8:11], s68 offen nt
  buffer_load_dwordx4 a[216:219], v3, s[24:27], s73 offen offset:256
  s_waitcnt vmcnt(7)
  v_dot2c_f32_bf16_dpp v12, v30, v124 row_newbcast:12
  v_dot2c_f32_bf16_dpp v13, v31, v124 row_newbcast:12
  v_dot2c_f32_bf16_dpp v14, v30, v125 row_newbcast:12
  v_dot2c_f32_bf16_dpp v15, v31, v125 row_newbcast:12
  v_dot2c_f32_bf16_dpp v16, v30, v126 row_newbcast:12
  v_dot2c_f32_bf16_dpp v17, v31, v126 row_newbcast:12
  v_dot2c_f32_bf16_dpp v18, v30, v127 row_newbcast:12
  v_dot2c_f32_bf16_dpp v19, v31, v127 row_newbcast:12
  s_cbranch_vccz L_d463
  s_waitcnt vmcnt(6)
L_d463:
  s_xor_b32 s68, s70, 0x64900
  buffer_load_dwordx4 v[84:87], v63, s[8:11], s68 offen nt
  s_barrier
  v_fma_f32 v28, v244, s71, -v29
  v_exp_f32 v28, v28
  s_nop 0
  v_cvt_pk_bf16_f32 v30, v28, 0
  v_cvt_pk_bf16_f32 v31, 0, v28
  v_add_f32 v21, v21, v28
  s_waitcnt vmcnt(7)
  v_dot2c_f32_bf16_dpp v12, v30, v64 row_newbcast:0
  v_dot2c_f32_bf16_dpp v13, v31, v64 row_newbcast:0
  v_dot2c_f32_bf16_dpp v14, v30, v65 row_newbcast:0
  v_dot2c_f32_bf16_dpp v15, v31, v65 row_newbcast:0
  v_dot2c_f32_bf16_dpp v16, v30, v66 row_newbcast:0
  v_dot2c_f32_bf16_dpp v17, v31, v66 row_newbcast:0
  v_dot2c_f32_bf16_dpp v18, v30, v67 row_newbcast:0
  v_dot2c_f32_bf16_dpp v19, v31, v67 row_newbcast:0
  s_cbranch_vccz L_d464
  s_waitcnt vmcnt(5)
L_d464:
  s_xor_b32 s68, s70, 0x64c00
  buffer_load_dwordx4 v[88:91], v63, s[8:11], s68 offen nt
  s_waitcnt vmcnt(6)
  v_dot2c_f32_bf16_dpp v12, v30, v68 row_newbcast:8
  v_dot2c_f32_bf16_dpp v13, v31, v68 row_newbcast:8
  v_dot2c_f32_bf16_dpp v14, v30, v69 row_newbcast:8
  v_dot2c_f32_bf16_dpp v15, v31, v69 row_newbcast:8
  v_dot2c_f32_bf16_dpp v16, v30, v70 row_newbcast:8
  v_dot2c_f32_bf16_dpp v17, v31, v70 row_newbcast:8
  v_dot2c_f32_bf16_dpp v18, v30, v71 row_newbcast:8
  v_dot2c_f32_bf16_dpp v19, v31, v71 row_newbcast:8
  s_cbranch_vccz L_d465
  s_waitcnt vmcnt(5)
L_d465:
  s_xor_b32 s68, s70, 0x64d00
  buffer_load_dwordx4 v[92:95], v63, s[8:11], s68 offen nt
  s_waitcnt vmcnt(6)
  v_dot2c_f32_bf16_dpp v12, v30, v72 row_newbcast:4
  v_dot2c_f32_bf16_dpp v13, v31, v72 row_newbcast:4
  v_dot2c_f32_bf16_dpp v14, v30, v73 row_newbcast:4
  v_dot2c_f32_bf16_dpp v15, v31, v73 row_newbcast:4
  v_dot2c_f32_bf16_dpp v16, v30, v74 row_newbcast:4
  v_dot2c_f32_bf16_dpp v17, v31, v74 row_newbcast:4
  v_dot2c_f32_bf16_dpp v18, v30, v75 row_newbcast:4
  v_dot2c_f32_bf16_dpp v19, v31, v75 row_newbcast:4
  s_cbranch_vccz L_d466
  s_waitcnt vmcnt(5)
L_d466:
  s_xor_b32 s68, s70, 0x74000
  buffer_load_dwordx4 v[96:99], v63, s[8:11], s68 offen nt
  buffer_load_dwordx4 a[212:215], v3, s[24:27], s73 offen offset:2048
  s_waitcnt vmcnt(7)
  v_dot2c_f32_bf16_dpp v12, v30, v76 row_newbcast:12
  v_dot2c_f32_bf16_dpp v13, v31, v76 row_newbcast:12
  v_dot2c_f32_bf16_dpp v14, v30, v77 row_newbcast:12
  v_dot2c_f32_bf16_dpp v15, v31, v77 row_newbcast:12
  v_dot2c_f32_bf16_dpp v16, v30, v78 row_newbcast:12
  v_dot2c_f32_bf16_dpp v17, v31, v78 row_newbcast:12
  v_dot2c_f32_bf16_dpp v18, v30, v79 row_newbcast:12
  v_dot2c_f32_bf16_dpp v19, v31, v79 row_newbcast:12
  s_cbranch_vccz L_d467
  s_waitcnt vmcnt(6)
L_d467:
  s_xor_b32 s68, s70, 0x74100
  buffer_load_dwordx4 v[100:103], v63, s[8:11], s68 offen nt
  s_barrier
  v_fma_f32 v28, v245, s71, -v29
  v_exp_f32 v28, v28
  s_nop 0
  v_cvt_pk_bf16_f32 v30, v28, 0
  v_cvt_pk_bf16_f32 v31, 0, v28
  v_add_f32 v21, v21, v28
  s_waitcnt vmcnt(7)
  v_dot2c_f32_bf16_dpp v12, v30, v80 row_newbcast:0
  v_dot2c_f32_bf16_dpp v13, v31, v80 row_newbcast:0
  v_dot2c_f32_bf16_dpp v14, v30, v81 row_newbcast:0
  v_dot2c_f32_bf16_dpp v15, v31, v81 row_newbcast:0
  v_dot2c_f32_bf16_dpp v16, v30, v82 row_newbcast:0
  v_dot2c_f32_bf16_dpp v17, v31, v82 row_newbcast:0
  v_dot2c_f32_bf16_dpp v18, v30, v83 row_newbcast:0
  v_dot2c_f32_bf16_dpp v19, v31, v83 row_newbcast:0
  s_cbranch_vccz L_d468
  s_waitcnt vmcnt(5)
L_d468:
  s_xor_b32 s68, s70, 0x74400
  buffer_load_dwordx4 v[104:107], v63, s[8:11], s68 offen nt
  s_waitcnt vmcnt(6)
  v_dot2c_f32_bf16_dpp v12, v30, v84 row_newbcast:8
  v_dot2c_f32_bf16_dpp v13, v31, v84 row_newbcast:8
  v_dot2c_f32_bf16_dpp v14, v30, v85 row_newbcast:8
  v_dot2c_f32_bf16_dpp v15, v31, v85 row_newbcast:8
  v_dot2c_f32_bf16_dpp v16, v30, v86 row_newbcast:8
  v_dot2c_f32_bf16_dpp v17, v31, v86 row_newbcast:8
  v_dot2c_f32_bf16_dpp v18, v30, v87 row_newbcast:8
  v_dot2c_f32_bf16_dpp v19, v31, v87 row_newbcast:8
  s_cbranch_vccz L_d469
  s_waitcnt vmcnt(5)
L_d469:
  s_xor_b32 s68, s70, 0x74500
  buffer_load_dwordx4 v[108:111], v63, s[8:11], s68 offen nt
  s_waitcnt vmcnt(6)
  v_dot2c_f32_bf16_dpp v12, v30, v88 row_newbcast:4
  v_dot2c_f32_bf16_dpp v13, v31, v88 row_newbcast:4
  v_dot2c_f32_bf16_dpp v14, v30, v89 row_newbcast:4
  v_dot2c_f32_bf16_dpp v15, v31, v89 row_newbcast:4
  v_dot2c_f32_bf16_dpp v16, v30, v90 row_newbcast:4
  v_dot2c_f32_bf16_dpp v17, v31, v90 row_newbcast:4
  v_dot2c_f32_bf16_dpp v18, v30, v91 row_newbcast:4
  v_dot2c_f32_bf16_dpp v19, v31, v91 row_newbcast:4
  s_cbranch_vccz L_d470
  s_waitcnt vmcnt(5)
L_d470:
  s_xor_b32 s68, s70, 0x74800
  buffer_load_dwordx4 v[112:115], v63, s[8:11], s68 offen nt
  buffer_load_dwordx4 a[220:223], v3, s[24:27], s73 offen offset:2304
  s_add_u32 s73, s73, 4096
  s_waitcnt vmcnt(7)
  v_dot2c_f32_bf16_dpp v12, v30, v92 row_newbcast:12
  v_dot2c_f32_bf16_dpp v13, v31, v92 row_newbcast:12
  v_dot2c_f32_bf16_dpp v14, v30, v93 row_newbcast:12
  v_dot2c_f32_bf16_dpp v15, v31, v93 row_newbcast:12
  v_dot2c_f32_bf16_dpp v16, v30, v94 row_newbcast:12
  v_dot2c_f32_bf16_dpp v17, v31, v94 row_newbcast:12
  v_dot2c_f32_bf16_dpp v18, v30, v95 row_newbcast:12
  v_dot2c_f32_bf16_dpp v19, v31, v95 row_newbcast:12
  s_cbranch_vccz L_d471
  s_waitcnt vmcnt(6)
L_d471:
  s_xor_b32 s68, s70, 0x74900
  buffer_load_dwordx4 v[116:119], v63, s[8:11], s68 offen nt
  s_barrier
  v_fma_f32 v28, v246, s71, -v29
  v_exp_f32 v28, v28
  s_nop 0
  v_cvt_pk_bf16_f32 v30, v28, 0
  v_cvt_pk_bf16_f32 v31, 0, v28
  v_add_f32 v21, v21, v28
  s_waitcnt vmcnt(7)
  v_dot2c_f32_bf16_dpp v12, v30, v96 row_newbcast:0
  v_dot2c_f32_bf16_dpp v13, v31, v96 row_newbcast:0
  v_dot2c_f32_bf16_dpp v14, v30, v97 row_newbcast:0
  v_dot2c_f32_bf16_dpp v15, v31, v97 row_newbcast:0
  v_dot2c_f32_bf16_dpp v16, v30, v98 row_newbcast:0
  v_dot2c_f32_bf16_dpp v17, v31, v98 row_newbcast:0
  v_dot2c_f32_bf16_dpp v18, v30, v99 row_newbcast:0
  v_dot2c_f32_bf16_dpp v19, v31, v99 row_newbcast:0
  s_cbranch_vccz L_d472
  s_waitcnt vmcnt(5)
L_d472:
  s_xor_b32 s68, s70, 0x74c00
  buffer_load_dwordx4 v[120:123], v63, s[8:11], s68 offen nt
  s_waitcnt vmcnt(6)
  v_dot2c_f32_bf16_dpp v12, v30, v100 row_newbcast:8
  v_dot2c_f32_bf16_dpp v13, v31, v100 row_newbcast:8
  v_dot2c_f32_bf16_dpp v14, v30, v101 row_newbcast:8
  v_dot2c_f32_bf16_dpp v15, v31, v101 row_newbcast:8
  v_dot2c_f32_bf16_dpp v16, v30, v102 row_newbcast:8
  v_dot2c_f32_bf16_dpp v17, v31, v102 row_newbcast:8
  v_dot2c_f32_bf16_dpp v18, v30, v103 row_newbcast:8
  v_dot2c_f32_bf16_dpp v19, v31, v103 row_newbcast:8
  s_cbranch_vccz L_d473
  s_waitcnt vmcnt(5)
L_d473:
  s_xor_b32 s68, s70, 0x74d00
  buffer_load_dwordx4 v[124:127], v63, s[8:11], s68 offen nt
  s_waitcnt vmcnt(6)
  v_dot2c_f32_bf16_dpp v12, v30, v104 row_newbcast:4
  v_dot2c_f32_bf16_dpp v13, v31, v104 row_newbcast:4
  v_dot2c_f32_bf16_dpp v14, v30, v105 row_newbcast:4
  v_dot2c_f32_bf16_dpp v15, v31, v105 row_newbcast:4
  v_dot2c_f32_bf16_dpp v16, v30, v106 row_newbcast:4
  v_dot2c_f32_bf16_dpp v17, v31, v106 row_newbcast:4
  v_dot2c_f32_bf16_dpp v18, v30, v107 row_newbcast:4
  v_dot2c_f32_bf16_dpp v19, v31, v107 row_newbcast:4
  s_cbranch_vccz L_d474
  s_waitcnt vmcnt(5)
L_d474:
  s_xor_b32 s68, s70, 0xc4000
  buffer_load_dwordx4 v[64:67], v63, s[8:11], s68 offen nt
  s_lshl_b32 s73, s81, 13
  s_add_u32 s73, s73, s84
  buffer_load_dwordx4 a[224:227], v3, s[24:27], s73 offen offset:0
  s_waitcnt vmcnt(7)
  v_dot2c_f32_bf16_dpp v12, v30, v108 row_newbcast:12
  v_dot2c_f32_bf16_dpp v13, v31, v108 row_newbcast:12
  v_dot2c_f32_bf16_dpp v14, v30, v109 row_newbcast:12
  v_dot2c_f32_bf16_dpp v15, v31, v109 row_newbcast:12
  v_dot2c_f32_bf16_dpp v16, v30, v110 row_newbcast:12
  v_dot2c_f32_bf16_dpp v17, v31, v110 row_newbcast:12
  v_dot2c_f32_bf16_dpp v18, v30, v111 row_newbcast:12
  v_dot2c_f32_bf16_dpp v19, v31, v111 row_newbcast:12
  s_cbranch_vccz L_d475
  s_waitcnt vmcnt(6)
L_d475:
  s_xor_b32 s68, s70, 0xc4100
  buffer_load_dwordx4 v[68:71], v63, s[8:11], s68 offen nt
  s_barrier
  v_fma_f32 v28, v247, s71, -v29
  v_exp_f32 v28, v28
  s_nop 0
  v_cvt_pk_bf16_f32 v30, v28, 0
  v_cvt_pk_bf16_f32 v31, 0, v28
  v_add_f32 v21, v21, v28
  s_waitcnt vmcnt(7)
  v_dot2c_f32_bf16_dpp v12, v30, v112 row_newbcast:0
  v_dot2c_f32_bf16_dpp v13, v31, v112 row_newbcast:0
  v_dot2c_f32_bf16_dpp v14, v30, v113 row_newbcast:0
  v_dot2c_f32_bf16_dpp v15, v31, v113 row_newbcast:0
  v_dot2c_f32_bf16_dpp v16, v30, v114 row_newbcast:0
  v_dot2c_f32_bf16_dpp v17, v31, v114 row_newbcast:0
  v_dot2c_f32_bf16_dpp v18, v30, v115 row_newbcast:0
  v_dot2c_f32_bf16_dpp v19, v31, v115 row_newbcast:0
  s_cbranch_vccz L_d476
  s_waitcnt vmcnt(5)
L_d476:
  s_xor_b32 s68, s70, 0xc4400
  buffer_load_dwordx4 v[72:75], v63, s[8:11], s68 offen nt
  s_waitcnt vmcnt(6)
  v_dot2c_f32_bf16_dpp v12, v30, v116 row_newbcast:8
  v_dot2c_f32_bf16_dpp v13, v31, v116 row_newbcast:8
  v_dot2c_f32_bf16_dpp v14, v30, v117 row_newbcast:8
  v_dot2c_f32_bf16_dpp v15, v31, v117 row_newbcast:8
  v_dot2c_f32_bf16_dpp v16, v30, v118 row_newbcast:8
  v_dot2c_f32_bf16_dpp v17, v31, v118 row_newbcast:8
  v_dot2c_f32_bf16_dpp v18, v30, v119 row_newbcast:8
  v_dot2c_f32_bf16_dpp v19, v31, v119 row_newbcast:8
  s_cbranch_vccz L_d477
  s_waitcnt vmcnt(5)
L_d477:
  s_xor_b32 s68, s70, 0xc4500
  buffer_load_dwordx4 v[76:79], v63, s[8:11], s68 offen nt
  s_waitcnt vmcnt(6)
  v_dot2c_f32_bf16_dpp v12, v30, v120 row_newbcast:4
  v_dot2c_f32_bf16_dpp v13, v31, v120 row_newbcast:4
  v_dot2c_f32_bf16_dpp v14, v30, v121 row_newbcast:4
  v_dot2c_f32_bf16_dpp v15, v31, v121 row_newbcast:4
  v_dot2c_f32_bf16_dpp v16, v30, v122 row_newbcast:4
  v_dot2c_f32_bf16_dpp v17, v31, v122 row_newbcast:4
  v_dot2c_f32_bf16_dpp v18, v30, v123 row_newbcast:4
  v_dot2c_f32_bf16_dpp v19, v31, v123 row_newbcast:4
  s_cbranch_vccz L_d478
  s_waitcnt vmcnt(5)
L_d478:
  s_xor_b32 s68, s70, 0xc4800
  buffer_load_dwordx4 v[80:83], v63, s[8:11], s68 offen nt
  buffer_load_dwordx4 a[232:235], v3, s[24:27], s73 offen offset:256
  s_waitcnt vmcnt(7)
  v_dot2c_f32_bf16_dpp v12, v30, v124 row_newbcast:12
  v_dot2c_f32_bf16_dpp v13, v31, v124 row_newbcast:12
  v_dot2c_f32_bf16_dpp v14, v30, v125 row_newbcast:12
  v_dot2c_f32_bf16_dpp v15, v31, v125 row_newbcast:12
  v_dot2c_f32_bf16_dpp v16, v30, v126 row_newbcast:12
  v_dot2c_f32_bf16_dpp v17, v31, v126 row_newbcast:12
  v_dot2c_f32_bf16_dpp v18, v30, v127 row_newbcast:12
  v_dot2c_f32_bf16_dpp v19, v31, v127 row_newbcast:12
  s_cbranch_vccz L_d479
  s_waitcnt vmcnt(6)
L_d479:
  s_xor_b32 s68, s70, 0xc4900
  buffer_load_dwordx4 v[84:87], v63, s[8:11], s68 offen nt
  s_barrier
  v_fma_f32 v28, v248, s71, -v29
  v_exp_f32 v28, v28
  s_nop 0
  v_cvt_pk_bf16_f32 v30, v28, 0
  v_cvt_pk_bf16_f32 v31, 0, v28
  v_add_f32 v21, v21, v28
  s_waitcnt vmcnt(7)
  v_dot2c_f32_bf16_dpp v12, v30, v64 row_newbcast:0
  v_dot2c_f32_bf16_dpp v13, v31, v64 row_newbcast:0
  v_dot2c_f32_bf16_dpp v14, v30, v65 row_newbcast:0
  v_dot2c_f32_bf16_dpp v15, v31, v65 row_newbcast:0
  v_dot2c_f32_bf16_dpp v16, v30, v66 row_newbcast:0
  v_dot2c_f32_bf16_dpp v17, v31, v66 row_newbcast:0
  v_dot2c_f32_bf16_dpp v18, v30, v67 row_newbcast:0
  v_dot2c_f32_bf16_dpp v19, v31, v67 row_newbcast:0
  s_cbranch_vccz L_d480
  s_waitcnt vmcnt(5)
L_d480:
  s_xor_b32 s68, s70, 0xc4c00
  buffer_load_dwordx4 v[88:91], v63, s[8:11], s68 offen nt
  s_waitcnt vmcnt(6)
  v_dot2c_f32_bf16_dpp v12, v30, v68 row_newbcast:8
  v_dot2c_f32_bf16_dpp v13, v31, v68 row_newbcast:8
  v_dot2c_f32_bf16_dpp v14, v30, v69 row_newbcast:8
  v_dot2c_f32_bf16_dpp v15, v31, v69 row_newbcast:8
  v_dot2c_f32_bf16_dpp v16, v30, v70 row_newbcast:8
  v_dot2c_f32_bf16_dpp v17, v31, v70 row_newbcast:8
  v_dot2c_f32_bf16_dpp v18, v30, v71 row_newbcast:8
  v_dot2c_f32_bf16_dpp v19, v31, v71 row_newbcast:8
  s_cbranch_vccz L_d481
  s_waitcnt vmcnt(5)
L_d481:
  s_xor_b32 s68, s70, 0xc4d00
  buffer_load_dwordx4 v[92:95], v63, s[8:11], s68 offen nt
  s_waitcnt vmcnt(6)
  v_dot2c_f32_bf16_dpp v12, v30, v72 row_newbcast:4
  v_dot2c_f32_bf16_dpp v13, v31, v72 row_newbcast:4
  v_dot2c_f32_bf16_dpp v14, v30, v73 row_newbcast:4
  v_dot2c_f32_bf16_dpp v15, v31, v73 row_newbcast:4
  v_dot2c_f32_bf16_dpp v16, v30, v74 row_newbcast:4
  v_dot2c_f32_bf16_dpp v17, v31, v74 row_newbcast:4
  v_dot2c_f32_bf16_dpp v18, v30, v75 row_newbcast:4
  v_dot2c_f32_bf16_dpp v19, v31, v75 row_newbcast:4
  s_cbranch_vccz L_d482
  s_waitcnt vmcnt(5)
L_d482:
  s_xor_b32 s68, s70, 0xd4000
  buffer_load_dwordx4 v[96:99], v63, s[8:11], s68 offen nt
  buffer_load_dwordx4 a[228:231], v3, s[24:27], s73 offen offset:2048
  s_waitcnt vmcnt(7)
  v_dot2c_f32_bf16_dpp v12, v30, v76 row_newbcast:12
  v_dot2c_f32_bf16_dpp v13, v31, v76 row_newbcast:12
  v_dot2c_f32_bf16_dpp v14, v30, v77 row_newbcast:12
  v_dot2c_f32_bf16_dpp v15, v31, v77 row_newbcast:12
  v_dot2c_f32_bf16_dpp v16, v30, v78 row_newbcast:12
  v_dot2c_f32_bf16_dpp v17, v31, v78 row_newbcast:12
  v_dot2c_f32_bf16_dpp v18, v30, v79 row_newbcast:12
  v_dot2c_f32_bf16_dpp v19, v31, v79 row_newbcast:12
  s_cbranch_vccz L_d483
  s_waitcnt vmcnt(6)
L_d483:
  s_xor_b32 s68, s70, 0xd4100
  buffer_load_dwordx4 v[100:103], v63, s[8:11], s68 offen nt
  s_barrier
  v_fma_f32 v28, v249, s71, -v29
  v_exp_f32 v28, v28
  s_nop 0
  v_cvt_pk_bf16_f32 v30, v28, 0
  v_cvt_pk_bf16_f32 v31, 0, v28
  v_add_f32 v21, v21, v28
  s_waitcnt vmcnt(7)
  v_dot2c_f32_bf16_dpp v12, v30, v80 row_newbcast:0
  v_dot2c_f32_bf16_dpp v13, v31, v80 row_newbcast:0
  v_dot2c_f32_bf16_dpp v14, v30, v81 row_newbcast:0
  v_dot2c_f32_bf16_dpp v15, v31, v81 row_newbcast:0
  v_dot2c_f32_bf16_dpp v16, v30, v82 row_newbcast:0
  v_dot2c_f32_bf16_dpp v17, v31, v82 row_newbcast:0
  v_dot2c_f32_bf16_dpp v18, v30, v83 row_newbcast:0
  v_dot2c_f32_bf16_dpp v19, v31, v83 row_newbcast:0
  s_cbranch_vccz L_d484
  s_waitcnt vmcnt(5)
L_d484:
  s_xor_b32 s68, s70, 0xd4400
  buffer_load_dwordx4 v[104:107], v63, s[8:11], s68 offen nt
  s_waitcnt vmcnt(6)
  v_dot2c_f32_bf16_dpp v12, v30, v84 row_newbcast:8
  v_dot2c_f32_bf16_dpp v13, v31, v84 row_newbcast:8
  v_dot2c_f32_bf16_dpp v14, v30, v85 row_newbcast:8
  v_dot2c_f32_bf16_dpp v15, v31, v85 row_newbcast:8
  v_dot2c_f32_bf16_dpp v16, v30, v86 row_newbcast:8
  v_dot2c_f32_bf16_dpp v17, v31, v86 row_newbcast:8
  v_dot2c_f32_bf16_dpp v18, v30, v87 row_newbcast:8
  v_dot2c_f32_bf16_dpp v19, v31, v87 row_newbcast:8
  s_cbranch_vccz L_d485
  s_waitcnt vmcnt(5)
L_d485:
  s_xor_b32 s68, s70, 0xd4500
  buffer_load_dwordx4 v[108:111], v63, s[8:11], s68 offen nt
  s_waitcnt vmcnt(6)
  v_dot2c_f32_bf16_dpp v12, v30, v88 row_newbcast:4
  v_dot2c_f32_bf16_dpp v13, v31, v88 row_newbcast:4
  v_dot2c_f32_bf16_dpp v14, v30, v89 row_newbcast:4
  v_dot2c_f32_bf16_dpp v15, v31, v89 row_newbcast:4
  v_dot2c_f32_bf16_dpp v16, v30, v90 row_newbcast:4
  v_dot2c_f32_bf16_dpp v17, v31, v90 row_newbcast:4
  v_dot2c_f32_bf16_dpp v18, v30, v91 row_newbcast:4
  v_dot2c_f32_bf16_dpp v19, v31, v91 row_newbcast:4
  s_cbranch_vccz L_d486
  s_waitcnt vmcnt(5)
L_d486:
  s_xor_b32 s68, s70, 0xd4800
  buffer_load_dwordx4 v[112:115], v63, s[8:11], s68 offen nt
  buffer_load_dwordx4 a[236:239], v3, s[24:27], s73 offen offset:2304
  s_add_u32 s73, s73, 4096
  s_waitcnt vmcnt(7)
  v_dot2c_f32_bf16_dpp v12, v30, v92 row_newbcast:12
  v_dot2c_f32_bf16_dpp v13, v31, v92 row_newbcast:12
  v_dot2c_f32_bf16_dpp v14, v30, v93 row_newbcast:12
  v_dot2c_f32_bf16_dpp v15, v31, v93 row_newbcast:12
  v_dot2c_f32_bf16_dpp v16, v30, v94 row_newbcast:12
  v_dot2c_f32_bf16_dpp v17, v31, v94 row_newbcast:12
  v_dot2c_f32_bf16_dpp v18, v30, v95 row_newbcast:12
  v_dot2c_f32_bf16_dpp v19, v31, v95 row_newbcast:12
  s_cbranch_vccz L_d487
  s_waitcnt vmcnt(6)
L_d487:
  s_xor_b32 s68, s70, 0xd4900
  buffer_load_dwordx4 v[116:119], v63, s[8:11], s68 offen nt
  s_barrier
  v_fma_f32 v28, v250, s71, -v29
  v_exp_f32 v28, v28
  s_nop 0
  v_cvt_pk_bf16_f32 v30, v28, 0
  v_cvt_pk_bf16_f32 v31, 0, v28
  v_add_f32 v21, v21, v28
  s_waitcnt vmcnt(7)
  v_dot2c_f32_bf16_dpp v12, v30, v96 row_newbcast:0
  v_dot2c_f32_bf16_dpp v13, v31, v96 row_newbcast:0
  v_dot2c_f32_bf16_dpp v14, v30, v97 row_newbcast:0
  v_dot2c_f32_bf16_dpp v15, v31, v97 row_newbcast:0
  v_dot2c_f32_bf16_dpp v16, v30, v98 row_newbcast:0
  v_dot2c_f32_bf16_dpp v17, v31, v98 row_newbcast:0
  v_dot2c_f32_bf16_dpp v18, v30, v99 row_newbcast:0
  v_dot2c_f32_bf16_dpp v19, v31, v99 row_newbcast:0
  s_cbranch_vccz L_d488
  s_waitcnt vmcnt(5)
L_d488:
  s_xor_b32 s68, s70, 0xd4c00
  buffer_load_dwordx4 v[120:123], v63, s[8:11], s68 offen nt
  s_cmp_eq_u32 s64, 2
  s_cbranch_scc0 L_wp122
  s_mov_b32 s100, 10
  s_atomic_umax s100, s[20:21], s88
  s_and_b32 s60, s88, 0xfffffc7f
  s_xor_b32 s61, s60, 2048
  s_add_u32 s38, s60, 0
  s_load_dword s40, s[20:21], s38 glc
  s_add_u32 s38, s61, 128
  s_load_dword s41, s[20:21], s38 glc
  s_add_u32 s38, s61, 256
  s_load_dword s42, s[20:21], s38 glc
  s_add_u32 s38, s60, 384
  s_load_dword s43, s[20:21], s38 glc
  s_add_u32 s38, s60, 512
  s_load_dword s44, s[20:21], s38 glc
  s_add_u32 s38, s61, 640
  s_load_dword s45, s[20:21], s38 glc
  s_add_u32 s38, s61, 768
  s_load_dword s46, s[20:21], s38 glc
  s_add_u32 s38, s60, 896
  s_load_dword s47, s[20:21], s38 glc
L_wp122:
  s_waitcnt vmcnt(6)
  v_dot2c_f32_bf16_dpp v12, v30, v100 row_newbcast:8
  v_dot2c_f32_bf16_dpp v13, v31, v100 row_newbcast:8
  v_dot2c_f32_bf16_dpp v14, v30, v101 row_newbcast:8
  v_dot2c_f32_bf16_dpp v15, v31, v101 row_newbcast:8
  v_dot2c_f32_bf16_dpp v16, v30, v102 row_newbcast:8
  v_dot2c_f32_bf16_dpp v17, v31, v102 row_newbcast:8
  v_dot2c_f32_bf16_dpp v18, v30, v103 row_newbcast:8
  v_dot2c_f32_bf16_dpp v19, v31, v103 row_newbcast:8
  s_cbranch_vccz L_d489
  s_waitcnt vmcnt(5)
L_d489:
  s_xor_b32 s68, s70, 0xd4d00
  buffer_load_dwordx4 v[124:127], v63, s[8:11], s68 offen nt
  s_waitcnt vmcnt(6)
  v_dot2c_f32_bf16_dpp v12, v30, v104 row_newbcast:4
  v_dot2c_f32_bf16_dpp v13, v31, v104 row_newbcast:4
  v_dot2c_f32_bf16_dpp v14, v30, v105 row_newbcast:4
  v_dot2c_f32_bf16_dpp v15, v31, v105 row_newbcast:4
  v_dot2c_f32_bf16_dpp v16, v30, v106 row_newbcast:4
  v_dot2c_f32_bf16_dpp v17, v31, v106 row_newbcast:4
  v_dot2c_f32_bf16_dpp v18, v30, v107 row_newbcast:4
  v_dot2c_f32_bf16_dpp v19, v31, v107 row_newbcast:4
  s_cbranch_vccz L_d490
  s_waitcnt vmcnt(5)
L_d490:
  s_xor_b32 s68, s70, 0xe4000
  buffer_load_dwordx4 v[64:67], v63, s[8:11], s68 offen nt
  buffer_load_dwordx4 a[240:243], v3, s[24:27], s73 offen offset:0
  s_waitcnt vmcnt(7)
  v_dot2c_f32_bf16_dpp v12, v30, v108 row_newbcast:12
  v_dot2c_f32_bf16_dpp v13, v31, v108 row_newbcast:12
  v_dot2c_f32_bf16_dpp v14, v30, v109 row_newbcast:12
  v_dot2c_f32_bf16_dpp v15, v31, v109 row_newbcast:12
  v_dot2c_f32_bf16_dpp v16, v30, v110 row_newbcast:12
  v_dot2c_f32_bf16_dpp v17, v31, v110 row_newbcast:12
  v_dot2c_f32_bf16_dpp v18, v30, v111 row_newbcast:12
  v_dot2c_f32_bf16_dpp v19, v31, v111 row_newbcast:12
  s_cbranch_vccz L_d491
  s_waitcnt vmcnt(6)
L_d491:
  s_xor_b32 s68, s70, 0xe4100
  buffer_load_dwordx4 v[68:71], v63, s[8:11], s68 offen nt
  s_barrier
  v_fma_f32 v28, v251, s71, -v29
  v_exp_f32 v28, v28
  s_nop 0
  v_cvt_pk_bf16_f32 v30, v28, 0
  v_cvt_pk_bf16_f32 v31, 0, v28
  v_add_f32 v21, v21, v28
  s_waitcnt vmcnt(7)
  v_dot2c_f32_bf16_dpp v12, v30, v112 row_newbcast:0
  v_dot2c_f32_bf16_dpp v13, v31, v112 row_newbcast:0
  v_dot2c_f32_bf16_dpp v14, v30, v113 row_newbcast:0
  v_dot2c_f32_bf16_dpp v15, v31, v113 row_newbcast:0
  v_dot2c_f32_bf16_dpp v16, v30, v114 row_newbcast:0
  v_dot2c_f32_bf16_dpp v17, v31, v114 row_newbcast:0
  v_dot2c_f32_bf16_dpp v18, v30, v115 row_newbcast:0
  v_dot2c_f32_bf16_dpp v19, v31, v115 row_newbcast:0
  s_cbranch_vccz L_d492
  s_waitcnt vmcnt(5)
L_d492:
  s_xor_b32 s68, s70, 0xe4400
  buffer_load_dwordx4 v[72:75], v63, s[8:11], s68 offen nt
  s_waitcnt vmcnt(6)
  v_dot2c_f32_bf16_dpp v12, v30, v116 row_newbcast:8
  v_dot2c_f32_bf16_dpp v13, v31, v116 row_newbcast:8
  v_dot2c_f32_bf16_dpp v14, v30, v117 row_newbcast:8
  v_dot2c_f32_bf16_dpp v15, v31, v117 row_newbcast:8
  v_dot2c_f32_bf16_dpp v16, v30, v118 row_newbcast:8
  v_dot2c_f32_bf16_dpp v17, v31, v118 row_newbcast:8
  v_dot2c_f32_bf16_dpp v18, v30, v119 row_newbcast:8
  v_dot2c_f32_bf16_dpp v19, v31, v119 row_newbcast:8
  s_cbranch_vccz L_d493
  s_waitcnt vmcnt(5)
L_d493:
  s_xor_b32 s68, s70, 0xe4500
  buffer_load_dwordx4 v[76:79], v63, s[8:11], s68 offen nt
  s_waitcnt vmcnt(6)
  v_dot2c_f32_bf16_dpp v12, v30, v120 row_newbcast:4
  v_dot2c_f32_bf16_dpp v13, v31, v120 row_newbcast:4
  v_dot2c_f32_bf16_dpp v14, v30, v121 row_newbcast:4
  v_dot2c_f32_bf16_dpp v15, v31, v121 row_newbcast:4
  v_dot2c_f32_bf16_dpp v16, v30, v122 row_newbcast:4
  v_dot2c_f32_bf16_dpp v17, v31, v122 row_newbcast:4
  v_dot2c_f32_bf16_dpp v18, v30, v123 row_newbcast:4
  v_dot2c_f32_bf16_dpp v19, v31, v123 row_newbcast:4
  s_cbranch_vccz L_d494
  s_waitcnt vmcnt(5)
L_d494:
  s_xor_b32 s68, s70, 0xe4800
  buffer_load_dwordx4 v[80:83], v63, s[8:11], s68 offen nt
  buffer_load_dwordx4 a[248:251], v3, s[24:27], s73 offen offset:256
  s_waitcnt vmcnt(7)
  v_dot2c_f32_bf16_dpp v12, v30, v124 row_newbcast:12
  v_dot2c_f32_bf16_dpp v13, v31, v124 row_newbcast:12
  v_dot2c_f32_bf16_dpp v14, v30, v125 row_newbcast:12
  v_dot2c_f32_bf16_dpp v15, v31, v125 row_newbcast:12
  v_dot2c_f32_bf16_dpp v16, v30, v126 row_newbcast:12
  v_dot2c_f32_bf16_dpp v17, v31, v126 row_newbcast:12
  v_dot2c_f32_bf16_dpp v18, v30, v127 row_newbcast:12
  v_dot2c_f32_bf16_dpp v19, v31, v127 row_newbcast:12
  s_cbranch_vccz L_d495
  s_waitcnt vmcnt(6)
L_d495:
  s_xor_b32 s68, s70, 0xe4900
  buffer_load_dwordx4 v[84:87], v63, s[8:11], s68 offen nt
  s_barrier
  v_fma_f32 v28, v252, s71, -v29
  v_exp_f32 v28, v28
  s_nop 0
  v_cvt_pk_bf16_f32 v30, v28, 0
  v_cvt_pk_bf16_f32 v31, 0, v28
  v_add_f32 v21, v21, v28
  s_waitcnt vmcnt(7)
  v_dot2c_f32_bf16_dpp v12, v30, v64 row_newbcast:0
  v_dot2c_f32_bf16_dpp v13, v31, v64 row_newbcast:0
  v_dot2c_f32_bf16_dpp v14, v30, v65 row_newbcast:0
  v_dot2c_f32_bf16_dpp v15, v31, v65 row_newbcast:0
  v_dot2c_f32_bf16_dpp v16, v30, v66 row_newbcast:0
  v_dot2c_f32_bf16_dpp v17, v31, v66 row_newbcast:0
  v_dot2c_f32_bf16_dpp v18, v30, v67 row_newbcast:0
  v_dot2c_f32_bf16_dpp v19, v31, v67 row_newbcast:0
  s_cbranch_vccz L_d496
  s_waitcnt vmcnt(5)
L_d496:
  s_xor_b32 s68, s70, 0xe4c00
  buffer_load_dwordx4 v[88:91], v63, s[8:11], s68 offen nt
  s_cmp_eq_u32 s64, 2
  s_cbranch_scc0 L_wp124
  s_mov_b32 s101, 0
  s_waitcnt lgkmcnt(0)
  s_cmp_ge_u32 s40, 10
  s_addc_u32 s101, s101, 0
  s_cmp_ge_u32 s41, 10
  s_addc_u32 s101, s101, 0
  s_cmp_ge_u32 s42, 10
  s_addc_u32 s101, s101, 0
  s_cmp_ge_u32 s43, 10
  s_addc_u32 s101, s101, 0
  s_cmp_ge_u32 s44, 10
  s_addc_u32 s101, s101, 0
  s_cmp_ge_u32 s45, 10
  s_addc_u32 s101, s101, 0
  s_cmp_ge_u32 s46, 10
  s_addc_u32 s101, s101, 0
  s_cmp_ge_u32 s47, 10
  s_addc_u32 s101, s101, 0
  s_cmp_lt_u32 s101, 6
  s_cselect_b32 s38, -1, 0
  v_mov_b32 v26, 0
  v_mov_b32 v27, s38
  ds_write_b32 v26, v27 offset:8512
L_wp124:
  s_waitcnt vmcnt(6)
  v_dot2c_f32_bf16_dpp v12, v30, v68 row_newbcast:8
  v_dot2c_f32_bf16_dpp v13, v31, v68 row_newbcast:8
  v_dot2c_f32_bf16_dpp v14, v30, v69 row_newbcast:8
  v_dot2c_f32_bf16_dpp v15, v31, v69 row_newbcast:8
  v_dot2c_f32_bf16_dpp v16, v30, v70 row_newbcast:8
  v_dot2c_f32_bf16_dpp v17, v31, v70 row_newbcast:8
  v_dot2c_f32_bf16_dpp v18, v30, v71 row_newbcast:8
  v_dot2c_f32_bf16_dpp v19, v31, v71 row_newbcast:8
  s_cbranch_vccz L_d497
  s_waitcnt vmcnt(5)
L_d497:
  s_xor_b32 s68, s70, 0xe4d00
  buffer_load_dwordx4 v[92:95], v63, s[8:11], s68 offen nt
  s_waitcnt vmcnt(6)
  v_dot2c_f32_bf16_dpp v12, v30, v72 row_newbcast:4
  v_dot2c_f32_bf16_dpp v13, v31, v72 row_newbcast:4
  v_dot2c_f32_bf16_dpp v14, v30, v73 row_newbcast:4
  v_dot2c_f32_bf16_dpp v15, v31, v73 row_newbcast:4
  v_dot2c_f32_bf16_dpp v16, v30, v74 row_newbcast:4
  v_dot2c_f32_bf16_dpp v17, v31, v74 row_newbcast:4
  v_dot2c_f32_bf16_dpp v18, v30, v75 row_newbcast:4
  v_dot2c_f32_bf16_dpp v19, v31, v75 row_newbcast:4
  s_cbranch_vccz L_d498
  s_waitcnt vmcnt(5)
L_d498:
  s_xor_b32 s68, s70, 0xf4000
  buffer_load_dwordx4 v[96:99], v63, s[8:11], s68 offen nt
  buffer_load_dwordx4 a[244:247], v3, s[24:27], s73 offen offset:2048
  s_waitcnt vmcnt(7)
  v_dot2c_f32_bf16_dpp v12, v30, v76 row_newbcast:12
  v_dot2c_f32_bf16_dpp v13, v31, v76 row_newbcast:12
  v_dot2c_f32_bf16_dpp v14, v30, v77 row_newbcast:12
  v_dot2c_f32_bf16_dpp v15, v31, v77 row_newbcast:12
  v_dot2c_f32_bf16_dpp v16, v30, v78 row_newbcast:12
  v_dot2c_f32_bf16_dpp v17, v31, v78 row_newbcast:12
  v_dot2c_f32_bf16_dpp v18, v30, v79 row_newbcast:12
  v_dot2c_f32_bf16_dpp v19, v31, v79 row_newbcast:12
  s_cbranch_vccz L_d499
  s_waitcnt vmcnt(6)
L_d499:
  s_xor_b32 s68, s70, 0xf4100
  buffer_load_dwordx4 v[100:103], v63, s[8:11], s68 offen nt
  s_barrier
  v_fma_f32 v28, v253, s71, -v29
  v_exp_f32 v28, v28
  s_nop 0
  v_cvt_pk_bf16_f32 v30, v28, 0
  v_cvt_pk_bf16_f32 v31, 0, v28
  v_add_f32 v21, v21, v28
  s_waitcnt vmcnt(7)
  v_dot2c_f32_bf16_dpp v12, v30, v80 row_newbcast:0
  v_dot2c_f32_bf16_dpp v13, v31, v80 row_newbcast:0
  v_dot2c_f32_bf16_dpp v14, v30, v81 row_newbcast:0
  v_dot2c_f32_bf16_dpp v15, v31, v81 row_newbcast:0
  v_dot2c_f32_bf16_dpp v16, v30, v82 row_newbcast:0
  v_dot2c_f32_bf16_dpp v17, v31, v82 row_newbcast:0
  v_dot2c_f32_bf16_dpp v18, v30, v83 row_newbcast:0
  v_dot2c_f32_bf16_dpp v19, v31, v83 row_newbcast:0
  s_cbranch_vccz L_d500
  s_waitcnt vmcnt(5)
L_d500:
  s_xor_b32 s68, s70, 0xf4400
  buffer_load_dwordx4 v[104:107], v63, s[8:11], s68 offen nt
  v_mov_b32 v26, 0
  ds_read_b32 v35, v26 offset:8512
  s_waitcnt vmcnt(6)
  v_dot2c_f32_bf16_dpp v12, v30, v84 row_newbcast:8
  v_dot2c_f32_bf16_dpp v13, v31, v84 row_newbcast:8
  v_dot2c_f32_bf16_dpp v14, v30, v85 row_newbcast:8
  v_dot2c_f32_bf16_dpp v15, v31, v85 row_newbcast:8
  v_dot2c_f32_bf16_dpp v16, v30, v86 row_newbcast:8
  v_dot2c_f32_bf16_dpp v17, v31, v86 row_newbcast:8
  v_dot2c_f32_bf16_dpp v18, v30, v87 row_newbcast:8
  v_dot2c_f32_bf16_dpp v19, v31, v87 row_newbcast:8
  s_cbranch_vccz L_d501
  s_waitcnt vmcnt(5)
L_d501:
  s_xor_b32 s68, s70, 0xf4500
  buffer_load_dwordx4 v[108:111], v63, s[8:11], s68 offen nt
  s_waitcnt vmcnt(6)
  v_dot2c_f32_bf16_dpp v12, v30, v88 row_newbcast:4
  v_dot2c_f32_bf16_dpp v13, v31, v88 row_newbcast:4
  v_dot2c_f32_bf16_dpp v14, v30, v89 row_newbcast:4
  v_dot2c_f32_bf16_dpp v15, v31, v89 row_newbcast:4
  v_dot2c_f32_bf16_dpp v16, v30, v90 row_newbcast:4
  v_dot2c_f32_bf16_dpp v17, v31, v90 row_newbcast:4
  v_dot2c_f32_bf16_dpp v18, v30, v91 row_newbcast:4
  v_dot2c_f32_bf16_dpp v19, v31, v91 row_newbcast:4
  s_cbranch_vccz L_d502
  s_waitcnt vmcnt(5)
L_d502:
  s_xor_b32 s68, s70, 0xf4800
  buffer_load_dwordx4 v[112:115], v63, s[8:11], s68 offen nt
  buffer_load_dwordx4 a[252:255], v3, s[24:27], s73 offen offset:2304
  s_add_u32 s73, s73, 4096
  s_waitcnt vmcnt(7)
  v_dot2c_f32_bf16_dpp v12, v30, v92 row_newbcast:12
  v_dot2c_f32_bf16_dpp v13, v31, v92 row_newbcast:12
  v_dot2c_f32_bf16_dpp v14, v30, v93 row_newbcast:12
  v_dot2c_f32_bf16_dpp v15, v31, v93 row_newbcast:12
  v_dot2c_f32_bf16_dpp v16, v30, v94 row_newbcast:12
  v_dot2c_f32_bf16_dpp v17, v31, v94 row_newbcast:12
  v_dot2c_f32_bf16_dpp v18, v30, v95 row_newbcast:12
  v_dot2c_f32_bf16_dpp v19, v31, v95 row_newbcast:12
  s_cbranch_vccz L_d503
  s_waitcnt vmcnt(6)
L_d503:
  s_xor_b32 s68, s70, 0xf4900
  buffer_load_dwordx4 v[116:119], v63, s[8:11], s68 offen nt
  s_barrier
  v_fma_f32 v28, v254, s71, -v29
  v_exp_f32 v28, v28
  s_nop 0
  v_cvt_pk_bf16_f32 v30, v28, 0
  v_cvt_pk_bf16_f32 v31, 0, v28
  v_add_f32 v21, v21, v28
  s_waitcnt vmcnt(7)
  v_dot2c_f32_bf16_dpp v12, v30, v96 row_newbcast:0
  v_dot2c_f32_bf16_dpp v13, v31, v96 row_newbcast:0
  v_dot2c_f32_bf16_dpp v14, v30, v97 row_newbcast:0
  v_dot2c_f32_bf16_dpp v15, v31, v97 row_newbcast:0
  v_dot2c_f32_bf16_dpp v16, v30, v98 row_newbcast:0
  v_dot2c_f32_bf16_dpp v17, v31, v98 row_newbcast:0
  v_dot2c_f32_bf16_dpp v18, v30, v99 row_newbcast:0
  v_dot2c_f32_bf16_dpp v19, v31, v99 row_newbcast:0
  s_cbranch_vccz L_d504
  s_waitcnt vmcnt(5)
L_d504:
  s_xor_b32 s68, s70, 0xf4c00
  buffer_load_dwordx4 v[120:123], v63, s[8:11], s68 offen nt
  s_waitcnt lgkmcnt(0)
  v_cmp_ne_u32 vcc, 0, v35
  s_waitcnt vmcnt(6)
  v_dot2c_f32_bf16_dpp v12, v30, v100 row_newbcast:8
  v_dot2c_f32_bf16_dpp v13, v31, v100 row_newbcast:8
  v_dot2c_f32_bf16_dpp v14, v30, v101 row_newbcast:8
  v_dot2c_f32_bf16_dpp v15, v31, v101 row_newbcast:8
  v_dot2c_f32_bf16_dpp v16, v30, v102 row_newbcast:8
  v_dot2c_f32_bf16_dpp v17, v31, v102 row_newbcast:8
  v_dot2c_f32_bf16_dpp v18, v30, v103 row_newbcast:8
  v_dot2c_f32_bf16_dpp v19, v31, v103 row_newbcast:8
  s_cbranch_vccz L_d505
  s_waitcnt vmcnt(5)
L_d505:
  s_xor_b32 s68, s70, 0xf4d00
  buffer_load_dwordx4 v[124:127], v63, s[8:11], s68 offen nt
  s_waitcnt vmcnt(6)
  v_dot2c_f32_bf16_dpp v12, v30, v104 row_newbcast:4
  v_dot2c_f32_bf16_dpp v13, v31, v104 row_newbcast:4
  v_dot2c_f32_bf16_dpp v14, v30, v105 row_newbcast:4
  v_dot2c_f32_bf16_dpp v15, v31, v105 row_newbcast:4
  v_dot2c_f32_bf16_dpp v16, v30, v106 row_newbcast:4
  v_dot2c_f32_bf16_dpp v17, v31, v106 row_newbcast:4
  v_dot2c_f32_bf16_dpp v18, v30, v107 row_newbcast:4
  v_dot2c_f32_bf16_dpp v19, v31, v107 row_newbcast:4
  s_cbranch_vccz L_d506
  s_waitcnt vmcnt(5)
L_d506:
  s_xor_b32 s68, s70, 0x0
  buffer_load_dwordx4 v[64:67], v63, s[12:15], s68 offen nt
  s_waitcnt vmcnt(6)
  v_dot2c_f32_bf16_dpp v12, v30, v108 row_newbcast:12
  v_dot2c_f32_bf16_dpp v13, v31, v108 row_newbcast:12
  v_dot2c_f32_bf16_dpp v14, v30, v109 row_newbcast:12
  v_dot2c_f32_bf16_dpp v15, v31, v109 row_newbcast:12
  v_dot2c_f32_bf16_dpp v16, v30, v110 row_newbcast:12
  v_dot2c_f32_bf16_dpp v17, v31, v110 row_newbcast:12
  v_dot2c_f32_bf16_dpp v18, v30, v111 row_newbcast:12
  v_dot2c_f32_bf16_dpp v19, v31, v111 row_newbcast:12
  s_cbranch_vccz L_d507
  s_waitcnt vmcnt(5)
L_d507:
  s_xor_b32 s68, s70, 0x100
  buffer_load_dwordx4 v[68:71], v63, s[12:15], s68 offen nt
  s_barrier
  v_fma_f32 v28, v255, s71, -v29
  v_exp_f32 v28, v28
  s_nop 0
  v_cvt_pk_bf16_f32 v30, v28, 0
  v_cvt_pk_bf16_f32 v31, 0, v28
  v_add_f32 v21, v21, v28
  s_waitcnt vmcnt(6)
  v_dot2c_f32_bf16_dpp v12, v30, v112 row_newbcast:0
  v_dot2c_f32_bf16_dpp v13, v31, v112 row_newbcast:0
  v_dot2c_f32_bf16_dpp v14, v30, v113 row_newbcast:0
  v_dot2c_f32_bf16_dpp v15, v31, v113 row_newbcast:0
  v_dot2c_f32_bf16_dpp v16, v30, v114 row_newbcast:0
  v_dot2c_f32_bf16_dpp v17, v31, v114 row_newbcast:0
  v_dot2c_f32_bf16_dpp v18, v30, v115 row_newbcast:0
  v_dot2c_f32_bf16_dpp v19, v31, v115 row_newbcast:0
  s_cbranch_vccz L_d508
  s_waitcnt vmcnt(4)
L_d508:
  s_xor_b32 s68, s70, 0x400
  buffer_load_dwordx4 v[72:75], v63, s[12:15], s68 offen nt
  s_waitcnt vmcnt(5)
  v_dot2c_f32_bf16_dpp v12, v30, v116 row_newbcast:8
  v_dot2c_f32_bf16_dpp v13, v31, v116 row_newbcast:8
  v_dot2c_f32_bf16_dpp v14, v30, v117 row_newbcast:8
  v_dot2c_f32_bf16_dpp v15, v31, v117 row_newbcast:8
  v_dot2c_f32_bf16_dpp v16, v30, v118 row_newbcast:8
  v_dot2c_f32_bf16_dpp v17, v31, v118 row_newbcast:8
  v_dot2c_f32_bf16_dpp v18, v30, v119 row_newbcast:8
  v_dot2c_f32_bf16_dpp v19, v31, v119 row_newbcast:8
  s_cbranch_vccz L_d509
  s_waitcnt vmcnt(4)
L_d509:
  s_xor_b32 s68, s70, 0x500
  buffer_load_dwordx4 v[76:79], v63, s[12:15], s68 offen nt
  s_waitcnt vmcnt(5)
  v_dot2c_f32_bf16_dpp v12, v30, v120 row_newbcast:4
  v_dot2c_f32_bf16_dpp v13, v31, v120 row_newbcast:4
  v_dot2c_f32_bf16_dpp v14, v30, v121 row_newbcast:4
  v_dot2c_f32_bf16_dpp v15, v31, v121 row_newbcast:4
  v_dot2c_f32_bf16_dpp v16, v30, v122 row_newbcast:4
  v_dot2c_f32_bf16_dpp v17, v31, v122 row_newbcast:4
  v_dot2c_f32_bf16_dpp v18, v30, v123 row_newbcast:4
  v_dot2c_f32_bf16_dpp v19, v31, v123 row_newbcast:4
  s_cbranch_vccz L_d510
  s_waitcnt vmcnt(4)
L_d510:
  s_xor_b32 s68, s70, 0x800
  buffer_load_dwordx4 v[80:83], v63, s[12:15], s68 offen nt
  s_waitcnt vmcnt(5)
  v_dot2c_f32_bf16_dpp v12, v30, v124 row_newbcast:12
  v_dot2c_f32_bf16_dpp v13, v31, v124 row_newbcast:12
  v_dot2c_f32_bf16_dpp v14, v30, v125 row_newbcast:12
  v_dot2c_f32_bf16_dpp v15, v31, v125 row_newbcast:12
  v_dot2c_f32_bf16_dpp v16, v30, v126 row_newbcast:12
  v_dot2c_f32_bf16_dpp v17, v31, v126 row_newbcast:12
  v_dot2c_f32_bf16_dpp v18, v30, v127 row_newbcast:12
  v_dot2c_f32_bf16_dpp v19, v31, v127 row_newbcast:12
  s_cbranch_vccz L_d511
  s_waitcnt vmcnt(4)
L_d511:
  s_xor_b32 s68, s70, 0x900
  buffer_load_dwordx4 v[84:87], v63, s[12:15], s68 offen nt
  s_barrier
  v_add_f32_dpp v21, v21, v21 row_ror:4
  s_nop 1
  v_add_f32_dpp v21, v21, v21 row_ror:8
  v_mov_b32 v26, v21
  s_nop 1
  v_permlane32_swap_b32 v21, v26
  v_add_f32 v21, v21, v26
  v_mov_b32 v26, v21
  s_nop 1
  v_permlane16_swap_b32 v21, v26
  v_add_f32 v21, v21, v26
  s_lshl_b32 s38, s64, 3
  v_mov_b32 v26, s38
  ds_write_b64 v26, v[20:21] offset:8192
  v_permlane32_swap_b32 v12, v16
  v_permlane32_swap_b32 v13, v17
  v_permlane32_swap_b32 v14, v18
  v_permlane32_swap_b32 v15, v19
  v_add_f32 v12, v12, v16
  v_add_f32 v13, v13, v17
  v_add_f32 v14, v14, v18
  v_add_f32 v15, v15, v19
  s_nop 0
  v_permlane16_swap_b32 v12, v14
  v_permlane16_swap_b32 v13, v15
  v_add_f32 v12, v12, v14
  v_add_f32 v13, v13, v15
  ds_write_b64 v36, v[12:13] offset:4096
  v_mov_b32 v4, v8
  v_mov_b32 v5, v9
  v_mov_b32 v6, v10
  v_mov_b32 v7, v11
  s_waitcnt vmcnt(5)
  v_dot2_f32_bf16 v22, v64, v4, 0
  v_dot2_f32_bf16 v22, v65, v5, v22
  v_dot2_f32_bf16 v22, v66, v6, v22
  v_dot2_f32_bf16 v22, v67, v7, v22
  s_cbranch_vccz L_d512
  s_waitcnt vmcnt(4)
L_d512:
  s_xor_b32 s68, s70, 0xc00
  buffer_load_dwordx4 v[88:91], v63, s[12:15], s68 offen nt
  s_waitcnt vmcnt(5)
  v_dot2_f32_bf16 v23, v68, v4, 0
  v_dot2_f32_bf16 v23, v69, v5, v23
  v_dot2_f32_bf16 v23, v70, v6, v23
  v_dot2_f32_bf16 v23, v71, v7, v23
  s_cbranch_vccz L_d513
  s_waitcnt vmcnt(4)
L_d513:
  s_xor_b32 s68, s70, 0xd00
  buffer_load_dwordx4 v[92:95], v63, s[12:15], s68 offen nt
  s_waitcnt vmcnt(5)
  v_dot2_f32_bf16 v24, v72, v4, 0
  v_dot2_f32_bf16 v24, v73, v5, v24
  v_dot2_f32_bf16 v24, v74, v6, v24
  v_dot2_f32_bf16 v24, v75, v7, v24
  s_cbranch_vccz L_d514
  s_waitcnt vmcnt(4)
L_d514:
  s_xor_b32 s68, s70, 0x10000
  buffer_load_dwordx4 v[96:99], v63, s[12:15], s68 offen nt
  s_waitcnt vmcnt(5)
  v_dot2_f32_bf16 v25, v76, v4, 0
  v_dot2_f32_bf16 v25, v77, v5, v25
  v_dot2_f32_bf16 v25, v78, v6, v25
  v_dot2_f32_bf16 v25, v79, v7, v25
  s_cbranch_vccz L_d515
  s_waitcnt vmcnt(4)
L_d515:
  s_xor_b32 s68, s70, 0x10100
  buffer_load_dwordx4 v[100:103], v63, s[12:15], s68 offen nt
  v_add_f32_dpp v26, v22, v22 row_ror:8 row_mask:0xf bank_mask:0x3
  v_add_f32_dpp v27, v24, v24 row_ror:8 row_mask:0xf bank_mask:0x3
  s_nop 0
  v_add_f32_dpp v26, v23, v23 row_ror:8 row_mask:0xf bank_mask:0xc
  v_add_f32_dpp v27, v25, v25 row_ror:8 row_mask:0xf bank_mask:0xc
  s_nop 0
  v_add_f32_dpp v28, v26, v26 row_half_mirror row_mask:0xf bank_mask:0x5
  s_nop 1
  v_add_f32_dpp v28, v27, v27 row_half_mirror row_mask:0xf bank_mask:0xa
  s_nop 1
  v_add_f32_dpp v28, v28, v28 quad_perm:[1,0,3,2]
  s_nop 1
  v_add_f32_dpp v192, v28, v28 quad_perm:[2,3,0,1]
  v_mov_b32 v20, v192
  s_barrier
  s_waitcnt vmcnt(5)
  v_dot2_f32_bf16 v22, v80, v4, 0
  v_dot2_f32_bf16 v22, v81, v5, v22
  v_dot2_f32_bf16 v22, v82, v6, v22
  v_dot2_f32_bf16 v22, v83, v7, v22
  s_cbranch_vccz L_d516
  s_waitcnt vmcnt(4)
L_d516:
  s_xor_b32 s68, s70, 0x10400
  buffer_load_dwordx4 v[104:107], v63, s[12:15], s68 offen nt
  s_waitcnt vmcnt(5)
  v_dot2_f32_bf16 v23, v84, v4, 0
  v_dot2_f32_bf16 v23, v85, v5, v23
  v_dot2_f32_bf16 v23, v86, v6, v23
  v_dot2_f32_bf16 v23, v87, v7, v23
  s_cbranch_vccz L_d517
  s_waitcnt vmcnt(4)
L_d517:
  s_xor_b32 s68, s70, 0x10500
  buffer_load_dwordx4 v[108:111], v63, s[12:15], s68 offen nt
  s_waitcnt vmcnt(5)
  v_dot2_f32_bf16 v24, v88, v4, 0
  v_dot2_f32_bf16 v24, v89, v5, v24
  v_dot2_f32_bf16 v24, v90, v6, v24
  v_dot2_f32_bf16 v24, v91, v7, v24
  s_cbranch_vccz L_d518
  s_waitcnt vmcnt(4)
L_d518:
  s_xor_b32 s68, s70, 0x10800
  buffer_load_dwordx4 v[112:115], v63, s[12:15], s68 offen nt
  s_waitcnt vmcnt(5)
  v_dot2_f32_bf16 v25, v92, v4, 0
  v_dot2_f32_bf16 v25, v93, v5, v25
  v_dot2_f32_bf16 v25, v94, v6, v25
  v_dot2_f32_bf16 v25, v95, v7, v25
  s_cbranch_vccz L_d519
  s_waitcnt vmcnt(4)
L_d519:
  s_xor_b32 s68, s70, 0x10900
  buffer_load_dwordx4 v[116:119], v63, s[12:15], s68 offen nt
  v_add_f32_dpp v26, v22, v22 row_ror:8 row_mask:0xf bank_mask:0x3
  v_add_f32_dpp v27, v24, v24 row_ror:8 row_mask:0xf bank_mask:0x3
  s_nop 0
  v_add_f32_dpp v26, v23, v23 row_ror:8 row_mask:0xf bank_mask:0xc
  v_add_f32_dpp v27, v25, v25 row_ror:8 row_mask:0xf bank_mask:0xc
  s_nop 0
  v_add_f32_dpp v28, v26, v26 row_half_mirror row_mask:0xf bank_mask:0x5
  s_nop 1
  v_add_f32_dpp v28, v27, v27 row_half_mirror row_mask:0xf bank_mask:0xa
  s_nop 1
  v_add_f32_dpp v28, v28, v28 quad_perm:[1,0,3,2]
  s_nop 1
  v_add_f32_dpp v193, v28, v28 quad_perm:[2,3,0,1]
  v_max_f32 v20, v20, v193
  s_barrier
  s_waitcnt vmcnt(5)
  v_dot2_f32_bf16 v22, v96, v4, 0
  v_dot2_f32_bf16 v22, v97, v5, v22
  v_dot2_f32_bf16 v22, v98, v6, v22
  v_dot2_f32_bf16 v22, v99, v7, v22
  s_cbranch_vccz L_d520
  s_waitcnt vmcnt(4)
L_d520:
  s_xor_b32 s68, s70, 0x10c00
  buffer_load_dwordx4 v[120:123], v63, s[12:15], s68 offen nt
  s_waitcnt vmcnt(5)
  v_dot2_f32_bf16 v23, v100, v4, 0
  v_dot2_f32_bf16 v23, v101, v5, v23
  v_dot2_f32_bf16 v23, v102, v6, v23
  v_dot2_f32_bf16 v23, v103, v7, v23
  s_cbranch_vccz L_d521
  s_waitcnt vmcnt(4)
L_d521:
  s_xor_b32 s68, s70, 0x10d00
  buffer_load_dwordx4 v[124:127], v63, s[12:15], s68 offen nt
  s_waitcnt vmcnt(5)
  v_dot2_f32_bf16 v24, v104, v4, 0
  v_dot2_f32_bf16 v24, v105, v5, v24
  v_dot2_f32_bf16 v24, v106, v6, v24
  v_dot2_f32_bf16 v24, v107, v7, v24
  s_cbranch_vccz L_d522
  s_waitcnt vmcnt(4)
L_d522:
  s_xor_b32 s68, s70, 0x20000
  buffer_load_dwordx4 v[64:67], v63, s[12:15], s68 offen nt
  s_waitcnt vmcnt(5)
  v_dot2_f32_bf16 v25, v108, v4, 0
  v_dot2_f32_bf16 v25, v109, v5, v25
  v_dot2_f32_bf16 v25, v110, v6, v25
  v_dot2_f32_bf16 v25, v111, v7, v25
  s_cbranch_vccz L_d523
  s_waitcnt vmcnt(4)
L_d523:
  s_xor_b32 s68, s70, 0x20100
  buffer_load_dwordx4 v[68:71], v63, s[12:15], s68 offen nt
  v_add_f32_dpp v26, v22, v22 row_ror:8 row_mask:0xf bank_mask:0x3
  v_add_f32_dpp v27, v24, v24 row_ror:8 row_mask:0xf bank_mask:0x3
  s_nop 0
  v_add_f32_dpp v26, v23, v23 row_ror:8 row_mask:0xf bank_mask:0xc
  v_add_f32_dpp v27, v25, v25 row_ror:8 row_mask:0xf bank_mask:0xc
  s_nop 0
  v_add_f32_dpp v28, v26, v26 row_half_mirror row_mask:0xf bank_mask:0x5
  s_nop 1
  v_add_f32_dpp v28, v27, v27 row_half_mirror row_mask:0xf bank_mask:0xa
  s_nop 1
  v_add_f32_dpp v28, v28, v28 quad_perm:[1,0,3,2]
  s_nop 1
  v_add_f32_dpp v194, v28, v28 quad_perm:[2,3,0,1]
  v_max_f32 v20, v20, v194
  s_barrier
  s_waitcnt vmcnt(5)
  v_dot2_f32_bf16 v22, v112, v4, 0
  v_dot2_f32_bf16 v22, v113, v5, v22
  v_dot2_f32_bf16 v22, v114, v6, v22
  v_dot2_f32_bf16 v22, v115, v7, v22
  s_cbranch_vccz L_d524
  s_waitcnt vmcnt(4)
L_d524:
  s_xor_b32 s68, s70, 0x20400
  buffer_load_dwordx4 v[72:75], v63, s[12:15], s68 offen nt
  s_waitcnt vmcnt(5)
  v_dot2_f32_bf16 v23, v116, v4, 0
  v_dot2_f32_bf16 v23, v117, v5, v23
  v_dot2_f32_bf16 v23, v118, v6, v23
  v_dot2_f32_bf16 v23, v119, v7, v23
  s_cbranch_vccz L_d525
  s_waitcnt vmcnt(4)
L_d525:
  s_xor_b32 s68, s70, 0x20500
  buffer_load_dwordx4 v[76:79], v63, s[12:15], s68 offen nt
  s_waitcnt vmcnt(5)
  v_dot2_f32_bf16 v24, v120, v4, 0
  v_dot2_f32_bf16 v24, v121, v5, v24
  v_dot2_f32_bf16 v24, v122, v6, v24
  v_dot2_f32_bf16 v24, v123, v7, v24
  s_cbranch_vccz L_d526
  s_waitcnt vmcnt(4)
L_d526:
  s_xor_b32 s68, s70, 0x20800
  buffer_load_dwordx4 v[80:83], v63, s[12:15], s68 offen nt
  s_waitcnt vmcnt(5)
  v_dot2_f32_bf16 v25, v124, v4, 0
  v_dot2_f32_bf16 v25, v125, v5, v25
  v_dot2_f32_bf16 v25, v126, v6, v25
  v_dot2_f32_bf16 v25, v127, v7, v25
  s_cbranch_vccz L_d527
  s_waitcnt vmcnt(4)
L_d527:
  s_xor_b32 s68, s70, 0x20900
  buffer_load_dwordx4 v[84:87], v63, s[12:15], s68 offen nt
  v_add_f32_dpp v26, v22, v22 row_ror:8 row_mask:0xf bank_mask:0x3
  v_add_f32_dpp v27, v24, v24 row_ror:8 row_mask:0xf bank_mask:0x3
  s_nop 0
  v_add_f32_dpp v26, v23, v23 row_ror:8 row_mask:0xf bank_mask:0xc
  v_add_f32_dpp v27, v25, v25 row_ror:8 row_mask:0xf bank_mask:0xc
  s_nop 0
  v_add_f32_dpp v28, v26, v26 row_half_mirror row_mask:0xf bank_mask:0x5
  s_nop 1
  v_add_f32_dpp v28, v27, v27 row_half_mirror row_mask:0xf bank_mask:0xa
  s_nop 1
  v_add_f32_dpp v28, v28, v28 quad_perm:[1,0,3,2]
  s_nop 1
  v_add_f32_dpp v195, v28, v28 quad_perm:[2,3,0,1]
  v_max_f32 v20, v20, v195
  s_barrier
  s_waitcnt vmcnt(5)
  v_dot2_f32_bf16 v22, v64, v4, 0
  v_dot2_f32_bf16 v22, v65, v5, v22
  v_dot2_f32_bf16 v22, v66, v6, v22
  v_dot2_f32_bf16 v22, v67, v7, v22
  s_cbranch_vccz L_d528
  s_waitcnt vmcnt(4)
L_d528:
  s_xor_b32 s68, s70, 0x20c00
  buffer_load_dwordx4 v[88:91], v63, s[12:15], s68 offen nt
  s_waitcnt vmcnt(5)
  v_dot2_f32_bf16 v23, v68, v4, 0
  v_dot2_f32_bf16 v23, v69, v5, v23
  v_dot2_f32_bf16 v23, v70, v6, v23
  v_dot2_f32_bf16 v23, v71, v7, v23
  s_cbranch_vccz L_d529
  s_waitcnt vmcnt(4)
L_d529:
  s_xor_b32 s68, s70, 0x20d00
  buffer_load_dwordx4 v[92:95], v63, s[12:15], s68 offen nt
  s_waitcnt vmcnt(5)
  v_dot2_f32_bf16 v24, v72, v4, 0
  v_dot2_f32_bf16 v24, v73, v5, v24
  v_dot2_f32_bf16 v24, v74, v6, v24
  v_dot2_f32_bf16 v24, v75, v7, v24
  s_cbranch_vccz L_d530
  s_waitcnt vmcnt(4)
L_d530:
  s_xor_b32 s68, s70, 0x30000
  buffer_load_dwordx4 v[96:99], v63, s[12:15], s68 offen nt
  s_waitcnt vmcnt(5)
  v_dot2_f32_bf16 v25, v76, v4, 0
  v_dot2_f32_bf16 v25, v77, v5, v25
  v_dot2_f32_bf16 v25, v78, v6, v25
  v_dot2_f32_bf16 v25, v79, v7, v25
  s_cbranch_vccz L_d531
  s_waitcnt vmcnt(4)
L_d531:
  s_xor_b32 s68, s70, 0x30100
  buffer_load_dwordx4 v[100:103], v63, s[12:15], s68 offen nt
  v_add_f32_dpp v26, v22, v22 row_ror:8 row_mask:0xf bank_mask:0x3
  v_add_f32_dpp v27, v24, v24 row_ror:8 row_mask:0xf bank_mask:0x3
  s_nop 0
  v_add_f32_dpp v26, v23, v23 row_ror:8 row_mask:0xf bank_mask:0xc
  v_add_f32_dpp v27, v25, v25 row_ror:8 row_mask:0xf bank_mask:0xc
  s_nop 0
  v_add_f32_dpp v28, v26, v26 row_half_mirror row_mask:0xf bank_mask:0x5
  s_nop 1
  v_add_f32_dpp v28, v27, v27 row_half_mirror row_mask:0xf bank_mask:0xa
  s_nop 1
  v_add_f32_dpp v28, v28, v28 quad_perm:[1,0,3,2]
  s_nop 1
  v_add_f32_dpp v196, v28, v28 quad_perm:[2,3,0,1]
  v_max_f32 v20, v20, v196
  s_barrier
  v_lshrrev_b32 v27, 4, v1
  s_lshl_b32 s38, s74, 1
  v_add_u32 v27, s38, v27
  v_and_b32 v27, 15, v27
  v_lshrrev_b32 v161, 8, v1
  v_and_b32 v26, 1, v161
  v_lshrrev_b32 v161, 1, v161
  v_lshlrev_b32 v161, 2, v161
  v_lshl_add_u32 v161, v26, 8, v161
  v_lshl_add_u32 v161, v27, 3, v161
  v_bfe_u32 v26, v1, 6, 1
  v_mul_u32_u24 v165, 0xffff, v26
  v_xor_b32 v164, 0xffff, v165
  v_bfe_u32 v26, v1, 4, 2
  v_xor_b32 v27, 1, v26
  v_lshl_add_u32 v26, v27, 2, v26
  v_mul_u32_u24 v166, 0x1111, v26
  s_waitcnt lgkmcnt(0)
  s_barrier
  v_mov_b32 v26, 0
  ds_read_b128 v[128:131], v26 offset:8192
  ds_read_b128 v[132:135], v26 offset:8208
  ds_read_b32 v136, v161 offset:4096
  ds_read_b32 v137, v161 offset:4224
  ds_read_b32 v138, v161 offset:4608
  ds_read_b32 v139, v161 offset:4736
  ds_read_b32 v140, v161 offset:5120
  ds_read_b32 v141, v161 offset:5248
  ds_read_b32 v142, v161 offset:5632
  ds_read_b32 v143, v161 offset:5760
  v_mov_b32 v56, 0
  v_mov_b32 v57, 0
  v_mov_b32 v58, 0
  v_mov_b32 v59, 0
  v_mov_b32 v176, 0
  v_mov_b32 v177, 0
  v_mov_b32 v178, 0
  v_mov_b32 v179, 0
  s_waitcnt lgkmcnt(8)
  v_max3_f32 v26, v128, v130, v132
  v_max_f32 v26, v26, v134
  v_mul_f32 v26, s71, v26
  v_fma_f32 v128, v128, s71, -v26
  v_fma_f32 v130, v130, s71, -v26
  v_fma_f32 v132, v132, s71, -v26
  v_fma_f32 v134, v134, s71, -v26
  v_exp_f32 v128, v128
  v_exp_f32 v130, v130
  v_exp_f32 v132, v132
  v_exp_f32 v134, v134
  v_mul_f32 v26, v128, v129
  v_fmac_f32 v26, v130, v131
  v_fmac_f32 v26, v132, v133
  v_fmac_f32 v26, v134, v135
  v_rcp_f32 v26, v26
  s_waitcnt lgkmcnt(0)
  v_mul_f32 v162, v128, v136
  v_fmac_f32 v162, v130, v138
  v_fmac_f32 v162, v132, v140
  v_fmac_f32 v162, v134, v142
  v_mul_f32 v163, v128, v137
  v_fmac_f32 v163, v130, v139
  v_fmac_f32 v163, v132, v141
  v_fmac_f32 v163, v134, v143
  v_mul_f32 v162, v162, v26
  v_mul_f32 v163, v163, v26
  v_cvt_pk_bf16_f32 v162, v162, v162
  v_cvt_pk_bf16_f32 v163, v163, v163
  s_waitcnt vmcnt(5)
  v_dot2_f32_bf16 v22, v80, v4, 0
  v_dot2_f32_bf16 v22, v81, v5, v22
  v_dot2_f32_bf16 v22, v82, v6, v22
  v_dot2_f32_bf16 v22, v83, v7, v22
  s_cbranch_vccz L_d532
  s_waitcnt vmcnt(4)
L_d532:
  s_xor_b32 s68, s70, 0x30400
  buffer_load_dwordx4 v[104:107], v63, s[12:15], s68 offen nt
  v_and_b32_dpp v48, v162, v164 row_newbcast:0
  v_and_b32_dpp v49, v162, v165 row_newbcast:0
  v_and_b32_dpp v50, v163, v164 row_newbcast:0
  v_and_b32_dpp v51, v163, v165 row_newbcast:0
  s_nop 1
  v_smfmac_f32_16x16x64_bf16 v[56:59], v[48:51], a[0:7], v166
  v_smfmac_f32_16x16x64_bf16 v[176:179], v[48:51], a[8:15], v166
  s_waitcnt vmcnt(5)
  v_dot2_f32_bf16 v23, v84, v4, 0
  v_dot2_f32_bf16 v23, v85, v5, v23
  v_dot2_f32_bf16 v23, v86, v6, v23
  v_dot2_f32_bf16 v23, v87, v7, v23
  s_cbranch_vccz L_d533
  s_waitcnt vmcnt(4)
L_d533:
  s_xor_b32 s68, s70, 0x30500
  buffer_load_dwordx4 v[108:111], v63, s[12:15], s68 offen nt
  s_waitcnt vmcnt(5)
  v_dot2_f32_bf16 v24, v88, v4, 0
  v_dot2_f32_bf16 v24, v89, v5, v24
  v_dot2_f32_bf16 v24, v90, v6, v24
  v_dot2_f32_bf16 v24, v91, v7, v24
  s_cbranch_vccz L_d534
  s_waitcnt vmcnt(4)
L_d534:
  s_xor_b32 s68, s70, 0x30800
  buffer_load_dwordx4 v[112:115], v63, s[12:15], s68 offen nt
  s_waitcnt vmcnt(5)
  v_dot2_f32_bf16 v25, v92, v4, 0
  v_dot2_f32_bf16 v25, v93, v5, v25
  v_dot2_f32_bf16 v25, v94, v6, v25
  v_dot2_f32_bf16 v25, v95, v7, v25
  s_cbranch_vccz L_d535
  s_waitcnt vmcnt(4)
L_d535:
  s_xor_b32 s68, s70, 0x30900
  buffer_load_dwordx4 v[116:119], v63, s[12:15], s68 offen nt
  v_add_f32_dpp v26, v22, v22 row_ror:8 row_mask:0xf bank_mask:0x3
  v_add_f32_dpp v27, v24, v24 row_ror:8 row_mask:0xf bank_mask:0x3
  s_nop 0
  v_add_f32_dpp v26, v23, v23 row_ror:8 row_mask:0xf bank_mask:0xc
  v_add_f32_dpp v27, v25, v25 row_ror:8 row_mask:0xf bank_mask:0xc
  s_nop 0
  v_add_f32_dpp v28, v26, v26 row_half_mirror row_mask:0xf bank_mask:0x5
  s_nop 1
  v_add_f32_dpp v28, v27, v27 row_half_mirror row_mask:0xf bank_mask:0xa
  s_nop 1
  v_add_f32_dpp v28, v28, v28 quad_perm:[1,0,3,2]
  s_nop 1
  v_add_f32_dpp v197, v28, v28 quad_perm:[2,3,0,1]
  v_max_f32 v20, v20, v197
  s_barrier
  s_waitcnt vmcnt(5)
  v_dot2_f32_bf16 v22, v96, v4, 0
  v_dot2_f32_bf16 v22, v97, v5, v22
  v_dot2_f32_bf16 v22, v98, v6, v22
  v_dot2_f32_bf16 v22, v99, v7, v22
  s_cbranch_vccz L_d536
  s_waitcnt vmcnt(4)
L_d536:
  s_xor_b32 s68, s70, 0x30c00
  buffer_load_dwordx4 v[120:123], v63, s[12:15], s68 offen nt
  v_and_b32_dpp v52, v162, v164 row_newbcast:1
  v_and_b32_dpp v53, v162, v165 row_newbcast:1
  v_and_b32_dpp v54, v163, v164 row_newbcast:1
  v_and_b32_dpp v55, v163, v165 row_newbcast:1
  s_nop 1
  v_smfmac_f32_16x16x64_bf16 v[56:59], v[52:55], a[16:23], v166
  v_smfmac_f32_16x16x64_bf16 v[176:179], v[52:55], a[24:31], v166
  s_cmp_eq_u32 s64, 3
  s_cbranch_scc0 L_wp134
  s_mov_b32 s100, 11
  s_atomic_umax s100, s[20:21], s88
  s_and_b32 s60, s88, 0xfffffc7f
  s_xor_b32 s61, s60, 4096
  s_add_u32 s38, s61, 0
  s_load_dword s40, s[20:21], s38 glc
  s_add_u32 s38, s60, 128
  s_load_dword s41, s[20:21], s38 glc
  s_add_u32 s38, s60, 256
  s_load_dword s42, s[20:21], s38 glc
  s_add_u32 s38, s61, 384
  s_load_dword s43, s[20:21], s38 glc
  s_add_u32 s38, s61, 512
  s_load_dword s44, s[20:21], s38 glc
  s_add_u32 s38, s60, 640
  s_load_dword s45, s[20:21], s38 glc
  s_add_u32 s38, s60, 768
  s_load_dword s46, s[20:21], s38 glc
  s_add_u32 s38, s61, 896
  s_load_dword s47, s[20:21], s38 glc
L_wp134:
  s_waitcnt vmcnt(5)
  v_dot2_f32_bf16 v23, v100, v4, 0
  v_dot2_f32_bf16 v23, v101, v5, v23
  v_dot2_f32_bf16 v23, v102, v6, v23
  v_dot2_f32_bf16 v23, v103, v7, v23
  s_cbranch_vccz L_d537
  s_waitcnt vmcnt(4)
L_d537:
  s_xor_b32 s68, s70, 0x30d00
  buffer_load_dwordx4 v[124:127], v63, s[12:15], s68 offen nt
  s_waitcnt vmcnt(5)
  v_dot2_f32_bf16 v24, v104, v4, 0
  v_dot2_f32_bf16 v24, v105, v5, v24
  v_dot2_f32_bf16 v24, v106, v6, v24
  v_dot2_f32_bf16 v24, v107, v7, v24
  s_cbranch_vccz L_d538
  s_waitcnt vmcnt(4)
L_d538:
  s_xor_b32 s68, s70, 0x80000
  buffer_load_dwordx4 v[64:67], v63, s[12:15], s68 offen nt
  s_waitcnt vmcnt(5)
  v_dot2_f32_bf16 v25, v108, v4, 0
  v_dot2_f32_bf16 v25, v109, v5, v25
  v_dot2_f32_bf16 v25, v110, v6, v25
  v_dot2_f32_bf16 v25, v111, v7, v25
  s_cbranch_vccz L_d539
  s_waitcnt vmcnt(4)
L_d539:
  s_xor_b32 s68, s70, 0x80100
  buffer_load_dwordx4 v[68:71], v63, s[12:15], s68 offen nt
  v_add_f32_dpp v26, v22, v22 row_ror:8 row_mask:0xf bank_mask:0x3
  v_add_f32_dpp v27, v24, v24 row_ror:8 row_mask:0xf bank_mask:0x3
  s_nop 0
  v_add_f32_dpp v26, v23, v23 row_ror:8 row_mask:0xf bank_mask:0xc
  v_add_f32_dpp v27, v25, v25 row_ror:8 row_mask:0xf bank_mask:0xc
  s_nop 0
  v_add_f32_dpp v28, v26, v26 row_half_mirror row_mask:0xf bank_mask:0x5
  s_nop 1
  v_add_f32_dpp v28, v27, v27 row_half_mirror row_mask:0xf bank_mask:0xa
  s_nop 1
  v_add_f32_dpp v28, v28, v28 quad_perm:[1,0,3,2]
  s_nop 1
  v_add_f32_dpp v198, v28, v28 quad_perm:[2,3,0,1]
  v_max_f32 v20, v20, v198
  s_barrier
  s_waitcnt vmcnt(5)
  v_dot2_f32_bf16 v22, v112, v4, 0
  v_dot2_f32_bf16 v22, v113, v5, v22
  v_dot2_f32_bf16 v22, v114, v6, v22
  v_dot2_f32_bf16 v22, v115, v7, v22
  s_cbranch_vccz L_d540
  s_waitcnt vmcnt(4)
L_d540:
  s_xor_b32 s68, s70, 0x80400
  buffer_load_dwordx4 v[72:75], v63, s[12:15], s68 offen nt
  v_and_b32_dpp v48, v162, v164 row_newbcast:2
  v_and_b32_dpp v49, v162, v165 row_newbcast:2
  v_and_b32_dpp v50, v163, v164 row_newbcast:2
  v_and_b32_dpp v51, v163, v165 row_newbcast:2
  s_nop 1
  v_smfmac_f32_16x16x64_bf16 v[56:59], v[48:51], a[32:39], v166
  v_smfmac_f32_16x16x64_bf16 v[176:179], v[48:51], a[40:47], v166
  s_waitcnt vmcnt(5)
  v_dot2_f32_bf16 v23, v116, v4, 0
  v_dot2_f32_bf16 v23, v117, v5, v23
  v_dot2_f32_bf16 v23, v118, v6, v23
  v_dot2_f32_bf16 v23, v119, v7, v23
  s_cbranch_vccz L_d541
  s_waitcnt vmcnt(4)
L_d541:
  s_xor_b32 s68, s70, 0x80500
  buffer_load_dwordx4 v[76:79], v63, s[12:15], s68 offen nt
  s_waitcnt vmcnt(5)
  v_dot2_f32_bf16 v24, v120, v4, 0
  v_dot2_f32_bf16 v24, v121, v5, v24
  v_dot2_f32_bf16 v24, v122, v6, v24
  v_dot2_f32_bf16 v24, v123, v7, v24
  s_cbranch_vccz L_d542
  s_waitcnt vmcnt(4)
L_d542:
  s_xor_b32 s68, s70, 0x80800
  buffer_load_dwordx4 v[80:83], v63, s[12:15], s68 offen nt
  s_mov_b32 s24, s58
  s_mov_b32 s25, s59
  s_lshl_b32 s38, s65, 18
  s_lshl_b32 s84, s64, 9
  s_add_u32 s84, s84, s38
  s_lshl_b32 s73, s74, 13
  s_add_u32 s73, s73, s84
  buffer_load_dwordx4 a[0:3], v3, s[24:27], s73 offen offset:0
  buffer_load_dwordx4 a[8:11], v3, s[24:27], s73 offen offset:256
  buffer_load_dwordx4 a[4:7], v3, s[24:27], s73 offen offset:2048
  buffer_load_dwordx4 a[12:15], v3, s[24:27], s73 offen offset:2304
  s_add_u32 s73, s73, 4096
  buffer_load_dwordx4 a[16:19], v3, s[24:27], s73 offen offset:0
  buffer_load_dwordx4 a[24:27], v3, s[24:27], s73 offen offset:256
  buffer_load_dwordx4 a[20:23], v3, s[24:27], s73 offen offset:2048
  buffer_load_dwordx4 a[28:31], v3, s[24:27], s73 offen offset:2304
  s_add_u32 s73, s73, 4096
  s_waitcnt vmcnt(13)
  v_dot2_f32_bf16 v25, v124, v4, 0
  v_dot2_f32_bf16 v25, v125, v5, v25
  v_dot2_f32_bf16 v25, v126, v6, v25
  v_dot2_f32_bf16 v25, v127, v7, v25
  s_cbranch_vccz L_d543
  s_waitcnt vmcnt(12)
L_d543:
  s_xor_b32 s68, s70, 0x80900
  buffer_load_dwordx4 v[84:87], v63, s[12:15], s68 offen nt
  v_add_f32_dpp v26, v22, v22 row_ror:8 row_mask:0xf bank_mask:0x3
  v_add_f32_dpp v27, v24, v24 row_ror:8 row_mask:0xf bank_mask:0x3
  s_nop 0
  v_add_f32_dpp v26, v23, v23 row_ror:8 row_mask:0xf bank_mask:0xc
  v_add_f32_dpp v27, v25, v25 row_ror:8 row_mask:0xf bank_mask:0xc
  s_nop 0
  v_add_f32_dpp v28, v26, v26 row_half_mirror row_mask:0xf bank_mask:0x5
  s_nop 1
  v_add_f32_dpp v28, v27, v27 row_half_mirror row_mask:0xf bank_mask:0xa
  s_nop 1
  v_add_f32_dpp v28, v28, v28 quad_perm:[1,0,3,2]
  s_nop 1
  v_add_f32_dpp v199, v28, v28 quad_perm:[2,3,0,1]
  v_max_f32 v20, v20, v199
  s_barrier
  s_waitcnt vmcnt(13)
  v_dot2_f32_bf16 v22, v64, v4, 0
  v_dot2_f32_bf16 v22, v65, v5, v22
  v_dot2_f32_bf16 v22, v66, v6, v22
  v_dot2_f32_bf16 v22, v67, v7, v22
  s_cbranch_vccz L_d544
  s_waitcnt vmcnt(12)
L_d544:
  s_xor_b32 s68, s70, 0x80c00
  buffer_load_dwordx4 v[88:91], v63, s[12:15], s68 offen nt
  v_and_b32_dpp v52, v162, v164 row_newbcast:3
  v_and_b32_dpp v53, v162, v165 row_newbcast:3
  v_and_b32_dpp v54, v163, v164 row_newbcast:3
  v_and_b32_dpp v55, v163, v165 row_newbcast:3
  s_nop 1
  v_smfmac_f32_16x16x64_bf16 v[56:59], v[52:55], a[48:55], v166
  v_smfmac_f32_16x16x64_bf16 v[176:179], v[52:55], a[56:63], v166
  s_cmp_eq_u32 s64, 3
  s_cbranch_scc0 L_wp136
  s_mov_b32 s101, 0
  s_waitcnt lgkmcnt(0)
  s_cmp_ge_u32 s40, 11
  s_addc_u32 s101, s101, 0
  s_cmp_ge_u32 s41, 11
  s_addc_u32 s101, s101, 0
  s_cmp_ge_u32 s42, 11
  s_addc_u32 s101, s101, 0
  s_cmp_ge_u32 s43, 11
  s_addc_u32 s101, s101, 0
  s_cmp_ge_u32 s44, 11
  s_addc_u32 s101, s101, 0
  s_cmp_ge_u32 s45, 11
  s_addc_u32 s101, s101, 0
  s_cmp_ge_u32 s46, 11
  s_addc_u32 s101, s101, 0
  s_cmp_ge_u32 s47, 11
  s_addc_u32 s101, s101, 0
  s_cmp_lt_u32 s101, 6
  s_cselect_b32 s38, -1, 0
  v_mov_b32 v26, 0
  v_mov_b32 v27, s38
  ds_write_b32 v26, v27 offset:8512
L_wp136:
  s_waitcnt vmcnt(13)
  v_dot2_f32_bf16 v23, v68, v4, 0
  v_dot2_f32_bf16 v23, v69, v5, v23
  v_dot2_f32_bf16 v23, v70, v6, v23
  v_dot2_f32_bf16 v23, v71, v7, v23
  s_cbranch_vccz L_d545
  s_waitcnt vmcnt(12)
L_d545:
  s_xor_b32 s68, s70, 0x80d00
  buffer_load_dwordx4 v[92:95], v63, s[12:15], s68 offen nt
  s_waitcnt vmcnt(13)
  v_dot2_f32_bf16 v24, v72, v4, 0
  v_dot2_f32_bf16 v24, v73, v5, v24
  v_dot2_f32_bf16 v24, v74, v6, v24
  v_dot2_f32_bf16 v24, v75, v7, v24
  s_cbranch_vccz L_d546
  s_waitcnt vmcnt(12)
L_d546:
  s_xor_b32 s68, s70, 0x90000
  buffer_load_dwordx4 v[96:99], v63, s[12:15], s68 offen nt
  s_waitcnt vmcnt(13)
  v_dot2_f32_bf16 v25, v76, v4, 0
  v_dot2_f32_bf16 v25, v77, v5, v25
  v_dot2_f32_bf16 v25, v78, v6, v25
  v_dot2_f32_bf16 v25, v79, v7, v25
  s_cbranch_vccz L_d547
  s_waitcnt vmcnt(12)
L_d547:
  s_xor_b32 s68, s70, 0x90100
  buffer_load_dwordx4 v[100:103], v63, s[12:15], s68 offen nt
  v_add_f32_dpp v26, v22, v22 row_ror:8 row_mask:0xf bank_mask:0x3
  v_add_f32_dpp v27, v24, v24 row_ror:8 row_mask:0xf bank_mask:0x3
  s_nop 0
  v_add_f32_dpp v26, v23, v23 row_ror:8 row_mask:0xf bank_mask:0xc
  v_add_f32_dpp v27, v25, v25 row_ror:8 row_mask:0xf bank_mask:0xc
  s_nop 0
  v_add_f32_dpp v28, v26, v26 row_half_mirror row_mask:0xf bank_mask:0x5
  s_nop 1
  v_add_f32_dpp v28, v27, v27 row_half_mirror row_mask:0xf bank_mask:0xa
  s_nop 1
  v_add_f32_dpp v28, v28, v28 quad_perm:[1,0,3,2]
  s_nop 1
  v_add_f32_dpp v200, v28, v28 quad_perm:[2,3,0,1]
  v_max_f32 v20, v20, v200
  s_barrier
  s_waitcnt vmcnt(13)
  v_dot2_f32_bf16 v22, v80, v4, 0
  v_dot2_f32_bf16 v22, v81, v5, v22
  v_dot2_f32_bf16 v22, v82, v6, v22
  v_dot2_f32_bf16 v22, v83, v7, v22
  s_cbranch_vccz L_d548
  s_waitcnt vmcnt(4)
L_d548:
  s_xor_b32 s68, s70, 0x90400
  buffer_load_dwordx4 v[104:107], v63, s[12:15], s68 offen nt
  v_and_b32_dpp v48, v162, v164 row_newbcast:4
  v_and_b32_dpp v49, v162, v165 row_newbcast:4
  v_and_b32_dpp v50, v163, v164 row_newbcast:4
  v_and_b32_dpp v51, v163, v165 row_newbcast:4
  s_nop 1
  v_smfmac_f32_16x16x64_bf16 v[56:59], v[48:51], a[64:71], v166
  v_smfmac_f32_16x16x64_bf16 v[176:179], v[48:51], a[72:79], v166
  v_mov_b32 v26, 0
  ds_read_b32 v35, v26 offset:8512
  s_waitcnt vmcnt(5)
  v_dot2_f32_bf16 v23, v84, v4, 0
  v_dot2_f32_bf16 v23, v85, v5, v23
  v_dot2_f32_bf16 v23, v86, v6, v23
  v_dot2_f32_bf16 v23, v87, v7, v23
  s_cbranch_vccz L_d549
  s_waitcnt vmcnt(4)
L_d549:
  s_xor_b32 s68, s70, 0x90500
  buffer_load_dwordx4 v[108:111], v63, s[12:15], s68 offen nt
  s_waitcnt vmcnt(5)
  v_dot2_f32_bf16 v24, v88, v4, 0
  v_dot2_f32_bf16 v24, v89, v5, v24
  v_dot2_f32_bf16 v24, v90, v6, v24
  v_dot2_f32_bf16 v24, v91, v7, v24
  s_cbranch_vccz L_d550
  s_waitcnt vmcnt(4)
L_d550:
  s_xor_b32 s68, s70, 0x90800
  buffer_load_dwordx4 v[112:115], v63, s[12:15], s68 offen nt
  s_waitcnt vmcnt(5)
  v_dot2_f32_bf16 v25, v92, v4, 0
  v_dot2_f32_bf16 v25, v93, v5, v25
  v_dot2_f32_bf16 v25, v94, v6, v25
  v_dot2_f32_bf16 v25, v95, v7, v25
  s_cbranch_vccz L_d551
  s_waitcnt vmcnt(4)
L_d551:
  s_xor_b32 s68, s70, 0x90900
  buffer_load_dwordx4 v[116:119], v63, s[12:15], s68 offen nt
  v_add_f32_dpp v26, v22, v22 row_ror:8 row_mask:0xf bank_mask:0x3
  v_add_f32_dpp v27, v24, v24 row_ror:8 row_mask:0xf bank_mask:0x3
  s_nop 0
  v_add_f32_dpp v26, v23, v23 row_ror:8 row_mask:0xf bank_mask:0xc
  v_add_f32_dpp v27, v25, v25 row_ror:8 row_mask:0xf bank_mask:0xc
  s_nop 0
  v_add_f32_dpp v28, v26, v26 row_half_mirror row_mask:0xf bank_mask:0x5
  s_nop 1
  v_add_f32_dpp v28, v27, v27 row_half_mirror row_mask:0xf bank_mask:0xa
  s_nop 1
  v_add_f32_dpp v28, v28, v28 quad_perm:[1,0,3,2]
  s_nop 1
  v_add_f32_dpp v201, v28, v28 quad_perm:[2,3,0,1]
  v_max_f32 v20, v20, v201
  s_barrier
  s_waitcnt vmcnt(5)
  v_dot2_f32_bf16 v22, v96, v4, 0
  v_dot2_f32_bf16 v22, v97, v5, v22
  v_dot2_f32_bf16 v22, v98, v6, v22
  v_dot2_f32_bf16 v22, v99, v7, v22
  s_cbranch_vccz L_d552
  s_waitcnt vmcnt(4)
L_d552:
  s_xor_b32 s68, s70, 0x90c00
  buffer_load_dwordx4 v[120:123], v63, s[12:15], s68 offen nt
  v_and_b32_dpp v52, v162, v164 row_newbcast:5
  v_and_b32_dpp v53, v162, v165 row_newbcast:5
  v_and_b32_dpp v54, v163, v164 row_newbcast:5
  v_and_b32_dpp v55, v163, v165 row_newbcast:5
  s_nop 1
  v_smfmac_f32_16x16x64_bf16 v[56:59], v[52:55], a[80:87], v166
  v_smfmac_f32_16x16x64_bf16 v[176:179], v[52:55], a[88:95], v166
  s_waitcnt lgkmcnt(0)
  v_cmp_ne_u32 vcc, 0, v35
  s_waitcnt vmcnt(5)
  v_dot2_f32_bf16 v23, v100, v4, 0
  v_dot2_f32_bf16 v23, v101, v5, v23
  v_dot2_f32_bf16 v23, v102, v6, v23
  v_dot2_f32_bf16 v23, v103, v7, v23
  s_cbranch_vccz L_d553
  s_waitcnt vmcnt(4)
L_d553:
  s_xor_b32 s68, s70, 0x90d00
  buffer_load_dwordx4 v[124:127], v63, s[12:15], s68 offen nt
  s_waitcnt vmcnt(5)
  v_dot2_f32_bf16 v24, v104, v4, 0
  v_dot2_f32_bf16 v24, v105, v5, v24
  v_dot2_f32_bf16 v24, v106, v6, v24
  v_dot2_f32_bf16 v24, v107, v7, v24
  s_cbranch_vccz L_d554
  s_waitcnt vmcnt(4)
L_d554:
  s_xor_b32 s68, s70, 0xa0000
  buffer_load_dwordx4 v[64:67], v63, s[12:15], s68 offen nt
  s_waitcnt vmcnt(5)
  v_dot2_f32_bf16 v25, v108, v4, 0
  v_dot2_f32_bf16 v25, v109, v5, v25
  v_dot2_f32_bf16 v25, v110, v6, v25
  v_dot2_f32_bf16 v25, v111, v7, v25
  s_cbranch_vccz L_d555
  s_waitcnt vmcnt(4)
L_d555:
  s_xor_b32 s68, s70, 0xa0100
  buffer_load_dwordx4 v[68:71], v63, s[12:15], s68 offen nt
  v_add_f32_dpp v26, v22, v22 row_ror:8 row_mask:0xf bank_mask:0x3
  v_add_f32_dpp v27, v24, v24 row_ror:8 row_mask:0xf bank_mask:0x3
  s_nop 0
  v_add_f32_dpp v26, v23, v23 row_ror:8 row_mask:0xf bank_mask:0xc
  v_add_f32_dpp v27, v25, v25 row_ror:8 row_mask:0xf bank_mask:0xc
  s_nop 0
  v_add_f32_dpp v28, v26, v26 row_half_mirror row_mask:0xf bank_mask:0x5
  s_nop 1
  v_add_f32_dpp v28, v27, v27 row_half_mirror row_mask:0xf bank_mask:0xa
  s_nop 1
  v_add_f32_dpp v28, v28, v28 quad_perm:[1,0,3,2]
  s_nop 1
  v_add_f32_dpp v202, v28, v28 quad_perm:[2,3,0,1]
  v_max_f32 v20, v20, v202
  s_barrier
  s_waitcnt vmcnt(5)
  v_dot2_f32_bf16 v22, v112, v4, 0
  v_dot2_f32_bf16 v22, v113, v5, v22
  v_dot2_f32_bf16 v22, v114, v6, v22
  v_dot2_f32_bf16 v22, v115, v7, v22
  s_cbranch_vccz L_d556
  s_waitcnt vmcnt(4)
L_d556:
  s_xor_b32 s68, s70, 0xa0400
  buffer_load_dwordx4 v[72:75], v63, s[12:15], s68 offen nt
  v_and_b32_dpp v48, v162, v164 row_newbcast:6
  v_and_b32_dpp v49, v162, v165 row_newbcast:6
  v_and_b32_dpp v50, v163, v164 row_newbcast:6
  v_and_b32_dpp v51, v163, v165 row_newbcast:6
  s_nop 1
  v_smfmac_f32_16x16x64_bf16 v[56:59], v[48:51], a[96:103], v166
  v_smfmac_f32_16x16x64_bf16 v[176:179], v[48:51], a[104:111], v166
  s_waitcnt vmcnt(5)
  v_dot2_f32_bf16 v23, v116, v4, 0
  v_dot2_f32_bf16 v23, v117, v5, v23
  v_dot2_f32_bf16 v23, v118, v6, v23
  v_dot2_f32_bf16 v23, v119, v7, v23
  s_cbranch_vccz L_d557
  s_waitcnt vmcnt(4)
L_d557:
  s_xor_b32 s68, s70, 0xa0500
  buffer_load_dwordx4 v[76:79], v63, s[12:15], s68 offen nt
  s_waitcnt vmcnt(5)
  v_dot2_f32_bf16 v24, v120, v4, 0
  v_dot2_f32_bf16 v24, v121, v5, v24
  v_dot2_f32_bf16 v24, v122, v6, v24
  v_dot2_f32_bf16 v24, v123, v7, v24
  s_cbranch_vccz L_d558
  s_waitcnt vmcnt(4)
L_d558:
  s_xor_b32 s68, s70, 0xa0800
  buffer_load_dwordx4 v[80:83], v63, s[12:15], s68 offen nt
  s_lshl_b32 s73, s75, 13
  s_add_u32 s73, s73, s84
  buffer_load_dwordx4 a[32:35], v3, s[24:27], s73 offen offset:0
  s_waitcnt vmcnt(6)
  v_dot2_f32_bf16 v25, v124, v4, 0
  v_dot2_f32_bf16 v25, v125, v5, v25
  v_dot2_f32_bf16 v25, v126, v6, v25
  v_dot2_f32_bf16 v25, v127, v7, v25
  s_cbranch_vccz L_d559
  s_waitcnt vmcnt(5)
L_d559:
  s_xor_b32 s68, s70, 0xa0900
  buffer_load_dwordx4 v[84:87], v63, s[12:15], s68 offen nt
  v_add_f32_dpp v26, v22, v22 row_ror:8 row_mask:0xf bank_mask:0x3
  v_add_f32_dpp v27, v24, v24 row_ror:8 row_mask:0xf bank_mask:0x3
  s_nop 0
  v_add_f32_dpp v26, v23, v23 row_ror:8 row_mask:0xf bank_mask:0xc
  v_add_f32_dpp v27, v25, v25 row_ror:8 row_mask:0xf bank_mask:0xc
  s_nop 0
  v_add_f32_dpp v28, v26, v26 row_half_mirror row_mask:0xf bank_mask:0x5
  s_nop 1
  v_add_f32_dpp v28, v27, v27 row_half_mirror row_mask:0xf bank_mask:0xa
  s_nop 1
  v_add_f32_dpp v28, v28, v28 quad_perm:[1,0,3,2]
  s_nop 1
  v_add_f32_dpp v203, v28, v28 quad_perm:[2,3,0,1]
  v_max_f32 v20, v20, v203
  s_barrier
  s_waitcnt vmcnt(6)
  v_dot2_f32_bf16 v22, v64, v4, 0
  v_dot2_f32_bf16 v22, v65, v5, v22
  v_dot2_f32_bf16 v22, v66, v6, v22
  v_dot2_f32_bf16 v22, v67, v7, v22
  s_cbranch_vccz L_d560
  s_waitcnt vmcnt(5)
L_d560:
  s_xor_b32 s68, s70, 0xa0c00
  buffer_load_dwordx4 v[88:91], v63, s[12:15], s68 offen nt
  v_and_b32_dpp v52, v162, v164 row_newbcast:7
  v_and_b32_dpp v53, v162, v165 row_newbcast:7
  v_and_b32_dpp v54, v163, v164 row_newbcast:7
  v_and_b32_dpp v55, v163, v165 row_newbcast:7
  s_nop 1
  v_smfmac_f32_16x16x64_bf16 v[56:59], v[52:55], a[112:119], v166
  v_smfmac_f32_16x16x64_bf16 v[176:179], v[52:55], a[120:127], v166
  s_waitcnt vmcnt(6)
  v_dot2_f32_bf16 v23, v68, v4, 0
  v_dot2_f32_bf16 v23, v69, v5, v23
  v_dot2_f32_bf16 v23, v70, v6, v23
  v_dot2_f32_bf16 v23, v71, v7, v23
  s_cbranch_vccz L_d561
  s_waitcnt vmcnt(5)
L_d561:
  s_xor_b32 s68, s70, 0xa0d00
  buffer_load_dwordx4 v[92:95], v63, s[12:15], s68 offen nt
  s_waitcnt vmcnt(6)
  v_dot2_f32_bf16 v24, v72, v4, 0
  v_dot2_f32_bf16 v24, v73, v5, v24
  v_dot2_f32_bf16 v24, v74, v6, v24
  v_dot2_f32_bf16 v24, v75, v7, v24
  s_cbranch_vccz L_d562
  s_waitcnt vmcnt(5)
L_d562:
  s_xor_b32 s68, s70, 0xb0000
  buffer_load_dwordx4 v[96:99], v63, s[12:15], s68 offen nt
  buffer_load_dwordx4 a[40:43], v3, s[24:27], s73 offen offset:256
  s_waitcnt vmcnt(7)
  v_dot2_f32_bf16 v25, v76, v4, 0
  v_dot2_f32_bf16 v25, v77, v5, v25
  v_dot2_f32_bf16 v25, v78, v6, v25
  v_dot2_f32_bf16 v25, v79, v7, v25
  s_cbranch_vccz L_d563
  s_waitcnt vmcnt(6)
L_d563:
  s_xor_b32 s68, s70, 0xb0100
  buffer_load_dwordx4 v[100:103], v63, s[12:15], s68 offen nt
  v_add_f32_dpp v26, v22, v22 row_ror:8 row_mask:0xf bank_mask:0x3
  v_add_f32_dpp v27, v24, v24 row_ror:8 row_mask:0xf bank_mask:0x3
  s_nop 0
  v_add_f32_dpp v26, v23, v23 row_ror:8 row_mask:0xf bank_mask:0xc
  v_add_f32_dpp v27, v25, v25 row_ror:8 row_mask:0xf bank_mask:0xc
  s_nop 0
  v_add_f32_dpp v28, v26, v26 row_half_mirror row_mask:0xf bank_mask:0x5
  s_nop 1
  v_add_f32_dpp v28, v27, v27 row_half_mirror row_mask:0xf bank_mask:0xa
  s_nop 1
  v_add_f32_dpp v28, v28, v28 quad_perm:[1,0,3,2]
  s_nop 1
  v_add_f32_dpp v204, v28, v28 quad_perm:[2,3,0,1]
  v_max_f32 v20, v20, v204
  s_barrier
  s_waitcnt vmcnt(7)
  v_dot2_f32_bf16 v22, v80, v4, 0
  v_dot2_f32_bf16 v22, v81, v5, v22
  v_dot2_f32_bf16 v22, v82, v6, v22
  v_dot2_f32_bf16 v22, v83, v7, v22
  s_cbranch_vccz L_d564
  s_waitcnt vmcnt(5)
L_d564:
  s_xor_b32 s68, s70, 0xb0400
  buffer_load_dwordx4 v[104:107], v63, s[12:15], s68 offen nt
  v_and_b32_dpp v48, v162, v164 row_newbcast:8
  v_and_b32_dpp v49, v162, v165 row_newbcast:8
  v_and_b32_dpp v50, v163, v164 row_newbcast:8
  v_and_b32_dpp v51, v163, v165 row_newbcast:8
  s_nop 1
  v_smfmac_f32_16x16x64_bf16 v[56:59], v[48:51], a[128:135], v166
  v_smfmac_f32_16x16x64_bf16 v[176:179], v[48:51], a[136:143], v166
  s_waitcnt vmcnt(6)
  v_dot2_f32_bf16 v23, v84, v4, 0
  v_dot2_f32_bf16 v23, v85, v5, v23
  v_dot2_f32_bf16 v23, v86, v6, v23
  v_dot2_f32_bf16 v23, v87, v7, v23
  s_cbranch_vccz L_d565
  s_waitcnt vmcnt(5)
L_d565:
  s_xor_b32 s68, s70, 0xb0500
  buffer_load_dwordx4 v[108:111], v63, s[12:15], s68 offen nt
  s_waitcnt vmcnt(6)
  v_dot2_f32_bf16 v24, v88, v4, 0
  v_dot2_f32_bf16 v24, v89, v5, v24
  v_dot2_f32_bf16 v24, v90, v6, v24
  v_dot2_f32_bf16 v24, v91, v7, v24
  s_cbranch_vccz L_d566
  s_waitcnt vmcnt(5)
L_d566:
  s_xor_b32 s68, s70, 0xb0800
  buffer_load_dwordx4 v[112:115], v63, s[12:15], s68 offen nt
  buffer_load_dwordx4 a[36:39], v3, s[24:27], s73 offen offset:2048
  s_waitcnt vmcnt(7)
  v_dot2_f32_bf16 v25, v92, v4, 0
  v_dot2_f32_bf16 v25, v93, v5, v25
  v_dot2_f32_bf16 v25, v94, v6, v25
  v_dot2_f32_bf16 v25, v95, v7, v25
  s_cbranch_vccz L_d567
  s_waitcnt vmcnt(6)
L_d567:
  s_xor_b32 s68, s70, 0xb0900
  buffer_load_dwordx4 v[116:119], v63, s[12:15], s68 offen nt
  v_add_f32_dpp v26, v22, v22 row_ror:8 row_mask:0xf bank_mask:0x3
  v_add_f32_dpp v27, v24, v24 row_ror:8 row_mask:0xf bank_mask:0x3
  s_nop 0
  v_add_f32_dpp v26, v23, v23 row_ror:8 row_mask:0xf bank_mask:0xc
  v_add_f32_dpp v27, v25, v25 row_ror:8 row_mask:0xf bank_mask:0xc
  s_nop 0
  v_add_f32_dpp v28, v26, v26 row_half_mirror row_mask:0xf bank_mask:0x5
  s_nop 1
  v_add_f32_dpp v28, v27, v27 row_half_mirror row_mask:0xf bank_mask:0xa
  s_nop 1
  v_add_f32_dpp v28, v28, v28 quad_perm:[1,0,3,2]
  s_nop 1
  v_add_f32_dpp v205, v28, v28 quad_perm:[2,3,0,1]
  v_max_f32 v20, v20, v205
  s_barrier
  s_waitcnt vmcnt(7)
  v_dot2_f32_bf16 v22, v96, v4, 0
  v_dot2_f32_bf16 v22, v97, v5, v22
  v_dot2_f32_bf16 v22, v98, v6, v22
  v_dot2_f32_bf16 v22, v99, v7, v22
  s_cbranch_vccz L_d568
  s_waitcnt vmcnt(5)
L_d568:
  s_xor_b32 s68, s70, 0xb0c00
  buffer_load_dwordx4 v[120:123], v63, s[12:15], s68 offen nt
  v_and_b32_dpp v52, v162, v164 row_newbcast:9
  v_and_b32_dpp v53, v162, v165 row_newbcast:9
  v_and_b32_dpp v54, v163, v164 row_newbcast:9
  v_and_b32_dpp v55, v163, v165 row_newbcast:9
  s_nop 1
  v_smfmac_f32_16x16x64_bf16 v[56:59], v[52:55], a[144:151], v166
  v_smfmac_f32_16x16x64_bf16 v[176:179], v[52:55], a[152:159], v166
  s_waitcnt vmcnt(6)
  v_dot2_f32_bf16 v23, v100, v4, 0
  v_dot2_f32_bf16 v23, v101, v5, v23
  v_dot2_f32_bf16 v23, v102, v6, v23
  v_dot2_f32_bf16 v23, v103, v7, v23
  s_cbranch_vccz L_d569
  s_waitcnt vmcnt(5)
L_d569:
  s_xor_b32 s68, s70, 0xb0d00
  buffer_load_dwordx4 v[124:127], v63, s[12:15], s68 offen nt
  s_waitcnt vmcnt(6)
  v_dot2_f32_bf16 v24, v104, v4, 0
  v_dot2_f32_bf16 v24, v105, v5, v24
  v_dot2_f32_bf16 v24, v106, v6, v24
  v_dot2_f32_bf16 v24, v107, v7, v24
  s_cbranch_vccz L_d570
  s_waitcnt vmcnt(5)
L_d570:
  s_xor_b32 s68, s70, 0x40000
  buffer_load_dwordx4 v[64:67], v63, s[12:15], s68 offen nt
  buffer_load_dwordx4 a[44:47], v3, s[24:27], s73 offen offset:2304
  s_add_u32 s73, s73, 4096
  s_waitcnt vmcnt(7)
  v_dot2_f32_bf16 v25, v108, v4, 0
  v_dot2_f32_bf16 v25, v109, v5, v25
  v_dot2_f32_bf16 v25, v110, v6, v25
  v_dot2_f32_bf16 v25, v111, v7, v25
  s_cbranch_vccz L_d571
  s_waitcnt vmcnt(6)
L_d571:
  s_xor_b32 s68, s70, 0x40100
  buffer_load_dwordx4 v[68:71], v63, s[12:15], s68 offen nt
  v_add_f32_dpp v26, v22, v22 row_ror:8 row_mask:0xf bank_mask:0x3
  v_add_f32_dpp v27, v24, v24 row_ror:8 row_mask:0xf bank_mask:0x3
  s_nop 0
  v_add_f32_dpp v26, v23, v23 row_ror:8 row_mask:0xf bank_mask:0xc
  v_add_f32_dpp v27, v25, v25 row_ror:8 row_mask:0xf bank_mask:0xc
  s_nop 0
  v_add_f32_dpp v28, v26, v26 row_half_mirror row_mask:0xf bank_mask:0x5
  s_nop 1
  v_add_f32_dpp v28, v27, v27 row_half_mirror row_mask:0xf bank_mask:0xa
  s_nop 1
  v_add_f32_dpp v28, v28, v28 quad_perm:[1,0,3,2]
  s_nop 1
  v_add_f32_dpp v206, v28, v28 quad_perm:[2,3,0,1]
  v_max_f32 v20, v20, v206
  s_barrier
  s_waitcnt vmcnt(7)
  v_dot2_f32_bf16 v22, v112, v4, 0
  v_dot2_f32_bf16 v22, v113, v5, v22
  v_dot2_f32_bf16 v22, v114, v6, v22
  v_dot2_f32_bf16 v22, v115, v7, v22
  s_cbranch_vccz L_d572
  s_waitcnt vmcnt(5)
L_d572:
  s_xor_b32 s68, s70, 0x40400
  buffer_load_dwordx4 v[72:75], v63, s[12:15], s68 offen nt
  v_and_b32_dpp v48, v162, v164 row_newbcast:10
  v_and_b32_dpp v49, v162, v165 row_newbcast:10
  v_and_b32_dpp v50, v163, v164 row_newbcast:10
  v_and_b32_dpp v51, v163, v165 row_newbcast:10
  s_nop 1
  v_smfmac_f32_16x16x64_bf16 v[56:59], v[48:51], a[160:167], v166
  v_smfmac_f32_16x16x64_bf16 v[176:179], v[48:51], a[168:175], v166
  s_waitcnt vmcnt(6)
  v_dot2_f32_bf16 v23, v116, v4, 0
  v_dot2_f32_bf16 v23, v117, v5, v23
  v_dot2_f32_bf16 v23, v118, v6, v23
  v_dot2_f32_bf16 v23, v119, v7, v23
  s_cbranch_vccz L_d573
  s_waitcnt vmcnt(5)
L_d573:
  s_xor_b32 s68, s70, 0x40500
  buffer_load_dwordx4 v[76:79], v63, s[12:15], s68 offen nt
  s_waitcnt vmcnt(6)
  v_dot2_f32_bf16 v24, v120, v4, 0
  v_dot2_f32_bf16 v24, v121, v5, v24
  v_dot2_f32_bf16 v24, v122, v6, v24
  v_dot2_f32_bf16 v24, v123, v7, v24
  s_cbranch_vccz L_d574
  s_waitcnt vmcnt(5)
L_d574:
  s_xor_b32 s68, s70, 0x40800
  buffer_load_dwordx4 v[80:83], v63, s[12:15], s68 offen nt
  buffer_load_dwordx4 a[48:51], v3, s[24:27], s73 offen offset:0
  s_waitcnt vmcnt(7)
  v_dot2_f32_bf16 v25, v124, v4, 0
  v_dot2_f32_bf16 v25, v125, v5, v25
  v_dot2_f32_bf16 v25, v126, v6, v25
  v_dot2_f32_bf16 v25, v127, v7, v25
  s_cbranch_vccz L_d575
  s_waitcnt vmcnt(6)
L_d575:
  s_xor_b32 s68, s70, 0x40900
  buffer_load_dwordx4 v[84:87], v63, s[12:15], s68 offen nt
  v_add_f32_dpp v26, v22, v22 row_ror:8 row_mask:0xf bank_mask:0x3
  v_add_f32_dpp v27, v24, v24 row_ror:8 row_mask:0xf bank_mask:0x3
  s_nop 0
  v_add_f32_dpp v26, v23, v23 row_ror:8 row_mask:0xf bank_mask:0xc
  v_add_f32_dpp v27, v25, v25 row_ror:8 row_mask:0xf bank_mask:0xc
  s_nop 0
  v_add_f32_dpp v28, v26, v26 row_half_mirror row_mask:0xf bank_mask:0x5
  s_nop 1
  v_add_f32_dpp v28, v27, v27 row_half_mirror row_mask:0xf bank_mask:0xa
  s_nop 1
  v_add_f32_dpp v28, v28, v28 quad_perm:[1,0,3,2]
  s_nop 1
  v_add_f32_dpp v207, v28, v28 quad_perm:[2,3,0,1]
  v_max_f32 v20, v20, v207
  s_barrier
  s_waitcnt vmcnt(7)
  v_dot2_f32_bf16 v22, v64, v4, 0
  v_dot2_f32_bf16 v22, v65, v5, v22
  v_dot2_f32_bf16 v22, v66, v6, v22
  v_dot2_f32_bf16 v22, v67, v7, v22
  s_cbranch_vccz L_d576
  s_waitcnt vmcnt(5)
L_d576:
  s_xor_b32 s68, s70, 0x40c00
  buffer_load_dwordx4 v[88:91], v63, s[12:15], s68 offen nt
  v_and_b32_dpp v52, v162, v164 row_newbcast:11
  v_and_b32_dpp v53, v162, v165 row_newbcast:11
  v_and_b32_dpp v54, v163, v164 row_newbcast:11
  v_and_b32_dpp v55, v163, v165 row_newbcast:11
  s_nop 1
  v_smfmac_f32_16x16x64_bf16 v[56:59], v[52:55], a[176:183], v166
  v_smfmac_f32_16x16x64_bf16 v[176:179], v[52:55], a[184:191], v166
  s_waitcnt vmcnt(6)
  v_dot2_f32_bf16 v23, v68, v4, 0
  v_dot2_f32_bf16 v23, v69, v5, v23
  v_dot2_f32_bf16 v23, v70, v6, v23
  v_dot2_f32_bf16 v23, v71, v7, v23
  s_cbranch_vccz L_d577
  s_waitcnt vmcnt(5)
L_d577:
  s_xor_b32 s68, s70, 0x40d00
  buffer_load_dwordx4 v[92:95], v63, s[12:15], s68 offen nt
  s_waitcnt vmcnt(6)
  v_dot2_f32_bf16 v24, v72, v4, 0
  v_dot2_f32_bf16 v24, v73, v5, v24
  v_dot2_f32_bf16 v24, v74, v6, v24
  v_dot2_f32_bf16 v24, v75, v7, v24
  s_cbranch_vccz L_d578
  s_waitcnt vmcnt(5)
L_d578:
  s_xor_b32 s68, s70, 0x50000
  buffer_load_dwordx4 v[96:99], v63, s[12:15], s68 offen nt
  buffer_load_dwordx4 a[56:59], v3, s[24:27], s73 offen offset:256
  s_waitcnt vmcnt(7)
  v_dot2_f32_bf16 v25, v76, v4, 0
  v_dot2_f32_bf16 v25, v77, v5, v25
  v_dot2_f32_bf16 v25, v78, v6, v25
  v_dot2_f32_bf16 v25, v79, v7, v25
  s_cbranch_vccz L_d579
  s_waitcnt vmcnt(6)
L_d579:
  s_xor_b32 s68, s70, 0x50100
  buffer_load_dwordx4 v[100:103], v63, s[12:15], s68 offen nt
  v_add_f32_dpp v26, v22, v22 row_ror:8 row_mask:0xf bank_mask:0x3
  v_add_f32_dpp v27, v24, v24 row_ror:8 row_mask:0xf bank_mask:0x3
  s_nop 0
  v_add_f32_dpp v26, v23, v23 row_ror:8 row_mask:0xf bank_mask:0xc
  v_add_f32_dpp v27, v25, v25 row_ror:8 row_mask:0xf bank_mask:0xc
  s_nop 0
  v_add_f32_dpp v28, v26, v26 row_half_mirror row_mask:0xf bank_mask:0x5
  s_nop 1
  v_add_f32_dpp v28, v27, v27 row_half_mirror row_mask:0xf bank_mask:0xa
  s_nop 1
  v_add_f32_dpp v28, v28, v28 quad_perm:[1,0,3,2]
  s_nop 1
  v_add_f32_dpp v208, v28, v28 quad_perm:[2,3,0,1]
  v_max_f32 v20, v20, v208
  s_barrier
  s_waitcnt vmcnt(7)
  v_dot2_f32_bf16 v22, v80, v4, 0
  v_dot2_f32_bf16 v22, v81, v5, v22
  v_dot2_f32_bf16 v22, v82, v6, v22
  v_dot2_f32_bf16 v22, v83, v7, v22
  s_cbranch_vccz L_d580
  s_waitcnt vmcnt(5)
L_d580:
  s_xor_b32 s68, s70, 0x50400
  buffer_load_dwordx4 v[104:107], v63, s[12:15], s68 offen nt
  v_and_b32_dpp v48, v162, v164 row_newbcast:12
  v_and_b32_dpp v49, v162, v165 row_newbcast:12
  v_and_b32_dpp v50, v163, v164 row_newbcast:12
  v_and_b32_dpp v51, v163, v165 row_newbcast:12
  s_nop 1
  v_smfmac_f32_16x16x64_bf16 v[56:59], v[48:51], a[192:199], v166
  v_smfmac_f32_16x16x64_bf16 v[176:179], v[48:51], a[200:207], v166
  s_waitcnt vmcnt(6)
  v_dot2_f32_bf16 v23, v84, v4, 0
  v_dot2_f32_bf16 v23, v85, v5, v23
  v_dot2_f32_bf16 v23, v86, v6, v23
  v_dot2_f32_bf16 v23, v87, v7, v23
  s_cbranch_vccz L_d581
  s_waitcnt vmcnt(5)
L_d581:
  s_xor_b32 s68, s70, 0x50500
  buffer_load_dwordx4 v[108:111], v63, s[12:15], s68 offen nt
  s_waitcnt vmcnt(6)
  v_dot2_f32_bf16 v24, v88, v4, 0
  v_dot2_f32_bf16 v24, v89, v5, v24
  v_dot2_f32_bf16 v24, v90, v6, v24
  v_dot2_f32_bf16 v24, v91, v7, v24
  s_cbranch_vccz L_d582
  s_waitcnt vmcnt(5)
L_d582:
  s_xor_b32 s68, s70, 0x50800
  buffer_load_dwordx4 v[112:115], v63, s[12:15], s68 offen nt
  buffer_load_dwordx4 a[52:55], v3, s[24:27], s73 offen offset:2048
  s_waitcnt vmcnt(7)
  v_dot2_f32_bf16 v25, v92, v4, 0
  v_dot2_f32_bf16 v25, v93, v5, v25
  v_dot2_f32_bf16 v25, v94, v6, v25
  v_dot2_f32_bf16 v25, v95, v7, v25
  s_cbranch_vccz L_d583
  s_waitcnt vmcnt(6)
L_d583:
  s_xor_b32 s68, s70, 0x50900
  buffer_load_dwordx4 v[116:119], v63, s[12:15], s68 offen nt
  v_add_f32_dpp v26, v22, v22 row_ror:8 row_mask:0xf bank_mask:0x3
  v_add_f32_dpp v27, v24, v24 row_ror:8 row_mask:0xf bank_mask:0x3
  s_nop 0
  v_add_f32_dpp v26, v23, v23 row_ror:8 row_mask:0xf bank_mask:0xc
  v_add_f32_dpp v27, v25, v25 row_ror:8 row_mask:0xf bank_mask:0xc
  s_nop 0
  v_add_f32_dpp v28, v26, v26 row_half_mirror row_mask:0xf bank_mask:0x5
  s_nop 1
  v_add_f32_dpp v28, v27, v27 row_half_mirror row_mask:0xf bank_mask:0xa
  s_nop 1
  v_add_f32_dpp v28, v28, v28 quad_perm:[1,0,3,2]
  s_nop 1
  v_add_f32_dpp v209, v28, v28 quad_perm:[2,3,0,1]
  v_max_f32 v20, v20, v209
  s_barrier
  s_waitcnt vmcnt(7)
  v_dot2_f32_bf16 v22, v96, v4, 0
  v_dot2_f32_bf16 v22, v97, v5, v22
  v_dot2_f32_bf16 v22, v98, v6, v22
  v_dot2_f32_bf16 v22, v99, v7, v22
  s_cbranch_vccz L_d584
  s_waitcnt vmcnt(5)
L_d584:
  s_xor_b32 s68, s70, 0x50c00
  buffer_load_dwordx4 v[120:123], v63, s[12:15], s68 offen nt
  v_and_b32_dpp v52, v162, v164 row_newbcast:13
  v_and_b32_dpp v53, v162, v165 row_newbcast:13
  v_and_b32_dpp v54, v163, v164 row_newbcast:13
  v_and_b32_dpp v55, v163, v165 row_newbcast:13
  s_nop 1
  v_smfmac_f32_16x16x64_bf16 v[56:59], v[52:55], a[208:215], v166
  v_smfmac_f32_16x16x64_bf16 v[176:179], v[52:55], a[216:223], v166
  s_cmp_eq_u32 s64, 0
  s_cbranch_scc0 L_wp146
  s_mov_b32 s100, 12
  s_atomic_umax s100, s[20:21], s88
  s_and_b32 s60, s88, 0xfffffc7f
  s_xor_b32 s61, s60, 8192
  s_add_u32 s38, s60, 0
  s_load_dword s40, s[20:21], s38 glc
  s_add_u32 s38, s61, 128
  s_load_dword s41, s[20:21], s38 glc
  s_add_u32 s38, s61, 256
  s_load_dword s42, s[20:21], s38 glc
  s_add_u32 s38, s60, 384
  s_load_dword s43, s[20:21], s38 glc
  s_add_u32 s38, s60, 512
  s_load_dword s44, s[20:21], s38 glc
  s_add_u32 s38, s61, 640
  s_load_dword s45, s[20:21], s38 glc
  s_add_u32 s38, s61, 768
  s_load_dword s46, s[20:21], s38 glc
  s_add_u32 s38, s60, 896
  s_load_dword s47, s[20:21], s38 glc
L_wp146:
  s_waitcnt vmcnt(6)
  v_dot2_f32_bf16 v23, v100, v4, 0
  v_dot2_f32_bf16 v23, v101, v5, v23
  v_dot2_f32_bf16 v23, v102, v6, v23
  v_dot2_f32_bf16 v23, v103, v7, v23
  s_cbranch_vccz L_d585
  s_waitcnt vmcnt(5)
L_d585:
  s_xor_b32 s68, s70, 0x50d00
  buffer_load_dwordx4 v[124:127], v63, s[12:15], s68 offen nt
  s_waitcnt vmcnt(6)
  v_dot2_f32_bf16 v24, v104, v4, 0
  v_dot2_f32_bf16 v24, v105, v5, v24
  v_dot2_f32_bf16 v24, v106, v6, v24
  v_dot2_f32_bf16 v24, v107, v7, v24
  s_cbranch_vccz L_d586
  s_waitcnt vmcnt(5)
L_d586:
  s_xor_b32 s68, s70, 0x60000
  buffer_load_dwordx4 v[64:67], v63, s[12:15], s68 offen nt
  buffer_load_dwordx4 a[60:63], v3, s[24:27], s73 offen offset:2304
  s_add_u32 s73, s73, 4096
  s_waitcnt vmcnt(7)
  v_dot2_f32_bf16 v25, v108, v4, 0
  v_dot2_f32_bf16 v25, v109, v5, v25
  v_dot2_f32_bf16 v25, v110, v6, v25
  v_dot2_f32_bf16 v25, v111, v7, v25
  s_cbranch_vccz L_d587
  s_waitcnt vmcnt(6)
L_d587:
  s_xor_b32 s68, s70, 0x60100
  buffer_load_dwordx4 v[68:71], v63, s[12:15], s68 offen nt
  v_add_f32_dpp v26, v22, v22 row_ror:8 row_mask:0xf bank_mask:0x3
  v_add_f32_dpp v27, v24, v24 row_ror:8 row_mask:0xf bank_mask:0x3
  s_nop 0
  v_add_f32_dpp v26, v23, v23 row_ror:8 row_mask:0xf bank_mask:0xc
  v_add_f32_dpp v27, v25, v25 row_ror:8 row_mask:0xf bank_mask:0xc
  s_nop 0
  v_add_f32_dpp v28, v26, v26 row_half_mirror row_mask:0xf bank_mask:0x5
  s_nop 1
  v_add_f32_dpp v28, v27, v27 row_half_mirror row_mask:0xf bank_mask:0xa
  s_nop 1
  v_add_f32_dpp v28, v28, v28 quad_perm:[1,0,3,2]
  s_nop 1
  v_add_f32_dpp v210, v28, v28 quad_perm:[2,3,0,1]
  v_max_f32 v20, v20, v210
  s_barrier
  s_waitcnt vmcnt(7)
  v_dot2_f32_bf16 v22, v112, v4, 0
  v_dot2_f32_bf16 v22, v113, v5, v22
  v_dot2_f32_bf16 v22, v114, v6, v22
  v_dot2_f32_bf16 v22, v115, v7, v22
  s_cbranch_vccz L_d588
  s_waitcnt vmcnt(5)
L_d588:
  s_xor_b32 s68, s70, 0x60400
  buffer_load_dwordx4 v[72:75], v63, s[12:15], s68 offen nt
  v_and_b32_dpp v48, v162, v164 row_newbcast:14
  v_and_b32_dpp v49, v162, v165 row_newbcast:14
  v_and_b32_dpp v50, v163, v164 row_newbcast:14
  v_and_b32_dpp v51, v163, v165 row_newbcast:14
  s_nop 1
  v_smfmac_f32_16x16x64_bf16 v[56:59], v[48:51], a[224:231], v166
  v_smfmac_f32_16x16x64_bf16 v[176:179], v[48:51], a[232:239], v166
  s_waitcnt vmcnt(6)
  v_dot2_f32_bf16 v23, v116, v4, 0
  v_dot2_f32_bf16 v23, v117, v5, v23
  v_dot2_f32_bf16 v23, v118, v6, v23
  v_dot2_f32_bf16 v23, v119, v7, v23
  s_cbranch_vccz L_d589
  s_waitcnt vmcnt(5)
L_d589:
  s_xor_b32 s68, s70, 0x60500
  buffer_load_dwordx4 v[76:79], v63, s[12:15], s68 offen nt
  s_waitcnt vmcnt(6)
  v_dot2_f32_bf16 v24, v120, v4, 0
  v_dot2_f32_bf16 v24, v121, v5, v24
  v_dot2_f32_bf16 v24, v122, v6, v24
  v_dot2_f32_bf16 v24, v123, v7, v24
  s_cbranch_vccz L_d590
  s_waitcnt vmcnt(5)
L_d590:
  s_xor_b32 s68, s70, 0x60800
  buffer_load_dwordx4 v[80:83], v63, s[12:15], s68 offen nt
  s_lshl_b32 s73, s76, 13
  s_add_u32 s73, s73, s84
  buffer_load_dwordx4 a[64:67], v3, s[24:27], s73 offen offset:0
  s_waitcnt vmcnt(7)
  v_dot2_f32_bf16 v25, v124, v4, 0
  v_dot2_f32_bf16 v25, v125, v5, v25
  v_dot2_f32_bf16 v25, v126, v6, v25
  v_dot2_f32_bf16 v25, v127, v7, v25
  s_cbranch_vccz L_d591
  s_waitcnt vmcnt(6)
L_d591:
  s_xor_b32 s68, s70, 0x60900
  buffer_load_dwordx4 v[84:87], v63, s[12:15], s68 offen nt
  v_add_f32_dpp v26, v22, v22 row_ror:8 row_mask:0xf bank_mask:0x3
  v_add_f32_dpp v27, v24, v24 row_ror:8 row_mask:0xf bank_mask:0x3
  s_nop 0
  v_add_f32_dpp v26, v23, v23 row_ror:8 row_mask:0xf bank_mask:0xc
  v_add_f32_dpp v27, v25, v25 row_ror:8 row_mask:0xf bank_mask:0xc
  s_nop 0
  v_add_f32_dpp v28, v26, v26 row_half_mirror row_mask:0xf bank_mask:0x5
  s_nop 1
  v_add_f32_dpp v28, v27, v27 row_half_mirror row_mask:0xf bank_mask:0xa
  s_nop 1
  v_add_f32_dpp v28, v28, v28 quad_perm:[1,0,3,2]
  s_nop 1
  v_add_f32_dpp v211, v28, v28 quad_perm:[2,3,0,1]
  v_max_f32 v20, v20, v211
  s_barrier
  s_waitcnt vmcnt(7)
  v_dot2_f32_bf16 v22, v64, v4, 0
  v_dot2_f32_bf16 v22, v65, v5, v22
  v_dot2_f32_bf16 v22, v66, v6, v22
  v_dot2_f32_bf16 v22, v67, v7, v22
  s_cbranch_vccz L_d592
  s_waitcnt vmcnt(5)
L_d592:
  s_xor_b32 s68, s70, 0x60c00
  buffer_load_dwordx4 v[88:91], v63, s[12:15], s68 offen nt
  v_and_b32_dpp v52, v162, v164 row_newbcast:15
  v_and_b32_dpp v53, v162, v165 row_newbcast:15
  v_and_b32_dpp v54, v163, v164 row_newbcast:15
  v_and_b32_dpp v55, v163, v165 row_newbcast:15
  s_nop 1
  v_smfmac_f32_16x16x64_bf16 v[56:59], v[52:55], a[240:247], v166
  v_smfmac_f32_16x16x64_bf16 v[176:179], v[52:55], a[248:255], v166
  s_cmp_eq_u32 s64, 0
  s_cbranch_scc0 L_wp148
  s_mov_b32 s101, 0
  s_waitcnt lgkmcnt(0)
  s_cmp_ge_u32 s40, 12
  s_addc_u32 s101, s101, 0
  s_cmp_ge_u32 s41, 12
  s_addc_u32 s101, s101, 0
  s_cmp_ge_u32 s42, 12
  s_addc_u32 s101, s101, 0
  s_cmp_ge_u32 s43, 12
  s_addc_u32 s101, s101, 0
  s_cmp_ge_u32 s44, 12
  s_addc_u32 s101, s101, 0
  s_cmp_ge_u32 s45, 12
  s_addc_u32 s101, s101, 0
  s_cmp_ge_u32 s46, 12
  s_addc_u32 s101, s101, 0
  s_cmp_ge_u32 s47, 12
  s_addc_u32 s101, s101, 0
  s_cmp_lt_u32 s101, 6
  s_cselect_b32 s38, -1, 0
  v_mov_b32 v26, 0
  v_mov_b32 v27, s38
  ds_write_b32 v26, v27 offset:8512
L_wp148:
  s_waitcnt vmcnt(6)
  v_dot2_f32_bf16 v23, v68, v4, 0
  v_dot2_f32_bf16 v23, v69, v5, v23
  v_dot2_f32_bf16 v23, v70, v6, v23
  v_dot2_f32_bf16 v23, v71, v7, v23
  s_cbranch_vccz L_d593
  s_waitcnt vmcnt(5)
L_d593:
  s_xor_b32 s68, s70, 0x60d00
  buffer_load_dwordx4 v[92:95], v63, s[12:15], s68 offen nt
  s_waitcnt vmcnt(6)
  v_dot2_f32_bf16 v24, v72, v4, 0
  v_dot2_f32_bf16 v24, v73, v5, v24
  v_dot2_f32_bf16 v24, v74, v6, v24
  v_dot2_f32_bf16 v24, v75, v7, v24
  s_cbranch_vccz L_d594
  s_waitcnt vmcnt(5)
L_d594:
  s_xor_b32 s68, s70, 0x70000
  buffer_load_dwordx4 v[96:99], v63, s[12:15], s68 offen nt
  buffer_load_dwordx4 a[72:75], v3, s[24:27], s73 offen offset:256
  s_waitcnt vmcnt(7)
  v_dot2_f32_bf16 v25, v76, v4, 0
  v_dot2_f32_bf16 v25, v77, v5, v25
  v_dot2_f32_bf16 v25, v78, v6, v25
  v_dot2_f32_bf16 v25, v79, v7, v25
  s_cbranch_vccz L_d595
  s_waitcnt vmcnt(6)
L_d595:
  s_xor_b32 s68, s70, 0x70100
  buffer_load_dwordx4 v[100:103], v63, s[12:15], s68 offen nt
  v_add_f32_dpp v26, v22, v22 row_ror:8 row_mask:0xf bank_mask:0x3
  v_add_f32_dpp v27, v24, v24 row_ror:8 row_mask:0xf bank_mask:0x3
  s_nop 0
  v_add_f32_dpp v26, v23, v23 row_ror:8 row_mask:0xf bank_mask:0xc
  v_add_f32_dpp v27, v25, v25 row_ror:8 row_mask:0xf bank_mask:0xc
  s_nop 0
  v_add_f32_dpp v28, v26, v26 row_half_mirror row_mask:0xf bank_mask:0x5
  s_nop 1
  v_add_f32_dpp v28, v27, v27 row_half_mirror row_mask:0xf bank_mask:0xa
  s_nop 1
  v_add_f32_dpp v28, v28, v28 quad_perm:[1,0,3,2]
  s_nop 1
  v_add_f32_dpp v212, v28, v28 quad_perm:[2,3,0,1]
  v_max_f32 v20, v20, v212
  s_barrier
  s_waitcnt vmcnt(7)
  v_dot2_f32_bf16 v22, v80, v4, 0
  v_dot2_f32_bf16 v22, v81, v5, v22
  v_dot2_f32_bf16 v22, v82, v6, v22
  v_dot2_f32_bf16 v22, v83, v7, v22
  s_cbranch_vccz L_d596
  s_waitcnt vmcnt(5)
L_d596:
  s_xor_b32 s68, s70, 0x70400
  buffer_load_dwordx4 v[104:107], v63, s[12:15], s68 offen nt
  v_mov_b32 v26, 0
  ds_read_b32 v35, v26 offset:8512
  s_waitcnt vmcnt(6)
  v_dot2_f32_bf16 v23, v84, v4, 0
  v_dot2_f32_bf16 v23, v85, v5, v23
  v_dot2_f32_bf16 v23, v86, v6, v23
  v_dot2_f32_bf16 v23, v87, v7, v23
  s_cbranch_vccz L_d597
  s_waitcnt vmcnt(5)
L_d597:
  s_xor_b32 s68, s70, 0x70500
  buffer_load_dwordx4 v[108:111], v63, s[12:15], s68 offen nt
  s_waitcnt vmcnt(6)
  v_dot2_f32_bf16 v24, v88, v4, 0
  v_dot2_f32_bf16 v24, v89, v5, v24
  v_dot2_f32_bf16 v24, v90, v6, v24
  v_dot2_f32_bf16 v24, v91, v7, v24
  s_cbranch_vccz L_d598
  s_waitcnt vmcnt(5)
L_d598:
  s_xor_b32 s68, s70, 0x70800
  buffer_load_dwordx4 v[112:115], v63, s[12:15], s68 offen nt
  buffer_load_dwordx4 a[68:71], v3, s[24:27], s73 offen offset:2048
  s_waitcnt vmcnt(7)
  v_dot2_f32_bf16 v25, v92, v4, 0
  v_dot2_f32_bf16 v25, v93, v5, v25
  v_dot2_f32_bf16 v25, v94, v6, v25
  v_dot2_f32_bf16 v25, v95, v7, v25
  s_cbranch_vccz L_d599
  s_waitcnt vmcnt(6)
L_d599:
  s_xor_b32 s68, s70, 0x70900
  buffer_load_dwordx4 v[116:119], v63, s[12:15], s68 offen nt
  v_add_f32_dpp v26, v22, v22 row_ror:8 row_mask:0xf bank_mask:0x3
  v_add_f32_dpp v27, v24, v24 row_ror:8 row_mask:0xf bank_mask:0x3
  s_nop 0
  v_add_f32_dpp v26, v23, v23 row_ror:8 row_mask:0xf bank_mask:0xc
  v_add_f32_dpp v27, v25, v25 row_ror:8 row_mask:0xf bank_mask:0xc
  s_nop 0
  v_add_f32_dpp v28, v26, v26 row_half_mirror row_mask:0xf bank_mask:0x5
  s_nop 1
  v_add_f32_dpp v28, v27, v27 row_half_mirror row_mask:0xf bank_mask:0xa
  s_nop 1
  v_add_f32_dpp v28, v28, v28 quad_perm:[1,0,3,2]
  s_nop 1
  v_add_f32_dpp v213, v28, v28 quad_perm:[2,3,0,1]
  v_max_f32 v20, v20, v213
  s_barrier
  s_waitcnt vmcnt(7)
  v_dot2_f32_bf16 v22, v96, v4, 0
  v_dot2_f32_bf16 v22, v97, v5, v22
  v_dot2_f32_bf16 v22, v98, v6, v22
  v_dot2_f32_bf16 v22, v99, v7, v22
  s_cbranch_vccz L_d600
  s_waitcnt vmcnt(5)
L_d600:
  s_xor_b32 s68, s70, 0x70c00
  buffer_load_dwordx4 v[120:123], v63, s[12:15], s68 offen nt
  s_waitcnt lgkmcnt(0)
  v_cmp_ne_u32 vcc, 0, v35
  s_waitcnt vmcnt(6)
  v_dot2_f32_bf16 v23, v100, v4, 0
  v_dot2_f32_bf16 v23, v101, v5, v23
  v_dot2_f32_bf16 v23, v102, v6, v23
  v_dot2_f32_bf16 v23, v103, v7, v23
  s_cbranch_vccz L_d601
  s_waitcnt vmcnt(5)
L_d601:
  s_xor_b32 s68, s70, 0x70d00
  buffer_load_dwordx4 v[124:127], v63, s[12:15], s68 offen nt
  s_waitcnt vmcnt(6)
  v_dot2_f32_bf16 v24, v104, v4, 0
  v_dot2_f32_bf16 v24, v105, v5, v24
  v_dot2_f32_bf16 v24, v106, v6, v24
  v_dot2_f32_bf16 v24, v107, v7, v24
  s_cbranch_vccz L_d602
  s_waitcnt vmcnt(5)
L_d602:
  s_xor_b32 s68, s70, 0xc0000
  buffer_load_dwordx4 v[64:67], v63, s[12:15], s68 offen nt
  buffer_load_dwordx4 a[76:79], v3, s[24:27], s73 offen offset:2304
  s_add_u32 s73, s73, 4096
  s_waitcnt vmcnt(7)
  v_dot2_f32_bf16 v25, v108, v4, 0
  v_dot2_f32_bf16 v25, v109, v5, v25
  v_dot2_f32_bf16 v25, v110, v6, v25
  v_dot2_f32_bf16 v25, v111, v7, v25
  s_cbranch_vccz L_d603
  s_waitcnt vmcnt(6)
L_d603:
  s_xor_b32 s68, s70, 0xc0100
  buffer_load_dwordx4 v[68:71], v63, s[12:15], s68 offen nt
  v_add_f32_dpp v26, v22, v22 row_ror:8 row_mask:0xf bank_mask:0x3
  v_add_f32_dpp v27, v24, v24 row_ror:8 row_mask:0xf bank_mask:0x3
  s_nop 0
  v_add_f32_dpp v26, v23, v23 row_ror:8 row_mask:0xf bank_mask:0xc
  v_add_f32_dpp v27, v25, v25 row_ror:8 row_mask:0xf bank_mask:0xc
  s_nop 0
  v_add_f32_dpp v28, v26, v26 row_half_mirror row_mask:0xf bank_mask:0x5
  s_nop 1
  v_add_f32_dpp v28, v27, v27 row_half_mirror row_mask:0xf bank_mask:0xa
  s_nop 1
  v_add_f32_dpp v28, v28, v28 quad_perm:[1,0,3,2]
  s_nop 1
  v_add_f32_dpp v214, v28, v28 quad_perm:[2,3,0,1]
  v_max_f32 v20, v20, v214
  s_barrier
  s_waitcnt vmcnt(7)
  v_dot2_f32_bf16 v22, v112, v4, 0
  v_dot2_f32_bf16 v22, v113, v5, v22
  v_dot2_f32_bf16 v22, v114, v6, v22
  v_dot2_f32_bf16 v22, v115, v7, v22
  s_cbranch_vccz L_d604
  s_waitcnt vmcnt(5)
L_d604:
  s_xor_b32 s68, s70, 0xc0400
  buffer_load_dwordx4 v[72:75], v63, s[12:15], s68 offen nt
  s_waitcnt vmcnt(6)
  v_dot2_f32_bf16 v23, v116, v4, 0
  v_dot2_f32_bf16 v23, v117, v5, v23
  v_dot2_f32_bf16 v23, v118, v6, v23
  v_dot2_f32_bf16 v23, v119, v7, v23
  s_cbranch_vccz L_d605
  s_waitcnt vmcnt(5)
L_d605:
  s_xor_b32 s68, s70, 0xc0500
  buffer_load_dwordx4 v[76:79], v63, s[12:15], s68 offen nt
  s_waitcnt vmcnt(6)
  v_dot2_f32_bf16 v24, v120, v4, 0
  v_dot2_f32_bf16 v24, v121, v5, v24
  v_dot2_f32_bf16 v24, v122, v6, v24
  v_dot2_f32_bf16 v24, v123, v7, v24
  s_cbranch_vccz L_d606
  s_waitcnt vmcnt(5)
L_d606:
  s_xor_b32 s68, s70, 0xc0800
  buffer_load_dwordx4 v[80:83], v63, s[12:15], s68 offen nt
  buffer_load_dwordx4 a[80:83], v3, s[24:27], s73 offen offset:0
  s_waitcnt vmcnt(7)
  v_dot2_f32_bf16 v25, v124, v4, 0
  v_dot2_f32_bf16 v25, v125, v5, v25
  v_dot2_f32_bf16 v25, v126, v6, v25
  v_dot2_f32_bf16 v25, v127, v7, v25
  s_cbranch_vccz L_d607
  s_waitcnt vmcnt(6)
L_d607:
  s_xor_b32 s68, s70, 0xc0900
  buffer_load_dwordx4 v[84:87], v63, s[12:15], s68 offen nt
  v_add_f32_dpp v26, v22, v22 row_ror:8 row_mask:0xf bank_mask:0x3
  v_add_f32_dpp v27, v24, v24 row_ror:8 row_mask:0xf bank_mask:0x3
  s_nop 0
  v_add_f32_dpp v26, v23, v23 row_ror:8 row_mask:0xf bank_mask:0xc
  v_add_f32_dpp v27, v25, v25 row_ror:8 row_mask:0xf bank_mask:0xc
  s_nop 0
  v_add_f32_dpp v28, v26, v26 row_half_mirror row_mask:0xf bank_mask:0x5
  s_nop 1
  v_add_f32_dpp v28, v27, v27 row_half_mirror row_mask:0xf bank_mask:0xa
  s_nop 1
  v_add_f32_dpp v28, v28, v28 quad_perm:[1,0,3,2]
  s_nop 1
  v_add_f32_dpp v215, v28, v28 quad_perm:[2,3,0,1]
  v_max_f32 v20, v20, v215
  s_barrier
  s_waitcnt vmcnt(7)
  v_dot2_f32_bf16 v22, v64, v4, 0
  v_dot2_f32_bf16 v22, v65, v5, v22
  v_dot2_f32_bf16 v22, v66, v6, v22
  v_dot2_f32_bf16 v22, v67, v7, v22
  s_cbranch_vccz L_d608
  s_waitcnt vmcnt(5)
L_d608:
  s_xor_b32 s68, s70, 0xc0c00
  buffer_load_dwordx4 v[88:91], v63, s[12:15], s68 offen nt
  s_waitcnt vmcnt(6)
  v_dot2_f32_bf16 v23, v68, v4, 0
  v_dot2_f32_bf16 v23, v69, v5, v23
  v_dot2_f32_bf16 v23, v70, v6, v23
  v_dot2_f32_bf16 v23, v71, v7, v23
  s_cbranch_vccz L_d609
  s_waitcnt vmcnt(5)
L_d609:
  s_xor_b32 s68, s70, 0xc0d00
  buffer_load_dwordx4 v[92:95], v63, s[12:15], s68 offen nt
  s_waitcnt vmcnt(6)
  v_dot2_f32_bf16 v24, v72, v4, 0
  v_dot2_f32_bf16 v24, v73, v5, v24
  v_dot2_f32_bf16 v24, v74, v6, v24
  v_dot2_f32_bf16 v24, v75, v7, v24
  s_cbranch_vccz L_d610
  s_waitcnt vmcnt(5)
L_d610:
  s_xor_b32 s68, s70, 0xd0000
  buffer_load_dwordx4 v[96:99], v63, s[12:15], s68 offen nt
  buffer_load_dwordx4 a[88:91], v3, s[24:27], s73 offen offset:256
  s_waitcnt vmcnt(7)
  v_dot2_f32_bf16 v25, v76, v4, 0
  v_dot2_f32_bf16 v25, v77, v5, v25
  v_dot2_f32_bf16 v25, v78, v6, v25
  v_dot2_f32_bf16 v25, v79, v7, v25
  s_cbranch_vccz L_d611
  s_waitcnt vmcnt(6)
L_d611:
  s_xor_b32 s68, s70, 0xd0100
  buffer_load_dwordx4 v[100:103], v63, s[12:15], s68 offen nt
  v_add_f32_dpp v26, v22, v22 row_ror:8 row_mask:0xf bank_mask:0x3
  v_add_f32_dpp v27, v24, v24 row_ror:8 row_mask:0xf bank_mask:0x3
  s_nop 0
  v_add_f32_dpp v26, v23, v23 row_ror:8 row_mask:0xf bank_mask:0xc
  v_add_f32_dpp v27, v25, v25 row_ror:8 row_mask:0xf bank_mask:0xc
  s_nop 0
  v_add_f32_dpp v28, v26, v26 row_half_mirror row_mask:0xf bank_mask:0x5
  s_nop 1
  v_add_f32_dpp v28, v27, v27 row_half_mirror row_mask:0xf bank_mask:0xa
  s_nop 1
  v_add_f32_dpp v28, v28, v28 quad_perm:[1,0,3,2]
  s_nop 1
  v_add_f32_dpp v216, v28, v28 quad_perm:[2,3,0,1]
  v_max_f32 v20, v20, v216
  s_barrier
  s_waitcnt vmcnt(7)
  v_dot2_f32_bf16 v22, v80, v4, 0
  v_dot2_f32_bf16 v22, v81, v5, v22
  v_dot2_f32_bf16 v22, v82, v6, v22
  v_dot2_f32_bf16 v22, v83, v7, v22
  s_cbranch_vccz L_d612
  s_waitcnt vmcnt(5)
L_d612:
  s_xor_b32 s68, s70, 0xd0400
  buffer_load_dwordx4 v[104:107], v63, s[12:15], s68 offen nt
  s_waitcnt vmcnt(6)
  v_dot2_f32_bf16 v23, v84, v4, 0
  v_dot2_f32_bf16 v23, v85, v5, v23
  v_dot2_f32_bf16 v23, v86, v6, v23
  v_dot2_f32_bf16 v23, v87, v7, v23
  s_cbranch_vccz L_d613
  s_waitcnt vmcnt(5)
L_d613:
  s_xor_b32 s68, s70, 0xd0500
  buffer_load_dwordx4 v[108:111], v63, s[12:15], s68 offen nt
  s_waitcnt vmcnt(6)
  v_dot2_f32_bf16 v24, v88, v4, 0
  v_dot2_f32_bf16 v24, v89, v5, v24
  v_dot2_f32_bf16 v24, v90, v6, v24
  v_dot2_f32_bf16 v24, v91, v7, v24
  s_cbranch_vccz L_d614
  s_waitcnt vmcnt(5)
L_d614:
  s_xor_b32 s68, s70, 0xd0800
  buffer_load_dwordx4 v[112:115], v63, s[12:15], s68 offen nt
  buffer_load_dwordx4 a[84:87], v3, s[24:27], s73 offen offset:2048
  s_waitcnt vmcnt(7)
  v_dot2_f32_bf16 v25, v92, v4, 0
  v_dot2_f32_bf16 v25, v93, v5, v25
  v_dot2_f32_bf16 v25, v94, v6, v25
  v_dot2_f32_bf16 v25, v95, v7, v25
  s_cbranch_vccz L_d615
  s_waitcnt vmcnt(6)
L_d615:
  s_xor_b32 s68, s70, 0xd0900
  buffer_load_dwordx4 v[116:119], v63, s[12:15], s68 offen nt
  v_add_f32_dpp v26, v22, v22 row_ror:8 row_mask:0xf bank_mask:0x3
  v_add_f32_dpp v27, v24, v24 row_ror:8 row_mask:0xf bank_mask:0x3
  s_nop 0
  v_add_f32_dpp v26, v23, v23 row_ror:8 row_mask:0xf bank_mask:0xc
  v_add_f32_dpp v27, v25, v25 row_ror:8 row_mask:0xf bank_mask:0xc
  s_nop 0
  v_add_f32_dpp v28, v26, v26 row_half_mirror row_mask:0xf bank_mask:0x5
  s_nop 1
  v_add_f32_dpp v28, v27, v27 row_half_mirror row_mask:0xf bank_mask:0xa
  s_nop 1
  v_add_f32_dpp v28, v28, v28 quad_perm:[1,0,3,2]
  s_nop 1
  v_add_f32_dpp v217, v28, v28 quad_perm:[2,3,0,1]
  v_max_f32 v20, v20, v217
  s_barrier
  s_waitcnt vmcnt(7)
  v_dot2_f32_bf16 v22, v96, v4, 0
  v_dot2_f32_bf16 v22, v97, v5, v22
  v_dot2_f32_bf16 v22, v98, v6, v22
  v_dot2_f32_bf16 v22, v99, v7, v22
  s_cbranch_vccz L_d616
  s_waitcnt vmcnt(5)
L_d616:
  s_xor_b32 s68, s70, 0xd0c00
  buffer_load_dwordx4 v[120:123], v63, s[12:15], s68 offen nt
  s_waitcnt vmcnt(6)
  v_dot2_f32_bf16 v23, v100, v4, 0
  v_dot2_f32_bf16 v23, v101, v5, v23
  v_dot2_f32_bf16 v23, v102, v6, v23
  v_dot2_f32_bf16 v23, v103, v7, v23
  s_cbranch_vccz L_d617
  s_waitcnt vmcnt(5)
L_d617:
  s_xor_b32 s68, s70, 0xd0d00
  buffer_load_dwordx4 v[124:127], v63, s[12:15], s68 offen nt
  s_waitcnt vmcnt(6)
  v_dot2_f32_bf16 v24, v104, v4, 0
  v_dot2_f32_bf16 v24, v105, v5, v24
  v_dot2_f32_bf16 v24, v106, v6, v24
  v_dot2_f32_bf16 v24, v107, v7, v24
  s_cbranch_vccz L_d618
  s_waitcnt vmcnt(5)
L_d618:
  s_xor_b32 s68, s70, 0xe0000
  buffer_load_dwordx4 v[64:67], v63, s[12:15], s68 offen nt
  buffer_load_dwordx4 a[92:95], v3, s[24:27], s73 offen offset:2304
  s_add_u32 s73, s73, 4096
  s_waitcnt vmcnt(7)
  v_dot2_f32_bf16 v25, v108, v4, 0
  v_dot2_f32_bf16 v25, v109, v5, v25
  v_dot2_f32_bf16 v25, v110, v6, v25
  v_dot2_f32_bf16 v25, v111, v7, v25
  s_cbranch_vccz L_d619
  s_waitcnt vmcnt(6)
L_d619:
  s_xor_b32 s68, s70, 0xe0100
  buffer_load_dwordx4 v[68:71], v63, s[12:15], s68 offen nt
  v_add_f32_dpp v26, v22, v22 row_ror:8 row_mask:0xf bank_mask:0x3
  v_add_f32_dpp v27, v24, v24 row_ror:8 row_mask:0xf bank_mask:0x3
  s_nop 0
  v_add_f32_dpp v26, v23, v23 row_ror:8 row_mask:0xf bank_mask:0xc
  v_add_f32_dpp v27, v25, v25 row_ror:8 row_mask:0xf bank_mask:0xc
  s_nop 0
  v_add_f32_dpp v28, v26, v26 row_half_mirror row_mask:0xf bank_mask:0x5
  s_nop 1
  v_add_f32_dpp v28, v27, v27 row_half_mirror row_mask:0xf bank_mask:0xa
  s_nop 1
  v_add_f32_dpp v28, v28, v28 quad_perm:[1,0,3,2]
  s_nop 1
  v_add_f32_dpp v218, v28, v28 quad_perm:[2,3,0,1]
  v_max_f32 v20, v20, v218
  s_barrier
  s_waitcnt vmcnt(7)
  v_dot2_f32_bf16 v22, v112, v4, 0
  v_dot2_f32_bf16 v22, v113, v5, v22
  v_dot2_f32_bf16 v22, v114, v6, v22
  v_dot2_f32_bf16 v22, v115, v7, v22
  s_cbranch_vccz L_d620
  s_waitcnt vmcnt(5)
L_d620:
  s_xor_b32 s68, s70, 0xe0400
  buffer_load_dwordx4 v[72:75], v63, s[12:15], s68 offen nt
  s_waitcnt vmcnt(6)
  v_dot2_f32_bf16 v23, v116, v4, 0
  v_dot2_f32_bf16 v23, v117, v5, v23
  v_dot2_f32_bf16 v23, v118, v6, v23
  v_dot2_f32_bf16 v23, v119, v7, v23
  s_cbranch_vccz L_d621
  s_waitcnt vmcnt(5)
L_d621:
  s_xor_b32 s68, s70, 0xe0500
  buffer_load_dwordx4 v[76:79], v63, s[12:15], s68 offen nt
  s_waitcnt vmcnt(6)
  v_dot2_f32_bf16 v24, v120, v4, 0
  v_dot2_f32_bf16 v24, v121, v5, v24
  v_dot2_f32_bf16 v24, v122, v6, v24
  v_dot2_f32_bf16 v24, v123, v7, v24
  s_cbranch_vccz L_d622
  s_waitcnt vmcnt(5)
L_d622:
  s_xor_b32 s68, s70, 0xe0800
  buffer_load_dwordx4 v[80:83], v63, s[12:15], s68 offen nt
  s_lshl_b32 s73, s77, 13
  s_add_u32 s73, s73, s84
  buffer_load_dwordx4 a[96:99], v3, s[24:27], s73 offen offset:0
  s_waitcnt vmcnt(7)
  v_dot2_f32_bf16 v25, v124, v4, 0
  v_dot2_f32_bf16 v25, v125, v5, v25
  v_dot2_f32_bf16 v25, v126, v6, v25
  v_dot2_f32_bf16 v25, v127, v7, v25
  s_cbranch_vccz L_d623
  s_waitcnt vmcnt(6)
L_d623:
  s_xor_b32 s68, s70, 0xe0900
  buffer_load_dwordx4 v[84:87], v63, s[12:15], s68 offen nt
  v_add_f32_dpp v26, v22, v22 row_ror:8 row_mask:0xf bank_mask:0x3
  v_add_f32_dpp v27, v24, v24 row_ror:8 row_mask:0xf bank_mask:0x3
  s_nop 0
  v_add_f32_dpp v26, v23, v23 row_ror:8 row_mask:0xf bank_mask:0xc
  v_add_f32_dpp v27, v25, v25 row_ror:8 row_mask:0xf bank_mask:0xc
  s_nop 0
  v_add_f32_dpp v28, v26, v26 row_half_mirror row_mask:0xf bank_mask:0x5
  s_nop 1
  v_add_f32_dpp v28, v27, v27 row_half_mirror row_mask:0xf bank_mask:0xa
  s_nop 1
  v_add_f32_dpp v28, v28, v28 quad_perm:[1,0,3,2]
  s_nop 1
  v_add_f32_dpp v219, v28, v28 quad_perm:[2,3,0,1]
  v_max_f32 v20, v20, v219
  s_barrier
  s_waitcnt vmcnt(7)
  v_dot2_f32_bf16 v22, v64, v4, 0
  v_dot2_f32_bf16 v22, v65, v5, v22
  v_dot2_f32_bf16 v22, v66, v6, v22
  v_dot2_f32_bf16 v22, v67, v7, v22
  s_cbranch_vccz L_d624
  s_waitcnt vmcnt(5)
L_d624:
  s_xor_b32 s68, s70, 0xe0c00
  buffer_load_dwordx4 v[88:91], v63, s[12:15], s68 offen nt
  s_waitcnt vmcnt(6)
  v_dot2_f32_bf16 v23, v68, v4, 0
  v_dot2_f32_bf16 v23, v69, v5, v23
  v_dot2_f32_bf16 v23, v70, v6, v23
  v_dot2_f32_bf16 v23, v71, v7, v23
  s_cbranch_vccz L_d625
  s_waitcnt vmcnt(5)
L_d625:
  s_xor_b32 s68, s70, 0xe0d00
  buffer_load_dwordx4 v[92:95], v63, s[12:15], s68 offen nt
  s_waitcnt vmcnt(6)
  v_dot2_f32_bf16 v24, v72, v4, 0
  v_dot2_f32_bf16 v24, v73, v5, v24
  v_dot2_f32_bf16 v24, v74, v6, v24
  v_dot2_f32_bf16 v24, v75, v7, v24
  s_cbranch_vccz L_d626
  s_waitcnt vmcnt(5)
L_d626:
  s_xor_b32 s68, s70, 0xf0000
  buffer_load_dwordx4 v[96:99], v63, s[12:15], s68 offen nt
  buffer_load_dwordx4 a[104:107], v3, s[24:27], s73 offen offset:256
  s_waitcnt vmcnt(7)
  v_dot2_f32_bf16 v25, v76, v4, 0
  v_dot2_f32_bf16 v25, v77, v5, v25
  v_dot2_f32_bf16 v25, v78, v6, v25
  v_dot2_f32_bf16 v25, v79, v7, v25
  s_cbranch_vccz L_d627
  s_waitcnt vmcnt(6)
L_d627:
  s_xor_b32 s68, s70, 0xf0100
  buffer_load_dwordx4 v[100:103], v63, s[12:15], s68 offen nt
  v_add_f32_dpp v26, v22, v22 row_ror:8 row_mask:0xf bank_mask:0x3
  v_add_f32_dpp v27, v24, v24 row_ror:8 row_mask:0xf bank_mask:0x3
  s_nop 0
  v_add_f32_dpp v26, v23, v23 row_ror:8 row_mask:0xf bank_mask:0xc
  v_add_f32_dpp v27, v25, v25 row_ror:8 row_mask:0xf bank_mask:0xc
  s_nop 0
  v_add_f32_dpp v28, v26, v26 row_half_mirror row_mask:0xf bank_mask:0x5
  s_nop 1
  v_add_f32_dpp v28, v27, v27 row_half_mirror row_mask:0xf bank_mask:0xa
  s_nop 1
  v_add_f32_dpp v28, v28, v28 quad_perm:[1,0,3,2]
  s_nop 1
  v_add_f32_dpp v220, v28, v28 quad_perm:[2,3,0,1]
  v_max_f32 v20, v20, v220
  s_barrier
  s_waitcnt vmcnt(7)
  v_dot2_f32_bf16 v22, v80, v4, 0
  v_dot2_f32_bf16 v22, v81, v5, v22
  v_dot2_f32_bf16 v22, v82, v6, v22
  v_dot2_f32_bf16 v22, v83, v7, v22
  s_cbranch_vccz L_d628
  s_waitcnt vmcnt(5)
L_d628:
  s_xor_b32 s68, s70, 0xf0400
  buffer_load_dwordx4 v[104:107], v63, s[12:15], s68 offen nt
  s_waitcnt vmcnt(6)
  v_dot2_f32_bf16 v23, v84, v4, 0
  v_dot2_f32_bf16 v23, v85, v5, v23
  v_dot2_f32_bf16 v23, v86, v6, v23
  v_dot2_f32_bf16 v23, v87, v7, v23
  s_cbranch_vccz L_d629
  s_waitcnt vmcnt(5)
L_d629:
  s_xor_b32 s68, s70, 0xf0500
  buffer_load_dwordx4 v[108:111], v63, s[12:15], s68 offen nt
  s_waitcnt vmcnt(6)
  v_dot2_f32_bf16 v24, v88, v4, 0
  v_dot2_f32_bf16 v24, v89, v5, v24
  v_dot2_f32_bf16 v24, v90, v6, v24
  v_dot2_f32_bf16 v24, v91, v7, v24
  s_cbranch_vccz L_d630
  s_waitcnt vmcnt(5)
L_d630:
  s_xor_b32 s68, s70, 0xf0800
  buffer_load_dwordx4 v[112:115], v63, s[12:15], s68 offen nt
  buffer_load_dwordx4 a[100:103], v3, s[24:27], s73 offen offset:2048
  s_waitcnt vmcnt(7)
  v_dot2_f32_bf16 v25, v92, v4, 0
  v_dot2_f32_bf16 v25, v93, v5, v25
  v_dot2_f32_bf16 v25, v94, v6, v25
  v_dot2_f32_bf16 v25, v95, v7, v25
  s_cbranch_vccz L_d631
  s_waitcnt vmcnt(6)
L_d631:
  s_xor_b32 s68, s70, 0xf0900
  buffer_load_dwordx4 v[116:119], v63, s[12:15], s68 offen nt
  v_add_f32_dpp v26, v22, v22 row_ror:8 row_mask:0xf bank_mask:0x3
  v_add_f32_dpp v27, v24, v24 row_ror:8 row_mask:0xf bank_mask:0x3
  s_nop 0
  v_add_f32_dpp v26, v23, v23 row_ror:8 row_mask:0xf bank_mask:0xc
  v_add_f32_dpp v27, v25, v25 row_ror:8 row_mask:0xf bank_mask:0xc
  s_nop 0
  v_add_f32_dpp v28, v26, v26 row_half_mirror row_mask:0xf bank_mask:0x5
  s_nop 1
  v_add_f32_dpp v28, v27, v27 row_half_mirror row_mask:0xf bank_mask:0xa
  s_nop 1
  v_add_f32_dpp v28, v28, v28 quad_perm:[1,0,3,2]
  s_nop 1
  v_add_f32_dpp v221, v28, v28 quad_perm:[2,3,0,1]
  v_max_f32 v20, v20, v221
  s_barrier
  s_waitcnt vmcnt(7)
  v_dot2_f32_bf16 v22, v96, v4, 0
  v_dot2_f32_bf16 v22, v97, v5, v22
  v_dot2_f32_bf16 v22, v98, v6, v22
  v_dot2_f32_bf16 v22, v99, v7, v22
  s_cbranch_vccz L_d632
  s_waitcnt vmcnt(5)
L_d632:
  s_xor_b32 s68, s70, 0xf0c00
  buffer_load_dwordx4 v[120:123], v63, s[12:15], s68 offen nt
  s_cmp_eq_u32 s64, 1
  s_cbranch_scc0 L_wp158
  s_mov_b32 s100, 13
  s_atomic_umax s100, s[20:21], s88
  s_and_b32 s60, s88, 0xfffffc7f
  s_xor_b32 s61, s60, 16384
  s_add_u32 s38, s61, 0
  s_load_dword s40, s[20:21], s38 glc
  s_add_u32 s38, s60, 128
  s_load_dword s41, s[20:21], s38 glc
  s_add_u32 s38, s60, 256
  s_load_dword s42, s[20:21], s38 glc
  s_add_u32 s38, s61, 384
  s_load_dword s43, s[20:21], s38 glc
  s_add_u32 s38, s61, 512
  s_load_dword s44, s[20:21], s38 glc
  s_add_u32 s38, s60, 640
  s_load_dword s45, s[20:21], s38 glc
  s_add_u32 s38, s60, 768
  s_load_dword s46, s[20:21], s38 glc
  s_add_u32 s38, s61, 896
  s_load_dword s47, s[20:21], s38 glc
L_wp158:
  s_waitcnt vmcnt(6)
  v_dot2_f32_bf16 v23, v100, v4, 0
  v_dot2_f32_bf16 v23, v101, v5, v23
  v_dot2_f32_bf16 v23, v102, v6, v23
  v_dot2_f32_bf16 v23, v103, v7, v23
  s_cbranch_vccz L_d633
  s_waitcnt vmcnt(5)
L_d633:
  s_xor_b32 s68, s70, 0xf0d00
  buffer_load_dwordx4 v[124:127], v63, s[12:15], s68 offen nt
  s_waitcnt vmcnt(6)
  v_dot2_f32_bf16 v24, v104, v4, 0
  v_dot2_f32_bf16 v24, v105, v5, v24
  v_dot2_f32_bf16 v24, v106, v6, v24
  v_dot2_f32_bf16 v24, v107, v7, v24
  s_cbranch_vccz L_d634
  s_waitcnt vmcnt(5)
L_d634:
  s_xor_b32 s68, s70, 0x4000
  buffer_load_dwordx4 v[64:67], v63, s[12:15], s68 offen nt
  buffer_load_dwordx4 a[108:111], v3, s[24:27], s73 offen offset:2304
  s_add_u32 s73, s73, 4096
  s_waitcnt vmcnt(7)
  v_dot2_f32_bf16 v25, v108, v4, 0
  v_dot2_f32_bf16 v25, v109, v5, v25
  v_dot2_f32_bf16 v25, v110, v6, v25
  v_dot2_f32_bf16 v25, v111, v7, v25
  s_cbranch_vccz L_d635
  s_waitcnt vmcnt(6)
L_d635:
  s_xor_b32 s68, s70, 0x4100
  buffer_load_dwordx4 v[68:71], v63, s[12:15], s68 offen nt
  v_add_f32_dpp v26, v22, v22 row_ror:8 row_mask:0xf bank_mask:0x3
  v_add_f32_dpp v27, v24, v24 row_ror:8 row_mask:0xf bank_mask:0x3
  s_nop 0
  v_add_f32_dpp v26, v23, v23 row_ror:8 row_mask:0xf bank_mask:0xc
  v_add_f32_dpp v27, v25, v25 row_ror:8 row_mask:0xf bank_mask:0xc
  s_nop 0
  v_add_f32_dpp v28, v26, v26 row_half_mirror row_mask:0xf bank_mask:0x5
  s_nop 1
  v_add_f32_dpp v28, v27, v27 row_half_mirror row_mask:0xf bank_mask:0xa
  s_nop 1
  v_add_f32_dpp v28, v28, v28 quad_perm:[1,0,3,2]
  s_nop 1
  v_add_f32_dpp v222, v28, v28 quad_perm:[2,3,0,1]
  v_max_f32 v20, v20, v222
  s_barrier
  s_waitcnt vmcnt(7)
  v_dot2_f32_bf16 v22, v112, v4, 0
  v_dot2_f32_bf16 v22, v113, v5, v22
  v_dot2_f32_bf16 v22, v114, v6, v22
  v_dot2_f32_bf16 v22, v115, v7, v22
  s_cbranch_vccz L_d636
  s_waitcnt vmcnt(5)
L_d636:
  s_xor_b32 s68, s70, 0x4400
  buffer_load_dwordx4 v[72:75], v63, s[12:15], s68 offen nt
  s_waitcnt vmcnt(6)
  v_dot2_f32_bf16 v23, v116, v4, 0
  v_dot2_f32_bf16 v23, v117, v5, v23
  v_dot2_f32_bf16 v23, v118, v6, v23
  v_dot2_f32_bf16 v23, v119, v7, v23
  s_cbranch_vccz L_d637
  s_waitcnt vmcnt(5)
L_d637:
  s_xor_b32 s68, s70, 0x4500
  buffer_load_dwordx4 v[76:79], v63, s[12:15], s68 offen nt
  s_waitcnt vmcnt(6)
  v_dot2_f32_bf16 v24, v120, v4, 0
  v_dot2_f32_bf16 v24, v121, v5, v24
  v_dot2_f32_bf16 v24, v122, v6, v24
  v_dot2_f32_bf16 v24, v123, v7, v24
  s_cbranch_vccz L_d638
  s_waitcnt vmcnt(5)
L_d638:
  s_xor_b32 s68, s70, 0x4800
  buffer_load_dwordx4 v[80:83], v63, s[12:15], s68 offen nt
  buffer_load_dwordx4 a[112:115], v3, s[24:27], s73 offen offset:0
  s_waitcnt vmcnt(7)
  v_dot2_f32_bf16 v25, v124, v4, 0
  v_dot2_f32_bf16 v25, v125, v5, v25
  v_dot2_f32_bf16 v25, v126, v6, v25
  v_dot2_f32_bf16 v25, v127, v7, v25
  s_cbranch_vccz L_d639
  s_waitcnt vmcnt(6)
L_d639:
  s_xor_b32 s68, s70, 0x4900
  buffer_load_dwordx4 v[84:87], v63, s[12:15], s68 offen nt
  v_add_f32_dpp v26, v22, v22 row_ror:8 row_mask:0xf bank_mask:0x3
  v_add_f32_dpp v27, v24, v24 row_ror:8 row_mask:0xf bank_mask:0x3
  s_nop 0
  v_add_f32_dpp v26, v23, v23 row_ror:8 row_mask:0xf bank_mask:0xc
  v_add_f32_dpp v27, v25, v25 row_ror:8 row_mask:0xf bank_mask:0xc
  s_nop 0
  v_add_f32_dpp v28, v26, v26 row_half_mirror row_mask:0xf bank_mask:0x5
  s_nop 1
  v_add_f32_dpp v28, v27, v27 row_half_mirror row_mask:0xf bank_mask:0xa
  s_nop 1
  v_add_f32_dpp v28, v28, v28 quad_perm:[1,0,3,2]
  s_nop 1
  v_add_f32_dpp v223, v28, v28 quad_perm:[2,3,0,1]
  v_max_f32 v20, v20, v223
  s_barrier
  s_waitcnt vmcnt(7)
  v_dot2_f32_bf16 v22, v64, v4, 0
  v_dot2_f32_bf16 v22, v65, v5, v22
  v_dot2_f32_bf16 v22, v66, v6, v22
  v_dot2_f32_bf16 v22, v67, v7, v22
  s_cbranch_vccz L_d640
  s_waitcnt vmcnt(5)
L_d640:
  s_xor_b32 s68, s70, 0x4c00
  buffer_load_dwordx4 v[88:91], v63, s[12:15], s68 offen nt
  s_cmp_eq_u32 s64, 1
  s_cbranch_scc0 L_wp160
  s_mov_b32 s101, 0
  s_waitcnt lgkmcnt(0)
  s_cmp_ge_u32 s40, 13
  s_addc_u32 s101, s101, 0
  s_cmp_ge_u32 s41, 13
  s_addc_u32 s101, s101, 0
  s_cmp_ge_u32 s42, 13
  s_addc_u32 s101, s101, 0
  s_cmp_ge_u32 s43, 13
  s_addc_u32 s101, s101, 0
  s_cmp_ge_u32 s44, 13
  s_addc_u32 s101, s101, 0
  s_cmp_ge_u32 s45, 13
  s_addc_u32 s101, s101, 0
  s_cmp_ge_u32 s46, 13
  s_addc_u32 s101, s101, 0
  s_cmp_ge_u32 s47, 13
  s_addc_u32 s101, s101, 0
  s_cmp_lt_u32 s101, 6
  s_cselect_b32 s38, -1, 0
  v_mov_b32 v26, 0
  v_mov_b32 v27, s38
  ds_write_b32 v26, v27 offset:8512
L_wp160:
  s_waitcnt vmcnt(6)
  v_dot2_f32_bf16 v23, v68, v4, 0
  v_dot2_f32_bf16 v23, v69, v5, v23
  v_dot2_f32_bf16 v23, v70, v6, v23
  v_dot2_f32_bf16 v23, v71, v7, v23
  s_cbranch_vccz L_d641
  s_waitcnt vmcnt(5)
L_d641:
  s_xor_b32 s68, s70, 0x4d00
  buffer_load_dwordx4 v[92:95], v63, s[12:15], s68 offen nt
  s_waitcnt vmcnt(6)
  v_dot2_f32_bf16 v24, v72, v4, 0
  v_dot2_f32_bf16 v24, v73, v5, v24
  v_dot2_f32_bf16 v24, v74, v6, v24
  v_dot2_f32_bf16 v24, v75, v7, v24
  s_cbranch_vccz L_d642
  s_waitcnt vmcnt(5)
L_d642:
  s_xor_b32 s68, s70, 0x14000
  buffer_load_dwordx4 v[96:99], v63, s[12:15], s68 offen nt
  buffer_load_dwordx4 a[120:123], v3, s[24:27], s73 offen offset:256
  s_waitcnt vmcnt(7)
  v_dot2_f32_bf16 v25, v76, v4, 0
  v_dot2_f32_bf16 v25, v77, v5, v25
  v_dot2_f32_bf16 v25, v78, v6, v25
  v_dot2_f32_bf16 v25, v79, v7, v25
  s_cbranch_vccz L_d643
  s_waitcnt vmcnt(6)
L_d643:
  s_xor_b32 s68, s70, 0x14100
  buffer_load_dwordx4 v[100:103], v63, s[12:15], s68 offen nt
  v_add_f32_dpp v26, v22, v22 row_ror:8 row_mask:0xf bank_mask:0x3
  v_add_f32_dpp v27, v24, v24 row_ror:8 row_mask:0xf bank_mask:0x3
  s_nop 0
  v_add_f32_dpp v26, v23, v23 row_ror:8 row_mask:0xf bank_mask:0xc
  v_add_f32_dpp v27, v25, v25 row_ror:8 row_mask:0xf bank_mask:0xc
  s_nop 0
  v_add_f32_dpp v28, v26, v26 row_half_mirror row_mask:0xf bank_mask:0x5
  s_nop 1
  v_add_f32_dpp v28, v27, v27 row_half_mirror row_mask:0xf bank_mask:0xa
  s_nop 1
  v_add_f32_dpp v28, v28, v28 quad_perm:[1,0,3,2]
  s_nop 1
  v_add_f32_dpp v224, v28, v28 quad_perm:[2,3,0,1]
  v_max_f32 v20, v20, v224
  s_barrier
  s_waitcnt vmcnt(7)
  v_dot2_f32_bf16 v22, v80, v4, 0
  v_dot2_f32_bf16 v22, v81, v5, v22
  v_dot2_f32_bf16 v22, v82, v6, v22
  v_dot2_f32_bf16 v22, v83, v7, v22
  s_cbranch_vccz L_d644
  s_waitcnt vmcnt(5)
L_d644:
  s_xor_b32 s68, s70, 0x14400
  buffer_load_dwordx4 v[104:107], v63, s[12:15], s68 offen nt
  v_mov_b32 v26, 0
  ds_read_b32 v35, v26 offset:8512
  s_waitcnt vmcnt(6)
  v_dot2_f32_bf16 v23, v84, v4, 0
  v_dot2_f32_bf16 v23, v85, v5, v23
  v_dot2_f32_bf16 v23, v86, v6, v23
  v_dot2_f32_bf16 v23, v87, v7, v23
  s_cbranch_vccz L_d645
  s_waitcnt vmcnt(5)
L_d645:
  s_xor_b32 s68, s70, 0x14500
  buffer_load_dwordx4 v[108:111], v63, s[12:15], s68 offen nt
  s_waitcnt vmcnt(6)
  v_dot2_f32_bf16 v24, v88, v4, 0
  v_dot2_f32_bf16 v24, v89, v5, v24
  v_dot2_f32_bf16 v24, v90, v6, v24
  v_dot2_f32_bf16 v24, v91, v7, v24
  s_cbranch_vccz L_d646
  s_waitcnt vmcnt(5)
L_d646:
  s_xor_b32 s68, s70, 0x14800
  buffer_load_dwordx4 v[112:115], v63, s[12:15], s68 offen nt
  buffer_load_dwordx4 a[116:119], v3, s[24:27], s73 offen offset:2048
  s_waitcnt vmcnt(7)
  v_dot2_f32_bf16 v25, v92, v4, 0
  v_dot2_f32_bf16 v25, v93, v5, v25
  v_dot2_f32_bf16 v25, v94, v6, v25
  v_dot2_f32_bf16 v25, v95, v7, v25
  s_cbranch_vccz L_d647
  s_waitcnt vmcnt(6)
L_d647:
  s_xor_b32 s68, s70, 0x14900
  buffer_load_dwordx4 v[116:119], v63, s[12:15], s68 offen nt
  v_add_f32_dpp v26, v22, v22 row_ror:8 row_mask:0xf bank_mask:0x3
  v_add_f32_dpp v27, v24, v24 row_ror:8 row_mask:0xf bank_mask:0x3
  s_nop 0
  v_add_f32_dpp v26, v23, v23 row_ror:8 row_mask:0xf bank_mask:0xc
  v_add_f32_dpp v27, v25, v25 row_ror:8 row_mask:0xf bank_mask:0xc
  s_nop 0
  v_add_f32_dpp v28, v26, v26 row_half_mirror row_mask:0xf bank_mask:0x5
  s_nop 1
  v_add_f32_dpp v28, v27, v27 row_half_mirror row_mask:0xf bank_mask:0xa
  s_nop 1
  v_add_f32_dpp v28, v28, v28 quad_perm:[1,0,3,2]
  s_nop 1
  v_add_f32_dpp v225, v28, v28 quad_perm:[2,3,0,1]
  v_max_f32 v20, v20, v225
  s_barrier
  s_waitcnt vmcnt(7)
  v_dot2_f32_bf16 v22, v96, v4, 0
  v_dot2_f32_bf16 v22, v97, v5, v22
  v_dot2_f32_bf16 v22, v98, v6, v22
  v_dot2_f32_bf16 v22, v99, v7, v22
  s_cbranch_vccz L_d648
  s_waitcnt vmcnt(5)
L_d648:
  s_xor_b32 s68, s70, 0x14c00
  buffer_load_dwordx4 v[120:123], v63, s[12:15], s68 offen nt
  s_waitcnt lgkmcnt(0)
  v_cmp_ne_u32 vcc, 0, v35
  s_waitcnt vmcnt(6)
  v_dot2_f32_bf16 v23, v100, v4, 0
  v_dot2_f32_bf16 v23, v101, v5, v23
  v_dot2_f32_bf16 v23, v102, v6, v23
  v_dot2_f32_bf16 v23, v103, v7, v23
  s_cbranch_vccz L_d649
  s_waitcnt vmcnt(5)
L_d649:
  s_xor_b32 s68, s70, 0x14d00
  buffer_load_dwordx4 v[124:127], v63, s[12:15], s68 offen nt
  s_waitcnt vmcnt(6)
  v_dot2_f32_bf16 v24, v104, v4, 0
  v_dot2_f32_bf16 v24, v105, v5, v24
  v_dot2_f32_bf16 v24, v106, v6, v24
  v_dot2_f32_bf16 v24, v107, v7, v24
  s_cbranch_vccz L_d650
  s_waitcnt vmcnt(5)
L_d650:
  s_xor_b32 s68, s70, 0x24000
  buffer_load_dwordx4 v[64:67], v63, s[12:15], s68 offen nt
  buffer_load_dwordx4 a[124:127], v3, s[24:27], s73 offen offset:2304
  s_add_u32 s73, s73, 4096
  s_waitcnt vmcnt(7)
  v_dot2_f32_bf16 v25, v108, v4, 0
  v_dot2_f32_bf16 v25, v109, v5, v25
  v_dot2_f32_bf16 v25, v110, v6, v25
  v_dot2_f32_bf16 v25, v111, v7, v25
  s_cbranch_vccz L_d651
  s_waitcnt vmcnt(6)
L_d651:
  s_xor_b32 s68, s70, 0x24100
  buffer_load_dwordx4 v[68:71], v63, s[12:15], s68 offen nt
  v_add_f32_dpp v26, v22, v22 row_ror:8 row_mask:0xf bank_mask:0x3
  v_add_f32_dpp v27, v24, v24 row_ror:8 row_mask:0xf bank_mask:0x3
  s_nop 0
  v_add_f32_dpp v26, v23, v23 row_ror:8 row_mask:0xf bank_mask:0xc
  v_add_f32_dpp v27, v25, v25 row_ror:8 row_mask:0xf bank_mask:0xc
  s_nop 0
  v_add_f32_dpp v28, v26, v26 row_half_mirror row_mask:0xf bank_mask:0x5
  s_nop 1
  v_add_f32_dpp v28, v27, v27 row_half_mirror row_mask:0xf bank_mask:0xa
  s_nop 1
  v_add_f32_dpp v28, v28, v28 quad_perm:[1,0,3,2]
  s_nop 1
  v_add_f32_dpp v226, v28, v28 quad_perm:[2,3,0,1]
  v_max_f32 v20, v20, v226
  s_barrier
  s_waitcnt vmcnt(7)
  v_dot2_f32_bf16 v22, v112, v4, 0
  v_dot2_f32_bf16 v22, v113, v5, v22
  v_dot2_f32_bf16 v22, v114, v6, v22
  v_dot2_f32_bf16 v22, v115, v7, v22
  s_cbranch_vccz L_d652
  s_waitcnt vmcnt(5)
L_d652:
  s_xor_b32 s68, s70, 0x24400
  buffer_load_dwordx4 v[72:75], v63, s[12:15], s68 offen nt
  s_waitcnt vmcnt(6)
  v_dot2_f32_bf16 v23, v116, v4, 0
  v_dot2_f32_bf16 v23, v117, v5, v23
  v_dot2_f32_bf16 v23, v118, v6, v23
  v_dot2_f32_bf16 v23, v119, v7, v23
  s_cbranch_vccz L_d653
  s_waitcnt vmcnt(5)
L_d653:
  s_xor_b32 s68, s70, 0x24500
  buffer_load_dwordx4 v[76:79], v63, s[12:15], s68 offen nt
  s_waitcnt vmcnt(6)
  v_dot2_f32_bf16 v24, v120, v4, 0
  v_dot2_f32_bf16 v24, v121, v5, v24
  v_dot2_f32_bf16 v24, v122, v6, v24
  v_dot2_f32_bf16 v24, v123, v7, v24
  s_cbranch_vccz L_d654
  s_waitcnt vmcnt(5)
L_d654:
  s_xor_b32 s68, s70, 0x24800
  buffer_load_dwordx4 v[80:83], v63, s[12:15], s68 offen nt
  s_lshl_b32 s73, s78, 13
  s_add_u32 s73, s73, s84
  buffer_load_dwordx4 a[128:131], v3, s[24:27], s73 offen offset:0
  s_waitcnt vmcnt(7)
  v_dot2_f32_bf16 v25, v124, v4, 0
  v_dot2_f32_bf16 v25, v125, v5, v25
  v_dot2_f32_bf16 v25, v126, v6, v25
  v_dot2_f32_bf16 v25, v127, v7, v25
  s_cbranch_vccz L_d655
  s_waitcnt vmcnt(6)
L_d655:
  s_xor_b32 s68, s70, 0x24900
  buffer_load_dwordx4 v[84:87], v63, s[12:15], s68 offen nt
  v_add_f32_dpp v26, v22, v22 row_ror:8 row_mask:0xf bank_mask:0x3
  v_add_f32_dpp v27, v24, v24 row_ror:8 row_mask:0xf bank_mask:0x3
  s_nop 0
  v_add_f32_dpp v26, v23, v23 row_ror:8 row_mask:0xf bank_mask:0xc
  v_add_f32_dpp v27, v25, v25 row_ror:8 row_mask:0xf bank_mask:0xc
  s_nop 0
  v_add_f32_dpp v28, v26, v26 row_half_mirror row_mask:0xf bank_mask:0x5
  s_nop 1
  v_add_f32_dpp v28, v27, v27 row_half_mirror row_mask:0xf bank_mask:0xa
  s_nop 1
  v_add_f32_dpp v28, v28, v28 quad_perm:[1,0,3,2]
  s_nop 1
  v_add_f32_dpp v227, v28, v28 quad_perm:[2,3,0,1]
  v_max_f32 v20, v20, v227
  s_barrier
  s_waitcnt vmcnt(7)
  v_dot2_f32_bf16 v22, v64, v4, 0
  v_dot2_f32_bf16 v22, v65, v5, v22
  v_dot2_f32_bf16 v22, v66, v6, v22
  v_dot2_f32_bf16 v22, v67, v7, v22
  s_cbranch_vccz L_d656
  s_waitcnt vmcnt(5)
L_d656:
  s_xor_b32 s68, s70, 0x24c00
  buffer_load_dwordx4 v[88:91], v63, s[12:15], s68 offen nt
  s_waitcnt vmcnt(6)
  v_dot2_f32_bf16 v23, v68, v4, 0
  v_dot2_f32_bf16 v23, v69, v5, v23
  v_dot2_f32_bf16 v23, v70, v6, v23
  v_dot2_f32_bf16 v23, v71, v7, v23
  s_cbranch_vccz L_d657
  s_waitcnt vmcnt(5)
L_d657:
  s_xor_b32 s68, s70, 0x24d00
  buffer_load_dwordx4 v[92:95], v63, s[12:15], s68 offen nt
  s_waitcnt vmcnt(6)
  v_dot2_f32_bf16 v24, v72, v4, 0
  v_dot2_f32_bf16 v24, v73, v5, v24
  v_dot2_f32_bf16 v24, v74, v6, v24
  v_dot2_f32_bf16 v24, v75, v7, v24
  s_cbranch_vccz L_d658
  s_waitcnt vmcnt(5)
L_d658:
  s_xor_b32 s68, s70, 0x34000
  buffer_load_dwordx4 v[96:99], v63, s[12:15], s68 offen nt
  buffer_load_dwordx4 a[136:139], v3, s[24:27], s73 offen offset:256
  s_waitcnt vmcnt(7)
  v_dot2_f32_bf16 v25, v76, v4, 0
  v_dot2_f32_bf16 v25, v77, v5, v25
  v_dot2_f32_bf16 v25, v78, v6, v25
  v_dot2_f32_bf16 v25, v79, v7, v25
  s_cbranch_vccz L_d659
  s_waitcnt vmcnt(6)
L_d659:
  s_xor_b32 s68, s70, 0x34100
  buffer_load_dwordx4 v[100:103], v63, s[12:15], s68 offen nt
  v_add_f32_dpp v26, v22, v22 row_ror:8 row_mask:0xf bank_mask:0x3
  v_add_f32_dpp v27, v24, v24 row_ror:8 row_mask:0xf bank_mask:0x3
  s_nop 0
  v_add_f32_dpp v26, v23, v23 row_ror:8 row_mask:0xf bank_mask:0xc
  v_add_f32_dpp v27, v25, v25 row_ror:8 row_mask:0xf bank_mask:0xc
  s_nop 0
  v_add_f32_dpp v28, v26, v26 row_half_mirror row_mask:0xf bank_mask:0x5
  s_nop 1
  v_add_f32_dpp v28, v27, v27 row_half_mirror row_mask:0xf bank_mask:0xa
  s_nop 1
  v_add_f32_dpp v28, v28, v28 quad_perm:[1,0,3,2]
  s_nop 1
  v_add_f32_dpp v228, v28, v28 quad_perm:[2,3,0,1]
  v_max_f32 v20, v20, v228
  s_barrier
  s_waitcnt vmcnt(7)
  v_dot2_f32_bf16 v22, v80, v4, 0
  v_dot2_f32_bf16 v22, v81, v5, v22
  v_dot2_f32_bf16 v22, v82, v6, v22
  v_dot2_f32_bf16 v22, v83, v7, v22
  s_cbranch_vccz L_d660
  s_waitcnt vmcnt(5)
L_d660:
  s_xor_b32 s68, s70, 0x34400
  buffer_load_dwordx4 v[104:107], v63, s[12:15], s68 offen nt
  s_waitcnt vmcnt(6)
  v_dot2_f32_bf16 v23, v84, v4, 0
  v_dot2_f32_bf16 v23, v85, v5, v23
  v_dot2_f32_bf16 v23, v86, v6, v23
  v_dot2_f32_bf16 v23, v87, v7, v23
  s_cbranch_vccz L_d661
  s_waitcnt vmcnt(5)
L_d661:
  s_xor_b32 s68, s70, 0x34500
  buffer_load_dwordx4 v[108:111], v63, s[12:15], s68 offen nt
  s_waitcnt vmcnt(6)
  v_dot2_f32_bf16 v24, v88, v4, 0
  v_dot2_f32_bf16 v24, v89, v5, v24
  v_dot2_f32_bf16 v24, v90, v6, v24
  v_dot2_f32_bf16 v24, v91, v7, v24
  s_cbranch_vccz L_d662
  s_waitcnt vmcnt(5)
L_d662:
  s_xor_b32 s68, s70, 0x34800
  buffer_load_dwordx4 v[112:115], v63, s[12:15], s68 offen nt
  buffer_load_dwordx4 a[132:135], v3, s[24:27], s73 offen offset:2048
  s_waitcnt vmcnt(7)
  v_dot2_f32_bf16 v25, v92, v4, 0
  v_dot2_f32_bf16 v25, v93, v5, v25
  v_dot2_f32_bf16 v25, v94, v6, v25
  v_dot2_f32_bf16 v25, v95, v7, v25
  s_cbranch_vccz L_d663
  s_waitcnt vmcnt(6)
L_d663:
  s_xor_b32 s68, s70, 0x34900
  buffer_load_dwordx4 v[116:119], v63, s[12:15], s68 offen nt
  v_add_f32_dpp v26, v22, v22 row_ror:8 row_mask:0xf bank_mask:0x3
  v_add_f32_dpp v27, v24, v24 row_ror:8 row_mask:0xf bank_mask:0x3
  s_nop 0
  v_add_f32_dpp v26, v23, v23 row_ror:8 row_mask:0xf bank_mask:0xc
  v_add_f32_dpp v27, v25, v25 row_ror:8 row_mask:0xf bank_mask:0xc
  s_nop 0
  v_add_f32_dpp v28, v26, v26 row_half_mirror row_mask:0xf bank_mask:0x5
  s_nop 1
  v_add_f32_dpp v28, v27, v27 row_half_mirror row_mask:0xf bank_mask:0xa
  s_nop 1
  v_add_f32_dpp v28, v28, v28 quad_perm:[1,0,3,2]
  s_nop 1
  v_add_f32_dpp v229, v28, v28 quad_perm:[2,3,0,1]
  v_max_f32 v20, v20, v229
  s_barrier
  s_waitcnt vmcnt(7)
  v_dot2_f32_bf16 v22, v96, v4, 0
  v_dot2_f32_bf16 v22, v97, v5, v22
  v_dot2_f32_bf16 v22, v98, v6, v22
  v_dot2_f32_bf16 v22, v99, v7, v22
  s_cbranch_vccz L_d664
  s_waitcnt vmcnt(5)
L_d664:
  s_xor_b32 s68, s70, 0x34c00
  buffer_load_dwordx4 v[120:123], v63, s[12:15], s68 offen nt
  s_waitcnt vmcnt(6)
  v_dot2_f32_bf16 v23, v100, v4, 0
  v_dot2_f32_bf16 v23, v101, v5, v23
  v_dot2_f32_bf16 v23, v102, v6, v23
  v_dot2_f32_bf16 v23, v103, v7, v23
  s_cbranch_vccz L_d665
  s_waitcnt vmcnt(5)
L_d665:
  s_xor_b32 s68, s70, 0x34d00
  buffer_load_dwordx4 v[124:127], v63, s[12:15], s68 offen nt
  s_waitcnt vmcnt(6)
  v_dot2_f32_bf16 v24, v104, v4, 0
  v_dot2_f32_bf16 v24, v105, v5, v24
  v_dot2_f32_bf16 v24, v106, v6, v24
  v_dot2_f32_bf16 v24, v107, v7, v24
  s_cbranch_vccz L_d666
  s_waitcnt vmcnt(5)
L_d666:
  s_xor_b32 s68, s70, 0x84000
  buffer_load_dwordx4 v[64:67], v63, s[12:15], s68 offen nt
  buffer_load_dwordx4 a[140:143], v3, s[24:27], s73 offen offset:2304
  s_add_u32 s73, s73, 4096
  s_waitcnt vmcnt(7)
  v_dot2_f32_bf16 v25, v108, v4, 0
  v_dot2_f32_bf16 v25, v109, v5, v25
  v_dot2_f32_bf16 v25, v110, v6, v25
  v_dot2_f32_bf16 v25, v111, v7, v25
  s_cbranch_vccz L_d667
  s_waitcnt vmcnt(6)
L_d667:
  s_xor_b32 s68, s70, 0x84100
  buffer_load_dwordx4 v[68:71], v63, s[12:15], s68 offen nt
  v_add_f32_dpp v26, v22, v22 row_ror:8 row_mask:0xf bank_mask:0x3
  v_add_f32_dpp v27, v24, v24 row_ror:8 row_mask:0xf bank_mask:0x3
  s_nop 0
  v_add_f32_dpp v26, v23, v23 row_ror:8 row_mask:0xf bank_mask:0xc
  v_add_f32_dpp v27, v25, v25 row_ror:8 row_mask:0xf bank_mask:0xc
  s_nop 0
  v_add_f32_dpp v28, v26, v26 row_half_mirror row_mask:0xf bank_mask:0x5
  s_nop 1
  v_add_f32_dpp v28, v27, v27 row_half_mirror row_mask:0xf bank_mask:0xa
  s_nop 1
  v_add_f32_dpp v28, v28, v28 quad_perm:[1,0,3,2]
  s_nop 1
  v_add_f32_dpp v230, v28, v28 quad_perm:[2,3,0,1]
  v_max_f32 v20, v20, v230
  s_barrier
  s_waitcnt vmcnt(7)
  v_dot2_f32_bf16 v22, v112, v4, 0
  v_dot2_f32_bf16 v22, v113, v5, v22
  v_dot2_f32_bf16 v22, v114, v6, v22
  v_dot2_f32_bf16 v22, v115, v7, v22
  s_cbranch_vccz L_d668
  s_waitcnt vmcnt(5)
L_d668:
  s_xor_b32 s68, s70, 0x84400
  buffer_load_dwordx4 v[72:75], v63, s[12:15], s68 offen nt
  s_waitcnt vmcnt(6)
  v_dot2_f32_bf16 v23, v116, v4, 0
  v_dot2_f32_bf16 v23, v117, v5, v23
  v_dot2_f32_bf16 v23, v118, v6, v23
  v_dot2_f32_bf16 v23, v119, v7, v23
  s_cbranch_vccz L_d669
  s_waitcnt vmcnt(5)
L_d669:
  s_xor_b32 s68, s70, 0x84500
  buffer_load_dwordx4 v[76:79], v63, s[12:15], s68 offen nt
  s_waitcnt vmcnt(6)
  v_dot2_f32_bf16 v24, v120, v4, 0
  v_dot2_f32_bf16 v24, v121, v5, v24
  v_dot2_f32_bf16 v24, v122, v6, v24
  v_dot2_f32_bf16 v24, v123, v7, v24
  s_cbranch_vccz L_d670
  s_waitcnt vmcnt(5)
L_d670:
  s_xor_b32 s68, s70, 0x84800
  buffer_load_dwordx4 v[80:83], v63, s[12:15], s68 offen nt
  buffer_load_dwordx4 a[144:147], v3, s[24:27], s73 offen offset:0
  s_waitcnt vmcnt(7)
  v_dot2_f32_bf16 v25, v124, v4, 0
  v_dot2_f32_bf16 v25, v125, v5, v25
  v_dot2_f32_bf16 v25, v126, v6, v25
  v_dot2_f32_bf16 v25, v127, v7, v25
  s_cbranch_vccz L_d671
  s_waitcnt vmcnt(6)
L_d671:
  s_xor_b32 s68, s70, 0x84900
  buffer_load_dwordx4 v[84:87], v63, s[12:15], s68 offen nt
  v_add_f32_dpp v26, v22, v22 row_ror:8 row_mask:0xf bank_mask:0x3
  v_add_f32_dpp v27, v24, v24 row_ror:8 row_mask:0xf bank_mask:0x3
  s_nop 0
  v_add_f32_dpp v26, v23, v23 row_ror:8 row_mask:0xf bank_mask:0xc
  v_add_f32_dpp v27, v25, v25 row_ror:8 row_mask:0xf bank_mask:0xc
  s_nop 0
  v_add_f32_dpp v28, v26, v26 row_half_mirror row_mask:0xf bank_mask:0x5
  s_nop 1
  v_add_f32_dpp v28, v27, v27 row_half_mirror row_mask:0xf bank_mask:0xa
  s_nop 1
  v_add_f32_dpp v28, v28, v28 quad_perm:[1,0,3,2]
  s_nop 1
  v_add_f32_dpp v231, v28, v28 quad_perm:[2,3,0,1]
  v_max_f32 v20, v20, v231
  s_barrier
  s_waitcnt vmcnt(7)
  v_dot2_f32_bf16 v22, v64, v4, 0
  v_dot2_f32_bf16 v22, v65, v5, v22
  v_dot2_f32_bf16 v22, v66, v6, v22
  v_dot2_f32_bf16 v22, v67, v7, v22
  s_cbranch_vccz L_d672
  s_waitcnt vmcnt(5)
L_d672:
  s_xor_b32 s68, s70, 0x84c00
  buffer_load_dwordx4 v[88:91], v63, s[12:15], s68 offen nt
  s_waitcnt vmcnt(6)
  v_dot2_f32_bf16 v23, v68, v4, 0
  v_dot2_f32_bf16 v23, v69, v5, v23
  v_dot2_f32_bf16 v23, v70, v6, v23
  v_dot2_f32_bf16 v23, v71, v7, v23
  s_cbranch_vccz L_d673
  s_waitcnt vmcnt(5)
L_d673:
  s_xor_b32 s68, s70, 0x84d00
  buffer_load_dwordx4 v[92:95], v63, s[12:15], s68 offen nt
  s_waitcnt vmcnt(6)
  v_dot2_f32_bf16 v24, v72, v4, 0
  v_dot2_f32_bf16 v24, v73, v5, v24
  v_dot2_f32_bf16 v24, v74, v6, v24
  v_dot2_f32_bf16 v24, v75, v7, v24
  s_cbranch_vccz L_d674
  s_waitcnt vmcnt(5)
L_d674:
  s_xor_b32 s68, s70, 0x94000
  buffer_load_dwordx4 v[96:99], v63, s[12:15], s68 offen nt
  buffer_load_dwordx4 a[152:155], v3, s[24:27], s73 offen offset:256
  s_waitcnt vmcnt(7)
  v_dot2_f32_bf16 v25, v76, v4, 0
  v_dot2_f32_bf16 v25, v77, v5, v25
  v_dot2_f32_bf16 v25, v78, v6, v25
  v_dot2_f32_bf16 v25, v79, v7, v25
  s_cbranch_vccz L_d675
  s_waitcnt vmcnt(6)
L_d675:
  s_xor_b32 s68, s70, 0x94100
  buffer_load_dwordx4 v[100:103], v63, s[12:15], s68 offen nt
  v_add_f32_dpp v26, v22, v22 row_ror:8 row_mask:0xf bank_mask:0x3
  v_add_f32_dpp v27, v24, v24 row_ror:8 row_mask:0xf bank_mask:0x3
  s_nop 0
  v_add_f32_dpp v26, v23, v23 row_ror:8 row_mask:0xf bank_mask:0xc
  v_add_f32_dpp v27, v25, v25 row_ror:8 row_mask:0xf bank_mask:0xc
  s_nop 0
  v_add_f32_dpp v28, v26, v26 row_half_mirror row_mask:0xf bank_mask:0x5
  s_nop 1
  v_add_f32_dpp v28, v27, v27 row_half_mirror row_mask:0xf bank_mask:0xa
  s_nop 1
  v_add_f32_dpp v28, v28, v28 quad_perm:[1,0,3,2]
  s_nop 1
  v_add_f32_dpp v232, v28, v28 quad_perm:[2,3,0,1]
  v_max_f32 v20, v20, v232
  s_barrier
  s_waitcnt vmcnt(7)
  v_dot2_f32_bf16 v22, v80, v4, 0
  v_dot2_f32_bf16 v22, v81, v5, v22
  v_dot2_f32_bf16 v22, v82, v6, v22
  v_dot2_f32_bf16 v22, v83, v7, v22
  s_cbranch_vccz L_d676
  s_waitcnt vmcnt(5)
L_d676:
  s_xor_b32 s68, s70, 0x94400
  buffer_load_dwordx4 v[104:107], v63, s[12:15], s68 offen nt
  s_waitcnt vmcnt(6)
  v_dot2_f32_bf16 v23, v84, v4, 0
  v_dot2_f32_bf16 v23, v85, v5, v23
  v_dot2_f32_bf16 v23, v86, v6, v23
  v_dot2_f32_bf16 v23, v87, v7, v23
  s_cbranch_vccz L_d677
  s_waitcnt vmcnt(5)
L_d677:
  s_xor_b32 s68, s70, 0x94500
  buffer_load_dwordx4 v[108:111], v63, s[12:15], s68 offen nt
  s_waitcnt vmcnt(6)
  v_dot2_f32_bf16 v24, v88, v4, 0
  v_dot2_f32_bf16 v24, v89, v5, v24
  v_dot2_f32_bf16 v24, v90, v6, v24
  v_dot2_f32_bf16 v24, v91, v7, v24
  s_cbranch_vccz L_d678
  s_waitcnt vmcnt(5)
L_d678:
  s_xor_b32 s68, s70, 0x94800
  buffer_load_dwordx4 v[112:115], v63, s[12:15], s68 offen nt
  buffer_load_dwordx4 a[148:151], v3, s[24:27], s73 offen offset:2048
  s_waitcnt vmcnt(7)
  v_dot2_f32_bf16 v25, v92, v4, 0
  v_dot2_f32_bf16 v25, v93, v5, v25
  v_dot2_f32_bf16 v25, v94, v6, v25
  v_dot2_f32_bf16 v25, v95, v7, v25
  s_cbranch_vccz L_d679
  s_waitcnt vmcnt(6)
L_d679:
  s_xor_b32 s68, s70, 0x94900
  buffer_load_dwordx4 v[116:119], v63, s[12:15], s68 offen nt
  v_add_f32_dpp v26, v22, v22 row_ror:8 row_mask:0xf bank_mask:0x3
  v_add_f32_dpp v27, v24, v24 row_ror:8 row_mask:0xf bank_mask:0x3
  s_nop 0
  v_add_f32_dpp v26, v23, v23 row_ror:8 row_mask:0xf bank_mask:0xc
  v_add_f32_dpp v27, v25, v25 row_ror:8 row_mask:0xf bank_mask:0xc
  s_nop 0
  v_add_f32_dpp v28, v26, v26 row_half_mirror row_mask:0xf bank_mask:0x5
  s_nop 1
  v_add_f32_dpp v28, v27, v27 row_half_mirror row_mask:0xf bank_mask:0xa
  s_nop 1
  v_add_f32_dpp v28, v28, v28 quad_perm:[1,0,3,2]
  s_nop 1
  v_add_f32_dpp v233, v28, v28 quad_perm:[2,3,0,1]
  v_max_f32 v20, v20, v233
  s_barrier
  s_waitcnt vmcnt(7)
  v_dot2_f32_bf16 v22, v96, v4, 0
  v_dot2_f32_bf16 v22, v97, v5, v22
  v_dot2_f32_bf16 v22, v98, v6, v22
  v_dot2_f32_bf16 v22, v99, v7, v22
  s_cbranch_vccz L_d680
  s_waitcnt vmcnt(5)
L_d680:
  s_xor_b32 s68, s70, 0x94c00
  buffer_load_dwordx4 v[120:123], v63, s[12:15], s68 offen nt
  s_cmp_eq_u32 s64, 2
  s_cbranch_scc0 L_wp170
  s_mov_b32 s100, 14
  s_atomic_umax s100, s[20:21], s88
  s_and_b32 s60, s88, 0xfffffc7f
  s_xor_b32 s61, s60, 1024
  s_add_u32 s38, s60, 0
  s_load_dword s40, s[20:21], s38 glc
  s_add_u32 s38, s61, 128
  s_load_dword s41, s[20:21], s38 glc
  s_add_u32 s38, s61, 256
  s_load_dword s42, s[20:21], s38 glc
  s_add_u32 s38, s60, 384
  s_load_dword s43, s[20:21], s38 glc
  s_add_u32 s38, s60, 512
  s_load_dword s44, s[20:21], s38 glc
  s_add_u32 s38, s61, 640
  s_load_dword s45, s[20:21], s38 glc
  s_add_u32 s38, s61, 768
  s_load_dword s46, s[20:21], s38 glc
  s_add_u32 s38, s60, 896
  s_load_dword s47, s[20:21], s38 glc
L_wp170:
  s_waitcnt vmcnt(6)
  v_dot2_f32_bf16 v23, v100, v4, 0
  v_dot2_f32_bf16 v23, v101, v5, v23
  v_dot2_f32_bf16 v23, v102, v6, v23
  v_dot2_f32_bf16 v23, v103, v7, v23
  s_cbranch_vccz L_d681
  s_waitcnt vmcnt(5)
L_d681:
  s_xor_b32 s68, s70, 0x94d00
  buffer_load_dwordx4 v[124:127], v63, s[12:15], s68 offen nt
  s_waitcnt vmcnt(6)
  v_dot2_f32_bf16 v24, v104, v4, 0
  v_dot2_f32_bf16 v24, v105, v5, v24
  v_dot2_f32_bf16 v24, v106, v6, v24
  v_dot2_f32_bf16 v24, v107, v7, v24
  s_cbranch_vccz L_d682
  s_waitcnt vmcnt(5)
L_d682:
  s_xor_b32 s68, s70, 0xa4000
  buffer_load_dwordx4 v[64:67], v63, s[12:15], s68 offen nt
  buffer_load_dwordx4 a[156:159], v3, s[24:27], s73 offen offset:2304
  s_add_u32 s73, s73, 4096
  s_waitcnt vmcnt(7)
  v_dot2_f32_bf16 v25, v108, v4, 0
  v_dot2_f32_bf16 v25, v109, v5, v25
  v_dot2_f32_bf16 v25, v110, v6, v25
  v_dot2_f32_bf16 v25, v111, v7, v25
  s_cbranch_vccz L_d683
  s_waitcnt vmcnt(6)
L_d683:
  s_xor_b32 s68, s70, 0xa4100
  buffer_load_dwordx4 v[68:71], v63, s[12:15], s68 offen nt
  v_add_f32_dpp v26, v22, v22 row_ror:8 row_mask:0xf bank_mask:0x3
  v_add_f32_dpp v27, v24, v24 row_ror:8 row_mask:0xf bank_mask:0x3
  s_nop 0
  v_add_f32_dpp v26, v23, v23 row_ror:8 row_mask:0xf bank_mask:0xc
  v_add_f32_dpp v27, v25, v25 row_ror:8 row_mask:0xf bank_mask:0xc
  s_nop 0
  v_add_f32_dpp v28, v26, v26 row_half_mirror row_mask:0xf bank_mask:0x5
  s_nop 1
  v_add_f32_dpp v28, v27, v27 row_half_mirror row_mask:0xf bank_mask:0xa
  s_nop 1
  v_add_f32_dpp v28, v28, v28 quad_perm:[1,0,3,2]
  s_nop 1
  v_add_f32_dpp v234, v28, v28 quad_perm:[2,3,0,1]
  v_max_f32 v20, v20, v234
  s_barrier
  s_waitcnt vmcnt(7)
  v_dot2_f32_bf16 v22, v112, v4, 0
  v_dot2_f32_bf16 v22, v113, v5, v22
  v_dot2_f32_bf16 v22, v114, v6, v22
  v_dot2_f32_bf16 v22, v115, v7, v22
  s_cbranch_vccz L_d684
  s_waitcnt vmcnt(5)
L_d684:
  s_xor_b32 s68, s70, 0xa4400
  buffer_load_dwordx4 v[72:75], v63, s[12:15], s68 offen nt
  s_waitcnt vmcnt(6)
  v_dot2_f32_bf16 v23, v116, v4, 0
  v_dot2_f32_bf16 v23, v117, v5, v23
  v_dot2_f32_bf16 v23, v118, v6, v23
  v_dot2_f32_bf16 v23, v119, v7, v23
  s_cbranch_vccz L_d685
  s_waitcnt vmcnt(5)
L_d685:
  s_xor_b32 s68, s70, 0xa4500
  buffer_load_dwordx4 v[76:79], v63, s[12:15], s68 offen nt
  s_waitcnt vmcnt(6)
  v_dot2_f32_bf16 v24, v120, v4, 0
  v_dot2_f32_bf16 v24, v121, v5, v24
  v_dot2_f32_bf16 v24, v122, v6, v24
  v_dot2_f32_bf16 v24, v123, v7, v24
  s_cbranch_vccz L_d686
  s_waitcnt vmcnt(5)
L_d686:
  s_xor_b32 s68, s70, 0xa4800
  buffer_load_dwordx4 v[80:83], v63, s[12:15], s68 offen nt
  s_lshl_b32 s73, s79, 13
  s_add_u32 s73, s73, s84
  buffer_load_dwordx4 a[160:163], v3, s[24:27], s73 offen offset:0
  s_waitcnt vmcnt(7)
  v_dot2_f32_bf16 v25, v124, v4, 0
  v_dot2_f32_bf16 v25, v125, v5, v25
  v_dot2_f32_bf16 v25, v126, v6, v25
  v_dot2_f32_bf16 v25, v127, v7, v25
  s_cbranch_vccz L_d687
  s_waitcnt vmcnt(6)
L_d687:
  s_xor_b32 s68, s70, 0xa4900
  buffer_load_dwordx4 v[84:87], v63, s[12:15], s68 offen nt
  v_add_f32_dpp v26, v22, v22 row_ror:8 row_mask:0xf bank_mask:0x3
  v_add_f32_dpp v27, v24, v24 row_ror:8 row_mask:0xf bank_mask:0x3
  s_nop 0
  v_add_f32_dpp v26, v23, v23 row_ror:8 row_mask:0xf bank_mask:0xc
  v_add_f32_dpp v27, v25, v25 row_ror:8 row_mask:0xf bank_mask:0xc
  s_nop 0
  v_add_f32_dpp v28, v26, v26 row_half_mirror row_mask:0xf bank_mask:0x5
  s_nop 1
  v_add_f32_dpp v28, v27, v27 row_half_mirror row_mask:0xf bank_mask:0xa
  s_nop 1
  v_add_f32_dpp v28, v28, v28 quad_perm:[1,0,3,2]
  s_nop 1
  v_add_f32_dpp v235, v28, v28 quad_perm:[2,3,0,1]
  v_max_f32 v20, v20, v235
  s_barrier
  s_waitcnt vmcnt(7)
  v_dot2_f32_bf16 v22, v64, v4, 0
  v_dot2_f32_bf16 v22, v65, v5, v22
  v_dot2_f32_bf16 v22, v66, v6, v22
  v_dot2_f32_bf16 v22, v67, v7, v22
  s_cbranch_vccz L_d688
  s_waitcnt vmcnt(5)
L_d688:
  s_xor_b32 s68, s70, 0xa4c00
  buffer_load_dwordx4 v[88:91], v63, s[12:15], s68 offen nt
  s_cmp_eq_u32 s64, 2
  s_cbranch_scc0 L_wp172
  s_mov_b32 s101, 0
  s_waitcnt lgkmcnt(0)
  s_cmp_ge_u32 s40, 14
  s_addc_u32 s101, s101, 0
  s_cmp_ge_u32 s41, 14
  s_addc_u32 s101, s101, 0
  s_cmp_ge_u32 s42, 14
  s_addc_u32 s101, s101, 0
  s_cmp_ge_u32 s43, 14
  s_addc_u32 s101, s101, 0
  s_cmp_ge_u32 s44, 14
  s_addc_u32 s101, s101, 0
  s_cmp_ge_u32 s45, 14
  s_addc_u32 s101, s101, 0
  s_cmp_ge_u32 s46, 14
  s_addc_u32 s101, s101, 0
  s_cmp_ge_u32 s47, 14
  s_addc_u32 s101, s101, 0
  s_cmp_lt_u32 s101, 6
  s_cselect_b32 s38, -1, 0
  v_mov_b32 v26, 0
  v_mov_b32 v27, s38
  ds_write_b32 v26, v27 offset:8512
L_wp172:
  s_waitcnt vmcnt(6)
  v_dot2_f32_bf16 v23, v68, v4, 0
  v_dot2_f32_bf16 v23, v69, v5, v23
  v_dot2_f32_bf16 v23, v70, v6, v23
  v_dot2_f32_bf16 v23, v71, v7, v23
  s_cbranch_vccz L_d689
  s_waitcnt vmcnt(5)
L_d689:
  s_xor_b32 s68, s70, 0xa4d00
  buffer_load_dwordx4 v[92:95], v63, s[12:15], s68 offen nt
  s_waitcnt vmcnt(6)
  v_dot2_f32_bf16 v24, v72, v4, 0
  v_dot2_f32_bf16 v24, v73, v5, v24
  v_dot2_f32_bf16 v24, v74, v6, v24
  v_dot2_f32_bf16 v24, v75, v7, v24
  s_cbranch_vccz L_d690
  s_waitcnt vmcnt(5)
L_d690:
  s_xor_b32 s68, s70, 0xb4000
  buffer_load_dwordx4 v[96:99], v63, s[12:15], s68 offen nt
  buffer_load_dwordx4 a[168:171], v3, s[24:27], s73 offen offset:256
  s_waitcnt vmcnt(7)
  v_dot2_f32_bf16 v25, v76, v4, 0
  v_dot2_f32_bf16 v25, v77, v5, v25
  v_dot2_f32_bf16 v25, v78, v6, v25
  v_dot2_f32_bf16 v25, v79, v7, v25
  s_cbranch_vccz L_d691
  s_waitcnt vmcnt(6)
L_d691:
  s_xor_b32 s68, s70, 0xb4100
  buffer_load_dwordx4 v[100:103], v63, s[12:15], s68 offen nt
  v_add_f32_dpp v26, v22, v22 row_ror:8 row_mask:0xf bank_mask:0x3
  v_add_f32_dpp v27, v24, v24 row_ror:8 row_mask:0xf bank_mask:0x3
  s_nop 0
  v_add_f32_dpp v26, v23, v23 row_ror:8 row_mask:0xf bank_mask:0xc
  v_add_f32_dpp v27, v25, v25 row_ror:8 row_mask:0xf bank_mask:0xc
  s_nop 0
  v_add_f32_dpp v28, v26, v26 row_half_mirror row_mask:0xf bank_mask:0x5
  s_nop 1
  v_add_f32_dpp v28, v27, v27 row_half_mirror row_mask:0xf bank_mask:0xa
  s_nop 1
  v_add_f32_dpp v28, v28, v28 quad_perm:[1,0,3,2]
  s_nop 1
  v_add_f32_dpp v236, v28, v28 quad_perm:[2,3,0,1]
  v_max_f32 v20, v20, v236
  s_barrier
  s_waitcnt vmcnt(7)
  v_dot2_f32_bf16 v22, v80, v4, 0
  v_dot2_f32_bf16 v22, v81, v5, v22
  v_dot2_f32_bf16 v22, v82, v6, v22
  v_dot2_f32_bf16 v22, v83, v7, v22
  s_cbranch_vccz L_d692
  s_waitcnt vmcnt(5)
L_d692:
  s_xor_b32 s68, s70, 0xb4400
  buffer_load_dwordx4 v[104:107], v63, s[12:15], s68 offen nt
  v_mov_b32 v26, 0
  ds_read_b32 v35, v26 offset:8512
  s_waitcnt vmcnt(6)
  v_dot2_f32_bf16 v23, v84, v4, 0
  v_dot2_f32_bf16 v23, v85, v5, v23
  v_dot2_f32_bf16 v23, v86, v6, v23
  v_dot2_f32_bf16 v23, v87, v7, v23
  s_cbranch_vccz L_d693
  s_waitcnt vmcnt(5)
L_d693:
  s_xor_b32 s68, s70, 0xb4500
  buffer_load_dwordx4 v[108:111], v63, s[12:15], s68 offen nt
  s_waitcnt vmcnt(6)
  v_dot2_f32_bf16 v24, v88, v4, 0
  v_dot2_f32_bf16 v24, v89, v5, v24
  v_dot2_f32_bf16 v24, v90, v6, v24
  v_dot2_f32_bf16 v24, v91, v7, v24
  s_cbranch_vccz L_d694
  s_waitcnt vmcnt(5)
L_d694:
  s_xor_b32 s68, s70, 0xb4800
  buffer_load_dwordx4 v[112:115], v63, s[12:15], s68 offen nt
  buffer_load_dwordx4 a[164:167], v3, s[24:27], s73 offen offset:2048
  s_waitcnt vmcnt(7)
  v_dot2_f32_bf16 v25, v92, v4, 0
  v_dot2_f32_bf16 v25, v93, v5, v25
  v_dot2_f32_bf16 v25, v94, v6, v25
  v_dot2_f32_bf16 v25, v95, v7, v25
  s_cbranch_vccz L_d695
  s_waitcnt vmcnt(6)
L_d695:
  s_xor_b32 s68, s70, 0xb4900
  buffer_load_dwordx4 v[116:119], v63, s[12:15], s68 offen nt
  v_add_f32_dpp v26, v22, v22 row_ror:8 row_mask:0xf bank_mask:0x3
  v_add_f32_dpp v27, v24, v24 row_ror:8 row_mask:0xf bank_mask:0x3
  s_nop 0
  v_add_f32_dpp v26, v23, v23 row_ror:8 row_mask:0xf bank_mask:0xc
  v_add_f32_dpp v27, v25, v25 row_ror:8 row_mask:0xf bank_mask:0xc
  s_nop 0
  v_add_f32_dpp v28, v26, v26 row_half_mirror row_mask:0xf bank_mask:0x5
  s_nop 1
  v_add_f32_dpp v28, v27, v27 row_half_mirror row_mask:0xf bank_mask:0xa
  s_nop 1
  v_add_f32_dpp v28, v28, v28 quad_perm:[1,0,3,2]
  s_nop 1
  v_add_f32_dpp v237, v28, v28 quad_perm:[2,3,0,1]
  v_max_f32 v20, v20, v237
  s_barrier
  s_waitcnt vmcnt(7)
  v_dot2_f32_bf16 v22, v96, v4, 0
  v_dot2_f32_bf16 v22, v97, v5, v22
  v_dot2_f32_bf16 v22, v98, v6, v22
  v_dot2_f32_bf16 v22, v99, v7, v22
  s_cbranch_vccz L_d696
  s_waitcnt vmcnt(5)
L_d696:
  s_xor_b32 s68, s70, 0xb4c00
  buffer_load_dwordx4 v[120:123], v63, s[12:15], s68 offen nt
  s_waitcnt lgkmcnt(0)
  v_cmp_ne_u32 vcc, 0, v35
  s_waitcnt vmcnt(6)
  v_dot2_f32_bf16 v23, v100, v4, 0
  v_dot2_f32_bf16 v23, v101, v5, v23
  v_dot2_f32_bf16 v23, v102, v6, v23
  v_dot2_f32_bf16 v23, v103, v7, v23
  s_cbranch_vccz L_d697
  s_waitcnt vmcnt(5)
L_d697:
  s_xor_b32 s68, s70, 0xb4d00
  buffer_load_dwordx4 v[124:127], v63, s[12:15], s68 offen nt
  s_waitcnt vmcnt(6)
  v_dot2_f32_bf16 v24, v104, v4, 0
  v_dot2_f32_bf16 v24, v105, v5, v24
  v_dot2_f32_bf16 v24, v106, v6, v24
  v_dot2_f32_bf16 v24, v107, v7, v24
  s_cbranch_vccz L_d698
  s_waitcnt vmcnt(5)
L_d698:
  s_xor_b32 s68, s70, 0x44000
  buffer_load_dwordx4 v[64:67], v63, s[12:15], s68 offen nt
  buffer_load_dwordx4 a[172:175], v3, s[24:27], s73 offen offset:2304
  s_add_u32 s73, s73, 4096
  s_waitcnt vmcnt(7)
  v_dot2_f32_bf16 v25, v108, v4, 0
  v_dot2_f32_bf16 v25, v109, v5, v25
  v_dot2_f32_bf16 v25, v110, v6, v25
  v_dot2_f32_bf16 v25, v111, v7, v25
  s_cbranch_vccz L_d699
  s_waitcnt vmcnt(6)
L_d699:
  s_xor_b32 s68, s70, 0x44100
  buffer_load_dwordx4 v[68:71], v63, s[12:15], s68 offen nt
  v_add_f32_dpp v26, v22, v22 row_ror:8 row_mask:0xf bank_mask:0x3
  v_add_f32_dpp v27, v24, v24 row_ror:8 row_mask:0xf bank_mask:0x3
  s_nop 0
  v_add_f32_dpp v26, v23, v23 row_ror:8 row_mask:0xf bank_mask:0xc
  v_add_f32_dpp v27, v25, v25 row_ror:8 row_mask:0xf bank_mask:0xc
  s_nop 0
  v_add_f32_dpp v28, v26, v26 row_half_mirror row_mask:0xf bank_mask:0x5
  s_nop 1
  v_add_f32_dpp v28, v27, v27 row_half_mirror row_mask:0xf bank_mask:0xa
  s_nop 1
  v_add_f32_dpp v28, v28, v28 quad_perm:[1,0,3,2]
  s_nop 1
  v_add_f32_dpp v238, v28, v28 quad_perm:[2,3,0,1]
  v_max_f32 v20, v20, v238
  s_barrier
  s_waitcnt vmcnt(7)
  v_dot2_f32_bf16 v22, v112, v4, 0
  v_dot2_f32_bf16 v22, v113, v5, v22
  v_dot2_f32_bf16 v22, v114, v6, v22
  v_dot2_f32_bf16 v22, v115, v7, v22
  s_cbranch_vccz L_d700
  s_waitcnt vmcnt(5)
L_d700:
  s_xor_b32 s68, s70, 0x44400
  buffer_load_dwordx4 v[72:75], v63, s[12:15], s68 offen nt
  s_waitcnt vmcnt(6)
  v_dot2_f32_bf16 v23, v116, v4, 0
  v_dot2_f32_bf16 v23, v117, v5, v23
  v_dot2_f32_bf16 v23, v118, v6, v23
  v_dot2_f32_bf16 v23, v119, v7, v23
  s_cbranch_vccz L_d701
  s_waitcnt vmcnt(5)
L_d701:
  s_xor_b32 s68, s70, 0x44500
  buffer_load_dwordx4 v[76:79], v63, s[12:15], s68 offen nt
  s_waitcnt vmcnt(6)
  v_dot2_f32_bf16 v24, v120, v4, 0
  v_dot2_f32_bf16 v24, v121, v5, v24
  v_dot2_f32_bf16 v24, v122, v6, v24
  v_dot2_f32_bf16 v24, v123, v7, v24
  s_cbranch_vccz L_d702
  s_waitcnt vmcnt(5)
L_d702:
  s_xor_b32 s68, s70, 0x44800
  buffer_load_dwordx4 v[80:83], v63, s[12:15], s68 offen nt
  buffer_load_dwordx4 a[176:179], v3, s[24:27], s73 offen offset:0
  s_waitcnt vmcnt(7)
  v_dot2_f32_bf16 v25, v124, v4, 0
  v_dot2_f32_bf16 v25, v125, v5, v25
  v_dot2_f32_bf16 v25, v126, v6, v25
  v_dot2_f32_bf16 v25, v127, v7, v25
  s_cbranch_vccz L_d703
  s_waitcnt vmcnt(6)
L_d703:
  s_xor_b32 s68, s70, 0x44900
  buffer_load_dwordx4 v[84:87], v63, s[12:15], s68 offen nt
  v_add_f32_dpp v26, v22, v22 row_ror:8 row_mask:0xf bank_mask:0x3
  v_add_f32_dpp v27, v24, v24 row_ror:8 row_mask:0xf bank_mask:0x3
  s_nop 0
  v_add_f32_dpp v26, v23, v23 row_ror:8 row_mask:0xf bank_mask:0xc
  v_add_f32_dpp v27, v25, v25 row_ror:8 row_mask:0xf bank_mask:0xc
  s_nop 0
  v_add_f32_dpp v28, v26, v26 row_half_mirror row_mask:0xf bank_mask:0x5
  s_nop 1
  v_add_f32_dpp v28, v27, v27 row_half_mirror row_mask:0xf bank_mask:0xa
  s_nop 1
  v_add_f32_dpp v28, v28, v28 quad_perm:[1,0,3,2]
  s_nop 1
  v_add_f32_dpp v239, v28, v28 quad_perm:[2,3,0,1]
  v_max_f32 v20, v20, v239
  s_barrier
  s_waitcnt vmcnt(7)
  v_dot2_f32_bf16 v22, v64, v4, 0
  v_dot2_f32_bf16 v22, v65, v5, v22
  v_dot2_f32_bf16 v22, v66, v6, v22
  v_dot2_f32_bf16 v22, v67, v7, v22
  s_cbranch_vccz L_d704
  s_waitcnt vmcnt(5)
L_d704:
  s_xor_b32 s68, s70, 0x44c00
  buffer_load_dwordx4 v[88:91], v63, s[12:15], s68 offen nt
  s_waitcnt vmcnt(6)
  v_dot2_f32_bf16 v23, v68, v4, 0
  v_dot2_f32_bf16 v23, v69, v5, v23
  v_dot2_f32_bf16 v23, v70, v6, v23
  v_dot2_f32_bf16 v23, v71, v7, v23
  s_cbranch_vccz L_d705
  s_waitcnt vmcnt(5)
L_d705:
  s_xor_b32 s68, s70, 0x44d00
  buffer_load_dwordx4 v[92:95], v63, s[12:15], s68 offen nt
  s_waitcnt vmcnt(6)
  v_dot2_f32_bf16 v24, v72, v4, 0
  v_dot2_f32_bf16 v24, v73, v5, v24
  v_dot2_f32_bf16 v24, v74, v6, v24
  v_dot2_f32_bf16 v24, v75, v7, v24
  s_cbranch_vccz L_d706
  s_waitcnt vmcnt(5)
L_d706:
  s_xor_b32 s68, s70, 0x54000
  buffer_load_dwordx4 v[96:99], v63, s[12:15], s68 offen nt
  buffer_load_dwordx4 a[184:187], v3, s[24:27], s73 offen offset:256
  s_waitcnt vmcnt(7)
  v_dot2_f32_bf16 v25, v76, v4, 0
  v_dot2_f32_bf16 v25, v77, v5, v25
  v_dot2_f32_bf16 v25, v78, v6, v25
  v_dot2_f32_bf16 v25, v79, v7, v25
  s_cbranch_vccz L_d707
  s_waitcnt vmcnt(6)
L_d707:
  s_xor_b32 s68, s70, 0x54100
  buffer_load_dwordx4 v[100:103], v63, s[12:15], s68 offen nt
  v_add_f32_dpp v26, v22, v22 row_ror:8 row_mask:0xf bank_mask:0x3
  v_add_f32_dpp v27, v24, v24 row_ror:8 row_mask:0xf bank_mask:0x3
  s_nop 0
  v_add_f32_dpp v26, v23, v23 row_ror:8 row_mask:0xf bank_mask:0xc
  v_add_f32_dpp v27, v25, v25 row_ror:8 row_mask:0xf bank_mask:0xc
  s_nop 0
  v_add_f32_dpp v28, v26, v26 row_half_mirror row_mask:0xf bank_mask:0x5
  s_nop 1
  v_add_f32_dpp v28, v27, v27 row_half_mirror row_mask:0xf bank_mask:0xa
  s_nop 1
  v_add_f32_dpp v28, v28, v28 quad_perm:[1,0,3,2]
  s_nop 1
  v_add_f32_dpp v240, v28, v28 quad_perm:[2,3,0,1]
  v_max_f32 v20, v20, v240
  s_barrier
  s_waitcnt vmcnt(7)
  v_dot2_f32_bf16 v22, v80, v4, 0
  v_dot2_f32_bf16 v22, v81, v5, v22
  v_dot2_f32_bf16 v22, v82, v6, v22
  v_dot2_f32_bf16 v22, v83, v7, v22
  s_cbranch_vccz L_d708
  s_waitcnt vmcnt(5)
L_d708:
  s_xor_b32 s68, s70, 0x54400
  buffer_load_dwordx4 v[104:107], v63, s[12:15], s68 offen nt
  s_waitcnt vmcnt(6)
  v_dot2_f32_bf16 v23, v84, v4, 0
  v_dot2_f32_bf16 v23, v85, v5, v23
  v_dot2_f32_bf16 v23, v86, v6, v23
  v_dot2_f32_bf16 v23, v87, v7, v23
  s_cbranch_vccz L_d709
  s_waitcnt vmcnt(5)
L_d709:
  s_xor_b32 s68, s70, 0x54500
  buffer_load_dwordx4 v[108:111], v63, s[12:15], s68 offen nt
  s_waitcnt vmcnt(6)
  v_dot2_f32_bf16 v24, v88, v4, 0
  v_dot2_f32_bf16 v24, v89, v5, v24
  v_dot2_f32_bf16 v24, v90, v6, v24
  v_dot2_f32_bf16 v24, v91, v7, v24
  s_cbranch_vccz L_d710
  s_waitcnt vmcnt(5)
L_d710:
  s_xor_b32 s68, s70, 0x54800
  buffer_load_dwordx4 v[112:115], v63, s[12:15], s68 offen nt
  buffer_load_dwordx4 a[180:183], v3, s[24:27], s73 offen offset:2048
  s_waitcnt vmcnt(7)
  v_dot2_f32_bf16 v25, v92, v4, 0
  v_dot2_f32_bf16 v25, v93, v5, v25
  v_dot2_f32_bf16 v25, v94, v6, v25
  v_dot2_f32_bf16 v25, v95, v7, v25
  s_cbranch_vccz L_d711
  s_waitcnt vmcnt(6)
L_d711:
  s_xor_b32 s68, s70, 0x54900
  buffer_load_dwordx4 v[116:119], v63, s[12:15], s68 offen nt
  v_add_f32_dpp v26, v22, v22 row_ror:8 row_mask:0xf bank_mask:0x3
  v_add_f32_dpp v27, v24, v24 row_ror:8 row_mask:0xf bank_mask:0x3
  s_nop 0
  v_add_f32_dpp v26, v23, v23 row_ror:8 row_mask:0xf bank_mask:0xc
  v_add_f32_dpp v27, v25, v25 row_ror:8 row_mask:0xf bank_mask:0xc
  s_nop 0
  v_add_f32_dpp v28, v26, v26 row_half_mirror row_mask:0xf bank_mask:0x5
  s_nop 1
  v_add_f32_dpp v28, v27, v27 row_half_mirror row_mask:0xf bank_mask:0xa
  s_nop 1
  v_add_f32_dpp v28, v28, v28 quad_perm:[1,0,3,2]
  s_nop 1
  v_add_f32_dpp v241, v28, v28 quad_perm:[2,3,0,1]
  v_max_f32 v20, v20, v241
  s_barrier
  s_waitcnt vmcnt(7)
  v_dot2_f32_bf16 v22, v96, v4, 0
  v_dot2_f32_bf16 v22, v97, v5, v22
  v_dot2_f32_bf16 v22, v98, v6, v22
  v_dot2_f32_bf16 v22, v99, v7, v22
  s_cbranch_vccz L_d712
  s_waitcnt vmcnt(5)
L_d712:
  s_xor_b32 s68, s70, 0x54c00
  buffer_load_dwordx4 v[120:123], v63, s[12:15], s68 offen nt
  s_waitcnt vmcnt(6)
  v_dot2_f32_bf16 v23, v100, v4, 0
  v_dot2_f32_bf16 v23, v101, v5, v23
  v_dot2_f32_bf16 v23, v102, v6, v23
  v_dot2_f32_bf16 v23, v103, v7, v23
  s_cbranch_vccz L_d713
  s_waitcnt vmcnt(5)
L_d713:
  s_xor_b32 s68, s70, 0x54d00
  buffer_load_dwordx4 v[124:127], v63, s[12:15], s68 offen nt
  s_waitcnt vmcnt(6)
  v_dot2_f32_bf16 v24, v104, v4, 0
  v_dot2_f32_bf16 v24, v105, v5, v24
  v_dot2_f32_bf16 v24, v106, v6, v24
  v_dot2_f32_bf16 v24, v107, v7, v24
  s_cbranch_vccz L_d714
  s_waitcnt vmcnt(5)
L_d714:
  s_xor_b32 s68, s70, 0x64000
  buffer_load_dwordx4 v[64:67], v63, s[12:15], s68 offen nt
  buffer_load_dwordx4 a[188:191], v3, s[24:27], s73 offen offset:2304
  s_add_u32 s73, s73, 4096
  s_waitcnt vmcnt(7)
  v_dot2_f32_bf16 v25, v108, v4, 0
  v_dot2_f32_bf16 v25, v109, v5, v25
  v_dot2_f32_bf16 v25, v110, v6, v25
  v_dot2_f32_bf16 v25, v111, v7, v25
  s_cbranch_vccz L_d715
  s_waitcnt vmcnt(6)
L_d715:
  s_xor_b32 s68, s70, 0x64100
  buffer_load_dwordx4 v[68:71], v63, s[12:15], s68 offen nt
  v_add_f32_dpp v26, v22, v22 row_ror:8 row_mask:0xf bank_mask:0x3
  v_add_f32_dpp v27, v24, v24 row_ror:8 row_mask:0xf bank_mask:0x3
  s_nop 0
  v_add_f32_dpp v26, v23, v23 row_ror:8 row_mask:0xf bank_mask:0xc
  v_add_f32_dpp v27, v25, v25 row_ror:8 row_mask:0xf bank_mask:0xc
  s_nop 0
  v_add_f32_dpp v28, v26, v26 row_half_mirror row_mask:0xf bank_mask:0x5
  s_nop 1
  v_add_f32_dpp v28, v27, v27 row_half_mirror row_mask:0xf bank_mask:0xa
  s_nop 1
  v_add_f32_dpp v28, v28, v28 quad_perm:[1,0,3,2]
  s_nop 1
  v_add_f32_dpp v242, v28, v28 quad_perm:[2,3,0,1]
  v_max_f32 v20, v20, v242
  s_barrier
  s_waitcnt vmcnt(7)
  v_dot2_f32_bf16 v22, v112, v4, 0
  v_dot2_f32_bf16 v22, v113, v5, v22
  v_dot2_f32_bf16 v22, v114, v6, v22
  v_dot2_f32_bf16 v22, v115, v7, v22
  s_cbranch_vccz L_d716
  s_waitcnt vmcnt(5)
L_d716:
  s_xor_b32 s68, s70, 0x64400
  buffer_load_dwordx4 v[72:75], v63, s[12:15], s68 offen nt
  s_waitcnt vmcnt(6)
  v_dot2_f32_bf16 v23, v116, v4, 0
  v_dot2_f32_bf16 v23, v117, v5, v23
  v_dot2_f32_bf16 v23, v118, v6, v23
  v_dot2_f32_bf16 v23, v119, v7, v23
  s_cbranch_vccz L_d717
  s_waitcnt vmcnt(5)
L_d717:
  s_xor_b32 s68, s70, 0x64500
  buffer_load_dwordx4 v[76:79], v63, s[12:15], s68 offen nt
  s_waitcnt vmcnt(6)
  v_dot2_f32_bf16 v24, v120, v4, 0
  v_dot2_f32_bf16 v24, v121, v5, v24
  v_dot2_f32_bf16 v24, v122, v6, v24
  v_dot2_f32_bf16 v24, v123, v7, v24
  s_cbranch_vccz L_d718
  s_waitcnt vmcnt(5)
L_d718:
  s_xor_b32 s68, s70, 0x64800
  buffer_load_dwordx4 v[80:83], v63, s[12:15], s68 offen nt
  s_lshl_b32 s73, s80, 13
  s_add_u32 s73, s73, s84
  buffer_load_dwordx4 a[192:195], v3, s[24:27], s73 offen offset:0
  s_waitcnt vmcnt(7)
  v_dot2_f32_bf16 v25, v124, v4, 0
  v_dot2_f32_bf16 v25, v125, v5, v25
  v_dot2_f32_bf16 v25, v126, v6, v25
  v_dot2_f32_bf16 v25, v127, v7, v25
  s_cbranch_vccz L_d719
  s_waitcnt vmcnt(6)
L_d719:
  s_xor_b32 s68, s70, 0x64900
  buffer_load_dwordx4 v[84:87], v63, s[12:15], s68 offen nt
  v_add_f32_dpp v26, v22, v22 row_ror:8 row_mask:0xf bank_mask:0x3
  v_add_f32_dpp v27, v24, v24 row_ror:8 row_mask:0xf bank_mask:0x3
  s_nop 0
  v_add_f32_dpp v26, v23, v23 row_ror:8 row_mask:0xf bank_mask:0xc
  v_add_f32_dpp v27, v25, v25 row_ror:8 row_mask:0xf bank_mask:0xc
  s_nop 0
  v_add_f32_dpp v28, v26, v26 row_half_mirror row_mask:0xf bank_mask:0x5
  s_nop 1
  v_add_f32_dpp v28, v27, v27 row_half_mirror row_mask:0xf bank_mask:0xa
  s_nop 1
  v_add_f32_dpp v28, v28, v28 quad_perm:[1,0,3,2]
  s_nop 1
  v_add_f32_dpp v243, v28, v28 quad_perm:[2,3,0,1]
  v_max_f32 v20, v20, v243
  s_barrier
  s_waitcnt vmcnt(7)
  v_dot2_f32_bf16 v22, v64, v4, 0
  v_dot2_f32_bf16 v22, v65, v5, v22
  v_dot2_f32_bf16 v22, v66, v6, v22
  v_dot2_f32_bf16 v22, v67, v7, v22
  s_cbranch_vccz L_d720
  s_waitcnt vmcnt(5)
L_d720:
  s_xor_b32 s68, s70, 0x64c00
  buffer_load_dwordx4 v[88:91], v63, s[12:15], s68 offen nt
  s_waitcnt vmcnt(6)
  v_dot2_f32_bf16 v23, v68, v4, 0
  v_dot2_f32_bf16 v23, v69, v5, v23
  v_dot2_f32_bf16 v23, v70, v6, v23
  v_dot2_f32_bf16 v23, v71, v7, v23
  s_cbranch_vccz L_d721
  s_waitcnt vmcnt(5)
L_d721:
  s_xor_b32 s68, s70, 0x64d00
  buffer_load_dwordx4 v[92:95], v63, s[12:15], s68 offen nt
  s_waitcnt vmcnt(6)
  v_dot2_f32_bf16 v24, v72, v4, 0
  v_dot2_f32_bf16 v24, v73, v5, v24
  v_dot2_f32_bf16 v24, v74, v6, v24
  v_dot2_f32_bf16 v24, v75, v7, v24
  s_cbranch_vccz L_d722
  s_waitcnt vmcnt(5)
L_d722:
  s_xor_b32 s68, s70, 0x74000
  buffer_load_dwordx4 v[96:99], v63, s[12:15], s68 offen nt
  buffer_load_dwordx4 a[200:203], v3, s[24:27], s73 offen offset:256
  s_waitcnt vmcnt(7)
  v_dot2_f32_bf16 v25, v76, v4, 0
  v_dot2_f32_bf16 v25, v77, v5, v25
  v_dot2_f32_bf16 v25, v78, v6, v25
  v_dot2_f32_bf16 v25, v79, v7, v25
  s_cbranch_vccz L_d723
  s_waitcnt vmcnt(6)
L_d723:
  s_xor_b32 s68, s70, 0x74100
  buffer_load_dwordx4 v[100:103], v63, s[12:15], s68 offen nt
  v_add_f32_dpp v26, v22, v22 row_ror:8 row_mask:0xf bank_mask:0x3
  v_add_f32_dpp v27, v24, v24 row_ror:8 row_mask:0xf bank_mask:0x3
  s_nop 0
  v_add_f32_dpp v26, v23, v23 row_ror:8 row_mask:0xf bank_mask:0xc
  v_add_f32_dpp v27, v25, v25 row_ror:8 row_mask:0xf bank_mask:0xc
  s_nop 0
  v_add_f32_dpp v28, v26, v26 row_half_mirror row_mask:0xf bank_mask:0x5
  s_nop 1
  v_add_f32_dpp v28, v27, v27 row_half_mirror row_mask:0xf bank_mask:0xa
  s_nop 1
  v_add_f32_dpp v28, v28, v28 quad_perm:[1,0,3,2]
  s_nop 1
  v_add_f32_dpp v244, v28, v28 quad_perm:[2,3,0,1]
  v_max_f32 v20, v20, v244
  s_barrier
  s_waitcnt vmcnt(7)
  v_dot2_f32_bf16 v22, v80, v4, 0
  v_dot2_f32_bf16 v22, v81, v5, v22
  v_dot2_f32_bf16 v22, v82, v6, v22
  v_dot2_f32_bf16 v22, v83, v7, v22
  s_cbranch_vccz L_d724
  s_waitcnt vmcnt(5)
L_d724:
  s_xor_b32 s68, s70, 0x74400
  buffer_load_dwordx4 v[104:107], v63, s[12:15], s68 offen nt
  s_waitcnt vmcnt(6)
  v_dot2_f32_bf16 v23, v84, v4, 0
  v_dot2_f32_bf16 v23, v85, v5, v23
  v_dot2_f32_bf16 v23, v86, v6, v23
  v_dot2_f32_bf16 v23, v87, v7, v23
  s_cbranch_vccz L_d725
  s_waitcnt vmcnt(5)
L_d725:
  s_xor_b32 s68, s70, 0x74500
  buffer_load_dwordx4 v[108:111], v63, s[12:15], s68 offen nt
  s_waitcnt vmcnt(6)
  v_dot2_f32_bf16 v24, v88, v4, 0
  v_dot2_f32_bf16 v24, v89, v5, v24
  v_dot2_f32_bf16 v24, v90, v6, v24
  v_dot2_f32_bf16 v24, v91, v7, v24
  s_cbranch_vccz L_d726
  s_waitcnt vmcnt(5)
L_d726:
  s_xor_b32 s68, s70, 0x74800
  buffer_load_dwordx4 v[112:115], v63, s[12:15], s68 offen nt
  buffer_load_dwordx4 a[196:199], v3, s[24:27], s73 offen offset:2048
  s_waitcnt vmcnt(7)
  v_dot2_f32_bf16 v25, v92, v4, 0
  v_dot2_f32_bf16 v25, v93, v5, v25
  v_dot2_f32_bf16 v25, v94, v6, v25
  v_dot2_f32_bf16 v25, v95, v7, v25
  s_cbranch_vccz L_d727
  s_waitcnt vmcnt(6)
L_d727:
  s_xor_b32 s68, s70, 0x74900
  buffer_load_dwordx4 v[116:119], v63, s[12:15], s68 offen nt
  v_add_f32_dpp v26, v22, v22 row_ror:8 row_mask:0xf bank_mask:0x3
  v_add_f32_dpp v27, v24, v24 row_ror:8 row_mask:0xf bank_mask:0x3
  s_nop 0
  v_add_f32_dpp v26, v23, v23 row_ror:8 row_mask:0xf bank_mask:0xc
  v_add_f32_dpp v27, v25, v25 row_ror:8 row_mask:0xf bank_mask:0xc
  s_nop 0
  v_add_f32_dpp v28, v26, v26 row_half_mirror row_mask:0xf bank_mask:0x5
  s_nop 1
  v_add_f32_dpp v28, v27, v27 row_half_mirror row_mask:0xf bank_mask:0xa
  s_nop 1
  v_add_f32_dpp v28, v28, v28 quad_perm:[1,0,3,2]
  s_nop 1
  v_add_f32_dpp v245, v28, v28 quad_perm:[2,3,0,1]
  v_max_f32 v20, v20, v245
  s_barrier
  s_waitcnt vmcnt(7)
  v_dot2_f32_bf16 v22, v96, v4, 0
  v_dot2_f32_bf16 v22, v97, v5, v22
  v_dot2_f32_bf16 v22, v98, v6, v22
  v_dot2_f32_bf16 v22, v99, v7, v22
  s_cbranch_vccz L_d728
  s_waitcnt vmcnt(5)
L_d728:
  s_xor_b32 s68, s70, 0x74c00
  buffer_load_dwordx4 v[120:123], v63, s[12:15], s68 offen nt
  s_cmp_eq_u32 s64, 3
  s_cbranch_scc0 L_wp182
  s_mov_b32 s100, 15
  s_atomic_umax s100, s[20:21], s88
  s_and_b32 s60, s88, 0xfffffc7f
  s_xor_b32 s61, s60, 2048
  s_add_u32 s38, s61, 0
  s_load_dword s40, s[20:21], s38 glc
  s_add_u32 s38, s60, 128
  s_load_dword s41, s[20:21], s38 glc
  s_add_u32 s38, s60, 256
  s_load_dword s42, s[20:21], s38 glc
  s_add_u32 s38, s61, 384
  s_load_dword s43, s[20:21], s38 glc
  s_add_u32 s38, s61, 512
  s_load_dword s44, s[20:21], s38 glc
  s_add_u32 s38, s60, 640
  s_load_dword s45, s[20:21], s38 glc
  s_add_u32 s38, s60, 768
  s_load_dword s46, s[20:21], s38 glc
  s_add_u32 s38, s61, 896
  s_load_dword s47, s[20:21], s38 glc
L_wp182:
  s_waitcnt vmcnt(6)
  v_dot2_f32_bf16 v23, v100, v4, 0
  v_dot2_f32_bf16 v23, v101, v5, v23
  v_dot2_f32_bf16 v23, v102, v6, v23
  v_dot2_f32_bf16 v23, v103, v7, v23
  s_cbranch_vccz L_d729
  s_waitcnt vmcnt(5)
L_d729:
  s_xor_b32 s68, s70, 0x74d00
  buffer_load_dwordx4 v[124:127], v63, s[12:15], s68 offen nt
  s_waitcnt vmcnt(6)
  v_dot2_f32_bf16 v24, v104, v4, 0
  v_dot2_f32_bf16 v24, v105, v5, v24
  v_dot2_f32_bf16 v24, v106, v6, v24
  v_dot2_f32_bf16 v24, v107, v7, v24
  s_cbranch_vccz L_d730
  s_waitcnt vmcnt(5)
L_d730:
  s_xor_b32 s68, s70, 0xc4000
  buffer_load_dwordx4 v[64:67], v63, s[12:15], s68 offen nt
  buffer_load_dwordx4 a[204:207], v3, s[24:27], s73 offen offset:2304
  s_add_u32 s73, s73, 4096
  s_waitcnt vmcnt(7)
  v_dot2_f32_bf16 v25, v108, v4, 0
  v_dot2_f32_bf16 v25, v109, v5, v25
  v_dot2_f32_bf16 v25, v110, v6, v25
  v_dot2_f32_bf16 v25, v111, v7, v25
  s_cbranch_vccz L_d731
  s_waitcnt vmcnt(6)
L_d731:
  s_xor_b32 s68, s70, 0xc4100
  buffer_load_dwordx4 v[68:71], v63, s[12:15], s68 offen nt
  v_add_f32_dpp v26, v22, v22 row_ror:8 row_mask:0xf bank_mask:0x3
  v_add_f32_dpp v27, v24, v24 row_ror:8 row_mask:0xf bank_mask:0x3
  s_nop 0
  v_add_f32_dpp v26, v23, v23 row_ror:8 row_mask:0xf bank_mask:0xc
  v_add_f32_dpp v27, v25, v25 row_ror:8 row_mask:0xf bank_mask:0xc
  s_nop 0
  v_add_f32_dpp v28, v26, v26 row_half_mirror row_mask:0xf bank_mask:0x5
  s_nop 1
  v_add_f32_dpp v28, v27, v27 row_half_mirror row_mask:0xf bank_mask:0xa
  s_nop 1
  v_add_f32_dpp v28, v28, v28 quad_perm:[1,0,3,2]
  s_nop 1
  v_add_f32_dpp v246, v28, v28 quad_perm:[2,3,0,1]
  v_max_f32 v20, v20, v246
  s_barrier
  s_waitcnt vmcnt(7)
  v_dot2_f32_bf16 v22, v112, v4, 0
  v_dot2_f32_bf16 v22, v113, v5, v22
  v_dot2_f32_bf16 v22, v114, v6, v22
  v_dot2_f32_bf16 v22, v115, v7, v22
  s_cbranch_vccz L_d732
  s_waitcnt vmcnt(5)
L_d732:
  s_xor_b32 s68, s70, 0xc4400
  buffer_load_dwordx4 v[72:75], v63, s[12:15], s68 offen nt
  s_waitcnt vmcnt(6)
  v_dot2_f32_bf16 v23, v116, v4, 0
  v_dot2_f32_bf16 v23, v117, v5, v23
  v_dot2_f32_bf16 v23, v118, v6, v23
  v_dot2_f32_bf16 v23, v119, v7, v23
  s_cbranch_vccz L_d733
  s_waitcnt vmcnt(5)
L_d733:
  s_xor_b32 s68, s70, 0xc4500
  buffer_load_dwordx4 v[76:79], v63, s[12:15], s68 offen nt
  s_waitcnt vmcnt(6)
  v_dot2_f32_bf16 v24, v120, v4, 0
  v_dot2_f32_bf16 v24, v121, v5, v24
  v_dot2_f32_bf16 v24, v122, v6, v24
  v_dot2_f32_bf16 v24, v123, v7, v24
  s_cbranch_vccz L_d734
  s_waitcnt vmcnt(5)
L_d734:
  s_xor_b32 s68, s70, 0xc4800
  buffer_load_dwordx4 v[80:83], v63, s[12:15], s68 offen nt
  buffer_load_dwordx4 a[208:211], v3, s[24:27], s73 offen offset:0
  s_waitcnt vmcnt(7)
  v_dot2_f32_bf16 v25, v124, v4, 0
  v_dot2_f32_bf16 v25, v125, v5, v25
  v_dot2_f32_bf16 v25, v126, v6, v25
  v_dot2_f32_bf16 v25, v127, v7, v25
  s_cbranch_vccz L_d735
  s_waitcnt vmcnt(6)
L_d735:
  s_xor_b32 s68, s70, 0xc4900
  buffer_load_dwordx4 v[84:87], v63, s[12:15], s68 offen nt
  v_add_f32_dpp v26, v22, v22 row_ror:8 row_mask:0xf bank_mask:0x3
  v_add_f32_dpp v27, v24, v24 row_ror:8 row_mask:0xf bank_mask:0x3
  s_nop 0
  v_add_f32_dpp v26, v23, v23 row_ror:8 row_mask:0xf bank_mask:0xc
  v_add_f32_dpp v27, v25, v25 row_ror:8 row_mask:0xf bank_mask:0xc
  s_nop 0
  v_add_f32_dpp v28, v26, v26 row_half_mirror row_mask:0xf bank_mask:0x5
  s_nop 1
  v_add_f32_dpp v28, v27, v27 row_half_mirror row_mask:0xf bank_mask:0xa
  s_nop 1
  v_add_f32_dpp v28, v28, v28 quad_perm:[1,0,3,2]
  s_nop 1
  v_add_f32_dpp v247, v28, v28 quad_perm:[2,3,0,1]
  v_max_f32 v20, v20, v247
  s_barrier
  s_waitcnt vmcnt(7)
  v_dot2_f32_bf16 v22, v64, v4, 0
  v_dot2_f32_bf16 v22, v65, v5, v22
  v_dot2_f32_bf16 v22, v66, v6, v22
  v_dot2_f32_bf16 v22, v67, v7, v22
  s_cbranch_vccz L_d736
  s_waitcnt vmcnt(5)
L_d736:
  s_xor_b32 s68, s70, 0xc4c00
  buffer_load_dwordx4 v[88:91], v63, s[12:15], s68 offen nt
  s_cmp_eq_u32 s64, 3
  s_cbranch_scc0 L_wp184
  s_mov_b32 s101, 0
  s_waitcnt lgkmcnt(0)
  s_cmp_ge_u32 s40, 15
  s_addc_u32 s101, s101, 0
  s_cmp_ge_u32 s41, 15
  s_addc_u32 s101, s101, 0
  s_cmp_ge_u32 s42, 15
  s_addc_u32 s101, s101, 0
  s_cmp_ge_u32 s43, 15
  s_addc_u32 s101, s101, 0
  s_cmp_ge_u32 s44, 15
  s_addc_u32 s101, s101, 0
  s_cmp_ge_u32 s45, 15
  s_addc_u32 s101, s101, 0
  s_cmp_ge_u32 s46, 15
  s_addc_u32 s101, s101, 0
  s_cmp_ge_u32 s47, 15
  s_addc_u32 s101, s101, 0
  s_cmp_lt_u32 s101, 6
  s_cselect_b32 s38, -1, 0
  v_mov_b32 v26, 0
  v_mov_b32 v27, s38
  ds_write_b32 v26, v27 offset:8512
L_wp184:
  s_waitcnt vmcnt(6)
  v_dot2_f32_bf16 v23, v68, v4, 0
  v_dot2_f32_bf16 v23, v69, v5, v23
  v_dot2_f32_bf16 v23, v70, v6, v23
  v_dot2_f32_bf16 v23, v71, v7, v23
  s_cbranch_vccz L_d737
  s_waitcnt vmcnt(5)
L_d737:
  s_xor_b32 s68, s70, 0xc4d00
  buffer_load_dwordx4 v[92:95], v63, s[12:15], s68 offen nt
  s_waitcnt vmcnt(6)
  v_dot2_f32_bf16 v24, v72, v4, 0
  v_dot2_f32_bf16 v24, v73, v5, v24
  v_dot2_f32_bf16 v24, v74, v6, v24
  v_dot2_f32_bf16 v24, v75, v7, v24
  s_cbranch_vccz L_d738
  s_waitcnt vmcnt(5)
L_d738:
  s_xor_b32 s68, s70, 0xd4000
  buffer_load_dwordx4 v[96:99], v63, s[12:15], s68 offen nt
  buffer_load_dwordx4 a[216:219], v3, s[24:27], s73 offen offset:256
  s_waitcnt vmcnt(7)
  v_dot2_f32_bf16 v25, v76, v4, 0
  v_dot2_f32_bf16 v25, v77, v5, v25
  v_dot2_f32_bf16 v25, v78, v6, v25
  v_dot2_f32_bf16 v25, v79, v7, v25
  s_cbranch_vccz L_d739
  s_waitcnt vmcnt(6)
L_d739:
  s_xor_b32 s68, s70, 0xd4100
  buffer_load_dwordx4 v[100:103], v63, s[12:15], s68 offen nt
  v_add_f32_dpp v26, v22, v22 row_ror:8 row_mask:0xf bank_mask:0x3
  v_add_f32_dpp v27, v24, v24 row_ror:8 row_mask:0xf bank_mask:0x3
  s_nop 0
  v_add_f32_dpp v26, v23, v23 row_ror:8 row_mask:0xf bank_mask:0xc
  v_add_f32_dpp v27, v25, v25 row_ror:8 row_mask:0xf bank_mask:0xc
  s_nop 0
  v_add_f32_dpp v28, v26, v26 row_half_mirror row_mask:0xf bank_mask:0x5
  s_nop 1
  v_add_f32_dpp v28, v27, v27 row_half_mirror row_mask:0xf bank_mask:0xa
  s_nop 1
  v_add_f32_dpp v28, v28, v28 quad_perm:[1,0,3,2]
  s_nop 1
  v_add_f32_dpp v248, v28, v28 quad_perm:[2,3,0,1]
  v_max_f32 v20, v20, v248
  s_barrier
  v_lshrrev_b32 v8, 7, v1
  v_and_b32 v8, 3, v8
  v_lshlrev_b32 v8, 13, v8
  v_and_b32 v9, 0x70, v1
  v_lshl_add_u32 v8, v9, 3, v8
  s_lshl_b32 s37, s66, 10
  s_add_u32 s37, s37, 2129920
  s_cmp_eq_u32 s64, 0
  s_cbranch_scc0 L_wf
  buffer_load_dword v9, v8, s[20:23], s37 offen sc1
L_wf:
  s_waitcnt vmcnt(7)
  v_dot2_f32_bf16 v22, v80, v4, 0
  v_dot2_f32_bf16 v22, v81, v5, v22
  v_dot2_f32_bf16 v22, v82, v6, v22
  v_dot2_f32_bf16 v22, v83, v7, v22
  s_cbranch_vccz L_d740
  s_waitcnt vmcnt(5)
L_d740:
  s_xor_b32 s68, s70, 0xd4400
  buffer_load_dwordx4 v[104:107], v63, s[12:15], s68 offen nt
  v_mov_b32 v26, 0
  ds_read_b32 v35, v26 offset:8512
  s_waitcnt vmcnt(6)
  v_dot2_f32_bf16 v23, v84, v4, 0
  v_dot2_f32_bf16 v23, v85, v5, v23
  v_dot2_f32_bf16 v23, v86, v6, v23
  v_dot2_f32_bf16 v23, v87, v7, v23
  s_cbranch_vccz L_d741
  s_waitcnt vmcnt(5)
L_d741:
  s_xor_b32 s68, s70, 0xd4500
  buffer_load_dwordx4 v[108:111], v63, s[12:15], s68 offen nt
  s_waitcnt vmcnt(6)
  v_dot2_f32_bf16 v24, v88, v4, 0
  v_dot2_f32_bf16 v24, v89, v5, v24
  v_dot2_f32_bf16 v24, v90, v6, v24
  v_dot2_f32_bf16 v24, v91, v7, v24
  s_cbranch_vccz L_d742
  s_waitcnt vmcnt(5)
L_d742:
  s_xor_b32 s68, s70, 0xd4800
  buffer_load_dwordx4 v[112:115], v63, s[12:15], s68 offen nt
  buffer_load_dwordx4 a[212:215], v3, s[24:27], s73 offen offset:2048
  s_waitcnt vmcnt(7)
  v_dot2_f32_bf16 v25, v92, v4, 0
  v_dot2_f32_bf16 v25, v93, v5, v25
  v_dot2_f32_bf16 v25, v94, v6, v25
  v_dot2_f32_bf16 v25, v95, v7, v25
  s_cbranch_vccz L_d743
  s_waitcnt vmcnt(6)
L_d743:
  s_xor_b32 s68, s70, 0xd4900
  buffer_load_dwordx4 v[116:119], v63, s[12:15], s68 offen nt
  v_add_f32_dpp v26, v22, v22 row_ror:8 row_mask:0xf bank_mask:0x3
  v_add_f32_dpp v27, v24, v24 row_ror:8 row_mask:0xf bank_mask:0x3
  s_nop 0
  v_add_f32_dpp v26, v23, v23 row_ror:8 row_mask:0xf bank_mask:0xc
  v_add_f32_dpp v27, v25, v25 row_ror:8 row_mask:0xf bank_mask:0xc
  s_nop 0
  v_add_f32_dpp v28, v26, v26 row_half_mirror row_mask:0xf bank_mask:0x5
  s_nop 1
  v_add_f32_dpp v28, v27, v27 row_half_mirror row_mask:0xf bank_mask:0xa
  s_nop 1
  v_add_f32_dpp v28, v28, v28 quad_perm:[1,0,3,2]
  s_nop 1
  v_add_f32_dpp v249, v28, v28 quad_perm:[2,3,0,1]
  v_max_f32 v20, v20, v249
  s_barrier
  s_waitcnt vmcnt(7)
  v_dot2_f32_bf16 v22, v96, v4, 0
  v_dot2_f32_bf16 v22, v97, v5, v22
  v_dot2_f32_bf16 v22, v98, v6, v22
  v_dot2_f32_bf16 v22, v99, v7, v22
  s_cbranch_vccz L_d744
  s_waitcnt vmcnt(5)
L_d744:
  s_xor_b32 s68, s70, 0xd4c00
  buffer_load_dwordx4 v[120:123], v63, s[12:15], s68 offen nt
  s_waitcnt lgkmcnt(0)
  v_cmp_ne_u32 vcc, 0, v35
  s_waitcnt vmcnt(6)
  v_dot2_f32_bf16 v23, v100, v4, 0
  v_dot2_f32_bf16 v23, v101, v5, v23
  v_dot2_f32_bf16 v23, v102, v6, v23
  v_dot2_f32_bf16 v23, v103, v7, v23
  s_cbranch_vccz L_d745
  s_waitcnt vmcnt(5)
L_d745:
  s_xor_b32 s68, s70, 0xd4d00
  buffer_load_dwordx4 v[124:127], v63, s[12:15], s68 offen nt
  s_waitcnt vmcnt(6)
  v_dot2_f32_bf16 v24, v104, v4, 0
  v_dot2_f32_bf16 v24, v105, v5, v24
  v_dot2_f32_bf16 v24, v106, v6, v24
  v_dot2_f32_bf16 v24, v107, v7, v24
  s_cbranch_vccz L_d746
  s_waitcnt vmcnt(5)
L_d746:
  s_xor_b32 s68, s70, 0xe4000
  buffer_load_dwordx4 v[64:67], v63, s[12:15], s68 offen nt
  buffer_load_dwordx4 a[220:223], v3, s[24:27], s73 offen offset:2304
  s_add_u32 s73, s73, 4096
  s_waitcnt vmcnt(7)
  v_dot2_f32_bf16 v25, v108, v4, 0
  v_dot2_f32_bf16 v25, v109, v5, v25
  v_dot2_f32_bf16 v25, v110, v6, v25
  v_dot2_f32_bf16 v25, v111, v7, v25
  s_cbranch_vccz L_d747
  s_waitcnt vmcnt(6)
L_d747:
  s_xor_b32 s68, s70, 0xe4100
  buffer_load_dwordx4 v[68:71], v63, s[12:15], s68 offen nt
  v_add_f32_dpp v26, v22, v22 row_ror:8 row_mask:0xf bank_mask:0x3
  v_add_f32_dpp v27, v24, v24 row_ror:8 row_mask:0xf bank_mask:0x3
  s_nop 0
  v_add_f32_dpp v26, v23, v23 row_ror:8 row_mask:0xf bank_mask:0xc
  v_add_f32_dpp v27, v25, v25 row_ror:8 row_mask:0xf bank_mask:0xc
  s_nop 0
  v_add_f32_dpp v28, v26, v26 row_half_mirror row_mask:0xf bank_mask:0x5
  s_nop 1
  v_add_f32_dpp v28, v27, v27 row_half_mirror row_mask:0xf bank_mask:0xa
  s_nop 1
  v_add_f32_dpp v28, v28, v28 quad_perm:[1,0,3,2]
  s_nop 1
  v_add_f32_dpp v250, v28, v28 quad_perm:[2,3,0,1]
  v_max_f32 v20, v20, v250
  s_barrier
  s_waitcnt vmcnt(7)
  v_dot2_f32_bf16 v22, v112, v4, 0
  v_dot2_f32_bf16 v22, v113, v5, v22
  v_dot2_f32_bf16 v22, v114, v6, v22
  v_dot2_f32_bf16 v22, v115, v7, v22
  s_cbranch_vccz L_d748
  s_waitcnt vmcnt(5)
L_d748:
  s_xor_b32 s68, s70, 0xe4400
  buffer_load_dwordx4 v[72:75], v63, s[12:15], s68 offen nt
  s_waitcnt vmcnt(6)
  v_dot2_f32_bf16 v23, v116, v4, 0
  v_dot2_f32_bf16 v23, v117, v5, v23
  v_dot2_f32_bf16 v23, v118, v6, v23
  v_dot2_f32_bf16 v23, v119, v7, v23
  s_cbranch_vccz L_d749
  s_waitcnt vmcnt(5)
L_d749:
  s_xor_b32 s68, s70, 0xe4500
  buffer_load_dwordx4 v[76:79], v63, s[12:15], s68 offen nt
  s_waitcnt vmcnt(6)
  v_dot2_f32_bf16 v24, v120, v4, 0
  v_dot2_f32_bf16 v24, v121, v5, v24
  v_dot2_f32_bf16 v24, v122, v6, v24
  v_dot2_f32_bf16 v24, v123, v7, v24
  s_cbranch_vccz L_d750
  s_waitcnt vmcnt(5)
L_d750:
  s_xor_b32 s68, s70, 0xe4800
  buffer_load_dwordx4 v[80:83], v63, s[12:15], s68 offen nt
  s_lshl_b32 s73, s81, 13
  s_add_u32 s73, s73, s84
  buffer_load_dwordx4 a[224:227], v3, s[24:27], s73 offen offset:0
  s_waitcnt vmcnt(7)
  v_dot2_f32_bf16 v25, v124, v4, 0
  v_dot2_f32_bf16 v25, v125, v5, v25
  v_dot2_f32_bf16 v25, v126, v6, v25
  v_dot2_f32_bf16 v25, v127, v7, v25
  s_cbranch_vccz L_d751
  s_waitcnt vmcnt(6)
L_d751:
  s_xor_b32 s68, s70, 0xe4900
  buffer_load_dwordx4 v[84:87], v63, s[12:15], s68 offen nt
  v_add_f32_dpp v26, v22, v22 row_ror:8 row_mask:0xf bank_mask:0x3
  v_add_f32_dpp v27, v24, v24 row_ror:8 row_mask:0xf bank_mask:0x3
  s_nop 0
  v_add_f32_dpp v26, v23, v23 row_ror:8 row_mask:0xf bank_mask:0xc
  v_add_f32_dpp v27, v25, v25 row_ror:8 row_mask:0xf bank_mask:0xc
  s_nop 0
  v_add_f32_dpp v28, v26, v26 row_half_mirror row_mask:0xf bank_mask:0x5
  s_nop 1
  v_add_f32_dpp v28, v27, v27 row_half_mirror row_mask:0xf bank_mask:0xa
  s_nop 1
  v_add_f32_dpp v28, v28, v28 quad_perm:[1,0,3,2]
  s_nop 1
  v_add_f32_dpp v251, v28, v28 quad_perm:[2,3,0,1]
  v_max_f32 v20, v20, v251
  s_barrier
  s_waitcnt vmcnt(7)
  v_dot2_f32_bf16 v22, v64, v4, 0
  v_dot2_f32_bf16 v22, v65, v5, v22
  v_dot2_f32_bf16 v22, v66, v6, v22
  v_dot2_f32_bf16 v22, v67, v7, v22
  s_cbranch_vccz L_d752
  s_waitcnt vmcnt(5)
L_d752:
  s_xor_b32 s68, s70, 0xe4c00
  buffer_load_dwordx4 v[88:91], v63, s[12:15], s68 offen nt
  s_waitcnt vmcnt(6)
  v_dot2_f32_bf16 v23, v68, v4, 0
  v_dot2_f32_bf16 v23, v69, v5, v23
  v_dot2_f32_bf16 v23, v70, v6, v23
  v_dot2_f32_bf16 v23, v71, v7, v23
  s_cbranch_vccz L_d753
  s_waitcnt vmcnt(5)
L_d753:
  s_xor_b32 s68, s70, 0xe4d00
  buffer_load_dwordx4 v[92:95], v63, s[12:15], s68 offen nt
  s_waitcnt vmcnt(6)
  v_dot2_f32_bf16 v24, v72, v4, 0
  v_dot2_f32_bf16 v24, v73, v5, v24
  v_dot2_f32_bf16 v24, v74, v6, v24
  v_dot2_f32_bf16 v24, v75, v7, v24
  s_cbranch_vccz L_d754
  s_waitcnt vmcnt(5)
L_d754:
  s_xor_b32 s68, s70, 0xf4000
  buffer_load_dwordx4 v[96:99], v63, s[12:15], s68 offen nt
  buffer_load_dwordx4 a[232:235], v3, s[24:27], s73 offen offset:256
  s_waitcnt vmcnt(7)
  v_dot2_f32_bf16 v25, v76, v4, 0
  v_dot2_f32_bf16 v25, v77, v5, v25
  v_dot2_f32_bf16 v25, v78, v6, v25
  v_dot2_f32_bf16 v25, v79, v7, v25
  s_cbranch_vccz L_d755
  s_waitcnt vmcnt(6)
L_d755:
  s_xor_b32 s68, s70, 0xf4100
  buffer_load_dwordx4 v[100:103], v63, s[12:15], s68 offen nt
  v_add_f32_dpp v26, v22, v22 row_ror:8 row_mask:0xf bank_mask:0x3
  v_add_f32_dpp v27, v24, v24 row_ror:8 row_mask:0xf bank_mask:0x3
  s_nop 0
  v_add_f32_dpp v26, v23, v23 row_ror:8 row_mask:0xf bank_mask:0xc
  v_add_f32_dpp v27, v25, v25 row_ror:8 row_mask:0xf bank_mask:0xc
  s_nop 0
  v_add_f32_dpp v28, v26, v26 row_half_mirror row_mask:0xf bank_mask:0x5
  s_nop 1
  v_add_f32_dpp v28, v27, v27 row_half_mirror row_mask:0xf bank_mask:0xa
  s_nop 1
  v_add_f32_dpp v28, v28, v28 quad_perm:[1,0,3,2]
  s_nop 1
  v_add_f32_dpp v252, v28, v28 quad_perm:[2,3,0,1]
  v_max_f32 v20, v20, v252
  s_barrier
  s_waitcnt vmcnt(7)
  v_dot2_f32_bf16 v22, v80, v4, 0
  v_dot2_f32_bf16 v22, v81, v5, v22
  v_dot2_f32_bf16 v22, v82, v6, v22
  v_dot2_f32_bf16 v22, v83, v7, v22
  s_cbranch_vccz L_d756
  s_waitcnt vmcnt(5)
L_d756:
  s_xor_b32 s68, s70, 0xf4400
  buffer_load_dwordx4 v[104:107], v63, s[12:15], s68 offen nt
  s_waitcnt vmcnt(6)
  v_dot2_f32_bf16 v23, v84, v4, 0
  v_dot2_f32_bf16 v23, v85, v5, v23
  v_dot2_f32_bf16 v23, v86, v6, v23
  v_dot2_f32_bf16 v23, v87, v7, v23
  s_cbranch_vccz L_d757
  s_waitcnt vmcnt(5)
L_d757:
  s_xor_b32 s68, s70, 0xf4500
  buffer_load_dwordx4 v[108:111], v63, s[12:15], s68 offen nt
  s_waitcnt vmcnt(6)
  v_dot2_f32_bf16 v24, v88, v4, 0
  v_dot2_f32_bf16 v24, v89, v5, v24
  v_dot2_f32_bf16 v24, v90, v6, v24
  v_dot2_f32_bf16 v24, v91, v7, v24
  s_cbranch_vccz L_d758
  s_waitcnt vmcnt(5)
L_d758:
  s_xor_b32 s68, s70, 0xf4800
  buffer_load_dwordx4 v[112:115], v63, s[12:15], s68 offen nt
  buffer_load_dwordx4 a[228:231], v3, s[24:27], s73 offen offset:2048
  s_waitcnt vmcnt(7)
  v_dot2_f32_bf16 v25, v92, v4, 0
  v_dot2_f32_bf16 v25, v93, v5, v25
  v_dot2_f32_bf16 v25, v94, v6, v25
  v_dot2_f32_bf16 v25, v95, v7, v25
  s_cbranch_vccz L_d759
  s_waitcnt vmcnt(6)
L_d759:
  s_xor_b32 s68, s70, 0xf4900
  buffer_load_dwordx4 v[116:119], v63, s[12:15], s68 offen nt
  v_add_f32_dpp v26, v22, v22 row_ror:8 row_mask:0xf bank_mask:0x3
  v_add_f32_dpp v27, v24, v24 row_ror:8 row_mask:0xf bank_mask:0x3
  s_nop 0
  v_add_f32_dpp v26, v23, v23 row_ror:8 row_mask:0xf bank_mask:0xc
  v_add_f32_dpp v27, v25, v25 row_ror:8 row_mask:0xf bank_mask:0xc
  s_nop 0
  v_add_f32_dpp v28, v26, v26 row_half_mirror row_mask:0xf bank_mask:0x5
  s_nop 1
  v_add_f32_dpp v28, v27, v27 row_half_mirror row_mask:0xf bank_mask:0xa
  s_nop 1
  v_add_f32_dpp v28, v28, v28 quad_perm:[1,0,3,2]
  s_nop 1
  v_add_f32_dpp v253, v28, v28 quad_perm:[2,3,0,1]
  v_max_f32 v20, v20, v253
  s_barrier
  s_waitcnt vmcnt(7)
  v_dot2_f32_bf16 v22, v96, v4, 0
  v_dot2_f32_bf16 v22, v97, v5, v22
  v_dot2_f32_bf16 v22, v98, v6, v22
  v_dot2_f32_bf16 v22, v99, v7, v22
  s_cbranch_vccz L_d760
  s_waitcnt vmcnt(5)
L_d760:
  s_xor_b32 s68, s70, 0xf4c00
  buffer_load_dwordx4 v[120:123], v63, s[12:15], s68 offen nt
  s_waitcnt vmcnt(6)
  v_dot2_f32_bf16 v23, v100, v4, 0
  v_dot2_f32_bf16 v23, v101, v5, v23
  v_dot2_f32_bf16 v23, v102, v6, v23
  v_dot2_f32_bf16 v23, v103, v7, v23
  s_cbranch_vccz L_d761
  s_waitcnt vmcnt(5)
L_d761:
  s_xor_b32 s68, s70, 0xf4d00
  buffer_load_dwordx4 v[124:127], v63, s[12:15], s68 offen nt
  s_waitcnt vmcnt(6)
  v_dot2_f32_bf16 v24, v104, v4, 0
  v_dot2_f32_bf16 v24, v105, v5, v24
  v_dot2_f32_bf16 v24, v106, v6, v24
  v_dot2_f32_bf16 v24, v107, v7, v24
  s_cbranch_vccz L_d762
  s_waitcnt vmcnt(5)
L_d762:
  s_xor_b32 s68, s70, 0x0
  buffer_load_dwordx4 v[64:67], v63, s[16:19], s68 offen nt
  buffer_load_dwordx4 a[236:239], v3, s[24:27], s73 offen offset:2304
  s_add_u32 s73, s73, 4096
  s_waitcnt vmcnt(7)
  v_dot2_f32_bf16 v25, v108, v4, 0
  v_dot2_f32_bf16 v25, v109, v5, v25
  v_dot2_f32_bf16 v25, v110, v6, v25
  v_dot2_f32_bf16 v25, v111, v7, v25
  s_cbranch_vccz L_d763
  s_waitcnt vmcnt(6)
L_d763:
  s_xor_b32 s68, s70, 0x100
  buffer_load_dwordx4 v[68:71], v63, s[16:19], s68 offen nt
  v_add_f32_dpp v26, v22, v22 row_ror:8 row_mask:0xf bank_mask:0x3
  v_add_f32_dpp v27, v24, v24 row_ror:8 row_mask:0xf bank_mask:0x3
  s_nop 0
  v_add_f32_dpp v26, v23, v23 row_ror:8 row_mask:0xf bank_mask:0xc
  v_add_f32_dpp v27, v25, v25 row_ror:8 row_mask:0xf bank_mask:0xc
  s_nop 0
  v_add_f32_dpp v28, v26, v26 row_half_mirror row_mask:0xf bank_mask:0x5
  s_nop 1
  v_add_f32_dpp v28, v27, v27 row_half_mirror row_mask:0xf bank_mask:0xa
  s_nop 1
  v_add_f32_dpp v28, v28, v28 quad_perm:[1,0,3,2]
  s_nop 1
  v_add_f32_dpp v254, v28, v28 quad_perm:[2,3,0,1]
  v_max_f32 v20, v20, v254
  s_barrier
  s_waitcnt vmcnt(7)
  v_dot2_f32_bf16 v22, v112, v4, 0
  v_dot2_f32_bf16 v22, v113, v5, v22
  v_dot2_f32_bf16 v22, v114, v6, v22
  v_dot2_f32_bf16 v22, v115, v7, v22
  s_cbranch_vccz L_d764
  s_waitcnt vmcnt(5)
L_d764:
  s_xor_b32 s68, s70, 0x400
  buffer_load_dwordx4 v[72:75], v63, s[16:19], s68 offen nt
  s_waitcnt vmcnt(6)
  v_dot2_f32_bf16 v23, v116, v4, 0
  v_dot2_f32_bf16 v23, v117, v5, v23
  v_dot2_f32_bf16 v23, v118, v6, v23
  v_dot2_f32_bf16 v23, v119, v7, v23
  s_cbranch_vccz L_d765
  s_waitcnt vmcnt(5)
L_d765:
  s_xor_b32 s68, s70, 0x500
  buffer_load_dwordx4 v[76:79], v63, s[16:19], s68 offen nt
  s_waitcnt vmcnt(6)
  v_dot2_f32_bf16 v24, v120, v4, 0
  v_dot2_f32_bf16 v24, v121, v5, v24
  v_dot2_f32_bf16 v24, v122, v6, v24
  v_dot2_f32_bf16 v24, v123, v7, v24
  s_cbranch_vccz L_d766
  s_waitcnt vmcnt(5)
L_d766:
  s_xor_b32 s68, s70, 0x800
  buffer_load_dwordx4 v[80:83], v63, s[16:19], s68 offen nt
  buffer_load_dwordx4 a[240:243], v3, s[24:27], s73 offen offset:0
  s_waitcnt vmcnt(7)
  v_dot2_f32_bf16 v25, v124, v4, 0
  v_dot2_f32_bf16 v25, v125, v5, v25
  v_dot2_f32_bf16 v25, v126, v6, v25
  v_dot2_f32_bf16 v25, v127, v7, v25
  s_cbranch_vccz L_d767
  s_waitcnt vmcnt(6)
L_d767:
  s_xor_b32 s68, s70, 0x900
  buffer_load_dwordx4 v[84:87], v63, s[16:19], s68 offen nt
  v_add_f32_dpp v26, v22, v22 row_ror:8 row_mask:0xf bank_mask:0x3
  v_add_f32_dpp v27, v24, v24 row_ror:8 row_mask:0xf bank_mask:0x3
  s_nop 0
  v_add_f32_dpp v26, v23, v23 row_ror:8 row_mask:0xf bank_mask:0xc
  v_add_f32_dpp v27, v25, v25 row_ror:8 row_mask:0xf bank_mask:0xc
  s_nop 0
  v_add_f32_dpp v28, v26, v26 row_half_mirror row_mask:0xf bank_mask:0x5
  s_nop 1
  v_add_f32_dpp v28, v27, v27 row_half_mirror row_mask:0xf bank_mask:0xa
  s_nop 1
  v_add_f32_dpp v28, v28, v28 quad_perm:[1,0,3,2]
  s_nop 1
  v_add_f32_dpp v255, v28, v28 quad_perm:[2,3,0,1]
  v_max_f32 v20, v20, v255
  s_barrier
  s_nop 0
  v_max_f32_dpp v20, v20, v20 row_ror:4
  s_nop 1
  v_max_f32_dpp v20, v20, v20 row_ror:8
  v_mov_b32 v26, v20
  s_nop 1
  v_permlane32_swap_b32 v20, v26
  v_max_f32 v20, v20, v26
  v_mov_b32 v26, v20
  s_nop 1
  v_permlane16_swap_b32 v20, v26
  v_max_f32 v20, v20, v26
  v_mul_f32 v29, s71, v20
  v_mov_b32 v21, 0
  v_mov_b32 v12, 0
  v_mov_b32 v13, 0
  v_mov_b32 v14, 0
  v_mov_b32 v15, 0
  v_mov_b32 v16, 0
  v_mov_b32 v17, 0
  v_mov_b32 v18, 0
  v_mov_b32 v19, 0
  v_fma_f32 v192, v192, s71, -v29
  v_exp_f32 v192, v192
  s_nop 0
  v_add_f32 v21, v21, v192
  v_cvt_pk_bf16_f32 v30, v192, 0
  v_cvt_pk_bf16_f32 v31, 0, v192
  s_waitcnt vmcnt(7)
  v_dot2c_f32_bf16_dpp v12, v30, v64 row_newbcast:0
  v_dot2c_f32_bf16_dpp v13, v31, v64 row_newbcast:0
  v_dot2c_f32_bf16_dpp v14, v30, v65 row_newbcast:0
  v_dot2c_f32_bf16_dpp v15, v31, v65 row_newbcast:0
  v_dot2c_f32_bf16_dpp v16, v30, v66 row_newbcast:0
  v_dot2c_f32_bf16_dpp v17, v31, v66 row_newbcast:0
  v_dot2c_f32_bf16_dpp v18, v30, v67 row_newbcast:0
  v_dot2c_f32_bf16_dpp v19, v31, v67 row_newbcast:0
  s_cbranch_vccz L_d768
  s_waitcnt vmcnt(5)
L_d768:
  s_xor_b32 s68, s70, 0xc00
  buffer_load_dwordx4 v[88:91], v63, s[16:19], s68 offen nt
  v_fma_f32 v193, v193, s71, -v29
  v_exp_f32 v193, v193
  s_nop 0
  v_add_f32 v21, v21, v193
  s_waitcnt vmcnt(6)
  v_dot2c_f32_bf16_dpp v12, v30, v68 row_newbcast:8
  v_dot2c_f32_bf16_dpp v13, v31, v68 row_newbcast:8
  v_dot2c_f32_bf16_dpp v14, v30, v69 row_newbcast:8
  v_dot2c_f32_bf16_dpp v15, v31, v69 row_newbcast:8
  v_dot2c_f32_bf16_dpp v16, v30, v70 row_newbcast:8
  v_dot2c_f32_bf16_dpp v17, v31, v70 row_newbcast:8
  v_dot2c_f32_bf16_dpp v18, v30, v71 row_newbcast:8
  v_dot2c_f32_bf16_dpp v19, v31, v71 row_newbcast:8
  s_cbranch_vccz L_d769
  s_waitcnt vmcnt(5)
L_d769:
  s_xor_b32 s68, s70, 0xd00
  buffer_load_dwordx4 v[92:95], v63, s[16:19], s68 offen nt
  v_fma_f32 v194, v194, s71, -v29
  v_exp_f32 v194, v194
  s_nop 0
  v_add_f32 v21, v21, v194
  s_waitcnt vmcnt(6)
  v_dot2c_f32_bf16_dpp v12, v30, v72 row_newbcast:4
  v_dot2c_f32_bf16_dpp v13, v31, v72 row_newbcast:4
  v_dot2c_f32_bf16_dpp v14, v30, v73 row_newbcast:4
  v_dot2c_f32_bf16_dpp v15, v31, v73 row_newbcast:4
  v_dot2c_f32_bf16_dpp v16, v30, v74 row_newbcast:4
  v_dot2c_f32_bf16_dpp v17, v31, v74 row_newbcast:4
  v_dot2c_f32_bf16_dpp v18, v30, v75 row_newbcast:4
  v_dot2c_f32_bf16_dpp v19, v31, v75 row_newbcast:4
  s_cbranch_vccz L_d770
  s_waitcnt vmcnt(5)
L_d770:
  s_xor_b32 s68, s70, 0x10000
  buffer_load_dwordx4 v[96:99], v63, s[16:19], s68 offen nt
  buffer_load_dwordx4 a[248:251], v3, s[24:27], s73 offen offset:256
  v_fma_f32 v195, v195, s71, -v29
  v_exp_f32 v195, v195
  s_nop 0
  v_add_f32 v21, v21, v195
  s_waitcnt vmcnt(7)
  v_dot2c_f32_bf16_dpp v12, v30, v76 row_newbcast:12
  v_dot2c_f32_bf16_dpp v13, v31, v76 row_newbcast:12
  v_dot2c_f32_bf16_dpp v14, v30, v77 row_newbcast:12
  v_dot2c_f32_bf16_dpp v15, v31, v77 row_newbcast:12
  v_dot2c_f32_bf16_dpp v16, v30, v78 row_newbcast:12
  v_dot2c_f32_bf16_dpp v17, v31, v78 row_newbcast:12
  v_dot2c_f32_bf16_dpp v18, v30, v79 row_newbcast:12
  v_dot2c_f32_bf16_dpp v19, v31, v79 row_newbcast:12
  s_cbranch_vccz L_d771
  s_waitcnt vmcnt(6)
L_d771:
  s_xor_b32 s68, s70, 0x10100
  buffer_load_dwordx4 v[100:103], v63, s[16:19], s68 offen nt
  s_barrier
  v_fma_f32 v196, v196, s71, -v29
  v_exp_f32 v196, v196
  s_nop 0
  v_add_f32 v21, v21, v196
  v_cvt_pk_bf16_f32 v30, v193, 0
  v_cvt_pk_bf16_f32 v31, 0, v193
  s_waitcnt vmcnt(7)
  v_dot2c_f32_bf16_dpp v12, v30, v80 row_newbcast:0
  v_dot2c_f32_bf16_dpp v13, v31, v80 row_newbcast:0
  v_dot2c_f32_bf16_dpp v14, v30, v81 row_newbcast:0
  v_dot2c_f32_bf16_dpp v15, v31, v81 row_newbcast:0
  v_dot2c_f32_bf16_dpp v16, v30, v82 row_newbcast:0
  v_dot2c_f32_bf16_dpp v17, v31, v82 row_newbcast:0
  v_dot2c_f32_bf16_dpp v18, v30, v83 row_newbcast:0
  v_dot2c_f32_bf16_dpp v19, v31, v83 row_newbcast:0
  s_cbranch_vccz L_d772
  s_waitcnt vmcnt(5)
L_d772:
  s_xor_b32 s68, s70, 0x10400
  buffer_load_dwordx4 v[104:107], v63, s[16:19], s68 offen nt
  v_fma_f32 v197, v197, s71, -v29
  v_exp_f32 v197, v197
  s_nop 0
  v_add_f32 v21, v21, v197
  s_waitcnt vmcnt(6)
  v_dot2c_f32_bf16_dpp v12, v30, v84 row_newbcast:8
  v_dot2c_f32_bf16_dpp v13, v31, v84 row_newbcast:8
  v_dot2c_f32_bf16_dpp v14, v30, v85 row_newbcast:8
  v_dot2c_f32_bf16_dpp v15, v31, v85 row_newbcast:8
  v_dot2c_f32_bf16_dpp v16, v30, v86 row_newbcast:8
  v_dot2c_f32_bf16_dpp v17, v31, v86 row_newbcast:8
  v_dot2c_f32_bf16_dpp v18, v30, v87 row_newbcast:8
  v_dot2c_f32_bf16_dpp v19, v31, v87 row_newbcast:8
  s_cbranch_vccz L_d773
  s_waitcnt vmcnt(5)
L_d773:
  s_xor_b32 s68, s70, 0x10500
  buffer_load_dwordx4 v[108:111], v63, s[16:19], s68 offen nt
  v_fma_f32 v198, v198, s71, -v29
  v_exp_f32 v198, v198
  s_nop 0
  v_add_f32 v21, v21, v198
  s_waitcnt vmcnt(6)
  v_dot2c_f32_bf16_dpp v12, v30, v88 row_newbcast:4
  v_dot2c_f32_bf16_dpp v13, v31, v88 row_newbcast:4
  v_dot2c_f32_bf16_dpp v14, v30, v89 row_newbcast:4
  v_dot2c_f32_bf16_dpp v15, v31, v89 row_newbcast:4
  v_dot2c_f32_bf16_dpp v16, v30, v90 row_newbcast:4
  v_dot2c_f32_bf16_dpp v17, v31, v90 row_newbcast:4
  v_dot2c_f32_bf16_dpp v18, v30, v91 row_newbcast:4
  v_dot2c_f32_bf16_dpp v19, v31, v91 row_newbcast:4
  s_cbranch_vccz L_d774
  s_waitcnt vmcnt(5)
L_d774:
  s_xor_b32 s68, s70, 0x10800
  buffer_load_dwordx4 v[112:115], v63, s[16:19], s68 offen nt
  buffer_load_dwordx4 a[244:247], v3, s[24:27], s73 offen offset:2048
  v_fma_f32 v199, v199, s71, -v29
  v_exp_f32 v199, v199
  s_nop 0
  v_add_f32 v21, v21, v199
  s_waitcnt vmcnt(7)
  v_dot2c_f32_bf16_dpp v12, v30, v92 row_newbcast:12
  v_dot2c_f32_bf16_dpp v13, v31, v92 row_newbcast:12
  v_dot2c_f32_bf16_dpp v14, v30, v93 row_newbcast:12
  v_dot2c_f32_bf16_dpp v15, v31, v93 row_newbcast:12
  v_dot2c_f32_bf16_dpp v16, v30, v94 row_newbcast:12
  v_dot2c_f32_bf16_dpp v17, v31, v94 row_newbcast:12
  v_dot2c_f32_bf16_dpp v18, v30, v95 row_newbcast:12
  v_dot2c_f32_bf16_dpp v19, v31, v95 row_newbcast:12
  s_cbranch_vccz L_d775
  s_waitcnt vmcnt(6)
L_d775:
  s_xor_b32 s68, s70, 0x10900
  buffer_load_dwordx4 v[116:119], v63, s[16:19], s68 offen nt
  s_barrier
  v_fma_f32 v200, v200, s71, -v29
  v_exp_f32 v200, v200
  s_nop 0
  v_add_f32 v21, v21, v200
  v_cvt_pk_bf16_f32 v30, v194, 0
  v_cvt_pk_bf16_f32 v31, 0, v194
  s_waitcnt vmcnt(7)
  v_dot2c_f32_bf16_dpp v12, v30, v96 row_newbcast:0
  v_dot2c_f32_bf16_dpp v13, v31, v96 row_newbcast:0
  v_dot2c_f32_bf16_dpp v14, v30, v97 row_newbcast:0
  v_dot2c_f32_bf16_dpp v15, v31, v97 row_newbcast:0
  v_dot2c_f32_bf16_dpp v16, v30, v98 row_newbcast:0
  v_dot2c_f32_bf16_dpp v17, v31, v98 row_newbcast:0
  v_dot2c_f32_bf16_dpp v18, v30, v99 row_newbcast:0
  v_dot2c_f32_bf16_dpp v19, v31, v99 row_newbcast:0
  s_cbranch_vccz L_d776
  s_waitcnt vmcnt(5)
L_d776:
  s_xor_b32 s68, s70, 0x10c00
  buffer_load_dwordx4 v[120:123], v63, s[16:19], s68 offen nt
  s_cmp_eq_u32 s64, 0
  s_cbranch_scc0 L_wp194
  s_mov_b32 s100, 16
  s_atomic_umax s100, s[20:21], s88
  s_and_b32 s60, s88, 0xfffffc7f
  s_xor_b32 s61, s60, 4096
  s_add_u32 s38, s60, 0
  s_load_dword s40, s[20:21], s38 glc
  s_add_u32 s38, s61, 128
  s_load_dword s41, s[20:21], s38 glc
  s_add_u32 s38, s61, 256
  s_load_dword s42, s[20:21], s38 glc
  s_add_u32 s38, s60, 384
  s_load_dword s43, s[20:21], s38 glc
  s_add_u32 s38, s60, 512
  s_load_dword s44, s[20:21], s38 glc
  s_add_u32 s38, s61, 640
  s_load_dword s45, s[20:21], s38 glc
  s_add_u32 s38, s61, 768
  s_load_dword s46, s[20:21], s38 glc
  s_add_u32 s38, s60, 896
  s_load_dword s47, s[20:21], s38 glc
L_wp194:
  v_fma_f32 v201, v201, s71, -v29
  v_exp_f32 v201, v201
  s_nop 0
  v_add_f32 v21, v21, v201
  s_waitcnt vmcnt(6)
  v_dot2c_f32_bf16_dpp v12, v30, v100 row_newbcast:8
  v_dot2c_f32_bf16_dpp v13, v31, v100 row_newbcast:8
  v_dot2c_f32_bf16_dpp v14, v30, v101 row_newbcast:8
  v_dot2c_f32_bf16_dpp v15, v31, v101 row_newbcast:8
  v_dot2c_f32_bf16_dpp v16, v30, v102 row_newbcast:8
  v_dot2c_f32_bf16_dpp v17, v31, v102 row_newbcast:8
  v_dot2c_f32_bf16_dpp v18, v30, v103 row_newbcast:8
  v_dot2c_f32_bf16_dpp v19, v31, v103 row_newbcast:8
  s_cbranch_vccz L_d777
  s_waitcnt vmcnt(5)
L_d777:
  s_xor_b32 s68, s70, 0x10d00
  buffer_load_dwordx4 v[124:127], v63, s[16:19], s68 offen nt
  v_fma_f32 v202, v202, s71, -v29
  v_exp_f32 v202, v202
  s_nop 0
  v_add_f32 v21, v21, v202
  s_waitcnt vmcnt(6)
  v_dot2c_f32_bf16_dpp v12, v30, v104 row_newbcast:4
  v_dot2c_f32_bf16_dpp v13, v31, v104 row_newbcast:4
  v_dot2c_f32_bf16_dpp v14, v30, v105 row_newbcast:4
  v_dot2c_f32_bf16_dpp v15, v31, v105 row_newbcast:4
  v_dot2c_f32_bf16_dpp v16, v30, v106 row_newbcast:4
  v_dot2c_f32_bf16_dpp v17, v31, v106 row_newbcast:4
  v_dot2c_f32_bf16_dpp v18, v30, v107 row_newbcast:4
  v_dot2c_f32_bf16_dpp v19, v31, v107 row_newbcast:4
  s_cbranch_vccz L_d778
  s_waitcnt vmcnt(5)
L_d778:
  s_xor_b32 s68, s70, 0x20000
  buffer_load_dwordx4 v[64:67], v63, s[16:19], s68 offen nt
  buffer_load_dwordx4 a[252:255], v3, s[24:27], s73 offen offset:2304
  s_add_u32 s73, s73, 4096
  v_fma_f32 v203, v203, s71, -v29
  v_exp_f32 v203, v203
  s_nop 0
  v_add_f32 v21, v21, v203
  s_waitcnt vmcnt(7)
  v_dot2c_f32_bf16_dpp v12, v30, v108 row_newbcast:12
  v_dot2c_f32_bf16_dpp v13, v31, v108 row_newbcast:12
  v_dot2c_f32_bf16_dpp v14, v30, v109 row_newbcast:12
  v_dot2c_f32_bf16_dpp v15, v31, v109 row_newbcast:12
  v_dot2c_f32_bf16_dpp v16, v30, v110 row_newbcast:12
  v_dot2c_f32_bf16_dpp v17, v31, v110 row_newbcast:12
  v_dot2c_f32_bf16_dpp v18, v30, v111 row_newbcast:12
  v_dot2c_f32_bf16_dpp v19, v31, v111 row_newbcast:12
  s_cbranch_vccz L_d779
  s_waitcnt vmcnt(6)
L_d779:
  s_xor_b32 s68, s70, 0x20100
  buffer_load_dwordx4 v[68:71], v63, s[16:19], s68 offen nt
  s_barrier
  v_fma_f32 v204, v204, s71, -v29
  v_exp_f32 v204, v204
  s_nop 0
  v_add_f32 v21, v21, v204
  v_cvt_pk_bf16_f32 v30, v195, 0
  v_cvt_pk_bf16_f32 v31, 0, v195
  s_waitcnt vmcnt(7)
  v_dot2c_f32_bf16_dpp v12, v30, v112 row_newbcast:0
  v_dot2c_f32_bf16_dpp v13, v31, v112 row_newbcast:0
  v_dot2c_f32_bf16_dpp v14, v30, v113 row_newbcast:0
  v_dot2c_f32_bf16_dpp v15, v31, v113 row_newbcast:0
  v_dot2c_f32_bf16_dpp v16, v30, v114 row_newbcast:0
  v_dot2c_f32_bf16_dpp v17, v31, v114 row_newbcast:0
  v_dot2c_f32_bf16_dpp v18, v30, v115 row_newbcast:0
  v_dot2c_f32_bf16_dpp v19, v31, v115 row_newbcast:0
  s_cbranch_vccz L_d780
  s_waitcnt vmcnt(5)
L_d780:
  s_xor_b32 s68, s70, 0x20400
  buffer_load_dwordx4 v[72:75], v63, s[16:19], s68 offen nt
  v_fma_f32 v205, v205, s71, -v29
  v_exp_f32 v205, v205
  s_nop 0
  v_add_f32 v21, v21, v205
  s_waitcnt vmcnt(6)
  v_dot2c_f32_bf16_dpp v12, v30, v116 row_newbcast:8
  v_dot2c_f32_bf16_dpp v13, v31, v116 row_newbcast:8
  v_dot2c_f32_bf16_dpp v14, v30, v117 row_newbcast:8
  v_dot2c_f32_bf16_dpp v15, v31, v117 row_newbcast:8
  v_dot2c_f32_bf16_dpp v16, v30, v118 row_newbcast:8
  v_dot2c_f32_bf16_dpp v17, v31, v118 row_newbcast:8
  v_dot2c_f32_bf16_dpp v18, v30, v119 row_newbcast:8
  v_dot2c_f32_bf16_dpp v19, v31, v119 row_newbcast:8
  s_cbranch_vccz L_d781
  s_waitcnt vmcnt(5)
L_d781:
  s_xor_b32 s68, s70, 0x20500
  buffer_load_dwordx4 v[76:79], v63, s[16:19], s68 offen nt
  v_fma_f32 v206, v206, s71, -v29
  v_exp_f32 v206, v206
  s_nop 0
  v_add_f32 v21, v21, v206
  s_waitcnt vmcnt(6)
  v_dot2c_f32_bf16_dpp v12, v30, v120 row_newbcast:4
  v_dot2c_f32_bf16_dpp v13, v31, v120 row_newbcast:4
  v_dot2c_f32_bf16_dpp v14, v30, v121 row_newbcast:4
  v_dot2c_f32_bf16_dpp v15, v31, v121 row_newbcast:4
  v_dot2c_f32_bf16_dpp v16, v30, v122 row_newbcast:4
  v_dot2c_f32_bf16_dpp v17, v31, v122 row_newbcast:4
  v_dot2c_f32_bf16_dpp v18, v30, v123 row_newbcast:4
  v_dot2c_f32_bf16_dpp v19, v31, v123 row_newbcast:4
  s_cbranch_vccz L_d782
  s_waitcnt vmcnt(5)
L_d782:
  s_xor_b32 s68, s70, 0x20800
  buffer_load_dwordx4 v[80:83], v63, s[16:19], s68 offen nt
  v_fma_f32 v207, v207, s71, -v29
  v_exp_f32 v207, v207
  s_nop 0
  v_add_f32 v21, v21, v207
  s_waitcnt vmcnt(6)
  v_dot2c_f32_bf16_dpp v12, v30, v124 row_newbcast:12
  v_dot2c_f32_bf16_dpp v13, v31, v124 row_newbcast:12
  v_dot2c_f32_bf16_dpp v14, v30, v125 row_newbcast:12
  v_dot2c_f32_bf16_dpp v15, v31, v125 row_newbcast:12
  v_dot2c_f32_bf16_dpp v16, v30, v126 row_newbcast:12
  v_dot2c_f32_bf16_dpp v17, v31, v126 row_newbcast:12
  v_dot2c_f32_bf16_dpp v18, v30, v127 row_newbcast:12
  v_dot2c_f32_bf16_dpp v19, v31, v127 row_newbcast:12
  s_cbranch_vccz L_d783
  s_waitcnt vmcnt(5)
L_d783:
  s_xor_b32 s68, s70, 0x20900
  buffer_load_dwordx4 v[84:87], v63, s[16:19], s68 offen nt
  s_barrier
  v_fma_f32 v208, v208, s71, -v29
  v_exp_f32 v208, v208
  s_nop 0
  v_add_f32 v21, v21, v208
  v_cvt_pk_bf16_f32 v30, v196, 0
  v_cvt_pk_bf16_f32 v31, 0, v196
  s_waitcnt vmcnt(6)
  v_dot2c_f32_bf16_dpp v12, v30, v64 row_newbcast:0
  v_dot2c_f32_bf16_dpp v13, v31, v64 row_newbcast:0
  v_dot2c_f32_bf16_dpp v14, v30, v65 row_newbcast:0
  v_dot2c_f32_bf16_dpp v15, v31, v65 row_newbcast:0
  v_dot2c_f32_bf16_dpp v16, v30, v66 row_newbcast:0
  v_dot2c_f32_bf16_dpp v17, v31, v66 row_newbcast:0
  v_dot2c_f32_bf16_dpp v18, v30, v67 row_newbcast:0
  v_dot2c_f32_bf16_dpp v19, v31, v67 row_newbcast:0
  s_cbranch_vccz L_d784
  s_waitcnt vmcnt(4)
L_d784:
  s_xor_b32 s68, s70, 0x20c00
  buffer_load_dwordx4 v[88:91], v63, s[16:19], s68 offen nt
  s_cmp_eq_u32 s64, 0
  s_cbranch_scc0 L_wp196
  s_mov_b32 s101, 0
  s_waitcnt lgkmcnt(0)
  s_cmp_ge_u32 s40, 16
  s_addc_u32 s101, s101, 0
  s_cmp_ge_u32 s41, 16
  s_addc_u32 s101, s101, 0
  s_cmp_ge_u32 s42, 16
  s_addc_u32 s101, s101, 0
  s_cmp_ge_u32 s43, 16
  s_addc_u32 s101, s101, 0
  s_cmp_ge_u32 s44, 16
  s_addc_u32 s101, s101, 0
  s_cmp_ge_u32 s45, 16
  s_addc_u32 s101, s101, 0
  s_cmp_ge_u32 s46, 16
  s_addc_u32 s101, s101, 0
  s_cmp_ge_u32 s47, 16
  s_addc_u32 s101, s101, 0
  s_cmp_lt_u32 s101, 6
  s_cselect_b32 s38, -1, 0
  v_mov_b32 v26, 0
  v_mov_b32 v27, s38
  ds_write_b32 v26, v27 offset:8512
L_wp196:
  v_fma_f32 v209, v209, s71, -v29
  v_exp_f32 v209, v209
  s_nop 0
  v_add_f32 v21, v21, v209
  s_waitcnt vmcnt(5)
  v_dot2c_f32_bf16_dpp v12, v30, v68 row_newbcast:8
  v_dot2c_f32_bf16_dpp v13, v31, v68 row_newbcast:8
  v_dot2c_f32_bf16_dpp v14, v30, v69 row_newbcast:8
  v_dot2c_f32_bf16_dpp v15, v31, v69 row_newbcast:8
  v_dot2c_f32_bf16_dpp v16, v30, v70 row_newbcast:8
  v_dot2c_f32_bf16_dpp v17, v31, v70 row_newbcast:8
  v_dot2c_f32_bf16_dpp v18, v30, v71 row_newbcast:8
  v_dot2c_f32_bf16_dpp v19, v31, v71 row_newbcast:8
  s_cbranch_vccz L_d785
  s_waitcnt vmcnt(4)
L_d785:
  s_xor_b32 s68, s70, 0x20d00
  buffer_load_dwordx4 v[92:95], v63, s[16:19], s68 offen nt
  v_fma_f32 v210, v210, s71, -v29
  v_exp_f32 v210, v210
  s_nop 0
  v_add_f32 v21, v21, v210
  s_waitcnt vmcnt(5)
  v_dot2c_f32_bf16_dpp v12, v30, v72 row_newbcast:4
  v_dot2c_f32_bf16_dpp v13, v31, v72 row_newbcast:4
  v_dot2c_f32_bf16_dpp v14, v30, v73 row_newbcast:4
  v_dot2c_f32_bf16_dpp v15, v31, v73 row_newbcast:4
  v_dot2c_f32_bf16_dpp v16, v30, v74 row_newbcast:4
  v_dot2c_f32_bf16_dpp v17, v31, v74 row_newbcast:4
  v_dot2c_f32_bf16_dpp v18, v30, v75 row_newbcast:4
  v_dot2c_f32_bf16_dpp v19, v31, v75 row_newbcast:4
  s_cbranch_vccz L_d786
  s_waitcnt vmcnt(4)
L_d786:
  s_xor_b32 s68, s70, 0x30000
  buffer_load_dwordx4 v[96:99], v63, s[16:19], s68 offen nt
  v_fma_f32 v211, v211, s71, -v29
  v_exp_f32 v211, v211
  s_nop 0
  v_add_f32 v21, v21, v211
  s_waitcnt vmcnt(5)
  v_dot2c_f32_bf16_dpp v12, v30, v76 row_newbcast:12
  v_dot2c_f32_bf16_dpp v13, v31, v76 row_newbcast:12
  v_dot2c_f32_bf16_dpp v14, v30, v77 row_newbcast:12
  v_dot2c_f32_bf16_dpp v15, v31, v77 row_newbcast:12
  v_dot2c_f32_bf16_dpp v16, v30, v78 row_newbcast:12
  v_dot2c_f32_bf16_dpp v17, v31, v78 row_newbcast:12
  v_dot2c_f32_bf16_dpp v18, v30, v79 row_newbcast:12
  v_dot2c_f32_bf16_dpp v19, v31, v79 row_newbcast:12
  s_cbranch_vccz L_d787
  s_waitcnt vmcnt(4)
L_d787:
  s_xor_b32 s68, s70, 0x30100
  buffer_load_dwordx4 v[100:103], v63, s[16:19], s68 offen nt
  s_barrier
  v_fma_f32 v212, v212, s71, -v29
  v_exp_f32 v212, v212
  s_nop 0
  v_add_f32 v21, v21, v212
  v_cvt_pk_bf16_f32 v30, v197, 0
  v_cvt_pk_bf16_f32 v31, 0, v197
  s_waitcnt vmcnt(5)
  v_dot2c_f32_bf16_dpp v12, v30, v80 row_newbcast:0
  v_dot2c_f32_bf16_dpp v13, v31, v80 row_newbcast:0
  v_dot2c_f32_bf16_dpp v14, v30, v81 row_newbcast:0
  v_dot2c_f32_bf16_dpp v15, v31, v81 row_newbcast:0
  v_dot2c_f32_bf16_dpp v16, v30, v82 row_newbcast:0
  v_dot2c_f32_bf16_dpp v17, v31, v82 row_newbcast:0
  v_dot2c_f32_bf16_dpp v18, v30, v83 row_newbcast:0
  v_dot2c_f32_bf16_dpp v19, v31, v83 row_newbcast:0
  s_cbranch_vccz L_d788
  s_waitcnt vmcnt(4)
L_d788:
  s_xor_b32 s68, s70, 0x30400
  buffer_load_dwordx4 v[104:107], v63, s[16:19], s68 offen nt
  v_mov_b32 v26, 0
  ds_read_b32 v35, v26 offset:8512
  v_fma_f32 v213, v213, s71, -v29
  v_exp_f32 v213, v213
  s_nop 0
  v_add_f32 v21, v21, v213
  s_waitcnt vmcnt(5)
  v_dot2c_f32_bf16_dpp v12, v30, v84 row_newbcast:8
  v_dot2c_f32_bf16_dpp v13, v31, v84 row_newbcast:8
  v_dot2c_f32_bf16_dpp v14, v30, v85 row_newbcast:8
  v_dot2c_f32_bf16_dpp v15, v31, v85 row_newbcast:8
  v_dot2c_f32_bf16_dpp v16, v30, v86 row_newbcast:8
  v_dot2c_f32_bf16_dpp v17, v31, v86 row_newbcast:8
  v_dot2c_f32_bf16_dpp v18, v30, v87 row_newbcast:8
  v_dot2c_f32_bf16_dpp v19, v31, v87 row_newbcast:8
  s_cbranch_vccz L_d789
  s_waitcnt vmcnt(4)
L_d789:
  s_xor_b32 s68, s70, 0x30500
  buffer_load_dwordx4 v[108:111], v63, s[16:19], s68 offen nt
  v_fma_f32 v214, v214, s71, -v29
  v_exp_f32 v214, v214
  s_nop 0
  v_add_f32 v21, v21, v214
  s_waitcnt vmcnt(5)
  v_dot2c_f32_bf16_dpp v12, v30, v88 row_newbcast:4
  v_dot2c_f32_bf16_dpp v13, v31, v88 row_newbcast:4
  v_dot2c_f32_bf16_dpp v14, v30, v89 row_newbcast:4
  v_dot2c_f32_bf16_dpp v15, v31, v89 row_newbcast:4
  v_dot2c_f32_bf16_dpp v16, v30, v90 row_newbcast:4
  v_dot2c_f32_bf16_dpp v17, v31, v90 row_newbcast:4
  v_dot2c_f32_bf16_dpp v18, v30, v91 row_newbcast:4
  v_dot2c_f32_bf16_dpp v19, v31, v91 row_newbcast:4
  s_cbranch_vccz L_d790
  s_waitcnt vmcnt(4)
L_d790:
  s_xor_b32 s68, s70, 0x30800
  buffer_load_dwordx4 v[112:115], v63, s[16:19], s68 offen nt
  v_fma_f32 v215, v215, s71, -v29
  v_exp_f32 v215, v215
  s_nop 0
  v_add_f32 v21, v21, v215
  s_waitcnt vmcnt(5)
  v_dot2c_f32_bf16_dpp v12, v30, v92 row_newbcast:12
  v_dot2c_f32_bf16_dpp v13, v31, v92 row_newbcast:12
  v_dot2c_f32_bf16_dpp v14, v30, v93 row_newbcast:12
  v_dot2c_f32_bf16_dpp v15, v31, v93 row_newbcast:12
  v_dot2c_f32_bf16_dpp v16, v30, v94 row_newbcast:12
  v_dot2c_f32_bf16_dpp v17, v31, v94 row_newbcast:12
  v_dot2c_f32_bf16_dpp v18, v30, v95 row_newbcast:12
  v_dot2c_f32_bf16_dpp v19, v31, v95 row_newbcast:12
  s_cbranch_vccz L_d791
  s_waitcnt vmcnt(4)
L_d791:
  s_xor_b32 s68, s70, 0x30900
  buffer_load_dwordx4 v[116:119], v63, s[16:19], s68 offen nt
  s_barrier
  v_fma_f32 v216, v216, s71, -v29
  v_exp_f32 v216, v216
  s_nop 0
  v_add_f32 v21, v21, v216
  v_cvt_pk_bf16_f32 v30, v198, 0
  v_cvt_pk_bf16_f32 v31, 0, v198
  s_waitcnt vmcnt(5)
  v_dot2c_f32_bf16_dpp v12, v30, v96 row_newbcast:0
  v_dot2c_f32_bf16_dpp v13, v31, v96 row_newbcast:0
  v_dot2c_f32_bf16_dpp v14, v30, v97 row_newbcast:0
  v_dot2c_f32_bf16_dpp v15, v31, v97 row_newbcast:0
  v_dot2c_f32_bf16_dpp v16, v30, v98 row_newbcast:0
  v_dot2c_f32_bf16_dpp v17, v31, v98 row_newbcast:0
  v_dot2c_f32_bf16_dpp v18, v30, v99 row_newbcast:0
  v_dot2c_f32_bf16_dpp v19, v31, v99 row_newbcast:0
  s_cbranch_vccz L_d792
  s_waitcnt vmcnt(4)
L_d792:
  s_xor_b32 s68, s70, 0x30c00
  buffer_load_dwordx4 v[120:123], v63, s[16:19], s68 offen nt
  s_waitcnt lgkmcnt(0)
  v_cmp_ne_u32 vcc, 0, v35
  v_fma_f32 v217, v217, s71, -v29
  v_exp_f32 v217, v217
  s_nop 0
  v_add_f32 v21, v21, v217
  s_waitcnt vmcnt(5)
  v_dot2c_f32_bf16_dpp v12, v30, v100 row_newbcast:8
  v_dot2c_f32_bf16_dpp v13, v31, v100 row_newbcast:8
  v_dot2c_f32_bf16_dpp v14, v30, v101 row_newbcast:8
  v_dot2c_f32_bf16_dpp v15, v31, v101 row_newbcast:8
  v_dot2c_f32_bf16_dpp v16, v30, v102 row_newbcast:8
  v_dot2c_f32_bf16_dpp v17, v31, v102 row_newbcast:8
  v_dot2c_f32_bf16_dpp v18, v30, v103 row_newbcast:8
  v_dot2c_f32_bf16_dpp v19, v31, v103 row_newbcast:8
  s_cbranch_vccz L_d793
  s_waitcnt vmcnt(4)
L_d793:
  s_xor_b32 s68, s70, 0x30d00
  buffer_load_dwordx4 v[124:127], v63, s[16:19], s68 offen nt
  v_fma_f32 v218, v218, s71, -v29
  v_exp_f32 v218, v218
  s_nop 0
  v_add_f32 v21, v21, v218
  s_waitcnt vmcnt(5)
  v_dot2c_f32_bf16_dpp v12, v30, v104 row_newbcast:4
  v_dot2c_f32_bf16_dpp v13, v31, v104 row_newbcast:4
  v_dot2c_f32_bf16_dpp v14, v30, v105 row_newbcast:4
  v_dot2c_f32_bf16_dpp v15, v31, v105 row_newbcast:4
  v_dot2c_f32_bf16_dpp v16, v30, v106 row_newbcast:4
  v_dot2c_f32_bf16_dpp v17, v31, v106 row_newbcast:4
  v_dot2c_f32_bf16_dpp v18, v30, v107 row_newbcast:4
  v_dot2c_f32_bf16_dpp v19, v31, v107 row_newbcast:4
  s_cbranch_vccz L_d794
  s_waitcnt vmcnt(4)
L_d794:
  s_xor_b32 s68, s70, 0x80000
  buffer_load_dwordx4 v[64:67], v63, s[16:19], s68 offen nt
  v_fma_f32 v219, v219, s71, -v29
  v_exp_f32 v219, v219
  s_nop 0
  v_add_f32 v21, v21, v219
  s_waitcnt vmcnt(5)
  v_dot2c_f32_bf16_dpp v12, v30, v108 row_newbcast:12
  v_dot2c_f32_bf16_dpp v13, v31, v108 row_newbcast:12
  v_dot2c_f32_bf16_dpp v14, v30, v109 row_newbcast:12
  v_dot2c_f32_bf16_dpp v15, v31, v109 row_newbcast:12
  v_dot2c_f32_bf16_dpp v16, v30, v110 row_newbcast:12
  v_dot2c_f32_bf16_dpp v17, v31, v110 row_newbcast:12
  v_dot2c_f32_bf16_dpp v18, v30, v111 row_newbcast:12
  v_dot2c_f32_bf16_dpp v19, v31, v111 row_newbcast:12
  s_cbranch_vccz L_d795
  s_waitcnt vmcnt(4)
L_d795:
  s_xor_b32 s68, s70, 0x80100
  buffer_load_dwordx4 v[68:71], v63, s[16:19], s68 offen nt
  s_barrier
  v_fma_f32 v220, v220, s71, -v29
  v_exp_f32 v220, v220
  s_nop 0
  v_add_f32 v21, v21, v220
  v_cvt_pk_bf16_f32 v30, v199, 0
  v_cvt_pk_bf16_f32 v31, 0, v199
  s_waitcnt vmcnt(5)
  v_dot2c_f32_bf16_dpp v12, v30, v112 row_newbcast:0
  v_dot2c_f32_bf16_dpp v13, v31, v112 row_newbcast:0
  v_dot2c_f32_bf16_dpp v14, v30, v113 row_newbcast:0
  v_dot2c_f32_bf16_dpp v15, v31, v113 row_newbcast:0
  v_dot2c_f32_bf16_dpp v16, v30, v114 row_newbcast:0
  v_dot2c_f32_bf16_dpp v17, v31, v114 row_newbcast:0
  v_dot2c_f32_bf16_dpp v18, v30, v115 row_newbcast:0
  v_dot2c_f32_bf16_dpp v19, v31, v115 row_newbcast:0
  s_cbranch_vccz L_d796
  s_waitcnt vmcnt(4)
L_d796:
  s_xor_b32 s68, s70, 0x80400
  buffer_load_dwordx4 v[72:75], v63, s[16:19], s68 offen nt
  v_fma_f32 v221, v221, s71, -v29
  v_exp_f32 v221, v221
  s_nop 0
  v_add_f32 v21, v21, v221
  s_waitcnt vmcnt(5)
  v_dot2c_f32_bf16_dpp v12, v30, v116 row_newbcast:8
  v_dot2c_f32_bf16_dpp v13, v31, v116 row_newbcast:8
  v_dot2c_f32_bf16_dpp v14, v30, v117 row_newbcast:8
  v_dot2c_f32_bf16_dpp v15, v31, v117 row_newbcast:8
  v_dot2c_f32_bf16_dpp v16, v30, v118 row_newbcast:8
  v_dot2c_f32_bf16_dpp v17, v31, v118 row_newbcast:8
  v_dot2c_f32_bf16_dpp v18, v30, v119 row_newbcast:8
  v_dot2c_f32_bf16_dpp v19, v31, v119 row_newbcast:8
  s_cbranch_vccz L_d797
  s_waitcnt vmcnt(4)
L_d797:
  s_xor_b32 s68, s70, 0x80500
  buffer_load_dwordx4 v[76:79], v63, s[16:19], s68 offen nt
  v_fma_f32 v222, v222, s71, -v29
  v_exp_f32 v222, v222
  s_nop 0
  v_add_f32 v21, v21, v222
  s_waitcnt vmcnt(5)
  v_dot2c_f32_bf16_dpp v12, v30, v120 row_newbcast:4
  v_dot2c_f32_bf16_dpp v13, v31, v120 row_newbcast:4
  v_dot2c_f32_bf16_dpp v14, v30, v121 row_newbcast:4
  v_dot2c_f32_bf16_dpp v15, v31, v121 row_newbcast:4
  v_dot2c_f32_bf16_dpp v16, v30, v122 row_newbcast:4
  v_dot2c_f32_bf16_dpp v17, v31, v122 row_newbcast:4
  v_dot2c_f32_bf16_dpp v18, v30, v123 row_newbcast:4
  v_dot2c_f32_bf16_dpp v19, v31, v123 row_newbcast:4
  s_cbranch_vccz L_d798
  s_waitcnt vmcnt(4)
L_d798:
  s_xor_b32 s68, s70, 0x80800
  buffer_load_dwordx4 v[80:83], v63, s[16:19], s68 offen nt
  v_fma_f32 v223, v223, s71, -v29
  v_exp_f32 v223, v223
  s_nop 0
  v_add_f32 v21, v21, v223
  s_waitcnt vmcnt(5)
  v_dot2c_f32_bf16_dpp v12, v30, v124 row_newbcast:12
  v_dot2c_f32_bf16_dpp v13, v31, v124 row_newbcast:12
  v_dot2c_f32_bf16_dpp v14, v30, v125 row_newbcast:12
  v_dot2c_f32_bf16_dpp v15, v31, v125 row_newbcast:12
  v_dot2c_f32_bf16_dpp v16, v30, v126 row_newbcast:12
  v_dot2c_f32_bf16_dpp v17, v31, v126 row_newbcast:12
  v_dot2c_f32_bf16_dpp v18, v30, v127 row_newbcast:12
  v_dot2c_f32_bf16_dpp v19, v31, v127 row_newbcast:12
  s_cbranch_vccz L_d799
  s_waitcnt vmcnt(4)
L_d799:
  s_xor_b32 s68, s70, 0x80900
  buffer_load_dwordx4 v[84:87], v63, s[16:19], s68 offen nt
  s_barrier
  v_fma_f32 v224, v224, s71, -v29
  v_exp_f32 v224, v224
  s_nop 0
  v_add_f32 v21, v21, v224
  v_cvt_pk_bf16_f32 v30, v200, 0
  v_cvt_pk_bf16_f32 v31, 0, v200
  s_waitcnt vmcnt(5)
  v_dot2c_f32_bf16_dpp v12, v30, v64 row_newbcast:0
  v_dot2c_f32_bf16_dpp v13, v31, v64 row_newbcast:0
  v_dot2c_f32_bf16_dpp v14, v30, v65 row_newbcast:0
  v_dot2c_f32_bf16_dpp v15, v31, v65 row_newbcast:0
  v_dot2c_f32_bf16_dpp v16, v30, v66 row_newbcast:0
  v_dot2c_f32_bf16_dpp v17, v31, v66 row_newbcast:0
  v_dot2c_f32_bf16_dpp v18, v30, v67 row_newbcast:0
  v_dot2c_f32_bf16_dpp v19, v31, v67 row_newbcast:0
  s_cbranch_vccz L_d800
  s_waitcnt vmcnt(4)
L_d800:
  s_xor_b32 s68, s70, 0x80c00
  buffer_load_dwordx4 v[88:91], v63, s[16:19], s68 offen nt
  v_fma_f32 v225, v225, s71, -v29
  v_exp_f32 v225, v225
  s_nop 0
  v_add_f32 v21, v21, v225
  s_waitcnt vmcnt(5)
  v_dot2c_f32_bf16_dpp v12, v30, v68 row_newbcast:8
  v_dot2c_f32_bf16_dpp v13, v31, v68 row_newbcast:8
  v_dot2c_f32_bf16_dpp v14, v30, v69 row_newbcast:8
  v_dot2c_f32_bf16_dpp v15, v31, v69 row_newbcast:8
  v_dot2c_f32_bf16_dpp v16, v30, v70 row_newbcast:8
  v_dot2c_f32_bf16_dpp v17, v31, v70 row_newbcast:8
  v_dot2c_f32_bf16_dpp v18, v30, v71 row_newbcast:8
  v_dot2c_f32_bf16_dpp v19, v31, v71 row_newbcast:8
  s_cbranch_vccz L_d801
  s_waitcnt vmcnt(4)
L_d801:
  s_xor_b32 s68, s70, 0x80d00
  buffer_load_dwordx4 v[92:95], v63, s[16:19], s68 offen nt
  v_fma_f32 v226, v226, s71, -v29
  v_exp_f32 v226, v226
  s_nop 0
  v_add_f32 v21, v21, v226
  s_waitcnt vmcnt(5)
  v_dot2c_f32_bf16_dpp v12, v30, v72 row_newbcast:4
  v_dot2c_f32_bf16_dpp v13, v31, v72 row_newbcast:4
  v_dot2c_f32_bf16_dpp v14, v30, v73 row_newbcast:4
  v_dot2c_f32_bf16_dpp v15, v31, v73 row_newbcast:4
  v_dot2c_f32_bf16_dpp v16, v30, v74 row_newbcast:4
  v_dot2c_f32_bf16_dpp v17, v31, v74 row_newbcast:4
  v_dot2c_f32_bf16_dpp v18, v30, v75 row_newbcast:4
  v_dot2c_f32_bf16_dpp v19, v31, v75 row_newbcast:4
  s_cbranch_vccz L_d802
  s_waitcnt vmcnt(4)
L_d802:
  s_xor_b32 s68, s70, 0x90000
  buffer_load_dwordx4 v[96:99], v63, s[16:19], s68 offen nt
  v_fma_f32 v227, v227, s71, -v29
  v_exp_f32 v227, v227
  s_nop 0
  v_add_f32 v21, v21, v227
  s_waitcnt vmcnt(5)
  v_dot2c_f32_bf16_dpp v12, v30, v76 row_newbcast:12
  v_dot2c_f32_bf16_dpp v13, v31, v76 row_newbcast:12
  v_dot2c_f32_bf16_dpp v14, v30, v77 row_newbcast:12
  v_dot2c_f32_bf16_dpp v15, v31, v77 row_newbcast:12
  v_dot2c_f32_bf16_dpp v16, v30, v78 row_newbcast:12
  v_dot2c_f32_bf16_dpp v17, v31, v78 row_newbcast:12
  v_dot2c_f32_bf16_dpp v18, v30, v79 row_newbcast:12
  v_dot2c_f32_bf16_dpp v19, v31, v79 row_newbcast:12
  s_cbranch_vccz L_d803
  s_waitcnt vmcnt(4)
L_d803:
  s_xor_b32 s68, s70, 0x90100
  buffer_load_dwordx4 v[100:103], v63, s[16:19], s68 offen nt
  s_barrier
  v_fma_f32 v228, v228, s71, -v29
  v_exp_f32 v228, v228
  s_nop 0
  v_add_f32 v21, v21, v228
  s_cmp_eq_u32 s64, 0
  s_cbranch_scc0 L_wr
  s_mov_b64 s[60:61], vcc
L_rdy:
  v_cmp_eq_u32 vcc, 0, v9
  s_nop 1
  s_cbranch_vccz L_rdyok
  buffer_load_dword v9, v8, s[20:23], s37 offen sc1
  s_sub_u32 s87, s87, 1
  s_cmp_eq_u32 s87, 0
  s_cbranch_scc1 L_end
  s_waitcnt vmcnt(0)
  s_branch L_rdy
L_rdyok:
  s_mov_b64 vcc, s[60:61]
L_wr:
  v_cvt_pk_bf16_f32 v30, v201, 0
  v_cvt_pk_bf16_f32 v31, 0, v201
  s_waitcnt vmcnt(5)
  v_dot2c_f32_bf16_dpp v12, v30, v80 row_newbcast:0
  v_dot2c_f32_bf16_dpp v13, v31, v80 row_newbcast:0
  v_dot2c_f32_bf16_dpp v14, v30, v81 row_newbcast:0
  v_dot2c_f32_bf16_dpp v15, v31, v81 row_newbcast:0
  v_dot2c_f32_bf16_dpp v16, v30, v82 row_newbcast:0
  v_dot2c_f32_bf16_dpp v17, v31, v82 row_newbcast:0
  v_dot2c_f32_bf16_dpp v18, v30, v83 row_newbcast:0
  v_dot2c_f32_bf16_dpp v19, v31, v83 row_newbcast:0
  s_cbranch_vccz L_d804
  s_waitcnt vmcnt(4)
L_d804:
  s_xor_b32 s68, s70, 0x90400
  buffer_load_dwordx4 v[104:107], v63, s[16:19], s68 offen nt
  v_fma_f32 v229, v229, s71, -v29
  v_exp_f32 v229, v229
  s_nop 0
  v_add_f32 v21, v21, v229
  s_waitcnt vmcnt(5)
  v_dot2c_f32_bf16_dpp v12, v30, v84 row_newbcast:8
  v_dot2c_f32_bf16_dpp v13, v31, v84 row_newbcast:8
  v_dot2c_f32_bf16_dpp v14, v30, v85 row_newbcast:8
  v_dot2c_f32_bf16_dpp v15, v31, v85 row_newbcast:8
  v_dot2c_f32_bf16_dpp v16, v30, v86 row_newbcast:8
  v_dot2c_f32_bf16_dpp v17, v31, v86 row_newbcast:8
  v_dot2c_f32_bf16_dpp v18, v30, v87 row_newbcast:8
  v_dot2c_f32_bf16_dpp v19, v31, v87 row_newbcast:8
  s_cbranch_vccz L_d805
  s_waitcnt vmcnt(4)
L_d805:
  s_xor_b32 s68, s70, 0x90500
  buffer_load_dwordx4 v[108:111], v63, s[16:19], s68 offen nt
  v_fma_f32 v230, v230, s71, -v29
  v_exp_f32 v230, v230
  s_nop 0
  v_add_f32 v21, v21, v230
  s_waitcnt vmcnt(5)
  v_dot2c_f32_bf16_dpp v12, v30, v88 row_newbcast:4
  v_dot2c_f32_bf16_dpp v13, v31, v88 row_newbcast:4
  v_dot2c_f32_bf16_dpp v14, v30, v89 row_newbcast:4
  v_dot2c_f32_bf16_dpp v15, v31, v89 row_newbcast:4
  v_dot2c_f32_bf16_dpp v16, v30, v90 row_newbcast:4
  v_dot2c_f32_bf16_dpp v17, v31, v90 row_newbcast:4
  v_dot2c_f32_bf16_dpp v18, v30, v91 row_newbcast:4
  v_dot2c_f32_bf16_dpp v19, v31, v91 row_newbcast:4
  s_cbranch_vccz L_d806
  s_waitcnt vmcnt(4)
L_d806:
  s_xor_b32 s68, s70, 0x90800
  buffer_load_dwordx4 v[112:115], v63, s[16:19], s68 offen nt
  v_fma_f32 v231, v231, s71, -v29
  v_exp_f32 v231, v231
  s_nop 0
  v_add_f32 v21, v21, v231
  s_waitcnt vmcnt(5)
  v_dot2c_f32_bf16_dpp v12, v30, v92 row_newbcast:12
  v_dot2c_f32_bf16_dpp v13, v31, v92 row_newbcast:12
  v_dot2c_f32_bf16_dpp v14, v30, v93 row_newbcast:12
  v_dot2c_f32_bf16_dpp v15, v31, v93 row_newbcast:12
  v_dot2c_f32_bf16_dpp v16, v30, v94 row_newbcast:12
  v_dot2c_f32_bf16_dpp v17, v31, v94 row_newbcast:12
  v_dot2c_f32_bf16_dpp v18, v30, v95 row_newbcast:12
  v_dot2c_f32_bf16_dpp v19, v31, v95 row_newbcast:12
  s_cbranch_vccz L_d807
  s_waitcnt vmcnt(4)
L_d807:
  s_xor_b32 s68, s70, 0x90900
  buffer_load_dwordx4 v[116:119], v63, s[16:19], s68 offen nt
  s_barrier
  v_fma_f32 v232, v232, s71, -v29
  v_exp_f32 v232, v232
  s_nop 0
  v_add_f32 v21, v21, v232
  v_cvt_pk_bf16_f32 v30, v202, 0
  v_cvt_pk_bf16_f32 v31, 0, v202
  s_waitcnt vmcnt(5)
  v_dot2c_f32_bf16_dpp v12, v30, v96 row_newbcast:0
  v_dot2c_f32_bf16_dpp v13, v31, v96 row_newbcast:0
  v_dot2c_f32_bf16_dpp v14, v30, v97 row_newbcast:0
  v_dot2c_f32_bf16_dpp v15, v31, v97 row_newbcast:0
  v_dot2c_f32_bf16_dpp v16, v30, v98 row_newbcast:0
  v_dot2c_f32_bf16_dpp v17, v31, v98 row_newbcast:0
  v_dot2c_f32_bf16_dpp v18, v30, v99 row_newbcast:0
  v_dot2c_f32_bf16_dpp v19, v31, v99 row_newbcast:0
  s_cbranch_vccz L_d808
  s_waitcnt vmcnt(4)
L_d808:
  s_xor_b32 s68, s70, 0x90c00
  buffer_load_dwordx4 v[120:123], v63, s[16:19], s68 offen nt
  v_fma_f32 v233, v233, s71, -v29
  v_exp_f32 v233, v233
  s_nop 0
  v_add_f32 v21, v21, v233
  s_waitcnt vmcnt(5)
  v_dot2c_f32_bf16_dpp v12, v30, v100 row_newbcast:8
  v_dot2c_f32_bf16_dpp v13, v31, v100 row_newbcast:8
  v_dot2c_f32_bf16_dpp v14, v30, v101 row_newbcast:8
  v_dot2c_f32_bf16_dpp v15, v31, v101 row_newbcast:8
  v_dot2c_f32_bf16_dpp v16, v30, v102 row_newbcast:8
  v_dot2c_f32_bf16_dpp v17, v31, v102 row_newbcast:8
  v_dot2c_f32_bf16_dpp v18, v30, v103 row_newbcast:8
  v_dot2c_f32_bf16_dpp v19, v31, v103 row_newbcast:8
  s_cbranch_vccz L_d809
  s_waitcnt vmcnt(4)
L_d809:
  s_xor_b32 s68, s70, 0x90d00
  buffer_load_dwordx4 v[124:127], v63, s[16:19], s68 offen nt
  v_fma_f32 v234, v234, s71, -v29
  v_exp_f32 v234, v234
  s_nop 0
  v_add_f32 v21, v21, v234
  s_waitcnt vmcnt(5)
  v_dot2c_f32_bf16_dpp v12, v30, v104 row_newbcast:4
  v_dot2c_f32_bf16_dpp v13, v31, v104 row_newbcast:4
  v_dot2c_f32_bf16_dpp v14, v30, v105 row_newbcast:4
  v_dot2c_f32_bf16_dpp v15, v31, v105 row_newbcast:4
  v_dot2c_f32_bf16_dpp v16, v30, v106 row_newbcast:4
  v_dot2c_f32_bf16_dpp v17, v31, v106 row_newbcast:4
  v_dot2c_f32_bf16_dpp v18, v30, v107 row_newbcast:4
  v_dot2c_f32_bf16_dpp v19, v31, v107 row_newbcast:4
  s_cbranch_vccz L_d810
  s_waitcnt vmcnt(4)
L_d810:
  s_xor_b32 s68, s70, 0xa0000
  buffer_load_dwordx4 v[64:67], v63, s[16:19], s68 offen nt
  v_fma_f32 v235, v235, s71, -v29
  v_exp_f32 v235, v235
  s_nop 0
  v_add_f32 v21, v21, v235
  s_waitcnt vmcnt(5)
  v_dot2c_f32_bf16_dpp v12, v30, v108 row_newbcast:12
  v_dot2c_f32_bf16_dpp v13, v31, v108 row_newbcast:12
  v_dot2c_f32_bf16_dpp v14, v30, v109 row_newbcast:12
  v_dot2c_f32_bf16_dpp v15, v31, v109 row_newbcast:12
  v_dot2c_f32_bf16_dpp v16, v30, v110 row_newbcast:12
  v_dot2c_f32_bf16_dpp v17, v31, v110 row_newbcast:12
  v_dot2c_f32_bf16_dpp v18, v30, v111 row_newbcast:12
  v_dot2c_f32_bf16_dpp v19, v31, v111 row_newbcast:12
  s_cbranch_vccz L_d811
  s_waitcnt vmcnt(4)
L_d811:
  s_xor_b32 s68, s70, 0xa0100
  buffer_load_dwordx4 v[68:71], v63, s[16:19], s68 offen nt
  s_barrier
  v_fma_f32 v236, v236, s71, -v29
  v_exp_f32 v236, v236
  s_nop 0
  v_add_f32 v21, v21, v236
  v_cvt_pk_bf16_f32 v30, v203, 0
  v_cvt_pk_bf16_f32 v31, 0, v203
  s_waitcnt vmcnt(5)
  v_dot2c_f32_bf16_dpp v12, v30, v112 row_newbcast:0
  v_dot2c_f32_bf16_dpp v13, v31, v112 row_newbcast:0
  v_dot2c_f32_bf16_dpp v14, v30, v113 row_newbcast:0
  v_dot2c_f32_bf16_dpp v15, v31, v113 row_newbcast:0
  v_dot2c_f32_bf16_dpp v16, v30, v114 row_newbcast:0
  v_dot2c_f32_bf16_dpp v17, v31, v114 row_newbcast:0
  v_dot2c_f32_bf16_dpp v18, v30, v115 row_newbcast:0
  v_dot2c_f32_bf16_dpp v19, v31, v115 row_newbcast:0
  s_cbranch_vccz L_d812
  s_waitcnt vmcnt(4)
L_d812:
  s_xor_b32 s68, s70, 0xa0400
  buffer_load_dwordx4 v[72:75], v63, s[16:19], s68 offen nt
  v_fma_f32 v237, v237, s71, -v29
  v_exp_f32 v237, v237
  s_nop 0
  v_add_f32 v21, v21, v237
  s_waitcnt vmcnt(5)
  v_dot2c_f32_bf16_dpp v12, v30, v116 row_newbcast:8
  v_dot2c_f32_bf16_dpp v13, v31, v116 row_newbcast:8
  v_dot2c_f32_bf16_dpp v14, v30, v117 row_newbcast:8
  v_dot2c_f32_bf16_dpp v15, v31, v117 row_newbcast:8
  v_dot2c_f32_bf16_dpp v16, v30, v118 row_newbcast:8
  v_dot2c_f32_bf16_dpp v17, v31, v118 row_newbcast:8
  v_dot2c_f32_bf16_dpp v18, v30, v119 row_newbcast:8
  v_dot2c_f32_bf16_dpp v19, v31, v119 row_newbcast:8
  s_cbranch_vccz L_d813
  s_waitcnt vmcnt(4)
L_d813:
  s_xor_b32 s68, s70, 0xa0500
  buffer_load_dwordx4 v[76:79], v63, s[16:19], s68 offen nt
  v_fma_f32 v238, v238, s71, -v29
  v_exp_f32 v238, v238
  s_nop 0
  v_add_f32 v21, v21, v238
  s_waitcnt vmcnt(5)
  v_dot2c_f32_bf16_dpp v12, v30, v120 row_newbcast:4
  v_dot2c_f32_bf16_dpp v13, v31, v120 row_newbcast:4
  v_dot2c_f32_bf16_dpp v14, v30, v121 row_newbcast:4
  v_dot2c_f32_bf16_dpp v15, v31, v121 row_newbcast:4
  v_dot2c_f32_bf16_dpp v16, v30, v122 row_newbcast:4
  v_dot2c_f32_bf16_dpp v17, v31, v122 row_newbcast:4
  v_dot2c_f32_bf16_dpp v18, v30, v123 row_newbcast:4
  v_dot2c_f32_bf16_dpp v19, v31, v123 row_newbcast:4
  s_cbranch_vccz L_d814
  s_waitcnt vmcnt(4)
L_d814:
  s_xor_b32 s68, s70, 0xa0800
  buffer_load_dwordx4 v[80:83], v63, s[16:19], s68 offen nt
  v_fma_f32 v239, v239, s71, -v29
  v_exp_f32 v239, v239
  s_nop 0
  v_add_f32 v21, v21, v239
  s_waitcnt vmcnt(5)
  v_dot2c_f32_bf16_dpp v12, v30, v124 row_newbcast:12
  v_dot2c_f32_bf16_dpp v13, v31, v124 row_newbcast:12
  v_dot2c_f32_bf16_dpp v14, v30, v125 row_newbcast:12
  v_dot2c_f32_bf16_dpp v15, v31, v125 row_newbcast:12
  v_dot2c_f32_bf16_dpp v16, v30, v126 row_newbcast:12
  v_dot2c_f32_bf16_dpp v17, v31, v126 row_newbcast:12
  v_dot2c_f32_bf16_dpp v18, v30, v127 row_newbcast:12
  v_dot2c_f32_bf16_dpp v19, v31, v127 row_newbcast:12
  s_cbranch_vccz L_d815
  s_waitcnt vmcnt(4)
L_d815:
  s_xor_b32 s68, s70, 0xa0900
  buffer_load_dwordx4 v[84:87], v63, s[16:19], s68 offen nt
  s_barrier
  v_fma_f32 v240, v240, s71, -v29
  v_exp_f32 v240, v240
  s_nop 0
  v_add_f32 v21, v21, v240
  v_cvt_pk_bf16_f32 v30, v204, 0
  v_cvt_pk_bf16_f32 v31, 0, v204
  s_waitcnt vmcnt(5)
  v_dot2c_f32_bf16_dpp v12, v30, v64 row_newbcast:0
  v_dot2c_f32_bf16_dpp v13, v31, v64 row_newbcast:0
  v_dot2c_f32_bf16_dpp v14, v30, v65 row_newbcast:0
  v_dot2c_f32_bf16_dpp v15, v31, v65 row_newbcast:0
  v_dot2c_f32_bf16_dpp v16, v30, v66 row_newbcast:0
  v_dot2c_f32_bf16_dpp v17, v31, v66 row_newbcast:0
  v_dot2c_f32_bf16_dpp v18, v30, v67 row_newbcast:0
  v_dot2c_f32_bf16_dpp v19, v31, v67 row_newbcast:0
  s_cbranch_vccz L_d816
  s_waitcnt vmcnt(4)
L_d816:
  s_xor_b32 s68, s70, 0xa0c00
  buffer_load_dwordx4 v[88:91], v63, s[16:19], s68 offen nt
  v_fma_f32 v241, v241, s71, -v29
  v_exp_f32 v241, v241
  s_nop 0
  v_add_f32 v21, v21, v241
  s_waitcnt vmcnt(5)
  v_dot2c_f32_bf16_dpp v12, v30, v68 row_newbcast:8
  v_dot2c_f32_bf16_dpp v13, v31, v68 row_newbcast:8
  v_dot2c_f32_bf16_dpp v14, v30, v69 row_newbcast:8
  v_dot2c_f32_bf16_dpp v15, v31, v69 row_newbcast:8
  v_dot2c_f32_bf16_dpp v16, v30, v70 row_newbcast:8
  v_dot2c_f32_bf16_dpp v17, v31, v70 row_newbcast:8
  v_dot2c_f32_bf16_dpp v18, v30, v71 row_newbcast:8
  v_dot2c_f32_bf16_dpp v19, v31, v71 row_newbcast:8
  s_cbranch_vccz L_d817
  s_waitcnt vmcnt(4)
L_d817:
  s_xor_b32 s68, s70, 0xa0d00
  buffer_load_dwordx4 v[92:95], v63, s[16:19], s68 offen nt
  v_fma_f32 v242, v242, s71, -v29
  v_exp_f32 v242, v242
  s_nop 0
  v_add_f32 v21, v21, v242
  s_waitcnt vmcnt(5)
  v_dot2c_f32_bf16_dpp v12, v30, v72 row_newbcast:4
  v_dot2c_f32_bf16_dpp v13, v31, v72 row_newbcast:4
  v_dot2c_f32_bf16_dpp v14, v30, v73 row_newbcast:4
  v_dot2c_f32_bf16_dpp v15, v31, v73 row_newbcast:4
  v_dot2c_f32_bf16_dpp v16, v30, v74 row_newbcast:4
  v_dot2c_f32_bf16_dpp v17, v31, v74 row_newbcast:4
  v_dot2c_f32_bf16_dpp v18, v30, v75 row_newbcast:4
  v_dot2c_f32_bf16_dpp v19, v31, v75 row_newbcast:4
  s_cbranch_vccz L_d818
  s_waitcnt vmcnt(4)
L_d818:
  s_xor_b32 s68, s70, 0xb0000
  buffer_load_dwordx4 v[96:99], v63, s[16:19], s68 offen nt
  v_fma_f32 v243, v243, s71, -v29
  v_exp_f32 v243, v243
  s_nop 0
  v_add_f32 v21, v21, v243
  s_waitcnt vmcnt(5)
  v_dot2c_f32_bf16_dpp v12, v30, v76 row_newbcast:12
  v_dot2c_f32_bf16_dpp v13, v31, v76 row_newbcast:12
  v_dot2c_f32_bf16_dpp v14, v30, v77 row_newbcast:12
  v_dot2c_f32_bf16_dpp v15, v31, v77 row_newbcast:12
  v_dot2c_f32_bf16_dpp v16, v30, v78 row_newbcast:12
  v_dot2c_f32_bf16_dpp v17, v31, v78 row_newbcast:12
  v_dot2c_f32_bf16_dpp v18, v30, v79 row_newbcast:12
  v_dot2c_f32_bf16_dpp v19, v31, v79 row_newbcast:12
  s_cbranch_vccz L_d819
  s_waitcnt vmcnt(4)
L_d819:
  s_xor_b32 s68, s70, 0xb0100
  buffer_load_dwordx4 v[100:103], v63, s[16:19], s68 offen nt
  s_barrier
  v_fma_f32 v244, v244, s71, -v29
  v_exp_f32 v244, v244
  s_nop 0
  v_add_f32 v21, v21, v244
  v_cvt_pk_bf16_f32 v30, v205, 0
  v_cvt_pk_bf16_f32 v31, 0, v205
  s_waitcnt vmcnt(5)
  v_dot2c_f32_bf16_dpp v12, v30, v80 row_newbcast:0
  v_dot2c_f32_bf16_dpp v13, v31, v80 row_newbcast:0
  v_dot2c_f32_bf16_dpp v14, v30, v81 row_newbcast:0
  v_dot2c_f32_bf16_dpp v15, v31, v81 row_newbcast:0
  v_dot2c_f32_bf16_dpp v16, v30, v82 row_newbcast:0
  v_dot2c_f32_bf16_dpp v17, v31, v82 row_newbcast:0
  v_dot2c_f32_bf16_dpp v18, v30, v83 row_newbcast:0
  v_dot2c_f32_bf16_dpp v19, v31, v83 row_newbcast:0
  s_cbranch_vccz L_d820
  s_waitcnt vmcnt(4)
L_d820:
  s_xor_b32 s68, s70, 0xb0400
  buffer_load_dwordx4 v[104:107], v63, s[16:19], s68 offen nt
  v_fma_f32 v245, v245, s71, -v29
  v_exp_f32 v245, v245
  s_nop 0
  v_add_f32 v21, v21, v245
  s_waitcnt vmcnt(5)
  v_dot2c_f32_bf16_dpp v12, v30, v84 row_newbcast:8
  v_dot2c_f32_bf16_dpp v13, v31, v84 row_newbcast:8
  v_dot2c_f32_bf16_dpp v14, v30, v85 row_newbcast:8
  v_dot2c_f32_bf16_dpp v15, v31, v85 row_newbcast:8
  v_dot2c_f32_bf16_dpp v16, v30, v86 row_newbcast:8
  v_dot2c_f32_bf16_dpp v17, v31, v86 row_newbcast:8
  v_dot2c_f32_bf16_dpp v18, v30, v87 row_newbcast:8
  v_dot2c_f32_bf16_dpp v19, v31, v87 row_newbcast:8
  s_cbranch_vccz L_d821
  s_waitcnt vmcnt(4)
L_d821:
  s_xor_b32 s68, s70, 0xb0500
  buffer_load_dwordx4 v[108:111], v63, s[16:19], s68 offen nt
  v_fma_f32 v246, v246, s71, -v29
  v_exp_f32 v246, v246
  s_nop 0
  v_add_f32 v21, v21, v246
  s_waitcnt vmcnt(5)
  v_dot2c_f32_bf16_dpp v12, v30, v88 row_newbcast:4
  v_dot2c_f32_bf16_dpp v13, v31, v88 row_newbcast:4
  v_dot2c_f32_bf16_dpp v14, v30, v89 row_newbcast:4
  v_dot2c_f32_bf16_dpp v15, v31, v89 row_newbcast:4
  v_dot2c_f32_bf16_dpp v16, v30, v90 row_newbcast:4
  v_dot2c_f32_bf16_dpp v17, v31, v90 row_newbcast:4
  v_dot2c_f32_bf16_dpp v18, v30, v91 row_newbcast:4
  v_dot2c_f32_bf16_dpp v19, v31, v91 row_newbcast:4
  s_cbranch_vccz L_d822
  s_waitcnt vmcnt(4)
L_d822:
  s_xor_b32 s68, s70, 0xb0800
  buffer_load_dwordx4 v[112:115], v63, s[16:19], s68 offen nt
  v_fma_f32 v247, v247, s71, -v29
  v_exp_f32 v247, v247
  s_nop 0
  v_add_f32 v21, v21, v247
  s_waitcnt vmcnt(5)
  v_dot2c_f32_bf16_dpp v12, v30, v92 row_newbcast:12
  v_dot2c_f32_bf16_dpp v13, v31, v92 row_newbcast:12
  v_dot2c_f32_bf16_dpp v14, v30, v93 row_newbcast:12
  v_dot2c_f32_bf16_dpp v15, v31, v93 row_newbcast:12
  v_dot2c_f32_bf16_dpp v16, v30, v94 row_newbcast:12
  v_dot2c_f32_bf16_dpp v17, v31, v94 row_newbcast:12
  v_dot2c_f32_bf16_dpp v18, v30, v95 row_newbcast:12
  v_dot2c_f32_bf16_dpp v19, v31, v95 row_newbcast:12
  s_cbranch_vccz L_d823
  s_waitcnt vmcnt(4)
L_d823:
  s_xor_b32 s68, s70, 0xb0900
  buffer_load_dwordx4 v[116:119], v63, s[16:19], s68 offen nt
  s_barrier
  v_fma_f32 v248, v248, s71, -v29
  v_exp_f32 v248, v248
  s_nop 0
  v_add_f32 v21, v21, v248
  v_cvt_pk_bf16_f32 v30, v206, 0
  v_cvt_pk_bf16_f32 v31, 0, v206
  s_waitcnt vmcnt(5)
  v_dot2c_f32_bf16_dpp v12, v30, v96 row_newbcast:0
  v_dot2c_f32_bf16_dpp v13, v31, v96 row_newbcast:0
  v_dot2c_f32_bf16_dpp v14, v30, v97 row_newbcast:0
  v_dot2c_f32_bf16_dpp v15, v31, v97 row_newbcast:0
  v_dot2c_f32_bf16_dpp v16, v30, v98 row_newbcast:0
  v_dot2c_f32_bf16_dpp v17, v31, v98 row_newbcast:0
  v_dot2c_f32_bf16_dpp v18, v30, v99 row_newbcast:0
  v_dot2c_f32_bf16_dpp v19, v31, v99 row_newbcast:0
  s_cbranch_vccz L_d824
  s_waitcnt vmcnt(4)
L_d824:
  s_xor_b32 s68, s70, 0xb0c00
  buffer_load_dwordx4 v[120:123], v63, s[16:19], s68 offen nt
  s_cmp_eq_u32 s64, 1
  s_cbranch_scc0 L_wp206
  s_mov_b32 s100, 17
  s_atomic_umax s100, s[20:21], s88
  s_and_b32 s60, s88, 0xfffffc7f
  s_xor_b32 s61, s60, 8192
  s_add_u32 s38, s61, 0
  s_load_dword s40, s[20:21], s38 glc
  s_add_u32 s38, s60, 128
  s_load_dword s41, s[20:21], s38 glc
  s_add_u32 s38, s60, 256
  s_load_dword s42, s[20:21], s38 glc
  s_add_u32 s38, s61, 384
  s_load_dword s43, s[20:21], s38 glc
  s_add_u32 s38, s61, 512
  s_load_dword s44, s[20:21], s38 glc
  s_add_u32 s38, s60, 640
  s_load_dword s45, s[20:21], s38 glc
  s_add_u32 s38, s60, 768
  s_load_dword s46, s[20:21], s38 glc
  s_add_u32 s38, s61, 896
  s_load_dword s47, s[20:21], s38 glc
L_wp206:
  v_fma_f32 v249, v249, s71, -v29
  v_exp_f32 v249, v249
  s_nop 0
  v_add_f32 v21, v21, v249
  s_waitcnt vmcnt(5)
  v_dot2c_f32_bf16_dpp v12, v30, v100 row_newbcast:8
  v_dot2c_f32_bf16_dpp v13, v31, v100 row_newbcast:8
  v_dot2c_f32_bf16_dpp v14, v30, v101 row_newbcast:8
  v_dot2c_f32_bf16_dpp v15, v31, v101 row_newbcast:8
  v_dot2c_f32_bf16_dpp v16, v30, v102 row_newbcast:8
  v_dot2c_f32_bf16_dpp v17, v31, v102 row_newbcast:8
  v_dot2c_f32_bf16_dpp v18, v30, v103 row_newbcast:8
  v_dot2c_f32_bf16_dpp v19, v31, v103 row_newbcast:8
  s_cbranch_vccz L_d825
  s_waitcnt vmcnt(4)
L_d825:
  s_xor_b32 s68, s70, 0xb0d00
  buffer_load_dwordx4 v[124:127], v63, s[16:19], s68 offen nt
  v_fma_f32 v250, v250, s71, -v29
  v_exp_f32 v250, v250
  s_nop 0
  v_add_f32 v21, v21, v250
  s_waitcnt vmcnt(5)
  v_dot2c_f32_bf16_dpp v12, v30, v104 row_newbcast:4
  v_dot2c_f32_bf16_dpp v13, v31, v104 row_newbcast:4
  v_dot2c_f32_bf16_dpp v14, v30, v105 row_newbcast:4
  v_dot2c_f32_bf16_dpp v15, v31, v105 row_newbcast:4
  v_dot2c_f32_bf16_dpp v16, v30, v106 row_newbcast:4
  v_dot2c_f32_bf16_dpp v17, v31, v106 row_newbcast:4
  v_dot2c_f32_bf16_dpp v18, v30, v107 row_newbcast:4
  v_dot2c_f32_bf16_dpp v19, v31, v107 row_newbcast:4
  s_cbranch_vccz L_d826
  s_waitcnt vmcnt(4)
L_d826:
  s_xor_b32 s68, s70, 0x40000
  buffer_load_dwordx4 v[64:67], v63, s[16:19], s68 offen nt
  v_fma_f32 v251, v251, s71, -v29
  v_exp_f32 v251, v251
  s_nop 0
  v_add_f32 v21, v21, v251
  s_waitcnt vmcnt(5)
  v_dot2c_f32_bf16_dpp v12, v30, v108 row_newbcast:12
  v_dot2c_f32_bf16_dpp v13, v31, v108 row_newbcast:12
  v_dot2c_f32_bf16_dpp v14, v30, v109 row_newbcast:12
  v_dot2c_f32_bf16_dpp v15, v31, v109 row_newbcast:12
  v_dot2c_f32_bf16_dpp v16, v30, v110 row_newbcast:12
  v_dot2c_f32_bf16_dpp v17, v31, v110 row_newbcast:12
  v_dot2c_f32_bf16_dpp v18, v30, v111 row_newbcast:12
  v_dot2c_f32_bf16_dpp v19, v31, v111 row_newbcast:12
  s_cbranch_vccz L_d827
  s_waitcnt vmcnt(4)
L_d827:
  s_xor_b32 s68, s70, 0x40100
  buffer_load_dwordx4 v[68:71], v63, s[16:19], s68 offen nt
  s_barrier
  v_fma_f32 v252, v252, s71, -v29
  v_exp_f32 v252, v252
  s_nop 0
  v_add_f32 v21, v21, v252
  v_cvt_pk_bf16_f32 v30, v207, 0
  v_cvt_pk_bf16_f32 v31, 0, v207
  s_waitcnt vmcnt(5)
  v_dot2c_f32_bf16_dpp v12, v30, v112 row_newbcast:0
  v_dot2c_f32_bf16_dpp v13, v31, v112 row_newbcast:0
  v_dot2c_f32_bf16_dpp v14, v30, v113 row_newbcast:0
  v_dot2c_f32_bf16_dpp v15, v31, v113 row_newbcast:0
  v_dot2c_f32_bf16_dpp v16, v30, v114 row_newbcast:0
  v_dot2c_f32_bf16_dpp v17, v31, v114 row_newbcast:0
  v_dot2c_f32_bf16_dpp v18, v30, v115 row_newbcast:0
  v_dot2c_f32_bf16_dpp v19, v31, v115 row_newbcast:0
  s_cbranch_vccz L_d828
  s_waitcnt vmcnt(4)
L_d828:
  s_xor_b32 s68, s70, 0x40400
  buffer_load_dwordx4 v[72:75], v63, s[16:19], s68 offen nt
  v_fma_f32 v253, v253, s71, -v29
  v_exp_f32 v253, v253
  s_nop 0
  v_add_f32 v21, v21, v253
  s_waitcnt vmcnt(5)
  v_dot2c_f32_bf16_dpp v12, v30, v116 row_newbcast:8
  v_dot2c_f32_bf16_dpp v13, v31, v116 row_newbcast:8
  v_dot2c_f32_bf16_dpp v14, v30, v117 row_newbcast:8
  v_dot2c_f32_bf16_dpp v15, v31, v117 row_newbcast:8
  v_dot2c_f32_bf16_dpp v16, v30, v118 row_newbcast:8
  v_dot2c_f32_bf16_dpp v17, v31, v118 row_newbcast:8
  v_dot2c_f32_bf16_dpp v18, v30, v119 row_newbcast:8
  v_dot2c_f32_bf16_dpp v19, v31, v119 row_newbcast:8
  s_cbranch_vccz L_d829
  s_waitcnt vmcnt(4)
L_d829:
  s_xor_b32 s68, s70, 0x40500
  buffer_load_dwordx4 v[76:79], v63, s[16:19], s68 offen nt
  v_fma_f32 v254, v254, s71, -v29
  v_exp_f32 v254, v254
  s_nop 0
  v_add_f32 v21, v21, v254
  s_waitcnt vmcnt(5)
  v_dot2c_f32_bf16_dpp v12, v30, v120 row_newbcast:4
  v_dot2c_f32_bf16_dpp v13, v31, v120 row_newbcast:4
  v_dot2c_f32_bf16_dpp v14, v30, v121 row_newbcast:4
  v_dot2c_f32_bf16_dpp v15, v31, v121 row_newbcast:4
  v_dot2c_f32_bf16_dpp v16, v30, v122 row_newbcast:4
  v_dot2c_f32_bf16_dpp v17, v31, v122 row_newbcast:4
  v_dot2c_f32_bf16_dpp v18, v30, v123 row_newbcast:4
  v_dot2c_f32_bf16_dpp v19, v31, v123 row_newbcast:4
  s_cbranch_vccz L_d830
  s_waitcnt vmcnt(4)
L_d830:
  s_xor_b32 s68, s70, 0x40800
  buffer_load_dwordx4 v[80:83], v63, s[16:19], s68 offen nt
  v_fma_f32 v255, v255, s71, -v29
  v_exp_f32 v255, v255
  s_nop 0
  v_add_f32 v21, v21, v255
  s_waitcnt vmcnt(5)
  v_dot2c_f32_bf16_dpp v12, v30, v124 row_newbcast:12
  v_dot2c_f32_bf16_dpp v13, v31, v124 row_newbcast:12
  v_dot2c_f32_bf16_dpp v14, v30, v125 row_newbcast:12
  v_dot2c_f32_bf16_dpp v15, v31, v125 row_newbcast:12
  v_dot2c_f32_bf16_dpp v16, v30, v126 row_newbcast:12
  v_dot2c_f32_bf16_dpp v17, v31, v126 row_newbcast:12
  v_dot2c_f32_bf16_dpp v18, v30, v127 row_newbcast:12
  v_dot2c_f32_bf16_dpp v19, v31, v127 row_newbcast:12
  s_cbranch_vccz L_d831
  s_waitcnt vmcnt(4)
L_d831:
  s_xor_b32 s68, s70, 0x40900
  buffer_load_dwordx4 v[84:87], v63, s[16:19], s68 offen nt
  s_barrier
  v_cvt_pk_bf16_f32 v30, v208, 0
  v_cvt_pk_bf16_f32 v31, 0, v208
  s_waitcnt vmcnt(5)
  v_dot2c_f32_bf16_dpp v12, v30, v64 row_newbcast:0
  v_dot2c_f32_bf16_dpp v13, v31, v64 row_newbcast:0
  v_dot2c_f32_bf16_dpp v14, v30, v65 row_newbcast:0
  v_dot2c_f32_bf16_dpp v15, v31, v65 row_newbcast:0
  v_dot2c_f32_bf16_dpp v16, v30, v66 row_newbcast:0
  v_dot2c_f32_bf16_dpp v17, v31, v66 row_newbcast:0
  v_dot2c_f32_bf16_dpp v18, v30, v67 row_newbcast:0
  v_dot2c_f32_bf16_dpp v19, v31, v67 row_newbcast:0
  s_cbranch_vccz L_d832
  s_waitcnt vmcnt(4)
L_d832:
  s_xor_b32 s68, s70, 0x40c00
  buffer_load_dwordx4 v[88:91], v63, s[16:19], s68 offen nt
  s_cmp_eq_u32 s64, 1
  s_cbranch_scc0 L_wp208
  s_mov_b32 s101, 0
  s_waitcnt lgkmcnt(0)
  s_cmp_ge_u32 s40, 17
  s_addc_u32 s101, s101, 0
  s_cmp_ge_u32 s41, 17
  s_addc_u32 s101, s101, 0
  s_cmp_ge_u32 s42, 17
  s_addc_u32 s101, s101, 0
  s_cmp_ge_u32 s43, 17
  s_addc_u32 s101, s101, 0
  s_cmp_ge_u32 s44, 17
  s_addc_u32 s101, s101, 0
  s_cmp_ge_u32 s45, 17
  s_addc_u32 s101, s101, 0
  s_cmp_ge_u32 s46, 17
  s_addc_u32 s101, s101, 0
  s_cmp_ge_u32 s47, 17
  s_addc_u32 s101, s101, 0
  s_cmp_lt_u32 s101, 6
  s_cselect_b32 s38, -1, 0
  v_mov_b32 v26, 0
  v_mov_b32 v27, s38
  ds_write_b32 v26, v27 offset:8512
L_wp208:
  s_waitcnt vmcnt(5)
  v_dot2c_f32_bf16_dpp v12, v30, v68 row_newbcast:8
  v_dot2c_f32_bf16_dpp v13, v31, v68 row_newbcast:8
  v_dot2c_f32_bf16_dpp v14, v30, v69 row_newbcast:8
  v_dot2c_f32_bf16_dpp v15, v31, v69 row_newbcast:8
  v_dot2c_f32_bf16_dpp v16, v30, v70 row_newbcast:8
  v_dot2c_f32_bf16_dpp v17, v31, v70 row_newbcast:8
  v_dot2c_f32_bf16_dpp v18, v30, v71 row_newbcast:8
  v_dot2c_f32_bf16_dpp v19, v31, v71 row_newbcast:8
  s_cbranch_vccz L_d833
  s_waitcnt vmcnt(4)
L_d833:
  s_xor_b32 s68, s70, 0x40d00
  buffer_load_dwordx4 v[92:95], v63, s[16:19], s68 offen nt
  s_waitcnt vmcnt(5)
  v_dot2c_f32_bf16_dpp v12, v30, v72 row_newbcast:4
  v_dot2c_f32_bf16_dpp v13, v31, v72 row_newbcast:4
  v_dot2c_f32_bf16_dpp v14, v30, v73 row_newbcast:4
  v_dot2c_f32_bf16_dpp v15, v31, v73 row_newbcast:4
  v_dot2c_f32_bf16_dpp v16, v30, v74 row_newbcast:4
  v_dot2c_f32_bf16_dpp v17, v31, v74 row_newbcast:4
  v_dot2c_f32_bf16_dpp v18, v30, v75 row_newbcast:4
  v_dot2c_f32_bf16_dpp v19, v31, v75 row_newbcast:4
  s_cbranch_vccz L_d834
  s_waitcnt vmcnt(4)
L_d834:
  s_xor_b32 s68, s70, 0x50000
  buffer_load_dwordx4 v[96:99], v63, s[16:19], s68 offen nt
  s_waitcnt vmcnt(5)
  v_dot2c_f32_bf16_dpp v12, v30, v76 row_newbcast:12
  v_dot2c_f32_bf16_dpp v13, v31, v76 row_newbcast:12
  v_dot2c_f32_bf16_dpp v14, v30, v77 row_newbcast:12
  v_dot2c_f32_bf16_dpp v15, v31, v77 row_newbcast:12
  v_dot2c_f32_bf16_dpp v16, v30, v78 row_newbcast:12
  v_dot2c_f32_bf16_dpp v17, v31, v78 row_newbcast:12
  v_dot2c_f32_bf16_dpp v18, v30, v79 row_newbcast:12
  v_dot2c_f32_bf16_dpp v19, v31, v79 row_newbcast:12
  s_cbranch_vccz L_d835
  s_waitcnt vmcnt(4)
L_d835:
  s_xor_b32 s68, s70, 0x50100
  buffer_load_dwordx4 v[100:103], v63, s[16:19], s68 offen nt
  s_barrier
  v_add_f32_dpp v21, v21, v21 row_ror:4
  s_nop 1
  v_add_f32_dpp v21, v21, v21 row_ror:8
  v_mov_b32 v26, v21
  s_nop 1
  v_permlane32_swap_b32 v21, v26
  v_add_f32 v21, v21, v26
  v_mov_b32 v26, v21
  s_nop 1
  v_permlane16_swap_b32 v21, v26
  v_add_f32 v21, v21, v26
  s_lshl_b32 s38, s64, 3
  v_mov_b32 v26, s38
  ds_write_b64 v26, v[20:21] offset:8224
  v_cvt_pk_bf16_f32 v30, v209, 0
  v_cvt_pk_bf16_f32 v31, 0, v209
  s_waitcnt vmcnt(5)
  v_dot2c_f32_bf16_dpp v12, v30, v80 row_newbcast:0
  v_dot2c_f32_bf16_dpp v13, v31, v80 row_newbcast:0
  v_dot2c_f32_bf16_dpp v14, v30, v81 row_newbcast:0
  v_dot2c_f32_bf16_dpp v15, v31, v81 row_newbcast:0
  v_dot2c_f32_bf16_dpp v16, v30, v82 row_newbcast:0
  v_dot2c_f32_bf16_dpp v17, v31, v82 row_newbcast:0
  v_dot2c_f32_bf16_dpp v18, v30, v83 row_newbcast:0
  v_dot2c_f32_bf16_dpp v19, v31, v83 row_newbcast:0
  s_cbranch_vccz L_d836
  s_waitcnt vmcnt(4)
L_d836:
  s_xor_b32 s68, s70, 0x50400
  buffer_load_dwordx4 v[104:107], v63, s[16:19], s68 offen nt
  v_mov_b32 v26, 0
  ds_read_b32 v35, v26 offset:8512
  s_waitcnt vmcnt(5)
  v_dot2c_f32_bf16_dpp v12, v30, v84 row_newbcast:8
  v_dot2c_f32_bf16_dpp v13, v31, v84 row_newbcast:8
  v_dot2c_f32_bf16_dpp v14, v30, v85 row_newbcast:8
  v_dot2c_f32_bf16_dpp v15, v31, v85 row_newbcast:8
  v_dot2c_f32_bf16_dpp v16, v30, v86 row_newbcast:8
  v_dot2c_f32_bf16_dpp v17, v31, v86 row_newbcast:8
  v_dot2c_f32_bf16_dpp v18, v30, v87 row_newbcast:8
  v_dot2c_f32_bf16_dpp v19, v31, v87 row_newbcast:8
  s_cbranch_vccz L_d837
  s_waitcnt vmcnt(4)
L_d837:
  s_xor_b32 s68, s70, 0x50500
  buffer_load_dwordx4 v[108:111], v63, s[16:19], s68 offen nt
  s_waitcnt vmcnt(5)
  v_dot2c_f32_bf16_dpp v12, v30, v88 row_newbcast:4
  v_dot2c_f32_bf16_dpp v13, v31, v88 row_newbcast:4
  v_dot2c_f32_bf16_dpp v14, v30, v89 row_newbcast:4
  v_dot2c_f32_bf16_dpp v15, v31, v89 row_newbcast:4
  v_dot2c_f32_bf16_dpp v16, v30, v90 row_newbcast:4
  v_dot2c_f32_bf16_dpp v17, v31, v90 row_newbcast:4
  v_dot2c_f32_bf16_dpp v18, v30, v91 row_newbcast:4
  v_dot2c_f32_bf16_dpp v19, v31, v91 row_newbcast:4
  s_cbranch_vccz L_d838
  s_waitcnt vmcnt(4)
L_d838:
  s_xor_b32 s68, s70, 0x50800
  buffer_load_dwordx4 v[112:115], v63, s[16:19], s68 offen nt
  s_waitcnt vmcnt(5)
  v_dot2c_f32_bf16_dpp v12, v30, v92 row_newbcast:12
  v_dot2c_f32_bf16_dpp v13, v31, v92 row_newbcast:12
  v_dot2c_f32_bf16_dpp v14, v30, v93 row_newbcast:12
  v_dot2c_f32_bf16_dpp v15, v31, v93 row_newbcast:12
  v_dot2c_f32_bf16_dpp v16, v30, v94 row_newbcast:12
  v_dot2c_f32_bf16_dpp v17, v31, v94 row_newbcast:12
  v_dot2c_f32_bf16_dpp v18, v30, v95 row_newbcast:12
  v_dot2c_f32_bf16_dpp v19, v31, v95 row_newbcast:12
  s_cbranch_vccz L_d839
  s_waitcnt vmcnt(4)
L_d839:
  s_xor_b32 s68, s70, 0x50900
  buffer_load_dwordx4 v[116:119], v63, s[16:19], s68 offen nt
  s_barrier
  v_cvt_pk_bf16_f32 v30, v210, 0
  v_cvt_pk_bf16_f32 v31, 0, v210
  s_waitcnt vmcnt(5)
  v_dot2c_f32_bf16_dpp v12, v30, v96 row_newbcast:0
  v_dot2c_f32_bf16_dpp v13, v31, v96 row_newbcast:0
  v_dot2c_f32_bf16_dpp v14, v30, v97 row_newbcast:0
  v_dot2c_f32_bf16_dpp v15, v31, v97 row_newbcast:0
  v_dot2c_f32_bf16_dpp v16, v30, v98 row_newbcast:0
  v_dot2c_f32_bf16_dpp v17, v31, v98 row_newbcast:0
  v_dot2c_f32_bf16_dpp v18, v30, v99 row_newbcast:0
  v_dot2c_f32_bf16_dpp v19, v31, v99 row_newbcast:0
  s_cbranch_vccz L_d840
  s_waitcnt vmcnt(4)
L_d840:
  s_xor_b32 s68, s70, 0x50c00
  buffer_load_dwordx4 v[120:123], v63, s[16:19], s68 offen nt
  s_waitcnt lgkmcnt(0)
  v_cmp_ne_u32 vcc, 0, v35
  s_waitcnt vmcnt(5)
  v_dot2c_f32_bf16_dpp v12, v30, v100 row_newbcast:8
  v_dot2c_f32_bf16_dpp v13, v31, v100 row_newbcast:8
  v_dot2c_f32_bf16_dpp v14, v30, v101 row_newbcast:8
  v_dot2c_f32_bf16_dpp v15, v31, v101 row_newbcast:8
  v_dot2c_f32_bf16_dpp v16, v30, v102 row_newbcast:8
  v_dot2c_f32_bf16_dpp v17, v31, v102 row_newbcast:8
  v_dot2c_f32_bf16_dpp v18, v30, v103 row_newbcast:8
  v_dot2c_f32_bf16_dpp v19, v31, v103 row_newbcast:8
  s_cbranch_vccz L_d841
  s_waitcnt vmcnt(4)
L_d841:
  s_xor_b32 s68, s70, 0x50d00
  buffer_load_dwordx4 v[124:127], v63, s[16:19], s68 offen nt
  s_waitcnt vmcnt(5)
  v_dot2c_f32_bf16_dpp v12, v30, v104 row_newbcast:4
  v_dot2c_f32_bf16_dpp v13, v31, v104 row_newbcast:4
  v_dot2c_f32_bf16_dpp v14, v30, v105 row_newbcast:4
  v_dot2c_f32_bf16_dpp v15, v31, v105 row_newbcast:4
  v_dot2c_f32_bf16_dpp v16, v30, v106 row_newbcast:4
  v_dot2c_f32_bf16_dpp v17, v31, v106 row_newbcast:4
  v_dot2c_f32_bf16_dpp v18, v30, v107 row_newbcast:4
  v_dot2c_f32_bf16_dpp v19, v31, v107 row_newbcast:4
  s_cbranch_vccz L_d842
  s_waitcnt vmcnt(4)
L_d842:
  s_xor_b32 s68, s70, 0x60000
  buffer_load_dwordx4 v[64:67], v63, s[16:19], s68 offen nt
  s_waitcnt vmcnt(5)
  v_dot2c_f32_bf16_dpp v12, v30, v108 row_newbcast:12
  v_dot2c_f32_bf16_dpp v13, v31, v108 row_newbcast:12
  v_dot2c_f32_bf16_dpp v14, v30, v109 row_newbcast:12
  v_dot2c_f32_bf16_dpp v15, v31, v109 row_newbcast:12
  v_dot2c_f32_bf16_dpp v16, v30, v110 row_newbcast:12
  v_dot2c_f32_bf16_dpp v17, v31, v110 row_newbcast:12
  v_dot2c_f32_bf16_dpp v18, v30, v111 row_newbcast:12
  v_dot2c_f32_bf16_dpp v19, v31, v111 row_newbcast:12
  s_cbranch_vccz L_d843
  s_waitcnt vmcnt(4)
L_d843:
  s_xor_b32 s68, s70, 0x60100
  buffer_load_dwordx4 v[68:71], v63, s[16:19], s68 offen nt
  s_barrier
  v_cvt_pk_bf16_f32 v30, v211, 0
  v_cvt_pk_bf16_f32 v31, 0, v211
  s_waitcnt vmcnt(5)
  v_dot2c_f32_bf16_dpp v12, v30, v112 row_newbcast:0
  v_dot2c_f32_bf16_dpp v13, v31, v112 row_newbcast:0
  v_dot2c_f32_bf16_dpp v14, v30, v113 row_newbcast:0
  v_dot2c_f32_bf16_dpp v15, v31, v113 row_newbcast:0
  v_dot2c_f32_bf16_dpp v16, v30, v114 row_newbcast:0
  v_dot2c_f32_bf16_dpp v17, v31, v114 row_newbcast:0
  v_dot2c_f32_bf16_dpp v18, v30, v115 row_newbcast:0
  v_dot2c_f32_bf16_dpp v19, v31, v115 row_newbcast:0
  s_cbranch_vccz L_d844
  s_waitcnt vmcnt(4)
L_d844:
  s_xor_b32 s68, s70, 0x60400
  buffer_load_dwordx4 v[72:75], v63, s[16:19], s68 offen nt
  s_waitcnt vmcnt(5)
  v_dot2c_f32_bf16_dpp v12, v30, v116 row_newbcast:8
  v_dot2c_f32_bf16_dpp v13, v31, v116 row_newbcast:8
  v_dot2c_f32_bf16_dpp v14, v30, v117 row_newbcast:8
  v_dot2c_f32_bf16_dpp v15, v31, v117 row_newbcast:8
  v_dot2c_f32_bf16_dpp v16, v30, v118 row_newbcast:8
  v_dot2c_f32_bf16_dpp v17, v31, v118 row_newbcast:8
  v_dot2c_f32_bf16_dpp v18, v30, v119 row_newbcast:8
  v_dot2c_f32_bf16_dpp v19, v31, v119 row_newbcast:8
  s_cbranch_vccz L_d845
  s_waitcnt vmcnt(4)
L_d845:
  s_xor_b32 s68, s70, 0x60500
  buffer_load_dwordx4 v[76:79], v63, s[16:19], s68 offen nt
  s_waitcnt vmcnt(5)
  v_dot2c_f32_bf16_dpp v12, v30, v120 row_newbcast:4
  v_dot2c_f32_bf16_dpp v13, v31, v120 row_newbcast:4
  v_dot2c_f32_bf16_dpp v14, v30, v121 row_newbcast:4
  v_dot2c_f32_bf16_dpp v15, v31, v121 row_newbcast:4
  v_dot2c_f32_bf16_dpp v16, v30, v122 row_newbcast:4
  v_dot2c_f32_bf16_dpp v17, v31, v122 row_newbcast:4
  v_dot2c_f32_bf16_dpp v18, v30, v123 row_newbcast:4
  v_dot2c_f32_bf16_dpp v19, v31, v123 row_newbcast:4
  s_cbranch_vccz L_d846
  s_waitcnt vmcnt(4)
L_d846:
  s_xor_b32 s68, s70, 0x60800
  buffer_load_dwordx4 v[80:83], v63, s[16:19], s68 offen nt
  s_waitcnt vmcnt(5)
  v_dot2c_f32_bf16_dpp v12, v30, v124 row_newbcast:12
  v_dot2c_f32_bf16_dpp v13, v31, v124 row_newbcast:12
  v_dot2c_f32_bf16_dpp v14, v30, v125 row_newbcast:12
  v_dot2c_f32_bf16_dpp v15, v31, v125 row_newbcast:12
  v_dot2c_f32_bf16_dpp v16, v30, v126 row_newbcast:12
  v_dot2c_f32_bf16_dpp v17, v31, v126 row_newbcast:12
  v_dot2c_f32_bf16_dpp v18, v30, v127 row_newbcast:12
  v_dot2c_f32_bf16_dpp v19, v31, v127 row_newbcast:12
  s_cbranch_vccz L_d847
  s_waitcnt vmcnt(4)
L_d847:
  s_xor_b32 s68, s70, 0x60900
  buffer_load_dwordx4 v[84:87], v63, s[16:19], s68 offen nt
  s_barrier
  v_cvt_pk_bf16_f32 v30, v212, 0
  v_cvt_pk_bf16_f32 v31, 0, v212
  s_waitcnt vmcnt(5)
  v_dot2c_f32_bf16_dpp v12, v30, v64 row_newbcast:0
  v_dot2c_f32_bf16_dpp v13, v31, v64 row_newbcast:0
  v_dot2c_f32_bf16_dpp v14, v30, v65 row_newbcast:0
  v_dot2c_f32_bf16_dpp v15, v31, v65 row_newbcast:0
  v_dot2c_f32_bf16_dpp v16, v30, v66 row_newbcast:0
  v_dot2c_f32_bf16_dpp v17, v31, v66 row_newbcast:0
  v_dot2c_f32_bf16_dpp v18, v30, v67 row_newbcast:0
  v_dot2c_f32_bf16_dpp v19, v31, v67 row_newbcast:0
  s_cbranch_vccz L_d848
  s_waitcnt vmcnt(4)
L_d848:
  s_xor_b32 s68, s70, 0x60c00
  buffer_load_dwordx4 v[88:91], v63, s[16:19], s68 offen nt
  s_waitcnt vmcnt(5)
  v_dot2c_f32_bf16_dpp v12, v30, v68 row_newbcast:8
  v_dot2c_f32_bf16_dpp v13, v31, v68 row_newbcast:8
  v_dot2c_f32_bf16_dpp v14, v30, v69 row_newbcast:8
  v_dot2c_f32_bf16_dpp v15, v31, v69 row_newbcast:8
  v_dot2c_f32_bf16_dpp v16, v30, v70 row_newbcast:8
  v_dot2c_f32_bf16_dpp v17, v31, v70 row_newbcast:8
  v_dot2c_f32_bf16_dpp v18, v30, v71 row_newbcast:8
  v_dot2c_f32_bf16_dpp v19, v31, v71 row_newbcast:8
  s_cbranch_vccz L_d849
  s_waitcnt vmcnt(4)
L_d849:
  s_xor_b32 s68, s70, 0x60d00
  buffer_load_dwordx4 v[92:95], v63, s[16:19], s68 offen nt
  s_waitcnt vmcnt(5)
  v_dot2c_f32_bf16_dpp v12, v30, v72 row_newbcast:4
  v_dot2c_f32_bf16_dpp v13, v31, v72 row_newbcast:4
  v_dot2c_f32_bf16_dpp v14, v30, v73 row_newbcast:4
  v_dot2c_f32_bf16_dpp v15, v31, v73 row_newbcast:4
  v_dot2c_f32_bf16_dpp v16, v30, v74 row_newbcast:4
  v_dot2c_f32_bf16_dpp v17, v31, v74 row_newbcast:4
  v_dot2c_f32_bf16_dpp v18, v30, v75 row_newbcast:4
  v_dot2c_f32_bf16_dpp v19, v31, v75 row_newbcast:4
  s_cbranch_vccz L_d850
  s_waitcnt vmcnt(4)
L_d850:
  s_xor_b32 s68, s70, 0x70000
  buffer_load_dwordx4 v[96:99], v63, s[16:19], s68 offen nt
  s_waitcnt vmcnt(5)
  v_dot2c_f32_bf16_dpp v12, v30, v76 row_newbcast:12
  v_dot2c_f32_bf16_dpp v13, v31, v76 row_newbcast:12
  v_dot2c_f32_bf16_dpp v14, v30, v77 row_newbcast:12
  v_dot2c_f32_bf16_dpp v15, v31, v77 row_newbcast:12
  v_dot2c_f32_bf16_dpp v16, v30, v78 row_newbcast:12
  v_dot2c_f32_bf16_dpp v17, v31, v78 row_newbcast:12
  v_dot2c_f32_bf16_dpp v18, v30, v79 row_newbcast:12
  v_dot2c_f32_bf16_dpp v19, v31, v79 row_newbcast:12
  s_cbranch_vccz L_d851
  s_waitcnt vmcnt(4)
L_d851:
  s_xor_b32 s68, s70, 0x70100
  buffer_load_dwordx4 v[100:103], v63, s[16:19], s68 offen nt
  s_barrier
  s_waitcnt lgkmcnt(0)
  s_barrier
  v_mov_b32 v26, 0
  ds_read_b128 v[128:131], v26 offset:8224
  ds_read_b128 v[132:135], v26 offset:8240
  v_lshrrev_b32 v5, 4, v1
  v_and_b32 v7, 15, v5
  v_lshrrev_b32 v6, 4, v5
  v_lshrrev_b32 v9, 2, v7
  v_lshlrev_b32 v9, 13, v9
  v_and_b32 v8, 3, v7
  v_lshl_add_u32 v9, v8, 5, v9
  v_lshl_add_u32 v9, v6, 4, v9
  s_lshl_b32 s96, s66, 18
  s_lshl_b32 s38, s64, 16
  s_add_u32 s96, s96, s38
  s_lshl_b32 s38, s65, 7
  s_add_u32 s96, s96, s38
  s_add_u32 s97, s96, 32768
  s_add_u32 s98, s96, 4096
  s_add_u32 s99, s97, 4096
  v_and_b32 v10, 7, v5
  v_lshrrev_b32 v11, 5, v5
  v_lshlrev_b32 v10, 3, v10
  v_lshl_add_u32 v10, v11, 2, v10
  s_lshl_b32 s94, s66, 12
  s_lshl_b32 s38, s65, 6
  s_add_u32 s94, s94, s38
  s_xor_b32 s38, s64, 1
  s_lshl_b32 s39, s38, 11
  s_add_u32 s94, s94, s39
  s_lshl_b32 s38, s38, 12
  s_add_u32 s95, s86, s38
  s_waitcnt lgkmcnt(0)
  v_mov_b32 v168, 0
  v_mov_b32 v169, 0
  v_mov_b32 v170, 0
  v_mov_b32 v171, 0
  v_mov_b32 v172, 0
  v_mov_b32 v173, 0
  v_mov_b32 v174, 0
  v_mov_b32 v175, 0
  v_max3_f32 v26, v128, v130, v132
  v_max_f32 v26, v26, v134
  v_mul_f32 v26, s71, v26
  v_fma_f32 v160, v20, s71, -v26
  v_fma_f32 v128, v128, s71, -v26
  v_fma_f32 v130, v130, s71, -v26
  v_fma_f32 v132, v132, s71, -v26
  v_fma_f32 v134, v134, s71, -v26
  v_exp_f32 v160, v160
  v_exp_f32 v128, v128
  v_exp_f32 v130, v130
  v_exp_f32 v132, v132
  v_exp_f32 v134, v134
  v_mul_f32 v26, v128, v129
  v_fmac_f32 v26, v130, v131
  v_fmac_f32 v26, v132, v133
  v_fmac_f32 v26, v134, v135
  v_rcp_f32 v26, v26
  s_nop 0
  v_mul_f32 v160, v160, v26
  v_cvt_pk_bf16_f32 v30, v213, 0
  v_cvt_pk_bf16_f32 v31, 0, v213
  s_waitcnt vmcnt(5)
  v_dot2c_f32_bf16_dpp v12, v30, v80 row_newbcast:0
  v_dot2c_f32_bf16_dpp v13, v31, v80 row_newbcast:0
  v_dot2c_f32_bf16_dpp v14, v30, v81 row_newbcast:0
  v_dot2c_f32_bf16_dpp v15, v31, v81 row_newbcast:0
  v_dot2c_f32_bf16_dpp v16, v30, v82 row_newbcast:0
  v_dot2c_f32_bf16_dpp v17, v31, v82 row_newbcast:0
  v_dot2c_f32_bf16_dpp v18, v30, v83 row_newbcast:0
  v_dot2c_f32_bf16_dpp v19, v31, v83 row_newbcast:0
  s_cbranch_vccz L_d852
  s_waitcnt vmcnt(4)
L_d852:
  s_xor_b32 s68, s70, 0x70400
  buffer_load_dwordx4 v[104:107], v63, s[16:19], s68 offen nt
  s_waitcnt vmcnt(5)
  v_dot2c_f32_bf16_dpp v12, v30, v84 row_newbcast:8
  v_dot2c_f32_bf16_dpp v13, v31, v84 row_newbcast:8
  v_dot2c_f32_bf16_dpp v14, v30, v85 row_newbcast:8
  v_dot2c_f32_bf16_dpp v15, v31, v85 row_newbcast:8
  v_dot2c_f32_bf16_dpp v16, v30, v86 row_newbcast:8
  v_dot2c_f32_bf16_dpp v17, v31, v86 row_newbcast:8
  v_dot2c_f32_bf16_dpp v18, v30, v87 row_newbcast:8
  v_dot2c_f32_bf16_dpp v19, v31, v87 row_newbcast:8
  s_cbranch_vccz L_d853
  s_waitcnt vmcnt(4)
L_d853:
  s_xor_b32 s68, s70, 0x70500
  buffer_load_dwordx4 v[108:111], v63, s[16:19], s68 offen nt
  s_waitcnt vmcnt(5)
  v_dot2c_f32_bf16_dpp v12, v30, v88 row_newbcast:4
  v_dot2c_f32_bf16_dpp v13, v31, v88 row_newbcast:4
  v_dot2c_f32_bf16_dpp v14, v30, v89 row_newbcast:4
  v_dot2c_f32_bf16_dpp v15, v31, v89 row_newbcast:4
  v_dot2c_f32_bf16_dpp v16, v30, v90 row_newbcast:4
  v_dot2c_f32_bf16_dpp v17, v31, v90 row_newbcast:4
  v_dot2c_f32_bf16_dpp v18, v30, v91 row_newbcast:4
  v_dot2c_f32_bf16_dpp v19, v31, v91 row_newbcast:4
  s_cbranch_vccz L_d854
  s_waitcnt vmcnt(4)
L_d854:
  s_xor_b32 s68, s70, 0x70800
  buffer_load_dwordx4 v[112:115], v63, s[16:19], s68 offen nt
  s_waitcnt vmcnt(5)
  v_dot2c_f32_bf16_dpp v12, v30, v92 row_newbcast:12
  v_dot2c_f32_bf16_dpp v13, v31, v92 row_newbcast:12
  v_dot2c_f32_bf16_dpp v14, v30, v93 row_newbcast:12
  v_dot2c_f32_bf16_dpp v15, v31, v93 row_newbcast:12
  v_dot2c_f32_bf16_dpp v16, v30, v94 row_newbcast:12
  v_dot2c_f32_bf16_dpp v17, v31, v94 row_newbcast:12
  v_dot2c_f32_bf16_dpp v18, v30, v95 row_newbcast:12
  v_dot2c_f32_bf16_dpp v19, v31, v95 row_newbcast:12
  s_cbranch_vccz L_d855
  s_waitcnt vmcnt(4)
L_d855:
  s_xor_b32 s68, s70, 0x70900
  buffer_load_dwordx4 v[116:119], v63, s[16:19], s68 offen nt
  s_barrier
  v_cvt_pk_bf16_f32 v30, v214, 0
  v_cvt_pk_bf16_f32 v31, 0, v214
  s_waitcnt vmcnt(5)
  v_dot2c_f32_bf16_dpp v12, v30, v96 row_newbcast:0
  v_dot2c_f32_bf16_dpp v13, v31, v96 row_newbcast:0
  v_dot2c_f32_bf16_dpp v14, v30, v97 row_newbcast:0
  v_dot2c_f32_bf16_dpp v15, v31, v97 row_newbcast:0
  v_dot2c_f32_bf16_dpp v16, v30, v98 row_newbcast:0
  v_dot2c_f32_bf16_dpp v17, v31, v98 row_newbcast:0
  v_dot2c_f32_bf16_dpp v18, v30, v99 row_newbcast:0
  v_dot2c_f32_bf16_dpp v19, v31, v99 row_newbcast:0
  s_cbranch_vccz L_d856
  s_waitcnt vmcnt(4)
L_d856:
  s_xor_b32 s68, s70, 0x70c00
  buffer_load_dwordx4 v[120:123], v63, s[16:19], s68 offen nt
  s_waitcnt vmcnt(5)
  v_dot2c_f32_bf16_dpp v12, v30, v100 row_newbcast:8
  v_dot2c_f32_bf16_dpp v13, v31, v100 row_newbcast:8
  v_dot2c_f32_bf16_dpp v14, v30, v101 row_newbcast:8
  v_dot2c_f32_bf16_dpp v15, v31, v101 row_newbcast:8
  v_dot2c_f32_bf16_dpp v16, v30, v102 row_newbcast:8
  v_dot2c_f32_bf16_dpp v17, v31, v102 row_newbcast:8
  v_dot2c_f32_bf16_dpp v18, v30, v103 row_newbcast:8
  v_dot2c_f32_bf16_dpp v19, v31, v103 row_newbcast:8
  s_cbranch_vccz L_d857
  s_waitcnt vmcnt(4)
L_d857:
  s_xor_b32 s68, s70, 0x70d00
  buffer_load_dwordx4 v[124:127], v63, s[16:19], s68 offen nt
  s_waitcnt vmcnt(5)
  v_dot2c_f32_bf16_dpp v12, v30, v104 row_newbcast:4
  v_dot2c_f32_bf16_dpp v13, v31, v104 row_newbcast:4
  v_dot2c_f32_bf16_dpp v14, v30, v105 row_newbcast:4
  v_dot2c_f32_bf16_dpp v15, v31, v105 row_newbcast:4
  v_dot2c_f32_bf16_dpp v16, v30, v106 row_newbcast:4
  v_dot2c_f32_bf16_dpp v17, v31, v106 row_newbcast:4
  v_dot2c_f32_bf16_dpp v18, v30, v107 row_newbcast:4
  v_dot2c_f32_bf16_dpp v19, v31, v107 row_newbcast:4
  s_cbranch_vccz L_d858
  s_waitcnt vmcnt(4)
L_d858:
  s_xor_b32 s68, s70, 0xc0000
  buffer_load_dwordx4 v[64:67], v63, s[16:19], s68 offen nt
  s_waitcnt vmcnt(5)
  v_dot2c_f32_bf16_dpp v12, v30, v108 row_newbcast:12
  v_dot2c_f32_bf16_dpp v13, v31, v108 row_newbcast:12
  v_dot2c_f32_bf16_dpp v14, v30, v109 row_newbcast:12
  v_dot2c_f32_bf16_dpp v15, v31, v109 row_newbcast:12
  v_dot2c_f32_bf16_dpp v16, v30, v110 row_newbcast:12
  v_dot2c_f32_bf16_dpp v17, v31, v110 row_newbcast:12
  v_dot2c_f32_bf16_dpp v18, v30, v111 row_newbcast:12
  v_dot2c_f32_bf16_dpp v19, v31, v111 row_newbcast:12
  s_cbranch_vccz L_d859
  s_waitcnt vmcnt(4)
L_d859:
  s_xor_b32 s68, s70, 0xc0100
  buffer_load_dwordx4 v[68:71], v63, s[16:19], s68 offen nt
  s_barrier
  v_cvt_pk_bf16_f32 v30, v215, 0
  v_cvt_pk_bf16_f32 v31, 0, v215
  s_waitcnt vmcnt(5)
  v_dot2c_f32_bf16_dpp v12, v30, v112 row_newbcast:0
  v_dot2c_f32_bf16_dpp v13, v31, v112 row_newbcast:0
  v_dot2c_f32_bf16_dpp v14, v30, v113 row_newbcast:0
  v_dot2c_f32_bf16_dpp v15, v31, v113 row_newbcast:0
  v_dot2c_f32_bf16_dpp v16, v30, v114 row_newbcast:0
  v_dot2c_f32_bf16_dpp v17, v31, v114 row_newbcast:0
  v_dot2c_f32_bf16_dpp v18, v30, v115 row_newbcast:0
  v_dot2c_f32_bf16_dpp v19, v31, v115 row_newbcast:0
  s_cbranch_vccz L_d860
  s_waitcnt vmcnt(4)
L_d860:
  s_xor_b32 s68, s70, 0xc0400
  buffer_load_dwordx4 v[72:75], v63, s[16:19], s68 offen nt
  s_waitcnt vmcnt(5)
  v_dot2c_f32_bf16_dpp v12, v30, v116 row_newbcast:8
  v_dot2c_f32_bf16_dpp v13, v31, v116 row_newbcast:8
  v_dot2c_f32_bf16_dpp v14, v30, v117 row_newbcast:8
  v_dot2c_f32_bf16_dpp v15, v31, v117 row_newbcast:8
  v_dot2c_f32_bf16_dpp v16, v30, v118 row_newbcast:8
  v_dot2c_f32_bf16_dpp v17, v31, v118 row_newbcast:8
  v_dot2c_f32_bf16_dpp v18, v30, v119 row_newbcast:8
  v_dot2c_f32_bf16_dpp v19, v31, v119 row_newbcast:8
  s_cbranch_vccz L_d861
  s_waitcnt vmcnt(4)
L_d861:
  s_xor_b32 s68, s70, 0xc0500
  buffer_load_dwordx4 v[76:79], v63, s[16:19], s68 offen nt
  s_waitcnt vmcnt(5)
  v_dot2c_f32_bf16_dpp v12, v30, v120 row_newbcast:4
  v_dot2c_f32_bf16_dpp v13, v31, v120 row_newbcast:4
  v_dot2c_f32_bf16_dpp v14, v30, v121 row_newbcast:4
  v_dot2c_f32_bf16_dpp v15, v31, v121 row_newbcast:4
  v_dot2c_f32_bf16_dpp v16, v30, v122 row_newbcast:4
  v_dot2c_f32_bf16_dpp v17, v31, v122 row_newbcast:4
  v_dot2c_f32_bf16_dpp v18, v30, v123 row_newbcast:4
  v_dot2c_f32_bf16_dpp v19, v31, v123 row_newbcast:4
  s_cbranch_vccz L_d862
  s_waitcnt vmcnt(4)
L_d862:
  s_xor_b32 s68, s70, 0xc0800
  buffer_load_dwordx4 v[80:83], v63, s[16:19], s68 offen nt
  s_waitcnt vmcnt(5)
  v_dot2c_f32_bf16_dpp v12, v30, v124 row_newbcast:12
  v_dot2c_f32_bf16_dpp v13, v31, v124 row_newbcast:12
  v_dot2c_f32_bf16_dpp v14, v30, v125 row_newbcast:12
  v_dot2c_f32_bf16_dpp v15, v31, v125 row_newbcast:12
  v_dot2c_f32_bf16_dpp v16, v30, v126 row_newbcast:12
  v_dot2c_f32_bf16_dpp v17, v31, v126 row_newbcast:12
  v_dot2c_f32_bf16_dpp v18, v30, v127 row_newbcast:12
  v_dot2c_f32_bf16_dpp v19, v31, v127 row_newbcast:12
  s_cbranch_vccz L_d863
  s_waitcnt vmcnt(4)
L_d863:
  s_xor_b32 s68, s70, 0xc0900
  buffer_load_dwordx4 v[84:87], v63, s[16:19], s68 offen nt
  s_barrier
  v_cvt_pk_bf16_f32 v30, v216, 0
  v_cvt_pk_bf16_f32 v31, 0, v216
  s_waitcnt vmcnt(5)
  v_dot2c_f32_bf16_dpp v12, v30, v64 row_newbcast:0
  v_dot2c_f32_bf16_dpp v13, v31, v64 row_newbcast:0
  v_dot2c_f32_bf16_dpp v14, v30, v65 row_newbcast:0
  v_dot2c_f32_bf16_dpp v15, v31, v65 row_newbcast:0
  v_dot2c_f32_bf16_dpp v16, v30, v66 row_newbcast:0
  v_dot2c_f32_bf16_dpp v17, v31, v66 row_newbcast:0
  v_dot2c_f32_bf16_dpp v18, v30, v67 row_newbcast:0
  v_dot2c_f32_bf16_dpp v19, v31, v67 row_newbcast:0
  s_cbranch_vccz L_d864
  s_waitcnt vmcnt(4)
L_d864:
  s_xor_b32 s68, s70, 0xc0c00
  buffer_load_dwordx4 v[88:91], v63, s[16:19], s68 offen nt
  s_waitcnt vmcnt(5)
  v_dot2c_f32_bf16_dpp v12, v30, v68 row_newbcast:8
  v_dot2c_f32_bf16_dpp v13, v31, v68 row_newbcast:8
  v_dot2c_f32_bf16_dpp v14, v30, v69 row_newbcast:8
  v_dot2c_f32_bf16_dpp v15, v31, v69 row_newbcast:8
  v_dot2c_f32_bf16_dpp v16, v30, v70 row_newbcast:8
  v_dot2c_f32_bf16_dpp v17, v31, v70 row_newbcast:8
  v_dot2c_f32_bf16_dpp v18, v30, v71 row_newbcast:8
  v_dot2c_f32_bf16_dpp v19, v31, v71 row_newbcast:8
  s_cbranch_vccz L_d865
  s_waitcnt vmcnt(4)
L_d865:
  s_xor_b32 s68, s70, 0xc0d00
  buffer_load_dwordx4 v[92:95], v63, s[16:19], s68 offen nt
  s_waitcnt vmcnt(5)
  v_dot2c_f32_bf16_dpp v12, v30, v72 row_newbcast:4
  v_dot2c_f32_bf16_dpp v13, v31, v72 row_newbcast:4
  v_dot2c_f32_bf16_dpp v14, v30, v73 row_newbcast:4
  v_dot2c_f32_bf16_dpp v15, v31, v73 row_newbcast:4
  v_dot2c_f32_bf16_dpp v16, v30, v74 row_newbcast:4
  v_dot2c_f32_bf16_dpp v17, v31, v74 row_newbcast:4
  v_dot2c_f32_bf16_dpp v18, v30, v75 row_newbcast:4
  v_dot2c_f32_bf16_dpp v19, v31, v75 row_newbcast:4
  s_cbranch_vccz L_d866
  s_waitcnt vmcnt(4)
L_d866:
  s_xor_b32 s68, s70, 0xd0000
  buffer_load_dwordx4 v[96:99], v63, s[16:19], s68 offen nt
  s_waitcnt vmcnt(5)
  v_dot2c_f32_bf16_dpp v12, v30, v76 row_newbcast:12
  v_dot2c_f32_bf16_dpp v13, v31, v76 row_newbcast:12
  v_dot2c_f32_bf16_dpp v14, v30, v77 row_newbcast:12
  v_dot2c_f32_bf16_dpp v15, v31, v77 row_newbcast:12
  v_dot2c_f32_bf16_dpp v16, v30, v78 row_newbcast:12
  v_dot2c_f32_bf16_dpp v17, v31, v78 row_newbcast:12
  v_dot2c_f32_bf16_dpp v18, v30, v79 row_newbcast:12
  v_dot2c_f32_bf16_dpp v19, v31, v79 row_newbcast:12
  s_cbranch_vccz L_d867
  s_waitcnt vmcnt(4)
L_d867:
  s_xor_b32 s68, s70, 0xd0100
  buffer_load_dwordx4 v[100:103], v63, s[16:19], s68 offen nt
  s_barrier
  v_cvt_pk_bf16_f32 v30, v217, 0
  v_cvt_pk_bf16_f32 v31, 0, v217
  s_waitcnt vmcnt(5)
  v_dot2c_f32_bf16_dpp v12, v30, v80 row_newbcast:0
  v_dot2c_f32_bf16_dpp v13, v31, v80 row_newbcast:0
  v_dot2c_f32_bf16_dpp v14, v30, v81 row_newbcast:0
  v_dot2c_f32_bf16_dpp v15, v31, v81 row_newbcast:0
  v_dot2c_f32_bf16_dpp v16, v30, v82 row_newbcast:0
  v_dot2c_f32_bf16_dpp v17, v31, v82 row_newbcast:0
  v_dot2c_f32_bf16_dpp v18, v30, v83 row_newbcast:0
  v_dot2c_f32_bf16_dpp v19, v31, v83 row_newbcast:0
  s_cbranch_vccz L_d868
  s_waitcnt vmcnt(4)
L_d868:
  s_xor_b32 s68, s70, 0xd0400
  buffer_load_dwordx4 v[104:107], v63, s[16:19], s68 offen nt
  s_waitcnt vmcnt(5)
  v_dot2c_f32_bf16_dpp v12, v30, v84 row_newbcast:8
  v_dot2c_f32_bf16_dpp v13, v31, v84 row_newbcast:8
  v_dot2c_f32_bf16_dpp v14, v30, v85 row_newbcast:8
  v_dot2c_f32_bf16_dpp v15, v31, v85 row_newbcast:8
  v_dot2c_f32_bf16_dpp v16, v30, v86 row_newbcast:8
  v_dot2c_f32_bf16_dpp v17, v31, v86 row_newbcast:8
  v_dot2c_f32_bf16_dpp v18, v30, v87 row_newbcast:8
  v_dot2c_f32_bf16_dpp v19, v31, v87 row_newbcast:8
  s_cbranch_vccz L_d869
  s_waitcnt vmcnt(4)
L_d869:
  s_xor_b32 s68, s70, 0xd0500
  buffer_load_dwordx4 v[108:111], v63, s[16:19], s68 offen nt
  s_waitcnt vmcnt(5)
  v_dot2c_f32_bf16_dpp v12, v30, v88 row_newbcast:4
  v_dot2c_f32_bf16_dpp v13, v31, v88 row_newbcast:4
  v_dot2c_f32_bf16_dpp v14, v30, v89 row_newbcast:4
  v_dot2c_f32_bf16_dpp v15, v31, v89 row_newbcast:4
  v_dot2c_f32_bf16_dpp v16, v30, v90 row_newbcast:4
  v_dot2c_f32_bf16_dpp v17, v31, v90 row_newbcast:4
  v_dot2c_f32_bf16_dpp v18, v30, v91 row_newbcast:4
  v_dot2c_f32_bf16_dpp v19, v31, v91 row_newbcast:4
  s_cbranch_vccz L_d870
  s_waitcnt vmcnt(4)
L_d870:
  s_xor_b32 s68, s70, 0xd0800
  buffer_load_dwordx4 v[112:115], v63, s[16:19], s68 offen nt
  s_waitcnt vmcnt(5)
  v_dot2c_f32_bf16_dpp v12, v30, v92 row_newbcast:12
  v_dot2c_f32_bf16_dpp v13, v31, v92 row_newbcast:12
  v_dot2c_f32_bf16_dpp v14, v30, v93 row_newbcast:12
  v_dot2c_f32_bf16_dpp v15, v31, v93 row_newbcast:12
  v_dot2c_f32_bf16_dpp v16, v30, v94 row_newbcast:12
  v_dot2c_f32_bf16_dpp v17, v31, v94 row_newbcast:12
  v_dot2c_f32_bf16_dpp v18, v30, v95 row_newbcast:12
  v_dot2c_f32_bf16_dpp v19, v31, v95 row_newbcast:12
  s_cbranch_vccz L_d871
  s_waitcnt vmcnt(4)
L_d871:
  s_xor_b32 s68, s70, 0xd0900
  buffer_load_dwordx4 v[116:119], v63, s[16:19], s68 offen nt
  s_barrier
  v_cvt_pk_bf16_f32 v30, v218, 0
  v_cvt_pk_bf16_f32 v31, 0, v218
  s_waitcnt vmcnt(5)
  v_dot2c_f32_bf16_dpp v12, v30, v96 row_newbcast:0
  v_dot2c_f32_bf16_dpp v13, v31, v96 row_newbcast:0
  v_dot2c_f32_bf16_dpp v14, v30, v97 row_newbcast:0
  v_dot2c_f32_bf16_dpp v15, v31, v97 row_newbcast:0
  v_dot2c_f32_bf16_dpp v16, v30, v98 row_newbcast:0
  v_dot2c_f32_bf16_dpp v17, v31, v98 row_newbcast:0
  v_dot2c_f32_bf16_dpp v18, v30, v99 row_newbcast:0
  v_dot2c_f32_bf16_dpp v19, v31, v99 row_newbcast:0
  s_cbranch_vccz L_d872
  s_waitcnt vmcnt(4)
L_d872:
  s_xor_b32 s68, s70, 0xd0c00
  buffer_load_dwordx4 v[120:123], v63, s[16:19], s68 offen nt
  s_cmp_eq_u32 s64, 2
  s_cbranch_scc0 L_wp218
  s_mov_b32 s100, 18
  s_atomic_umax s100, s[20:21], s88
  s_and_b32 s60, s88, 0xfffffc7f
  s_xor_b32 s61, s60, 16384
  s_add_u32 s38, s60, 0
  s_load_dword s40, s[20:21], s38 glc
  s_add_u32 s38, s61, 128
  s_load_dword s41, s[20:21], s38 glc
  s_add_u32 s38, s61, 256
  s_load_dword s42, s[20:21], s38 glc
  s_add_u32 s38, s60, 384
  s_load_dword s43, s[20:21], s38 glc
  s_add_u32 s38, s60, 512
  s_load_dword s44, s[20:21], s38 glc
  s_add_u32 s38, s61, 640
  s_load_dword s45, s[20:21], s38 glc
  s_add_u32 s38, s61, 768
  s_load_dword s46, s[20:21], s38 glc
  s_add_u32 s38, s60, 896
  s_load_dword s47, s[20:21], s38 glc
L_wp218:
  s_waitcnt vmcnt(5)
  v_dot2c_f32_bf16_dpp v12, v30, v100 row_newbcast:8
  v_dot2c_f32_bf16_dpp v13, v31, v100 row_newbcast:8
  v_dot2c_f32_bf16_dpp v14, v30, v101 row_newbcast:8
  v_dot2c_f32_bf16_dpp v15, v31, v101 row_newbcast:8
  v_dot2c_f32_bf16_dpp v16, v30, v102 row_newbcast:8
  v_dot2c_f32_bf16_dpp v17, v31, v102 row_newbcast:8
  v_dot2c_f32_bf16_dpp v18, v30, v103 row_newbcast:8
  v_dot2c_f32_bf16_dpp v19, v31, v103 row_newbcast:8
  s_cbranch_vccz L_d873
  s_waitcnt vmcnt(4)
L_d873:
  s_xor_b32 s68, s70, 0xd0d00
  buffer_load_dwordx4 v[124:127], v63, s[16:19], s68 offen nt
  s_waitcnt vmcnt(5)
  v_dot2c_f32_bf16_dpp v12, v30, v104 row_newbcast:4
  v_dot2c_f32_bf16_dpp v13, v31, v104 row_newbcast:4
  v_dot2c_f32_bf16_dpp v14, v30, v105 row_newbcast:4
  v_dot2c_f32_bf16_dpp v15, v31, v105 row_newbcast:4
  v_dot2c_f32_bf16_dpp v16, v30, v106 row_newbcast:4
  v_dot2c_f32_bf16_dpp v17, v31, v106 row_newbcast:4
  v_dot2c_f32_bf16_dpp v18, v30, v107 row_newbcast:4
  v_dot2c_f32_bf16_dpp v19, v31, v107 row_newbcast:4
  s_cbranch_vccz L_d874
  s_waitcnt vmcnt(4)
L_d874:
  s_xor_b32 s68, s70, 0xe0000
  buffer_load_dwordx4 v[64:67], v63, s[16:19], s68 offen nt
  s_waitcnt vmcnt(5)
  v_dot2c_f32_bf16_dpp v12, v30, v108 row_newbcast:12
  v_dot2c_f32_bf16_dpp v13, v31, v108 row_newbcast:12
  v_dot2c_f32_bf16_dpp v14, v30, v109 row_newbcast:12
  v_dot2c_f32_bf16_dpp v15, v31, v109 row_newbcast:12
  v_dot2c_f32_bf16_dpp v16, v30, v110 row_newbcast:12
  v_dot2c_f32_bf16_dpp v17, v31, v110 row_newbcast:12
  v_dot2c_f32_bf16_dpp v18, v30, v111 row_newbcast:12
  v_dot2c_f32_bf16_dpp v19, v31, v111 row_newbcast:12
  s_cbranch_vccz L_d875
  s_waitcnt vmcnt(4)
L_d875:
  s_xor_b32 s68, s70, 0xe0100
  buffer_load_dwordx4 v[68:71], v63, s[16:19], s68 offen nt
  s_barrier
  v_cvt_pk_bf16_f32 v30, v219, 0
  v_cvt_pk_bf16_f32 v31, 0, v219
  s_waitcnt vmcnt(5)
  v_dot2c_f32_bf16_dpp v12, v30, v112 row_newbcast:0
  v_dot2c_f32_bf16_dpp v13, v31, v112 row_newbcast:0
  v_dot2c_f32_bf16_dpp v14, v30, v113 row_newbcast:0
  v_dot2c_f32_bf16_dpp v15, v31, v113 row_newbcast:0
  v_dot2c_f32_bf16_dpp v16, v30, v114 row_newbcast:0
  v_dot2c_f32_bf16_dpp v17, v31, v114 row_newbcast:0
  v_dot2c_f32_bf16_dpp v18, v30, v115 row_newbcast:0
  v_dot2c_f32_bf16_dpp v19, v31, v115 row_newbcast:0
  s_cbranch_vccz L_d876
  s_waitcnt vmcnt(4)
L_d876:
  s_xor_b32 s68, s70, 0xe0400
  buffer_load_dwordx4 v[72:75], v63, s[16:19], s68 offen nt
  s_waitcnt vmcnt(5)
  v_dot2c_f32_bf16_dpp v12, v30, v116 row_newbcast:8
  v_dot2c_f32_bf16_dpp v13, v31, v116 row_newbcast:8
  v_dot2c_f32_bf16_dpp v14, v30, v117 row_newbcast:8
  v_dot2c_f32_bf16_dpp v15, v31, v117 row_newbcast:8
  v_dot2c_f32_bf16_dpp v16, v30, v118 row_newbcast:8
  v_dot2c_f32_bf16_dpp v17, v31, v118 row_newbcast:8
  v_dot2c_f32_bf16_dpp v18, v30, v119 row_newbcast:8
  v_dot2c_f32_bf16_dpp v19, v31, v119 row_newbcast:8
  s_cbranch_vccz L_d877
  s_waitcnt vmcnt(4)
L_d877:
  s_xor_b32 s68, s70, 0xe0500
  buffer_load_dwordx4 v[76:79], v63, s[16:19], s68 offen nt
  s_waitcnt vmcnt(5)
  v_dot2c_f32_bf16_dpp v12, v30, v120 row_newbcast:4
  v_dot2c_f32_bf16_dpp v13, v31, v120 row_newbcast:4
  v_dot2c_f32_bf16_dpp v14, v30, v121 row_newbcast:4
  v_dot2c_f32_bf16_dpp v15, v31, v121 row_newbcast:4
  v_dot2c_f32_bf16_dpp v16, v30, v122 row_newbcast:4
  v_dot2c_f32_bf16_dpp v17, v31, v122 row_newbcast:4
  v_dot2c_f32_bf16_dpp v18, v30, v123 row_newbcast:4
  v_dot2c_f32_bf16_dpp v19, v31, v123 row_newbcast:4
  s_cbranch_vccz L_d878
  s_waitcnt vmcnt(4)
L_d878:
  s_xor_b32 s68, s70, 0xe0800
  buffer_load_dwordx4 v[80:83], v63, s[16:19], s68 offen nt
  s_waitcnt vmcnt(5)
  v_dot2c_f32_bf16_dpp v12, v30, v124 row_newbcast:12
  v_dot2c_f32_bf16_dpp v13, v31, v124 row_newbcast:12
  v_dot2c_f32_bf16_dpp v14, v30, v125 row_newbcast:12
  v_dot2c_f32_bf16_dpp v15, v31, v125 row_newbcast:12
  v_dot2c_f32_bf16_dpp v16, v30, v126 row_newbcast:12
  v_dot2c_f32_bf16_dpp v17, v31, v126 row_newbcast:12
  v_dot2c_f32_bf16_dpp v18, v30, v127 row_newbcast:12
  v_dot2c_f32_bf16_dpp v19, v31, v127 row_newbcast:12
  s_cbranch_vccz L_d879
  s_waitcnt vmcnt(4)
L_d879:
  s_xor_b32 s68, s70, 0xe0900
  buffer_load_dwordx4 v[84:87], v63, s[16:19], s68 offen nt
  s_barrier
  v_cvt_pk_bf16_f32 v30, v220, 0
  v_cvt_pk_bf16_f32 v31, 0, v220
  s_waitcnt vmcnt(5)
  v_dot2c_f32_bf16_dpp v12, v30, v64 row_newbcast:0
  v_dot2c_f32_bf16_dpp v13, v31, v64 row_newbcast:0
  v_dot2c_f32_bf16_dpp v14, v30, v65 row_newbcast:0
  v_dot2c_f32_bf16_dpp v15, v31, v65 row_newbcast:0
  v_dot2c_f32_bf16_dpp v16, v30, v66 row_newbcast:0
  v_dot2c_f32_bf16_dpp v17, v31, v66 row_newbcast:0
  v_dot2c_f32_bf16_dpp v18, v30, v67 row_newbcast:0
  v_dot2c_f32_bf16_dpp v19, v31, v67 row_newbcast:0
  s_cbranch_vccz L_d880
  s_waitcnt vmcnt(4)
L_d880:
  s_xor_b32 s68, s70, 0xe0c00
  buffer_load_dwordx4 v[88:91], v63, s[16:19], s68 offen nt
  s_cmp_eq_u32 s64, 2
  s_cbranch_scc0 L_wp220
  s_mov_b32 s101, 0
  s_waitcnt lgkmcnt(0)
  s_cmp_ge_u32 s40, 18
  s_addc_u32 s101, s101, 0
  s_cmp_ge_u32 s41, 18
  s_addc_u32 s101, s101, 0
  s_cmp_ge_u32 s42, 18
  s_addc_u32 s101, s101, 0
  s_cmp_ge_u32 s43, 18
  s_addc_u32 s101, s101, 0
  s_cmp_ge_u32 s44, 18
  s_addc_u32 s101, s101, 0
  s_cmp_ge_u32 s45, 18
  s_addc_u32 s101, s101, 0
  s_cmp_ge_u32 s46, 18
  s_addc_u32 s101, s101, 0
  s_cmp_ge_u32 s47, 18
  s_addc_u32 s101, s101, 0
  s_cmp_lt_u32 s101, 6
  s_cselect_b32 s38, -1, 0
  v_mov_b32 v26, 0
  v_mov_b32 v27, s38
  ds_write_b32 v26, v27 offset:8512
L_wp220:
  s_waitcnt vmcnt(5)
  v_dot2c_f32_bf16_dpp v12, v30, v68 row_newbcast:8
  v_dot2c_f32_bf16_dpp v13, v31, v68 row_newbcast:8
  v_dot2c_f32_bf16_dpp v14, v30, v69 row_newbcast:8
  v_dot2c_f32_bf16_dpp v15, v31, v69 row_newbcast:8
  v_dot2c_f32_bf16_dpp v16, v30, v70 row_newbcast:8
  v_dot2c_f32_bf16_dpp v17, v31, v70 row_newbcast:8
  v_dot2c_f32_bf16_dpp v18, v30, v71 row_newbcast:8
  v_dot2c_f32_bf16_dpp v19, v31, v71 row_newbcast:8
  s_cbranch_vccz L_d881
  s_waitcnt vmcnt(4)
L_d881:
  s_xor_b32 s68, s70, 0xe0d00
  buffer_load_dwordx4 v[92:95], v63, s[16:19], s68 offen nt
  s_waitcnt vmcnt(5)
  v_dot2c_f32_bf16_dpp v12, v30, v72 row_newbcast:4
  v_dot2c_f32_bf16_dpp v13, v31, v72 row_newbcast:4
  v_dot2c_f32_bf16_dpp v14, v30, v73 row_newbcast:4
  v_dot2c_f32_bf16_dpp v15, v31, v73 row_newbcast:4
  v_dot2c_f32_bf16_dpp v16, v30, v74 row_newbcast:4
  v_dot2c_f32_bf16_dpp v17, v31, v74 row_newbcast:4
  v_dot2c_f32_bf16_dpp v18, v30, v75 row_newbcast:4
  v_dot2c_f32_bf16_dpp v19, v31, v75 row_newbcast:4
  s_cbranch_vccz L_d882
  s_waitcnt vmcnt(4)
L_d882:
  s_xor_b32 s68, s70, 0xf0000
  buffer_load_dwordx4 v[96:99], v63, s[16:19], s68 offen nt
  s_waitcnt vmcnt(5)
  v_dot2c_f32_bf16_dpp v12, v30, v76 row_newbcast:12
  v_dot2c_f32_bf16_dpp v13, v31, v76 row_newbcast:12
  v_dot2c_f32_bf16_dpp v14, v30, v77 row_newbcast:12
  v_dot2c_f32_bf16_dpp v15, v31, v77 row_newbcast:12
  v_dot2c_f32_bf16_dpp v16, v30, v78 row_newbcast:12
  v_dot2c_f32_bf16_dpp v17, v31, v78 row_newbcast:12
  v_dot2c_f32_bf16_dpp v18, v30, v79 row_newbcast:12
  v_dot2c_f32_bf16_dpp v19, v31, v79 row_newbcast:12
  s_cbranch_vccz L_d883
  s_waitcnt vmcnt(4)
L_d883:
  s_xor_b32 s68, s70, 0xf0100
  buffer_load_dwordx4 v[100:103], v63, s[16:19], s68 offen nt
  s_barrier
  v_cvt_pk_bf16_f32 v30, v221, 0
  v_cvt_pk_bf16_f32 v31, 0, v221
  s_waitcnt vmcnt(5)
  v_dot2c_f32_bf16_dpp v12, v30, v80 row_newbcast:0
  v_dot2c_f32_bf16_dpp v13, v31, v80 row_newbcast:0
  v_dot2c_f32_bf16_dpp v14, v30, v81 row_newbcast:0
  v_dot2c_f32_bf16_dpp v15, v31, v81 row_newbcast:0
  v_dot2c_f32_bf16_dpp v16, v30, v82 row_newbcast:0
  v_dot2c_f32_bf16_dpp v17, v31, v82 row_newbcast:0
  v_dot2c_f32_bf16_dpp v18, v30, v83 row_newbcast:0
  v_dot2c_f32_bf16_dpp v19, v31, v83 row_newbcast:0
  s_cbranch_vccz L_d884
  s_waitcnt vmcnt(4)
L_d884:
  s_xor_b32 s68, s70, 0xf0400
  buffer_load_dwordx4 v[104:107], v63, s[16:19], s68 offen nt
  v_mov_b32 v26, 0
  ds_read_b32 v35, v26 offset:8512
  s_waitcnt vmcnt(5)
  v_dot2c_f32_bf16_dpp v12, v30, v84 row_newbcast:8
  v_dot2c_f32_bf16_dpp v13, v31, v84 row_newbcast:8
  v_dot2c_f32_bf16_dpp v14, v30, v85 row_newbcast:8
  v_dot2c_f32_bf16_dpp v15, v31, v85 row_newbcast:8
  v_dot2c_f32_bf16_dpp v16, v30, v86 row_newbcast:8
  v_dot2c_f32_bf16_dpp v17, v31, v86 row_newbcast:8
  v_dot2c_f32_bf16_dpp v18, v30, v87 row_newbcast:8
  v_dot2c_f32_bf16_dpp v19, v31, v87 row_newbcast:8
  s_cbranch_vccz L_d885
  s_waitcnt vmcnt(4)
L_d885:
  s_xor_b32 s68, s70, 0xf0500
  buffer_load_dwordx4 v[108:111], v63, s[16:19], s68 offen nt
  s_waitcnt vmcnt(5)
  v_dot2c_f32_bf16_dpp v12, v30, v88 row_newbcast:4
  v_dot2c_f32_bf16_dpp v13, v31, v88 row_newbcast:4
  v_dot2c_f32_bf16_dpp v14, v30, v89 row_newbcast:4
  v_dot2c_f32_bf16_dpp v15, v31, v89 row_newbcast:4
  v_dot2c_f32_bf16_dpp v16, v30, v90 row_newbcast:4
  v_dot2c_f32_bf16_dpp v17, v31, v90 row_newbcast:4
  v_dot2c_f32_bf16_dpp v18, v30, v91 row_newbcast:4
  v_dot2c_f32_bf16_dpp v19, v31, v91 row_newbcast:4
  s_cbranch_vccz L_d886
  s_waitcnt vmcnt(4)
L_d886:
  s_xor_b32 s68, s70, 0xf0800
  buffer_load_dwordx4 v[112:115], v63, s[16:19], s68 offen nt
  s_waitcnt vmcnt(5)
  v_dot2c_f32_bf16_dpp v12, v30, v92 row_newbcast:12
  v_dot2c_f32_bf16_dpp v13, v31, v92 row_newbcast:12
  v_dot2c_f32_bf16_dpp v14, v30, v93 row_newbcast:12
  v_dot2c_f32_bf16_dpp v15, v31, v93 row_newbcast:12
  v_dot2c_f32_bf16_dpp v16, v30, v94 row_newbcast:12
  v_dot2c_f32_bf16_dpp v17, v31, v94 row_newbcast:12
  v_dot2c_f32_bf16_dpp v18, v30, v95 row_newbcast:12
  v_dot2c_f32_bf16_dpp v19, v31, v95 row_newbcast:12
  s_cbranch_vccz L_d887
  s_waitcnt vmcnt(4)
L_d887:
  s_xor_b32 s68, s70, 0xf0900
  buffer_load_dwordx4 v[116:119], v63, s[16:19], s68 offen nt
  s_barrier
  v_cvt_pk_bf16_f32 v30, v222, 0
  v_cvt_pk_bf16_f32 v31, 0, v222
  s_waitcnt vmcnt(5)
  v_dot2c_f32_bf16_dpp v12, v30, v96 row_newbcast:0
  v_dot2c_f32_bf16_dpp v13, v31, v96 row_newbcast:0
  v_dot2c_f32_bf16_dpp v14, v30, v97 row_newbcast:0
  v_dot2c_f32_bf16_dpp v15, v31, v97 row_newbcast:0
  v_dot2c_f32_bf16_dpp v16, v30, v98 row_newbcast:0
  v_dot2c_f32_bf16_dpp v17, v31, v98 row_newbcast:0
  v_dot2c_f32_bf16_dpp v18, v30, v99 row_newbcast:0
  v_dot2c_f32_bf16_dpp v19, v31, v99 row_newbcast:0
  s_cbranch_vccz L_d888
  s_waitcnt vmcnt(4)
L_d888:
  s_xor_b32 s68, s70, 0xf0c00
  buffer_load_dwordx4 v[120:123], v63, s[16:19], s68 offen nt
  s_waitcnt lgkmcnt(0)
  v_cmp_ne_u32 vcc, 0, v35
  s_waitcnt vmcnt(5)
  v_dot2c_f32_bf16_dpp v12, v30, v100 row_newbcast:8
  v_dot2c_f32_bf16_dpp v13, v31, v100 row_newbcast:8
  v_dot2c_f32_bf16_dpp v14, v30, v101 row_newbcast:8
  v_dot2c_f32_bf16_dpp v15, v31, v101 row_newbcast:8
  v_dot2c_f32_bf16_dpp v16, v30, v102 row_newbcast:8
  v_dot2c_f32_bf16_dpp v17, v31, v102 row_newbcast:8
  v_dot2c_f32_bf16_dpp v18, v30, v103 row_newbcast:8
  v_dot2c_f32_bf16_dpp v19, v31, v103 row_newbcast:8
  s_cbranch_vccz L_d889
  s_waitcnt vmcnt(4)
L_d889:
  s_xor_b32 s68, s70, 0xf0d00
  buffer_load_dwordx4 v[124:127], v63, s[16:19], s68 offen nt
  s_waitcnt vmcnt(5)
  v_dot2c_f32_bf16_dpp v12, v30, v104 row_newbcast:4
  v_dot2c_f32_bf16_dpp v13, v31, v104 row_newbcast:4
  v_dot2c_f32_bf16_dpp v14, v30, v105 row_newbcast:4
  v_dot2c_f32_bf16_dpp v15, v31, v105 row_newbcast:4
  v_dot2c_f32_bf16_dpp v16, v30, v106 row_newbcast:4
  v_dot2c_f32_bf16_dpp v17, v31, v106 row_newbcast:4
  v_dot2c_f32_bf16_dpp v18, v30, v107 row_newbcast:4
  v_dot2c_f32_bf16_dpp v19, v31, v107 row_newbcast:4
  s_cbranch_vccz L_d890
  s_waitcnt vmcnt(4)
L_d890:
  s_xor_b32 s68, s70, 0x4000
  buffer_load_dwordx4 v[64:67], v63, s[16:19], s68 offen nt
  s_waitcnt vmcnt(5)
  v_dot2c_f32_bf16_dpp v12, v30, v108 row_newbcast:12
  v_dot2c_f32_bf16_dpp v13, v31, v108 row_newbcast:12
  v_dot2c_f32_bf16_dpp v14, v30, v109 row_newbcast:12
  v_dot2c_f32_bf16_dpp v15, v31, v109 row_newbcast:12
  v_dot2c_f32_bf16_dpp v16, v30, v110 row_newbcast:12
  v_dot2c_f32_bf16_dpp v17, v31, v110 row_newbcast:12
  v_dot2c_f32_bf16_dpp v18, v30, v111 row_newbcast:12
  v_dot2c_f32_bf16_dpp v19, v31, v111 row_newbcast:12
  s_cbranch_vccz L_d891
  s_waitcnt vmcnt(4)
L_d891:
  s_xor_b32 s68, s70, 0x4100
  buffer_load_dwordx4 v[68:71], v63, s[16:19], s68 offen nt
  s_barrier
  v_cvt_pk_bf16_f32 v30, v223, 0
  v_cvt_pk_bf16_f32 v31, 0, v223
  s_waitcnt vmcnt(5)
  v_dot2c_f32_bf16_dpp v12, v30, v112 row_newbcast:0
  v_dot2c_f32_bf16_dpp v13, v31, v112 row_newbcast:0
  v_dot2c_f32_bf16_dpp v14, v30, v113 row_newbcast:0
  v_dot2c_f32_bf16_dpp v15, v31, v113 row_newbcast:0
  v_dot2c_f32_bf16_dpp v16, v30, v114 row_newbcast:0
  v_dot2c_f32_bf16_dpp v17, v31, v114 row_newbcast:0
  v_dot2c_f32_bf16_dpp v18, v30, v115 row_newbcast:0
  v_dot2c_f32_bf16_dpp v19, v31, v115 row_newbcast:0
  s_cbranch_vccz L_d892
  s_waitcnt vmcnt(4)
L_d892:
  s_xor_b32 s68, s70, 0x4400
  buffer_load_dwordx4 v[72:75], v63, s[16:19], s68 offen nt
  s_waitcnt vmcnt(5)
  v_dot2c_f32_bf16_dpp v12, v30, v116 row_newbcast:8
  v_dot2c_f32_bf16_dpp v13, v31, v116 row_newbcast:8
  v_dot2c_f32_bf16_dpp v14, v30, v117 row_newbcast:8
  v_dot2c_f32_bf16_dpp v15, v31, v117 row_newbcast:8
  v_dot2c_f32_bf16_dpp v16, v30, v118 row_newbcast:8
  v_dot2c_f32_bf16_dpp v17, v31, v118 row_newbcast:8
  v_dot2c_f32_bf16_dpp v18, v30, v119 row_newbcast:8
  v_dot2c_f32_bf16_dpp v19, v31, v119 row_newbcast:8
  s_cbranch_vccz L_d893
  s_waitcnt vmcnt(4)
L_d893:
  s_xor_b32 s68, s70, 0x4500
  buffer_load_dwordx4 v[76:79], v63, s[16:19], s68 offen nt
  s_waitcnt vmcnt(5)
  v_dot2c_f32_bf16_dpp v12, v30, v120 row_newbcast:4
  v_dot2c_f32_bf16_dpp v13, v31, v120 row_newbcast:4
  v_dot2c_f32_bf16_dpp v14, v30, v121 row_newbcast:4
  v_dot2c_f32_bf16_dpp v15, v31, v121 row_newbcast:4
  v_dot2c_f32_bf16_dpp v16, v30, v122 row_newbcast:4
  v_dot2c_f32_bf16_dpp v17, v31, v122 row_newbcast:4
  v_dot2c_f32_bf16_dpp v18, v30, v123 row_newbcast:4
  v_dot2c_f32_bf16_dpp v19, v31, v123 row_newbcast:4
  s_cbranch_vccz L_d894
  s_waitcnt vmcnt(4)
L_d894:
  s_xor_b32 s68, s70, 0x4800
  buffer_load_dwordx4 v[80:83], v63, s[16:19], s68 offen nt
  s_waitcnt vmcnt(5)
  v_dot2c_f32_bf16_dpp v12, v30, v124 row_newbcast:12
  v_dot2c_f32_bf16_dpp v13, v31, v124 row_newbcast:12
  v_dot2c_f32_bf16_dpp v14, v30, v125 row_newbcast:12
  v_dot2c_f32_bf16_dpp v15, v31, v125 row_newbcast:12
  v_dot2c_f32_bf16_dpp v16, v30, v126 row_newbcast:12
  v_dot2c_f32_bf16_dpp v17, v31, v126 row_newbcast:12
  v_dot2c_f32_bf16_dpp v18, v30, v127 row_newbcast:12
  v_dot2c_f32_bf16_dpp v19, v31, v127 row_newbcast:12
  s_cbranch_vccz L_d895
  s_waitcnt vmcnt(4)
L_d895:
  s_xor_b32 s68, s70, 0x4900
  buffer_load_dwordx4 v[84:87], v63, s[16:19], s68 offen nt
  s_barrier
  v_cvt_pk_bf16_f32 v30, v224, 0
  v_cvt_pk_bf16_f32 v31, 0, v224
  s_waitcnt vmcnt(5)
  v_dot2c_f32_bf16_dpp v12, v30, v64 row_newbcast:0
  v_dot2c_f32_bf16_dpp v13, v31, v64 row_newbcast:0
  v_dot2c_f32_bf16_dpp v14, v30, v65 row_newbcast:0
  v_dot2c_f32_bf16_dpp v15, v31, v65 row_newbcast:0
  v_dot2c_f32_bf16_dpp v16, v30, v66 row_newbcast:0
  v_dot2c_f32_bf16_dpp v17, v31, v66 row_newbcast:0
  v_dot2c_f32_bf16_dpp v18, v30, v67 row_newbcast:0
  v_dot2c_f32_bf16_dpp v19, v31, v67 row_newbcast:0
  s_cbranch_vccz L_d896
  s_waitcnt vmcnt(4)
L_d896:
  s_xor_b32 s68, s70, 0x4c00
  buffer_load_dwordx4 v[88:91], v63, s[16:19], s68 offen nt
  s_waitcnt vmcnt(5)
  v_dot2c_f32_bf16_dpp v12, v30, v68 row_newbcast:8
  v_dot2c_f32_bf16_dpp v13, v31, v68 row_newbcast:8
  v_dot2c_f32_bf16_dpp v14, v30, v69 row_newbcast:8
  v_dot2c_f32_bf16_dpp v15, v31, v69 row_newbcast:8
  v_dot2c_f32_bf16_dpp v16, v30, v70 row_newbcast:8
  v_dot2c_f32_bf16_dpp v17, v31, v70 row_newbcast:8
  v_dot2c_f32_bf16_dpp v18, v30, v71 row_newbcast:8
  v_dot2c_f32_bf16_dpp v19, v31, v71 row_newbcast:8
  s_cbranch_vccz L_d897
  s_waitcnt vmcnt(4)
L_d897:
  s_xor_b32 s68, s70, 0x4d00
  buffer_load_dwordx4 v[92:95], v63, s[16:19], s68 offen nt
  s_waitcnt vmcnt(5)
  v_dot2c_f32_bf16_dpp v12, v30, v72 row_newbcast:4
  v_dot2c_f32_bf16_dpp v13, v31, v72 row_newbcast:4
  v_dot2c_f32_bf16_dpp v14, v30, v73 row_newbcast:4
  v_dot2c_f32_bf16_dpp v15, v31, v73 row_newbcast:4
  v_dot2c_f32_bf16_dpp v16, v30, v74 row_newbcast:4
  v_dot2c_f32_bf16_dpp v17, v31, v74 row_newbcast:4
  v_dot2c_f32_bf16_dpp v18, v30, v75 row_newbcast:4
  v_dot2c_f32_bf16_dpp v19, v31, v75 row_newbcast:4
  s_cbranch_vccz L_d898
  s_waitcnt vmcnt(4)
L_d898:
  s_xor_b32 s68, s70, 0x14000
  buffer_load_dwordx4 v[96:99], v63, s[16:19], s68 offen nt
  s_waitcnt vmcnt(5)
  v_dot2c_f32_bf16_dpp v12, v30, v76 row_newbcast:12
  v_dot2c_f32_bf16_dpp v13, v31, v76 row_newbcast:12
  v_dot2c_f32_bf16_dpp v14, v30, v77 row_newbcast:12
  v_dot2c_f32_bf16_dpp v15, v31, v77 row_newbcast:12
  v_dot2c_f32_bf16_dpp v16, v30, v78 row_newbcast:12
  v_dot2c_f32_bf16_dpp v17, v31, v78 row_newbcast:12
  v_dot2c_f32_bf16_dpp v18, v30, v79 row_newbcast:12
  v_dot2c_f32_bf16_dpp v19, v31, v79 row_newbcast:12
  s_cbranch_vccz L_d899
  s_waitcnt vmcnt(4)
L_d899:
  s_xor_b32 s68, s70, 0x14100
  buffer_load_dwordx4 v[100:103], v63, s[16:19], s68 offen nt
  s_barrier
  v_cvt_pk_bf16_f32 v30, v225, 0
  v_cvt_pk_bf16_f32 v31, 0, v225
  s_waitcnt vmcnt(5)
  v_dot2c_f32_bf16_dpp v12, v30, v80 row_newbcast:0
  v_dot2c_f32_bf16_dpp v13, v31, v80 row_newbcast:0
  v_dot2c_f32_bf16_dpp v14, v30, v81 row_newbcast:0
  v_dot2c_f32_bf16_dpp v15, v31, v81 row_newbcast:0
  v_dot2c_f32_bf16_dpp v16, v30, v82 row_newbcast:0
  v_dot2c_f32_bf16_dpp v17, v31, v82 row_newbcast:0
  v_dot2c_f32_bf16_dpp v18, v30, v83 row_newbcast:0
  v_dot2c_f32_bf16_dpp v19, v31, v83 row_newbcast:0
  s_cbranch_vccz L_d900
  s_waitcnt vmcnt(4)
L_d900:
  s_xor_b32 s68, s70, 0x14400
  buffer_load_dwordx4 v[104:107], v63, s[16:19], s68 offen nt
  s_waitcnt vmcnt(5)
  v_dot2c_f32_bf16_dpp v12, v30, v84 row_newbcast:8
  v_dot2c_f32_bf16_dpp v13, v31, v84 row_newbcast:8
  v_dot2c_f32_bf16_dpp v14, v30, v85 row_newbcast:8
  v_dot2c_f32_bf16_dpp v15, v31, v85 row_newbcast:8
  v_dot2c_f32_bf16_dpp v16, v30, v86 row_newbcast:8
  v_dot2c_f32_bf16_dpp v17, v31, v86 row_newbcast:8
  v_dot2c_f32_bf16_dpp v18, v30, v87 row_newbcast:8
  v_dot2c_f32_bf16_dpp v19, v31, v87 row_newbcast:8
  s_cbranch_vccz L_d901
  s_waitcnt vmcnt(4)
L_d901:
  s_xor_b32 s68, s70, 0x14500
  buffer_load_dwordx4 v[108:111], v63, s[16:19], s68 offen nt
  s_waitcnt vmcnt(5)
  v_dot2c_f32_bf16_dpp v12, v30, v88 row_newbcast:4
  v_dot2c_f32_bf16_dpp v13, v31, v88 row_newbcast:4
  v_dot2c_f32_bf16_dpp v14, v30, v89 row_newbcast:4
  v_dot2c_f32_bf16_dpp v15, v31, v89 row_newbcast:4
  v_dot2c_f32_bf16_dpp v16, v30, v90 row_newbcast:4
  v_dot2c_f32_bf16_dpp v17, v31, v90 row_newbcast:4
  v_dot2c_f32_bf16_dpp v18, v30, v91 row_newbcast:4
  v_dot2c_f32_bf16_dpp v19, v31, v91 row_newbcast:4
  s_cbranch_vccz L_d902
  s_waitcnt vmcnt(4)
L_d902:
  s_xor_b32 s68, s70, 0x14800
  buffer_load_dwordx4 v[112:115], v63, s[16:19], s68 offen nt
  s_waitcnt vmcnt(5)
  v_dot2c_f32_bf16_dpp v12, v30, v92 row_newbcast:12
  v_dot2c_f32_bf16_dpp v13, v31, v92 row_newbcast:12
  v_dot2c_f32_bf16_dpp v14, v30, v93 row_newbcast:12
  v_dot2c_f32_bf16_dpp v15, v31, v93 row_newbcast:12
  v_dot2c_f32_bf16_dpp v16, v30, v94 row_newbcast:12
  v_dot2c_f32_bf16_dpp v17, v31, v94 row_newbcast:12
  v_dot2c_f32_bf16_dpp v18, v30, v95 row_newbcast:12
  v_dot2c_f32_bf16_dpp v19, v31, v95 row_newbcast:12
  s_cbranch_vccz L_d903
  s_waitcnt vmcnt(4)
L_d903:
  s_xor_b32 s68, s70, 0x14900
  buffer_load_dwordx4 v[116:119], v63, s[16:19], s68 offen nt
  s_barrier
  v_cvt_pk_bf16_f32 v30, v226, 0
  v_cvt_pk_bf16_f32 v31, 0, v226
  s_waitcnt vmcnt(5)
  v_dot2c_f32_bf16_dpp v12, v30, v96 row_newbcast:0
  v_dot2c_f32_bf16_dpp v13, v31, v96 row_newbcast:0
  v_dot2c_f32_bf16_dpp v14, v30, v97 row_newbcast:0
  v_dot2c_f32_bf16_dpp v15, v31, v97 row_newbcast:0
  v_dot2c_f32_bf16_dpp v16, v30, v98 row_newbcast:0
  v_dot2c_f32_bf16_dpp v17, v31, v98 row_newbcast:0
  v_dot2c_f32_bf16_dpp v18, v30, v99 row_newbcast:0
  v_dot2c_f32_bf16_dpp v19, v31, v99 row_newbcast:0
  s_cbranch_vccz L_d904
  s_waitcnt vmcnt(4)
L_d904:
  s_xor_b32 s68, s70, 0x14c00
  buffer_load_dwordx4 v[120:123], v63, s[16:19], s68 offen nt
  s_waitcnt vmcnt(5)
  v_dot2c_f32_bf16_dpp v12, v30, v100 row_newbcast:8
  v_dot2c_f32_bf16_dpp v13, v31, v100 row_newbcast:8
  v_dot2c_f32_bf16_dpp v14, v30, v101 row_newbcast:8
  v_dot2c_f32_bf16_dpp v15, v31, v101 row_newbcast:8
  v_dot2c_f32_bf16_dpp v16, v30, v102 row_newbcast:8
  v_dot2c_f32_bf16_dpp v17, v31, v102 row_newbcast:8
  v_dot2c_f32_bf16_dpp v18, v30, v103 row_newbcast:8
  v_dot2c_f32_bf16_dpp v19, v31, v103 row_newbcast:8
  s_cbranch_vccz L_d905
  s_waitcnt vmcnt(4)
L_d905:
  s_xor_b32 s68, s70, 0x14d00
  buffer_load_dwordx4 v[124:127], v63, s[16:19], s68 offen nt
  s_waitcnt vmcnt(5)
  v_dot2c_f32_bf16_dpp v12, v30, v104 row_newbcast:4
  v_dot2c_f32_bf16_dpp v13, v31, v104 row_newbcast:4
  v_dot2c_f32_bf16_dpp v14, v30, v105 row_newbcast:4
  v_dot2c_f32_bf16_dpp v15, v31, v105 row_newbcast:4
  v_dot2c_f32_bf16_dpp v16, v30, v106 row_newbcast:4
  v_dot2c_f32_bf16_dpp v17, v31, v106 row_newbcast:4
  v_dot2c_f32_bf16_dpp v18, v30, v107 row_newbcast:4
  v_dot2c_f32_bf16_dpp v19, v31, v107 row_newbcast:4
  s_cbranch_vccz L_d906
  s_waitcnt vmcnt(4)
L_d906:
  s_xor_b32 s68, s70, 0x24000
  buffer_load_dwordx4 v[64:67], v63, s[16:19], s68 offen nt
  s_waitcnt vmcnt(5)
  v_dot2c_f32_bf16_dpp v12, v30, v108 row_newbcast:12
  v_dot2c_f32_bf16_dpp v13, v31, v108 row_newbcast:12
  v_dot2c_f32_bf16_dpp v14, v30, v109 row_newbcast:12
  v_dot2c_f32_bf16_dpp v15, v31, v109 row_newbcast:12
  v_dot2c_f32_bf16_dpp v16, v30, v110 row_newbcast:12
  v_dot2c_f32_bf16_dpp v17, v31, v110 row_newbcast:12
  v_dot2c_f32_bf16_dpp v18, v30, v111 row_newbcast:12
  v_dot2c_f32_bf16_dpp v19, v31, v111 row_newbcast:12
  s_cbranch_vccz L_d907
  s_waitcnt vmcnt(4)
L_d907:
  s_xor_b32 s68, s70, 0x24100
  buffer_load_dwordx4 v[68:71], v63, s[16:19], s68 offen nt
  s_barrier
  v_cvt_pk_bf16_f32 v30, v227, 0
  v_cvt_pk_bf16_f32 v31, 0, v227
  s_waitcnt vmcnt(5)
  v_dot2c_f32_bf16_dpp v12, v30, v112 row_newbcast:0
  v_dot2c_f32_bf16_dpp v13, v31, v112 row_newbcast:0
  v_dot2c_f32_bf16_dpp v14, v30, v113 row_newbcast:0
  v_dot2c_f32_bf16_dpp v15, v31, v113 row_newbcast:0
  v_dot2c_f32_bf16_dpp v16, v30, v114 row_newbcast:0
  v_dot2c_f32_bf16_dpp v17, v31, v114 row_newbcast:0
  v_dot2c_f32_bf16_dpp v18, v30, v115 row_newbcast:0
  v_dot2c_f32_bf16_dpp v19, v31, v115 row_newbcast:0
  s_cbranch_vccz L_d908
  s_waitcnt vmcnt(4)
L_d908:
  s_xor_b32 s68, s70, 0x24400
  buffer_load_dwordx4 v[72:75], v63, s[16:19], s68 offen nt
  s_waitcnt vmcnt(5)
  v_dot2c_f32_bf16_dpp v12, v30, v116 row_newbcast:8
  v_dot2c_f32_bf16_dpp v13, v31, v116 row_newbcast:8
  v_dot2c_f32_bf16_dpp v14, v30, v117 row_newbcast:8
  v_dot2c_f32_bf16_dpp v15, v31, v117 row_newbcast:8
  v_dot2c_f32_bf16_dpp v16, v30, v118 row_newbcast:8
  v_dot2c_f32_bf16_dpp v17, v31, v118 row_newbcast:8
  v_dot2c_f32_bf16_dpp v18, v30, v119 row_newbcast:8
  v_dot2c_f32_bf16_dpp v19, v31, v119 row_newbcast:8
  s_cbranch_vccz L_d909
  s_waitcnt vmcnt(4)
L_d909:
  s_xor_b32 s68, s70, 0x24500
  buffer_load_dwordx4 v[76:79], v63, s[16:19], s68 offen nt
  s_waitcnt vmcnt(5)
  v_dot2c_f32_bf16_dpp v12, v30, v120 row_newbcast:4
  v_dot2c_f32_bf16_dpp v13, v31, v120 row_newbcast:4
  v_dot2c_f32_bf16_dpp v14, v30, v121 row_newbcast:4
  v_dot2c_f32_bf16_dpp v15, v31, v121 row_newbcast:4
  v_dot2c_f32_bf16_dpp v16, v30, v122 row_newbcast:4
  v_dot2c_f32_bf16_dpp v17, v31, v122 row_newbcast:4
  v_dot2c_f32_bf16_dpp v18, v30, v123 row_newbcast:4
  v_dot2c_f32_bf16_dpp v19, v31, v123 row_newbcast:4
  s_cbranch_vccz L_d910
  s_waitcnt vmcnt(4)
L_d910:
  s_xor_b32 s68, s70, 0x24800
  buffer_load_dwordx4 v[80:83], v63, s[16:19], s68 offen nt
  s_waitcnt vmcnt(5)
  v_dot2c_f32_bf16_dpp v12, v30, v124 row_newbcast:12
  v_dot2c_f32_bf16_dpp v13, v31, v124 row_newbcast:12
  v_dot2c_f32_bf16_dpp v14, v30, v125 row_newbcast:12
  v_dot2c_f32_bf16_dpp v15, v31, v125 row_newbcast:12
  v_dot2c_f32_bf16_dpp v16, v30, v126 row_newbcast:12
  v_dot2c_f32_bf16_dpp v17, v31, v126 row_newbcast:12
  v_dot2c_f32_bf16_dpp v18, v30, v127 row_newbcast:12
  v_dot2c_f32_bf16_dpp v19, v31, v127 row_newbcast:12
  s_cbranch_vccz L_d911
  s_waitcnt vmcnt(4)
L_d911:
  s_xor_b32 s68, s70, 0x24900
  buffer_load_dwordx4 v[84:87], v63, s[16:19], s68 offen nt
  s_barrier
  v_cvt_pk_bf16_f32 v30, v228, 0
  v_cvt_pk_bf16_f32 v31, 0, v228
  s_waitcnt vmcnt(5)
  v_dot2c_f32_bf16_dpp v12, v30, v64 row_newbcast:0
  v_dot2c_f32_bf16_dpp v13, v31, v64 row_newbcast:0
  v_dot2c_f32_bf16_dpp v14, v30, v65 row_newbcast:0
  v_dot2c_f32_bf16_dpp v15, v31, v65 row_newbcast:0
  v_dot2c_f32_bf16_dpp v16, v30, v66 row_newbcast:0
  v_dot2c_f32_bf16_dpp v17, v31, v66 row_newbcast:0
  v_dot2c_f32_bf16_dpp v18, v30, v67 row_newbcast:0
  v_dot2c_f32_bf16_dpp v19, v31, v67 row_newbcast:0
  s_cbranch_vccz L_d912
  s_waitcnt vmcnt(4)
L_d912:
  s_xor_b32 s68, s70, 0x24c00
  buffer_load_dwordx4 v[88:91], v63, s[16:19], s68 offen nt
  s_waitcnt vmcnt(5)
  v_dot2c_f32_bf16_dpp v12, v30, v68 row_newbcast:8
  v_dot2c_f32_bf16_dpp v13, v31, v68 row_newbcast:8
  v_dot2c_f32_bf16_dpp v14, v30, v69 row_newbcast:8
  v_dot2c_f32_bf16_dpp v15, v31, v69 row_newbcast:8
  v_dot2c_f32_bf16_dpp v16, v30, v70 row_newbcast:8
  v_dot2c_f32_bf16_dpp v17, v31, v70 row_newbcast:8
  v_dot2c_f32_bf16_dpp v18, v30, v71 row_newbcast:8
  v_dot2c_f32_bf16_dpp v19, v31, v71 row_newbcast:8
  s_cbranch_vccz L_d913
  s_waitcnt vmcnt(4)
L_d913:
  s_xor_b32 s68, s70, 0x24d00
  buffer_load_dwordx4 v[92:95], v63, s[16:19], s68 offen nt
  s_waitcnt vmcnt(5)
  v_dot2c_f32_bf16_dpp v12, v30, v72 row_newbcast:4
  v_dot2c_f32_bf16_dpp v13, v31, v72 row_newbcast:4
  v_dot2c_f32_bf16_dpp v14, v30, v73 row_newbcast:4
  v_dot2c_f32_bf16_dpp v15, v31, v73 row_newbcast:4
  v_dot2c_f32_bf16_dpp v16, v30, v74 row_newbcast:4
  v_dot2c_f32_bf16_dpp v17, v31, v74 row_newbcast:4
  v_dot2c_f32_bf16_dpp v18, v30, v75 row_newbcast:4
  v_dot2c_f32_bf16_dpp v19, v31, v75 row_newbcast:4
  s_cbranch_vccz L_d914
  s_waitcnt vmcnt(4)
L_d914:
  s_xor_b32 s68, s70, 0x34000
  buffer_load_dwordx4 v[96:99], v63, s[16:19], s68 offen nt
  s_waitcnt vmcnt(5)
  v_dot2c_f32_bf16_dpp v12, v30, v76 row_newbcast:12
  v_dot2c_f32_bf16_dpp v13, v31, v76 row_newbcast:12
  v_dot2c_f32_bf16_dpp v14, v30, v77 row_newbcast:12
  v_dot2c_f32_bf16_dpp v15, v31, v77 row_newbcast:12
  v_dot2c_f32_bf16_dpp v16, v30, v78 row_newbcast:12
  v_dot2c_f32_bf16_dpp v17, v31, v78 row_newbcast:12
  v_dot2c_f32_bf16_dpp v18, v30, v79 row_newbcast:12
  v_dot2c_f32_bf16_dpp v19, v31, v79 row_newbcast:12
  s_cbranch_vccz L_d915
  s_waitcnt vmcnt(4)
L_d915:
  s_xor_b32 s68, s70, 0x34100
  buffer_load_dwordx4 v[100:103], v63, s[16:19], s68 offen nt
  s_barrier
  v_cvt_pk_bf16_f32 v30, v229, 0
  v_cvt_pk_bf16_f32 v31, 0, v229
  s_waitcnt vmcnt(5)
  v_dot2c_f32_bf16_dpp v12, v30, v80 row_newbcast:0
  v_dot2c_f32_bf16_dpp v13, v31, v80 row_newbcast:0
  v_dot2c_f32_bf16_dpp v14, v30, v81 row_newbcast:0
  v_dot2c_f32_bf16_dpp v15, v31, v81 row_newbcast:0
  v_dot2c_f32_bf16_dpp v16, v30, v82 row_newbcast:0
  v_dot2c_f32_bf16_dpp v17, v31, v82 row_newbcast:0
  v_dot2c_f32_bf16_dpp v18, v30, v83 row_newbcast:0
  v_dot2c_f32_bf16_dpp v19, v31, v83 row_newbcast:0
  s_cbranch_vccz L_d916
  s_waitcnt vmcnt(4)
L_d916:
  s_xor_b32 s68, s70, 0x34400
  buffer_load_dwordx4 v[104:107], v63, s[16:19], s68 offen nt
  s_waitcnt vmcnt(5)
  v_dot2c_f32_bf16_dpp v12, v30, v84 row_newbcast:8
  v_dot2c_f32_bf16_dpp v13, v31, v84 row_newbcast:8
  v_dot2c_f32_bf16_dpp v14, v30, v85 row_newbcast:8
  v_dot2c_f32_bf16_dpp v15, v31, v85 row_newbcast:8
  v_dot2c_f32_bf16_dpp v16, v30, v86 row_newbcast:8
  v_dot2c_f32_bf16_dpp v17, v31, v86 row_newbcast:8
  v_dot2c_f32_bf16_dpp v18, v30, v87 row_newbcast:8
  v_dot2c_f32_bf16_dpp v19, v31, v87 row_newbcast:8
  s_cbranch_vccz L_d917
  s_waitcnt vmcnt(4)
L_d917:
  s_xor_b32 s68, s70, 0x34500
  buffer_load_dwordx4 v[108:111], v63, s[16:19], s68 offen nt
  s_waitcnt vmcnt(5)
  v_dot2c_f32_bf16_dpp v12, v30, v88 row_newbcast:4
  v_dot2c_f32_bf16_dpp v13, v31, v88 row_newbcast:4
  v_dot2c_f32_bf16_dpp v14, v30, v89 row_newbcast:4
  v_dot2c_f32_bf16_dpp v15, v31, v89 row_newbcast:4
  v_dot2c_f32_bf16_dpp v16, v30, v90 row_newbcast:4
  v_dot2c_f32_bf16_dpp v17, v31, v90 row_newbcast:4
  v_dot2c_f32_bf16_dpp v18, v30, v91 row_newbcast:4
  v_dot2c_f32_bf16_dpp v19, v31, v91 row_newbcast:4
  s_cbranch_vccz L_d918
  s_waitcnt vmcnt(4)
L_d918:
  s_xor_b32 s68, s70, 0x34800
  buffer_load_dwordx4 v[112:115], v63, s[16:19], s68 offen nt
  s_waitcnt vmcnt(5)
  v_dot2c_f32_bf16_dpp v12, v30, v92 row_newbcast:12
  v_dot2c_f32_bf16_dpp v13, v31, v92 row_newbcast:12
  v_dot2c_f32_bf16_dpp v14, v30, v93 row_newbcast:12
  v_dot2c_f32_bf16_dpp v15, v31, v93 row_newbcast:12
  v_dot2c_f32_bf16_dpp v16, v30, v94 row_newbcast:12
  v_dot2c_f32_bf16_dpp v17, v31, v94 row_newbcast:12
  v_dot2c_f32_bf16_dpp v18, v30, v95 row_newbcast:12
  v_dot2c_f32_bf16_dpp v19, v31, v95 row_newbcast:12
  s_cbranch_vccz L_d919
  s_waitcnt vmcnt(4)
L_d919:
  s_xor_b32 s68, s70, 0x34900
  buffer_load_dwordx4 v[116:119], v63, s[16:19], s68 offen nt
  s_barrier
  v_cvt_pk_bf16_f32 v30, v230, 0
  v_cvt_pk_bf16_f32 v31, 0, v230
  s_waitcnt vmcnt(5)
  v_dot2c_f32_bf16_dpp v12, v30, v96 row_newbcast:0
  v_dot2c_f32_bf16_dpp v13, v31, v96 row_newbcast:0
  v_dot2c_f32_bf16_dpp v14, v30, v97 row_newbcast:0
  v_dot2c_f32_bf16_dpp v15, v31, v97 row_newbcast:0
  v_dot2c_f32_bf16_dpp v16, v30, v98 row_newbcast:0
  v_dot2c_f32_bf16_dpp v17, v31, v98 row_newbcast:0
  v_dot2c_f32_bf16_dpp v18, v30, v99 row_newbcast:0
  v_dot2c_f32_bf16_dpp v19, v31, v99 row_newbcast:0
  s_cbranch_vccz L_d920
  s_waitcnt vmcnt(4)
L_d920:
  s_xor_b32 s68, s70, 0x34c00
  buffer_load_dwordx4 v[120:123], v63, s[16:19], s68 offen nt
  s_cmp_eq_u32 s64, 3
  s_cbranch_scc0 L_wp230
  s_mov_b32 s100, 19
  s_atomic_umax s100, s[20:21], s88
  s_and_b32 s60, s88, 0xfffffc7f
  s_xor_b32 s61, s60, 1024
  s_add_u32 s38, s61, 0
  s_load_dword s40, s[20:21], s38 glc
  s_add_u32 s38, s60, 128
  s_load_dword s41, s[20:21], s38 glc
  s_add_u32 s38, s60, 256
  s_load_dword s42, s[20:21], s38 glc
  s_add_u32 s38, s61, 384
  s_load_dword s43, s[20:21], s38 glc
  s_add_u32 s38, s61, 512
  s_load_dword s44, s[20:21], s38 glc
  s_add_u32 s38, s60, 640
  s_load_dword s45, s[20:21], s38 glc
  s_add_u32 s38, s60, 768
  s_load_dword s46, s[20:21], s38 glc
  s_add_u32 s38, s61, 896
  s_load_dword s47, s[20:21], s38 glc
L_wp230:
  s_waitcnt vmcnt(5)
  v_dot2c_f32_bf16_dpp v12, v30, v100 row_newbcast:8
  v_dot2c_f32_bf16_dpp v13, v31, v100 row_newbcast:8
  v_dot2c_f32_bf16_dpp v14, v30, v101 row_newbcast:8
  v_dot2c_f32_bf16_dpp v15, v31, v101 row_newbcast:8
  v_dot2c_f32_bf16_dpp v16, v30, v102 row_newbcast:8
  v_dot2c_f32_bf16_dpp v17, v31, v102 row_newbcast:8
  v_dot2c_f32_bf16_dpp v18, v30, v103 row_newbcast:8
  v_dot2c_f32_bf16_dpp v19, v31, v103 row_newbcast:8
  s_cbranch_vccz L_d921
  s_waitcnt vmcnt(4)
L_d921:
  s_xor_b32 s68, s70, 0x34d00
  buffer_load_dwordx4 v[124:127], v63, s[16:19], s68 offen nt
  s_waitcnt vmcnt(5)
  v_dot2c_f32_bf16_dpp v12, v30, v104 row_newbcast:4
  v_dot2c_f32_bf16_dpp v13, v31, v104 row_newbcast:4
  v_dot2c_f32_bf16_dpp v14, v30, v105 row_newbcast:4
  v_dot2c_f32_bf16_dpp v15, v31, v105 row_newbcast:4
  v_dot2c_f32_bf16_dpp v16, v30, v106 row_newbcast:4
  v_dot2c_f32_bf16_dpp v17, v31, v106 row_newbcast:4
  v_dot2c_f32_bf16_dpp v18, v30, v107 row_newbcast:4
  v_dot2c_f32_bf16_dpp v19, v31, v107 row_newbcast:4
  s_cbranch_vccz L_d922
  s_waitcnt vmcnt(4)
L_d922:
  s_xor_b32 s68, s70, 0x84000
  buffer_load_dwordx4 v[64:67], v63, s[16:19], s68 offen nt
  s_waitcnt vmcnt(5)
  v_dot2c_f32_bf16_dpp v12, v30, v108 row_newbcast:12
  v_dot2c_f32_bf16_dpp v13, v31, v108 row_newbcast:12
  v_dot2c_f32_bf16_dpp v14, v30, v109 row_newbcast:12
  v_dot2c_f32_bf16_dpp v15, v31, v109 row_newbcast:12
  v_dot2c_f32_bf16_dpp v16, v30, v110 row_newbcast:12
  v_dot2c_f32_bf16_dpp v17, v31, v110 row_newbcast:12
  v_dot2c_f32_bf16_dpp v18, v30, v111 row_newbcast:12
  v_dot2c_f32_bf16_dpp v19, v31, v111 row_newbcast:12
  s_cbranch_vccz L_d923
  s_waitcnt vmcnt(4)
L_d923:
  s_xor_b32 s68, s70, 0x84100
  buffer_load_dwordx4 v[68:71], v63, s[16:19], s68 offen nt
  s_barrier
  v_cvt_pk_bf16_f32 v30, v231, 0
  v_cvt_pk_bf16_f32 v31, 0, v231
  s_waitcnt vmcnt(5)
  v_dot2c_f32_bf16_dpp v12, v30, v112 row_newbcast:0
  v_dot2c_f32_bf16_dpp v13, v31, v112 row_newbcast:0
  v_dot2c_f32_bf16_dpp v14, v30, v113 row_newbcast:0
  v_dot2c_f32_bf16_dpp v15, v31, v113 row_newbcast:0
  v_dot2c_f32_bf16_dpp v16, v30, v114 row_newbcast:0
  v_dot2c_f32_bf16_dpp v17, v31, v114 row_newbcast:0
  v_dot2c_f32_bf16_dpp v18, v30, v115 row_newbcast:0
  v_dot2c_f32_bf16_dpp v19, v31, v115 row_newbcast:0
  s_cbranch_vccz L_d924
  s_waitcnt vmcnt(4)
L_d924:
  s_xor_b32 s68, s70, 0x84400
  buffer_load_dwordx4 v[72:75], v63, s[16:19], s68 offen nt
  s_waitcnt vmcnt(5)
  v_dot2c_f32_bf16_dpp v12, v30, v116 row_newbcast:8
  v_dot2c_f32_bf16_dpp v13, v31, v116 row_newbcast:8
  v_dot2c_f32_bf16_dpp v14, v30, v117 row_newbcast:8
  v_dot2c_f32_bf16_dpp v15, v31, v117 row_newbcast:8
  v_dot2c_f32_bf16_dpp v16, v30, v118 row_newbcast:8
  v_dot2c_f32_bf16_dpp v17, v31, v118 row_newbcast:8
  v_dot2c_f32_bf16_dpp v18, v30, v119 row_newbcast:8
  v_dot2c_f32_bf16_dpp v19, v31, v119 row_newbcast:8
  s_cbranch_vccz L_d925
  s_waitcnt vmcnt(4)
L_d925:
  s_xor_b32 s68, s70, 0x84500
  buffer_load_dwordx4 v[76:79], v63, s[16:19], s68 offen nt
  s_waitcnt vmcnt(5)
  v_dot2c_f32_bf16_dpp v12, v30, v120 row_newbcast:4
  v_dot2c_f32_bf16_dpp v13, v31, v120 row_newbcast:4
  v_dot2c_f32_bf16_dpp v14, v30, v121 row_newbcast:4
  v_dot2c_f32_bf16_dpp v15, v31, v121 row_newbcast:4
  v_dot2c_f32_bf16_dpp v16, v30, v122 row_newbcast:4
  v_dot2c_f32_bf16_dpp v17, v31, v122 row_newbcast:4
  v_dot2c_f32_bf16_dpp v18, v30, v123 row_newbcast:4
  v_dot2c_f32_bf16_dpp v19, v31, v123 row_newbcast:4
  s_cbranch_vccz L_d926
  s_waitcnt vmcnt(4)
L_d926:
  s_xor_b32 s68, s70, 0x84800
  buffer_load_dwordx4 v[80:83], v63, s[16:19], s68 offen nt
  s_waitcnt vmcnt(5)
  v_dot2c_f32_bf16_dpp v12, v30, v124 row_newbcast:12
  v_dot2c_f32_bf16_dpp v13, v31, v124 row_newbcast:12
  v_dot2c_f32_bf16_dpp v14, v30, v125 row_newbcast:12
  v_dot2c_f32_bf16_dpp v15, v31, v125 row_newbcast:12
  v_dot2c_f32_bf16_dpp v16, v30, v126 row_newbcast:12
  v_dot2c_f32_bf16_dpp v17, v31, v126 row_newbcast:12
  v_dot2c_f32_bf16_dpp v18, v30, v127 row_newbcast:12
  v_dot2c_f32_bf16_dpp v19, v31, v127 row_newbcast:12
  s_cbranch_vccz L_d927
  s_waitcnt vmcnt(4)
L_d927:
  s_xor_b32 s68, s70, 0x84900
  buffer_load_dwordx4 v[84:87], v63, s[16:19], s68 offen nt
  s_barrier
  v_cvt_pk_bf16_f32 v30, v232, 0
  v_cvt_pk_bf16_f32 v31, 0, v232
  s_waitcnt vmcnt(5)
  v_dot2c_f32_bf16_dpp v12, v30, v64 row_newbcast:0
  v_dot2c_f32_bf16_dpp v13, v31, v64 row_newbcast:0
  v_dot2c_f32_bf16_dpp v14, v30, v65 row_newbcast:0
  v_dot2c_f32_bf16_dpp v15, v31, v65 row_newbcast:0
  v_dot2c_f32_bf16_dpp v16, v30, v66 row_newbcast:0
  v_dot2c_f32_bf16_dpp v17, v31, v66 row_newbcast:0
  v_dot2c_f32_bf16_dpp v18, v30, v67 row_newbcast:0
  v_dot2c_f32_bf16_dpp v19, v31, v67 row_newbcast:0
  s_cbranch_vccz L_d928
  s_waitcnt vmcnt(4)
L_d928:
  s_xor_b32 s68, s70, 0x84c00
  buffer_load_dwordx4 v[88:91], v63, s[16:19], s68 offen nt
  s_cmp_eq_u32 s64, 3
  s_cbranch_scc0 L_wp232
  s_mov_b32 s101, 0
  s_waitcnt lgkmcnt(0)
  s_cmp_ge_u32 s40, 19
  s_addc_u32 s101, s101, 0
  s_cmp_ge_u32 s41, 19
  s_addc_u32 s101, s101, 0
  s_cmp_ge_u32 s42, 19
  s_addc_u32 s101, s101, 0
  s_cmp_ge_u32 s43, 19
  s_addc_u32 s101, s101, 0
  s_cmp_ge_u32 s44, 19
  s_addc_u32 s101, s101, 0
  s_cmp_ge_u32 s45, 19
  s_addc_u32 s101, s101, 0
  s_cmp_ge_u32 s46, 19
  s_addc_u32 s101, s101, 0
  s_cmp_ge_u32 s47, 19
  s_addc_u32 s101, s101, 0
  s_cmp_lt_u32 s101, 6
  s_cselect_b32 s38, -1, 0
  v_mov_b32 v26, 0
  v_mov_b32 v27, s38
  ds_write_b32 v26, v27 offset:8512
L_wp232:
  s_waitcnt vmcnt(5)
  v_dot2c_f32_bf16_dpp v12, v30, v68 row_newbcast:8
  v_dot2c_f32_bf16_dpp v13, v31, v68 row_newbcast:8
  v_dot2c_f32_bf16_dpp v14, v30, v69 row_newbcast:8
  v_dot2c_f32_bf16_dpp v15, v31, v69 row_newbcast:8
  v_dot2c_f32_bf16_dpp v16, v30, v70 row_newbcast:8
  v_dot2c_f32_bf16_dpp v17, v31, v70 row_newbcast:8
  v_dot2c_f32_bf16_dpp v18, v30, v71 row_newbcast:8
  v_dot2c_f32_bf16_dpp v19, v31, v71 row_newbcast:8
  s_cbranch_vccz L_d929
  s_waitcnt vmcnt(4)
L_d929:
  s_xor_b32 s68, s70, 0x84d00
  buffer_load_dwordx4 v[92:95], v63, s[16:19], s68 offen nt
  s_waitcnt vmcnt(5)
  v_dot2c_f32_bf16_dpp v12, v30, v72 row_newbcast:4
  v_dot2c_f32_bf16_dpp v13, v31, v72 row_newbcast:4
  v_dot2c_f32_bf16_dpp v14, v30, v73 row_newbcast:4
  v_dot2c_f32_bf16_dpp v15, v31, v73 row_newbcast:4
  v_dot2c_f32_bf16_dpp v16, v30, v74 row_newbcast:4
  v_dot2c_f32_bf16_dpp v17, v31, v74 row_newbcast:4
  v_dot2c_f32_bf16_dpp v18, v30, v75 row_newbcast:4
  v_dot2c_f32_bf16_dpp v19, v31, v75 row_newbcast:4
  s_cbranch_vccz L_d930
  s_waitcnt vmcnt(4)
L_d930:
  s_xor_b32 s68, s70, 0x94000
  buffer_load_dwordx4 v[96:99], v63, s[16:19], s68 offen nt
  s_waitcnt vmcnt(5)
  v_dot2c_f32_bf16_dpp v12, v30, v76 row_newbcast:12
  v_dot2c_f32_bf16_dpp v13, v31, v76 row_newbcast:12
  v_dot2c_f32_bf16_dpp v14, v30, v77 row_newbcast:12
  v_dot2c_f32_bf16_dpp v15, v31, v77 row_newbcast:12
  v_dot2c_f32_bf16_dpp v16, v30, v78 row_newbcast:12
  v_dot2c_f32_bf16_dpp v17, v31, v78 row_newbcast:12
  v_dot2c_f32_bf16_dpp v18, v30, v79 row_newbcast:12
  v_dot2c_f32_bf16_dpp v19, v31, v79 row_newbcast:12
  s_cbranch_vccz L_d931
  s_waitcnt vmcnt(4)
L_d931:
  s_xor_b32 s68, s70, 0x94100
  buffer_load_dwordx4 v[100:103], v63, s[16:19], s68 offen nt
  s_barrier
  v_cvt_pk_bf16_f32 v30, v233, 0
  v_cvt_pk_bf16_f32 v31, 0, v233
  s_waitcnt vmcnt(5)
  v_dot2c_f32_bf16_dpp v12, v30, v80 row_newbcast:0
  v_dot2c_f32_bf16_dpp v13, v31, v80 row_newbcast:0
  v_dot2c_f32_bf16_dpp v14, v30, v81 row_newbcast:0
  v_dot2c_f32_bf16_dpp v15, v31, v81 row_newbcast:0
  v_dot2c_f32_bf16_dpp v16, v30, v82 row_newbcast:0
  v_dot2c_f32_bf16_dpp v17, v31, v82 row_newbcast:0
  v_dot2c_f32_bf16_dpp v18, v30, v83 row_newbcast:0
  v_dot2c_f32_bf16_dpp v19, v31, v83 row_newbcast:0
  s_cbranch_vccz L_d932
  s_waitcnt vmcnt(4)
L_d932:
  s_xor_b32 s68, s70, 0x94400
  buffer_load_dwordx4 v[104:107], v63, s[16:19], s68 offen nt
  v_mov_b32 v26, 0
  ds_read_b32 v35, v26 offset:8512
  s_waitcnt vmcnt(5)
  v_dot2c_f32_bf16_dpp v12, v30, v84 row_newbcast:8
  v_dot2c_f32_bf16_dpp v13, v31, v84 row_newbcast:8
  v_dot2c_f32_bf16_dpp v14, v30, v85 row_newbcast:8
  v_dot2c_f32_bf16_dpp v15, v31, v85 row_newbcast:8
  v_dot2c_f32_bf16_dpp v16, v30, v86 row_newbcast:8
  v_dot2c_f32_bf16_dpp v17, v31, v86 row_newbcast:8
  v_dot2c_f32_bf16_dpp v18, v30, v87 row_newbcast:8
  v_dot2c_f32_bf16_dpp v19, v31, v87 row_newbcast:8
  s_cbranch_vccz L_d933
  s_waitcnt vmcnt(4)
L_d933:
  s_xor_b32 s68, s70, 0x94500
  buffer_load_dwordx4 v[108:111], v63, s[16:19], s68 offen nt
  s_waitcnt vmcnt(5)
  v_dot2c_f32_bf16_dpp v12, v30, v88 row_newbcast:4
  v_dot2c_f32_bf16_dpp v13, v31, v88 row_newbcast:4
  v_dot2c_f32_bf16_dpp v14, v30, v89 row_newbcast:4
  v_dot2c_f32_bf16_dpp v15, v31, v89 row_newbcast:4
  v_dot2c_f32_bf16_dpp v16, v30, v90 row_newbcast:4
  v_dot2c_f32_bf16_dpp v17, v31, v90 row_newbcast:4
  v_dot2c_f32_bf16_dpp v18, v30, v91 row_newbcast:4
  v_dot2c_f32_bf16_dpp v19, v31, v91 row_newbcast:4
  s_cbranch_vccz L_d934
  s_waitcnt vmcnt(4)
L_d934:
  s_xor_b32 s68, s70, 0x94800
  buffer_load_dwordx4 v[112:115], v63, s[16:19], s68 offen nt
  s_waitcnt vmcnt(5)
  v_dot2c_f32_bf16_dpp v12, v30, v92 row_newbcast:12
  v_dot2c_f32_bf16_dpp v13, v31, v92 row_newbcast:12
  v_dot2c_f32_bf16_dpp v14, v30, v93 row_newbcast:12
  v_dot2c_f32_bf16_dpp v15, v31, v93 row_newbcast:12
  v_dot2c_f32_bf16_dpp v16, v30, v94 row_newbcast:12
  v_dot2c_f32_bf16_dpp v17, v31, v94 row_newbcast:12
  v_dot2c_f32_bf16_dpp v18, v30, v95 row_newbcast:12
  v_dot2c_f32_bf16_dpp v19, v31, v95 row_newbcast:12
  s_cbranch_vccz L_d935
  s_waitcnt vmcnt(4)
L_d935:
  s_xor_b32 s68, s70, 0x94900
  buffer_load_dwordx4 v[116:119], v63, s[16:19], s68 offen nt
  s_barrier
  v_cvt_pk_bf16_f32 v30, v234, 0
  v_cvt_pk_bf16_f32 v31, 0, v234
  s_waitcnt vmcnt(5)
  v_dot2c_f32_bf16_dpp v12, v30, v96 row_newbcast:0
  v_dot2c_f32_bf16_dpp v13, v31, v96 row_newbcast:0
  v_dot2c_f32_bf16_dpp v14, v30, v97 row_newbcast:0
  v_dot2c_f32_bf16_dpp v15, v31, v97 row_newbcast:0
  v_dot2c_f32_bf16_dpp v16, v30, v98 row_newbcast:0
  v_dot2c_f32_bf16_dpp v17, v31, v98 row_newbcast:0
  v_dot2c_f32_bf16_dpp v18, v30, v99 row_newbcast:0
  v_dot2c_f32_bf16_dpp v19, v31, v99 row_newbcast:0
  s_cbranch_vccz L_d936
  s_waitcnt vmcnt(4)
L_d936:
  s_xor_b32 s68, s70, 0x94c00
  buffer_load_dwordx4 v[120:123], v63, s[16:19], s68 offen nt
  s_waitcnt lgkmcnt(0)
  v_cmp_ne_u32 vcc, 0, v35
  s_waitcnt vmcnt(5)
  v_dot2c_f32_bf16_dpp v12, v30, v100 row_newbcast:8
  v_dot2c_f32_bf16_dpp v13, v31, v100 row_newbcast:8
  v_dot2c_f32_bf16_dpp v14, v30, v101 row_newbcast:8
  v_dot2c_f32_bf16_dpp v15, v31, v101 row_newbcast:8
  v_dot2c_f32_bf16_dpp v16, v30, v102 row_newbcast:8
  v_dot2c_f32_bf16_dpp v17, v31, v102 row_newbcast:8
  v_dot2c_f32_bf16_dpp v18, v30, v103 row_newbcast:8
  v_dot2c_f32_bf16_dpp v19, v31, v103 row_newbcast:8
  s_cbranch_vccz L_d937
  s_waitcnt vmcnt(4)
L_d937:
  s_xor_b32 s68, s70, 0x94d00
  buffer_load_dwordx4 v[124:127], v63, s[16:19], s68 offen nt
  s_waitcnt vmcnt(5)
  v_dot2c_f32_bf16_dpp v12, v30, v104 row_newbcast:4
  v_dot2c_f32_bf16_dpp v13, v31, v104 row_newbcast:4
  v_dot2c_f32_bf16_dpp v14, v30, v105 row_newbcast:4
  v_dot2c_f32_bf16_dpp v15, v31, v105 row_newbcast:4
  v_dot2c_f32_bf16_dpp v16, v30, v106 row_newbcast:4
  v_dot2c_f32_bf16_dpp v17, v31, v106 row_newbcast:4
  v_dot2c_f32_bf16_dpp v18, v30, v107 row_newbcast:4
  v_dot2c_f32_bf16_dpp v19, v31, v107 row_newbcast:4
  s_cbranch_vccz L_d938
  s_waitcnt vmcnt(4)
L_d938:
  s_xor_b32 s68, s70, 0xa4000
  buffer_load_dwordx4 v[64:67], v63, s[16:19], s68 offen nt
  s_waitcnt vmcnt(5)
  v_dot2c_f32_bf16_dpp v12, v30, v108 row_newbcast:12
  v_dot2c_f32_bf16_dpp v13, v31, v108 row_newbcast:12
  v_dot2c_f32_bf16_dpp v14, v30, v109 row_newbcast:12
  v_dot2c_f32_bf16_dpp v15, v31, v109 row_newbcast:12
  v_dot2c_f32_bf16_dpp v16, v30, v110 row_newbcast:12
  v_dot2c_f32_bf16_dpp v17, v31, v110 row_newbcast:12
  v_dot2c_f32_bf16_dpp v18, v30, v111 row_newbcast:12
  v_dot2c_f32_bf16_dpp v19, v31, v111 row_newbcast:12
  s_cbranch_vccz L_d939
  s_waitcnt vmcnt(4)
L_d939:
  s_xor_b32 s68, s70, 0xa4100
  buffer_load_dwordx4 v[68:71], v63, s[16:19], s68 offen nt
  s_barrier
  v_cvt_pk_bf16_f32 v30, v235, 0
  v_cvt_pk_bf16_f32 v31, 0, v235
  s_waitcnt vmcnt(5)
  v_dot2c_f32_bf16_dpp v12, v30, v112 row_newbcast:0
  v_dot2c_f32_bf16_dpp v13, v31, v112 row_newbcast:0
  v_dot2c_f32_bf16_dpp v14, v30, v113 row_newbcast:0
  v_dot2c_f32_bf16_dpp v15, v31, v113 row_newbcast:0
  v_dot2c_f32_bf16_dpp v16, v30, v114 row_newbcast:0
  v_dot2c_f32_bf16_dpp v17, v31, v114 row_newbcast:0
  v_dot2c_f32_bf16_dpp v18, v30, v115 row_newbcast:0
  v_dot2c_f32_bf16_dpp v19, v31, v115 row_newbcast:0
  s_cbranch_vccz L_d940
  s_waitcnt vmcnt(4)
L_d940:
  s_xor_b32 s68, s70, 0xa4400
  buffer_load_dwordx4 v[72:75], v63, s[16:19], s68 offen nt
  s_waitcnt vmcnt(5)
  v_dot2c_f32_bf16_dpp v12, v30, v116 row_newbcast:8
  v_dot2c_f32_bf16_dpp v13, v31, v116 row_newbcast:8
  v_dot2c_f32_bf16_dpp v14, v30, v117 row_newbcast:8
  v_dot2c_f32_bf16_dpp v15, v31, v117 row_newbcast:8
  v_dot2c_f32_bf16_dpp v16, v30, v118 row_newbcast:8
  v_dot2c_f32_bf16_dpp v17, v31, v118 row_newbcast:8
  v_dot2c_f32_bf16_dpp v18, v30, v119 row_newbcast:8
  v_dot2c_f32_bf16_dpp v19, v31, v119 row_newbcast:8
  s_cbranch_vccz L_d941
  s_waitcnt vmcnt(4)
L_d941:
  s_xor_b32 s68, s70, 0xa4500
  buffer_load_dwordx4 v[76:79], v63, s[16:19], s68 offen nt
  s_waitcnt vmcnt(5)
  v_dot2c_f32_bf16_dpp v12, v30, v120 row_newbcast:4
  v_dot2c_f32_bf16_dpp v13, v31, v120 row_newbcast:4
  v_dot2c_f32_bf16_dpp v14, v30, v121 row_newbcast:4
  v_dot2c_f32_bf16_dpp v15, v31, v121 row_newbcast:4
  v_dot2c_f32_bf16_dpp v16, v30, v122 row_newbcast:4
  v_dot2c_f32_bf16_dpp v17, v31, v122 row_newbcast:4
  v_dot2c_f32_bf16_dpp v18, v30, v123 row_newbcast:4
  v_dot2c_f32_bf16_dpp v19, v31, v123 row_newbcast:4
  s_cbranch_vccz L_d942
  s_waitcnt vmcnt(4)
L_d942:
  s_xor_b32 s68, s70, 0xa4800
  buffer_load_dwordx4 v[80:83], v63, s[16:19], s68 offen nt
  s_waitcnt vmcnt(5)
  v_dot2c_f32_bf16_dpp v12, v30, v124 row_newbcast:12
  v_dot2c_f32_bf16_dpp v13, v31, v124 row_newbcast:12
  v_dot2c_f32_bf16_dpp v14, v30, v125 row_newbcast:12
  v_dot2c_f32_bf16_dpp v15, v31, v125 row_newbcast:12
  v_dot2c_f32_bf16_dpp v16, v30, v126 row_newbcast:12
  v_dot2c_f32_bf16_dpp v17, v31, v126 row_newbcast:12
  v_dot2c_f32_bf16_dpp v18, v30, v127 row_newbcast:12
  v_dot2c_f32_bf16_dpp v19, v31, v127 row_newbcast:12
  s_cbranch_vccz L_d943
  s_waitcnt vmcnt(4)
L_d943:
  s_xor_b32 s68, s70, 0xa4900
  buffer_load_dwordx4 v[84:87], v63, s[16:19], s68 offen nt
  s_barrier
  v_cvt_pk_bf16_f32 v30, v236, 0
  v_cvt_pk_bf16_f32 v31, 0, v236
  s_waitcnt vmcnt(5)
  v_dot2c_f32_bf16_dpp v12, v30, v64 row_newbcast:0
  v_dot2c_f32_bf16_dpp v13, v31, v64 row_newbcast:0
  v_dot2c_f32_bf16_dpp v14, v30, v65 row_newbcast:0
  v_dot2c_f32_bf16_dpp v15, v31, v65 row_newbcast:0
  v_dot2c_f32_bf16_dpp v16, v30, v66 row_newbcast:0
  v_dot2c_f32_bf16_dpp v17, v31, v66 row_newbcast:0
  v_dot2c_f32_bf16_dpp v18, v30, v67 row_newbcast:0
  v_dot2c_f32_bf16_dpp v19, v31, v67 row_newbcast:0
  s_cbranch_vccz L_d944
  s_waitcnt vmcnt(4)
L_d944:
  s_xor_b32 s68, s70, 0xa4c00
  buffer_load_dwordx4 v[88:91], v63, s[16:19], s68 offen nt
  s_waitcnt vmcnt(5)
  v_dot2c_f32_bf16_dpp v12, v30, v68 row_newbcast:8
  v_dot2c_f32_bf16_dpp v13, v31, v68 row_newbcast:8
  v_dot2c_f32_bf16_dpp v14, v30, v69 row_newbcast:8
  v_dot2c_f32_bf16_dpp v15, v31, v69 row_newbcast:8
  v_dot2c_f32_bf16_dpp v16, v30, v70 row_newbcast:8
  v_dot2c_f32_bf16_dpp v17, v31, v70 row_newbcast:8
  v_dot2c_f32_bf16_dpp v18, v30, v71 row_newbcast:8
  v_dot2c_f32_bf16_dpp v19, v31, v71 row_newbcast:8
  s_cbranch_vccz L_d945
  s_waitcnt vmcnt(4)
L_d945:
  s_xor_b32 s68, s70, 0xa4d00
  buffer_load_dwordx4 v[92:95], v63, s[16:19], s68 offen nt
  s_waitcnt vmcnt(5)
  v_dot2c_f32_bf16_dpp v12, v30, v72 row_newbcast:4
  v_dot2c_f32_bf16_dpp v13, v31, v72 row_newbcast:4
  v_dot2c_f32_bf16_dpp v14, v30, v73 row_newbcast:4
  v_dot2c_f32_bf16_dpp v15, v31, v73 row_newbcast:4
  v_dot2c_f32_bf16_dpp v16, v30, v74 row_newbcast:4
  v_dot2c_f32_bf16_dpp v17, v31, v74 row_newbcast:4
  v_dot2c_f32_bf16_dpp v18, v30, v75 row_newbcast:4
  v_dot2c_f32_bf16_dpp v19, v31, v75 row_newbcast:4
  s_cbranch_vccz L_d946
  s_waitcnt vmcnt(4)
L_d946:
  s_xor_b32 s68, s70, 0xb4000
  buffer_load_dwordx4 v[96:99], v63, s[16:19], s68 offen nt
  s_waitcnt vmcnt(5)
  v_dot2c_f32_bf16_dpp v12, v30, v76 row_newbcast:12
  v_dot2c_f32_bf16_dpp v13, v31, v76 row_newbcast:12
  v_dot2c_f32_bf16_dpp v14, v30, v77 row_newbcast:12
  v_dot2c_f32_bf16_dpp v15, v31, v77 row_newbcast:12
  v_dot2c_f32_bf16_dpp v16, v30, v78 row_newbcast:12
  v_dot2c_f32_bf16_dpp v17, v31, v78 row_newbcast:12
  v_dot2c_f32_bf16_dpp v18, v30, v79 row_newbcast:12
  v_dot2c_f32_bf16_dpp v19, v31, v79 row_newbcast:12
  s_cbranch_vccz L_d947
  s_waitcnt vmcnt(4)
L_d947:
  s_xor_b32 s68, s70, 0xb4100
  buffer_load_dwordx4 v[100:103], v63, s[16:19], s68 offen nt
  s_barrier
  v_cvt_pk_bf16_f32 v30, v237, 0
  v_cvt_pk_bf16_f32 v31, 0, v237
  s_waitcnt vmcnt(5)
  v_dot2c_f32_bf16_dpp v12, v30, v80 row_newbcast:0
  v_dot2c_f32_bf16_dpp v13, v31, v80 row_newbcast:0
  v_dot2c_f32_bf16_dpp v14, v30, v81 row_newbcast:0
  v_dot2c_f32_bf16_dpp v15, v31, v81 row_newbcast:0
  v_dot2c_f32_bf16_dpp v16, v30, v82 row_newbcast:0
  v_dot2c_f32_bf16_dpp v17, v31, v82 row_newbcast:0
  v_dot2c_f32_bf16_dpp v18, v30, v83 row_newbcast:0
  v_dot2c_f32_bf16_dpp v19, v31, v83 row_newbcast:0
  s_cbranch_vccz L_d948
  s_waitcnt vmcnt(4)
L_d948:
  s_xor_b32 s68, s70, 0xb4400
  buffer_load_dwordx4 v[104:107], v63, s[16:19], s68 offen nt
  s_waitcnt vmcnt(5)
  v_dot2c_f32_bf16_dpp v12, v30, v84 row_newbcast:8
  v_dot2c_f32_bf16_dpp v13, v31, v84 row_newbcast:8
  v_dot2c_f32_bf16_dpp v14, v30, v85 row_newbcast:8
  v_dot2c_f32_bf16_dpp v15, v31, v85 row_newbcast:8
  v_dot2c_f32_bf16_dpp v16, v30, v86 row_newbcast:8
  v_dot2c_f32_bf16_dpp v17, v31, v86 row_newbcast:8
  v_dot2c_f32_bf16_dpp v18, v30, v87 row_newbcast:8
  v_dot2c_f32_bf16_dpp v19, v31, v87 row_newbcast:8
  s_cbranch_vccz L_d949
  s_waitcnt vmcnt(4)
L_d949:
  s_xor_b32 s68, s70, 0xb4500
  buffer_load_dwordx4 v[108:111], v63, s[16:19], s68 offen nt
  s_waitcnt vmcnt(5)
  v_dot2c_f32_bf16_dpp v12, v30, v88 row_newbcast:4
  v_dot2c_f32_bf16_dpp v13, v31, v88 row_newbcast:4
  v_dot2c_f32_bf16_dpp v14, v30, v89 row_newbcast:4
  v_dot2c_f32_bf16_dpp v15, v31, v89 row_newbcast:4
  v_dot2c_f32_bf16_dpp v16, v30, v90 row_newbcast:4
  v_dot2c_f32_bf16_dpp v17, v31, v90 row_newbcast:4
  v_dot2c_f32_bf16_dpp v18, v30, v91 row_newbcast:4
  v_dot2c_f32_bf16_dpp v19, v31, v91 row_newbcast:4
  s_cbranch_vccz L_d950
  s_waitcnt vmcnt(4)
L_d950:
  s_xor_b32 s68, s70, 0xb4800
  buffer_load_dwordx4 v[112:115], v63, s[16:19], s68 offen nt
  s_waitcnt vmcnt(5)
  v_dot2c_f32_bf16_dpp v12, v30, v92 row_newbcast:12
  v_dot2c_f32_bf16_dpp v13, v31, v92 row_newbcast:12
  v_dot2c_f32_bf16_dpp v14, v30, v93 row_newbcast:12
  v_dot2c_f32_bf16_dpp v15, v31, v93 row_newbcast:12
  v_dot2c_f32_bf16_dpp v16, v30, v94 row_newbcast:12
  v_dot2c_f32_bf16_dpp v17, v31, v94 row_newbcast:12
  v_dot2c_f32_bf16_dpp v18, v30, v95 row_newbcast:12
  v_dot2c_f32_bf16_dpp v19, v31, v95 row_newbcast:12
  s_cbranch_vccz L_d951
  s_waitcnt vmcnt(4)
L_d951:
  s_xor_b32 s68, s70, 0xb4900
  buffer_load_dwordx4 v[116:119], v63, s[16:19], s68 offen nt
  s_barrier
  v_cvt_pk_bf16_f32 v30, v238, 0
  v_cvt_pk_bf16_f32 v31, 0, v238
  s_waitcnt vmcnt(5)
  v_dot2c_f32_bf16_dpp v12, v30, v96 row_newbcast:0
  v_dot2c_f32_bf16_dpp v13, v31, v96 row_newbcast:0
  v_dot2c_f32_bf16_dpp v14, v30, v97 row_newbcast:0
  v_dot2c_f32_bf16_dpp v15, v31, v97 row_newbcast:0
  v_dot2c_f32_bf16_dpp v16, v30, v98 row_newbcast:0
  v_dot2c_f32_bf16_dpp v17, v31, v98 row_newbcast:0
  v_dot2c_f32_bf16_dpp v18, v30, v99 row_newbcast:0
  v_dot2c_f32_bf16_dpp v19, v31, v99 row_newbcast:0
  s_cbranch_vccz L_d952
  s_waitcnt vmcnt(4)
L_d952:
  s_xor_b32 s68, s70, 0xb4c00
  buffer_load_dwordx4 v[120:123], v63, s[16:19], s68 offen nt
  s_waitcnt vmcnt(5)
  v_dot2c_f32_bf16_dpp v12, v30, v100 row_newbcast:8
  v_dot2c_f32_bf16_dpp v13, v31, v100 row_newbcast:8
  v_dot2c_f32_bf16_dpp v14, v30, v101 row_newbcast:8
  v_dot2c_f32_bf16_dpp v15, v31, v101 row_newbcast:8
  v_dot2c_f32_bf16_dpp v16, v30, v102 row_newbcast:8
  v_dot2c_f32_bf16_dpp v17, v31, v102 row_newbcast:8
  v_dot2c_f32_bf16_dpp v18, v30, v103 row_newbcast:8
  v_dot2c_f32_bf16_dpp v19, v31, v103 row_newbcast:8
  s_cbranch_vccz L_d953
  s_waitcnt vmcnt(4)
L_d953:
  s_xor_b32 s68, s70, 0xb4d00
  buffer_load_dwordx4 v[124:127], v63, s[16:19], s68 offen nt
  s_waitcnt vmcnt(5)
  v_dot2c_f32_bf16_dpp v12, v30, v104 row_newbcast:4
  v_dot2c_f32_bf16_dpp v13, v31, v104 row_newbcast:4
  v_dot2c_f32_bf16_dpp v14, v30, v105 row_newbcast:4
  v_dot2c_f32_bf16_dpp v15, v31, v105 row_newbcast:4
  v_dot2c_f32_bf16_dpp v16, v30, v106 row_newbcast:4
  v_dot2c_f32_bf16_dpp v17, v31, v106 row_newbcast:4
  v_dot2c_f32_bf16_dpp v18, v30, v107 row_newbcast:4
  v_dot2c_f32_bf16_dpp v19, v31, v107 row_newbcast:4
  s_cbranch_vccz L_d954
  s_waitcnt vmcnt(4)
L_d954:
  s_xor_b32 s68, s70, 0x44000
  buffer_load_dwordx4 v[64:67], v63, s[16:19], s68 offen nt
  s_waitcnt vmcnt(5)
  v_dot2c_f32_bf16_dpp v12, v30, v108 row_newbcast:12
  v_dot2c_f32_bf16_dpp v13, v31, v108 row_newbcast:12
  v_dot2c_f32_bf16_dpp v14, v30, v109 row_newbcast:12
  v_dot2c_f32_bf16_dpp v15, v31, v109 row_newbcast:12
  v_dot2c_f32_bf16_dpp v16, v30, v110 row_newbcast:12
  v_dot2c_f32_bf16_dpp v17, v31, v110 row_newbcast:12
  v_dot2c_f32_bf16_dpp v18, v30, v111 row_newbcast:12
  v_dot2c_f32_bf16_dpp v19, v31, v111 row_newbcast:12
  s_cbranch_vccz L_d955
  s_waitcnt vmcnt(4)
L_d955:
  s_xor_b32 s68, s70, 0x44100
  buffer_load_dwordx4 v[68:71], v63, s[16:19], s68 offen nt
  s_barrier
  v_cvt_pk_bf16_f32 v30, v239, 0
  v_cvt_pk_bf16_f32 v31, 0, v239
  s_waitcnt vmcnt(5)
  v_dot2c_f32_bf16_dpp v12, v30, v112 row_newbcast:0
  v_dot2c_f32_bf16_dpp v13, v31, v112 row_newbcast:0
  v_dot2c_f32_bf16_dpp v14, v30, v113 row_newbcast:0
  v_dot2c_f32_bf16_dpp v15, v31, v113 row_newbcast:0
  v_dot2c_f32_bf16_dpp v16, v30, v114 row_newbcast:0
  v_dot2c_f32_bf16_dpp v17, v31, v114 row_newbcast:0
  v_dot2c_f32_bf16_dpp v18, v30, v115 row_newbcast:0
  v_dot2c_f32_bf16_dpp v19, v31, v115 row_newbcast:0
  s_cbranch_vccz L_d956
  s_waitcnt vmcnt(4)
L_d956:
  s_xor_b32 s68, s70, 0x44400
  buffer_load_dwordx4 v[72:75], v63, s[16:19], s68 offen nt
  s_waitcnt vmcnt(5)
  v_dot2c_f32_bf16_dpp v12, v30, v116 row_newbcast:8
  v_dot2c_f32_bf16_dpp v13, v31, v116 row_newbcast:8
  v_dot2c_f32_bf16_dpp v14, v30, v117 row_newbcast:8
  v_dot2c_f32_bf16_dpp v15, v31, v117 row_newbcast:8
  v_dot2c_f32_bf16_dpp v16, v30, v118 row_newbcast:8
  v_dot2c_f32_bf16_dpp v17, v31, v118 row_newbcast:8
  v_dot2c_f32_bf16_dpp v18, v30, v119 row_newbcast:8
  v_dot2c_f32_bf16_dpp v19, v31, v119 row_newbcast:8
  s_cbranch_vccz L_d957
  s_waitcnt vmcnt(4)
L_d957:
  s_xor_b32 s68, s70, 0x44500
  buffer_load_dwordx4 v[76:79], v63, s[16:19], s68 offen nt
  s_waitcnt vmcnt(5)
  v_dot2c_f32_bf16_dpp v12, v30, v120 row_newbcast:4
  v_dot2c_f32_bf16_dpp v13, v31, v120 row_newbcast:4
  v_dot2c_f32_bf16_dpp v14, v30, v121 row_newbcast:4
  v_dot2c_f32_bf16_dpp v15, v31, v121 row_newbcast:4
  v_dot2c_f32_bf16_dpp v16, v30, v122 row_newbcast:4
  v_dot2c_f32_bf16_dpp v17, v31, v122 row_newbcast:4
  v_dot2c_f32_bf16_dpp v18, v30, v123 row_newbcast:4
  v_dot2c_f32_bf16_dpp v19, v31, v123 row_newbcast:4
  s_cbranch_vccz L_d958
  s_waitcnt vmcnt(4)
L_d958:
  s_xor_b32 s68, s70, 0x44800
  buffer_load_dwordx4 v[80:83], v63, s[16:19], s68 offen nt
  s_waitcnt vmcnt(5)
  v_dot2c_f32_bf16_dpp v12, v30, v124 row_newbcast:12
  v_dot2c_f32_bf16_dpp v13, v31, v124 row_newbcast:12
  v_dot2c_f32_bf16_dpp v14, v30, v125 row_newbcast:12
  v_dot2c_f32_bf16_dpp v15, v31, v125 row_newbcast:12
  v_dot2c_f32_bf16_dpp v16, v30, v126 row_newbcast:12
  v_dot2c_f32_bf16_dpp v17, v31, v126 row_newbcast:12
  v_dot2c_f32_bf16_dpp v18, v30, v127 row_newbcast:12
  v_dot2c_f32_bf16_dpp v19, v31, v127 row_newbcast:12
  s_cbranch_vccz L_d959
  s_waitcnt vmcnt(4)
L_d959:
  s_xor_b32 s68, s70, 0x44900
  buffer_load_dwordx4 v[84:87], v63, s[16:19], s68 offen nt
  s_barrier
  v_cvt_pk_bf16_f32 v30, v240, 0
  v_cvt_pk_bf16_f32 v31, 0, v240
  s_waitcnt vmcnt(5)
  v_dot2c_f32_bf16_dpp v12, v30, v64 row_newbcast:0
  v_dot2c_f32_bf16_dpp v13, v31, v64 row_newbcast:0
  v_dot2c_f32_bf16_dpp v14, v30, v65 row_newbcast:0
  v_dot2c_f32_bf16_dpp v15, v31, v65 row_newbcast:0
  v_dot2c_f32_bf16_dpp v16, v30, v66 row_newbcast:0
  v_dot2c_f32_bf16_dpp v17, v31, v66 row_newbcast:0
  v_dot2c_f32_bf16_dpp v18, v30, v67 row_newbcast:0
  v_dot2c_f32_bf16_dpp v19, v31, v67 row_newbcast:0
  s_cbranch_vccz L_d960
  s_waitcnt vmcnt(4)
L_d960:
  s_xor_b32 s68, s70, 0x44c00
  buffer_load_dwordx4 v[88:91], v63, s[16:19], s68 offen nt
  s_waitcnt vmcnt(5)
  v_dot2c_f32_bf16_dpp v12, v30, v68 row_newbcast:8
  v_dot2c_f32_bf16_dpp v13, v31, v68 row_newbcast:8
  v_dot2c_f32_bf16_dpp v14, v30, v69 row_newbcast:8
  v_dot2c_f32_bf16_dpp v15, v31, v69 row_newbcast:8
  v_dot2c_f32_bf16_dpp v16, v30, v70 row_newbcast:8
  v_dot2c_f32_bf16_dpp v17, v31, v70 row_newbcast:8
  v_dot2c_f32_bf16_dpp v18, v30, v71 row_newbcast:8
  v_dot2c_f32_bf16_dpp v19, v31, v71 row_newbcast:8
  s_cbranch_vccz L_d961
  s_waitcnt vmcnt(4)
L_d961:
  s_xor_b32 s68, s70, 0x44d00
  buffer_load_dwordx4 v[92:95], v63, s[16:19], s68 offen nt
  s_waitcnt vmcnt(5)
  v_dot2c_f32_bf16_dpp v12, v30, v72 row_newbcast:4
  v_dot2c_f32_bf16_dpp v13, v31, v72 row_newbcast:4
  v_dot2c_f32_bf16_dpp v14, v30, v73 row_newbcast:4
  v_dot2c_f32_bf16_dpp v15, v31, v73 row_newbcast:4
  v_dot2c_f32_bf16_dpp v16, v30, v74 row_newbcast:4
  v_dot2c_f32_bf16_dpp v17, v31, v74 row_newbcast:4
  v_dot2c_f32_bf16_dpp v18, v30, v75 row_newbcast:4
  v_dot2c_f32_bf16_dpp v19, v31, v75 row_newbcast:4
  s_cbranch_vccz L_d962
  s_waitcnt vmcnt(4)
L_d962:
  s_xor_b32 s68, s70, 0x54000
  buffer_load_dwordx4 v[96:99], v63, s[16:19], s68 offen nt
  s_waitcnt vmcnt(5)
  v_dot2c_f32_bf16_dpp v12, v30, v76 row_newbcast:12
  v_dot2c_f32_bf16_dpp v13, v31, v76 row_newbcast:12
  v_dot2c_f32_bf16_dpp v14, v30, v77 row_newbcast:12
  v_dot2c_f32_bf16_dpp v15, v31, v77 row_newbcast:12
  v_dot2c_f32_bf16_dpp v16, v30, v78 row_newbcast:12
  v_dot2c_f32_bf16_dpp v17, v31, v78 row_newbcast:12
  v_dot2c_f32_bf16_dpp v18, v30, v79 row_newbcast:12
  v_dot2c_f32_bf16_dpp v19, v31, v79 row_newbcast:12
  s_cbranch_vccz L_d963
  s_waitcnt vmcnt(4)
L_d963:
  s_xor_b32 s68, s70, 0x54100
  buffer_load_dwordx4 v[100:103], v63, s[16:19], s68 offen nt
  s_barrier
  v_cvt_pk_bf16_f32 v30, v241, 0
  v_cvt_pk_bf16_f32 v31, 0, v241
  s_waitcnt vmcnt(5)
  v_dot2c_f32_bf16_dpp v12, v30, v80 row_newbcast:0
  v_dot2c_f32_bf16_dpp v13, v31, v80 row_newbcast:0
  v_dot2c_f32_bf16_dpp v14, v30, v81 row_newbcast:0
  v_dot2c_f32_bf16_dpp v15, v31, v81 row_newbcast:0
  v_dot2c_f32_bf16_dpp v16, v30, v82 row_newbcast:0
  v_dot2c_f32_bf16_dpp v17, v31, v82 row_newbcast:0
  v_dot2c_f32_bf16_dpp v18, v30, v83 row_newbcast:0
  v_dot2c_f32_bf16_dpp v19, v31, v83 row_newbcast:0
  s_cbranch_vccz L_d964
  s_waitcnt vmcnt(4)
L_d964:
  s_xor_b32 s68, s70, 0x54400
  buffer_load_dwordx4 v[104:107], v63, s[16:19], s68 offen nt
  s_waitcnt vmcnt(5)
  v_dot2c_f32_bf16_dpp v12, v30, v84 row_newbcast:8
  v_dot2c_f32_bf16_dpp v13, v31, v84 row_newbcast:8
  v_dot2c_f32_bf16_dpp v14, v30, v85 row_newbcast:8
  v_dot2c_f32_bf16_dpp v15, v31, v85 row_newbcast:8
  v_dot2c_f32_bf16_dpp v16, v30, v86 row_newbcast:8
  v_dot2c_f32_bf16_dpp v17, v31, v86 row_newbcast:8
  v_dot2c_f32_bf16_dpp v18, v30, v87 row_newbcast:8
  v_dot2c_f32_bf16_dpp v19, v31, v87 row_newbcast:8
  s_cbranch_vccz L_d965
  s_waitcnt vmcnt(4)
L_d965:
  s_xor_b32 s68, s70, 0x54500
  buffer_load_dwordx4 v[108:111], v63, s[16:19], s68 offen nt
  s_waitcnt vmcnt(5)
  v_dot2c_f32_bf16_dpp v12, v30, v88 row_newbcast:4
  v_dot2c_f32_bf16_dpp v13, v31, v88 row_newbcast:4
  v_dot2c_f32_bf16_dpp v14, v30, v89 row_newbcast:4
  v_dot2c_f32_bf16_dpp v15, v31, v89 row_newbcast:4
  v_dot2c_f32_bf16_dpp v16, v30, v90 row_newbcast:4
  v_dot2c_f32_bf16_dpp v17, v31, v90 row_newbcast:4
  v_dot2c_f32_bf16_dpp v18, v30, v91 row_newbcast:4
  v_dot2c_f32_bf16_dpp v19, v31, v91 row_newbcast:4
  s_cbranch_vccz L_d966
  s_waitcnt vmcnt(4)
L_d966:
  s_xor_b32 s68, s70, 0x54800
  buffer_load_dwordx4 v[112:115], v63, s[16:19], s68 offen nt
  s_waitcnt vmcnt(5)
  v_dot2c_f32_bf16_dpp v12, v30, v92 row_newbcast:12
  v_dot2c_f32_bf16_dpp v13, v31, v92 row_newbcast:12
  v_dot2c_f32_bf16_dpp v14, v30, v93 row_newbcast:12
  v_dot2c_f32_bf16_dpp v15, v31, v93 row_newbcast:12
  v_dot2c_f32_bf16_dpp v16, v30, v94 row_newbcast:12
  v_dot2c_f32_bf16_dpp v17, v31, v94 row_newbcast:12
  v_dot2c_f32_bf16_dpp v18, v30, v95 row_newbcast:12
  v_dot2c_f32_bf16_dpp v19, v31, v95 row_newbcast:12
  s_cbranch_vccz L_d967
  s_waitcnt vmcnt(4)
L_d967:
  s_xor_b32 s68, s70, 0x54900
  buffer_load_dwordx4 v[116:119], v63, s[16:19], s68 offen nt
  s_barrier
  v_cvt_pk_bf16_f32 v30, v242, 0
  v_cvt_pk_bf16_f32 v31, 0, v242
  s_waitcnt vmcnt(5)
  v_dot2c_f32_bf16_dpp v12, v30, v96 row_newbcast:0
  v_dot2c_f32_bf16_dpp v13, v31, v96 row_newbcast:0
  v_dot2c_f32_bf16_dpp v14, v30, v97 row_newbcast:0
  v_dot2c_f32_bf16_dpp v15, v31, v97 row_newbcast:0
  v_dot2c_f32_bf16_dpp v16, v30, v98 row_newbcast:0
  v_dot2c_f32_bf16_dpp v17, v31, v98 row_newbcast:0
  v_dot2c_f32_bf16_dpp v18, v30, v99 row_newbcast:0
  v_dot2c_f32_bf16_dpp v19, v31, v99 row_newbcast:0
  s_cbranch_vccz L_d968
  s_waitcnt vmcnt(4)
L_d968:
  s_xor_b32 s68, s70, 0x54c00
  buffer_load_dwordx4 v[120:123], v63, s[16:19], s68 offen nt
  s_cmp_eq_u32 s64, 0
  s_cbranch_scc0 L_wp242
  s_mov_b32 s100, 20
  s_atomic_umax s100, s[20:21], s88
  s_and_b32 s60, s88, 0xfffffc7f
  s_xor_b32 s61, s60, 2048
  s_add_u32 s38, s60, 0
  s_load_dword s40, s[20:21], s38 glc
  s_add_u32 s38, s61, 128
  s_load_dword s41, s[20:21], s38 glc
  s_add_u32 s38, s61, 256
  s_load_dword s42, s[20:21], s38 glc
  s_add_u32 s38, s60, 384
  s_load_dword s43, s[20:21], s38 glc
  s_add_u32 s38, s60, 512
  s_load_dword s44, s[20:21], s38 glc
  s_add_u32 s38, s61, 640
  s_load_dword s45, s[20:21], s38 glc
  s_add_u32 s38, s61, 768
  s_load_dword s46, s[20:21], s38 glc
  s_add_u32 s38, s60, 896
  s_load_dword s47, s[20:21], s38 glc
L_wp242:
  s_waitcnt vmcnt(5)
  v_dot2c_f32_bf16_dpp v12, v30, v100 row_newbcast:8
  v_dot2c_f32_bf16_dpp v13, v31, v100 row_newbcast:8
  v_dot2c_f32_bf16_dpp v14, v30, v101 row_newbcast:8
  v_dot2c_f32_bf16_dpp v15, v31, v101 row_newbcast:8
  v_dot2c_f32_bf16_dpp v16, v30, v102 row_newbcast:8
  v_dot2c_f32_bf16_dpp v17, v31, v102 row_newbcast:8
  v_dot2c_f32_bf16_dpp v18, v30, v103 row_newbcast:8
  v_dot2c_f32_bf16_dpp v19, v31, v103 row_newbcast:8
  s_cbranch_vccz L_d969
  s_waitcnt vmcnt(4)
L_d969:
  s_xor_b32 s68, s70, 0x54d00
  buffer_load_dwordx4 v[124:127], v63, s[16:19], s68 offen nt
  s_waitcnt vmcnt(5)
  v_dot2c_f32_bf16_dpp v12, v30, v104 row_newbcast:4
  v_dot2c_f32_bf16_dpp v13, v31, v104 row_newbcast:4
  v_dot2c_f32_bf16_dpp v14, v30, v105 row_newbcast:4
  v_dot2c_f32_bf16_dpp v15, v31, v105 row_newbcast:4
  v_dot2c_f32_bf16_dpp v16, v30, v106 row_newbcast:4
  v_dot2c_f32_bf16_dpp v17, v31, v106 row_newbcast:4
  v_dot2c_f32_bf16_dpp v18, v30, v107 row_newbcast:4
  v_dot2c_f32_bf16_dpp v19, v31, v107 row_newbcast:4
  s_cbranch_vccz L_d970
  s_waitcnt vmcnt(4)
L_d970:
  s_xor_b32 s68, s70, 0x64000
  buffer_load_dwordx4 v[64:67], v63, s[16:19], s68 offen nt
  s_waitcnt vmcnt(5)
  v_dot2c_f32_bf16_dpp v12, v30, v108 row_newbcast:12
  v_dot2c_f32_bf16_dpp v13, v31, v108 row_newbcast:12
  v_dot2c_f32_bf16_dpp v14, v30, v109 row_newbcast:12
  v_dot2c_f32_bf16_dpp v15, v31, v109 row_newbcast:12
  v_dot2c_f32_bf16_dpp v16, v30, v110 row_newbcast:12
  v_dot2c_f32_bf16_dpp v17, v31, v110 row_newbcast:12
  v_dot2c_f32_bf16_dpp v18, v30, v111 row_newbcast:12
  v_dot2c_f32_bf16_dpp v19, v31, v111 row_newbcast:12
  s_cbranch_vccz L_d971
  s_waitcnt vmcnt(4)
L_d971:
  s_xor_b32 s68, s70, 0x64100
  buffer_load_dwordx4 v[68:71], v63, s[16:19], s68 offen nt
  s_barrier
  v_cvt_pk_bf16_f32 v30, v243, 0
  v_cvt_pk_bf16_f32 v31, 0, v243
  s_waitcnt vmcnt(5)
  v_dot2c_f32_bf16_dpp v12, v30, v112 row_newbcast:0
  v_dot2c_f32_bf16_dpp v13, v31, v112 row_newbcast:0
  v_dot2c_f32_bf16_dpp v14, v30, v113 row_newbcast:0
  v_dot2c_f32_bf16_dpp v15, v31, v113 row_newbcast:0
  v_dot2c_f32_bf16_dpp v16, v30, v114 row_newbcast:0
  v_dot2c_f32_bf16_dpp v17, v31, v114 row_newbcast:0
  v_dot2c_f32_bf16_dpp v18, v30, v115 row_newbcast:0
  v_dot2c_f32_bf16_dpp v19, v31, v115 row_newbcast:0
  s_cbranch_vccz L_d972
  s_waitcnt vmcnt(4)
L_d972:
  s_xor_b32 s68, s70, 0x64400
  buffer_load_dwordx4 v[72:75], v63, s[16:19], s68 offen nt
  s_waitcnt vmcnt(5)
  v_dot2c_f32_bf16_dpp v12, v30, v116 row_newbcast:8
  v_dot2c_f32_bf16_dpp v13, v31, v116 row_newbcast:8
  v_dot2c_f32_bf16_dpp v14, v30, v117 row_newbcast:8
  v_dot2c_f32_bf16_dpp v15, v31, v117 row_newbcast:8
  v_dot2c_f32_bf16_dpp v16, v30, v118 row_newbcast:8
  v_dot2c_f32_bf16_dpp v17, v31, v118 row_newbcast:8
  v_dot2c_f32_bf16_dpp v18, v30, v119 row_newbcast:8
  v_dot2c_f32_bf16_dpp v19, v31, v119 row_newbcast:8
  s_cbranch_vccz L_d973
  s_waitcnt vmcnt(4)
L_d973:
  s_xor_b32 s68, s70, 0x64500
  buffer_load_dwordx4 v[76:79], v63, s[16:19], s68 offen nt
  s_waitcnt vmcnt(5)
  v_dot2c_f32_bf16_dpp v12, v30, v120 row_newbcast:4
  v_dot2c_f32_bf16_dpp v13, v31, v120 row_newbcast:4
  v_dot2c_f32_bf16_dpp v14, v30, v121 row_newbcast:4
  v_dot2c_f32_bf16_dpp v15, v31, v121 row_newbcast:4
  v_dot2c_f32_bf16_dpp v16, v30, v122 row_newbcast:4
  v_dot2c_f32_bf16_dpp v17, v31, v122 row_newbcast:4
  v_dot2c_f32_bf16_dpp v18, v30, v123 row_newbcast:4
  v_dot2c_f32_bf16_dpp v19, v31, v123 row_newbcast:4
  s_cbranch_vccz L_d974
  s_waitcnt vmcnt(4)
L_d974:
  s_xor_b32 s68, s70, 0x64800
  buffer_load_dwordx4 v[80:83], v63, s[16:19], s68 offen nt
  s_waitcnt vmcnt(5)
  v_dot2c_f32_bf16_dpp v12, v30, v124 row_newbcast:12
  v_dot2c_f32_bf16_dpp v13, v31, v124 row_newbcast:12
  v_dot2c_f32_bf16_dpp v14, v30, v125 row_newbcast:12
  v_dot2c_f32_bf16_dpp v15, v31, v125 row_newbcast:12
  v_dot2c_f32_bf16_dpp v16, v30, v126 row_newbcast:12
  v_dot2c_f32_bf16_dpp v17, v31, v126 row_newbcast:12
  v_dot2c_f32_bf16_dpp v18, v30, v127 row_newbcast:12
  v_dot2c_f32_bf16_dpp v19, v31, v127 row_newbcast:12
  s_cbranch_vccz L_d975
  s_waitcnt vmcnt(4)
L_d975:
  s_xor_b32 s68, s70, 0x64900
  buffer_load_dwordx4 v[84:87], v63, s[16:19], s68 offen nt
  s_barrier
  v_cvt_pk_bf16_f32 v30, v244, 0
  v_cvt_pk_bf16_f32 v31, 0, v244
  s_waitcnt vmcnt(5)
  v_dot2c_f32_bf16_dpp v12, v30, v64 row_newbcast:0
  v_dot2c_f32_bf16_dpp v13, v31, v64 row_newbcast:0
  v_dot2c_f32_bf16_dpp v14, v30, v65 row_newbcast:0
  v_dot2c_f32_bf16_dpp v15, v31, v65 row_newbcast:0
  v_dot2c_f32_bf16_dpp v16, v30, v66 row_newbcast:0
  v_dot2c_f32_bf16_dpp v17, v31, v66 row_newbcast:0
  v_dot2c_f32_bf16_dpp v18, v30, v67 row_newbcast:0
  v_dot2c_f32_bf16_dpp v19, v31, v67 row_newbcast:0
  s_cbranch_vccz L_d976
  s_waitcnt vmcnt(4)
L_d976:
  s_xor_b32 s68, s70, 0x64c00
  buffer_load_dwordx4 v[88:91], v63, s[16:19], s68 offen nt
  s_cmp_eq_u32 s64, 0
  s_cbranch_scc0 L_wp244
  s_mov_b32 s101, 0
  s_waitcnt lgkmcnt(0)
  s_cmp_ge_u32 s40, 20
  s_addc_u32 s101, s101, 0
  s_cmp_ge_u32 s41, 20
  s_addc_u32 s101, s101, 0
  s_cmp_ge_u32 s42, 20
  s_addc_u32 s101, s101, 0
  s_cmp_ge_u32 s43, 20
  s_addc_u32 s101, s101, 0
  s_cmp_ge_u32 s44, 20
  s_addc_u32 s101, s101, 0
  s_cmp_ge_u32 s45, 20
  s_addc_u32 s101, s101, 0
  s_cmp_ge_u32 s46, 20
  s_addc_u32 s101, s101, 0
  s_cmp_ge_u32 s47, 20
  s_addc_u32 s101, s101, 0
  s_cmp_lt_u32 s101, 6
  s_cselect_b32 s38, -1, 0
  v_mov_b32 v26, 0
  v_mov_b32 v27, s38
  ds_write_b32 v26, v27 offset:8512
L_wp244:
  s_waitcnt vmcnt(5)
  v_dot2c_f32_bf16_dpp v12, v30, v68 row_newbcast:8
  v_dot2c_f32_bf16_dpp v13, v31, v68 row_newbcast:8
  v_dot2c_f32_bf16_dpp v14, v30, v69 row_newbcast:8
  v_dot2c_f32_bf16_dpp v15, v31, v69 row_newbcast:8
  v_dot2c_f32_bf16_dpp v16, v30, v70 row_newbcast:8
  v_dot2c_f32_bf16_dpp v17, v31, v70 row_newbcast:8
  v_dot2c_f32_bf16_dpp v18, v30, v71 row_newbcast:8
  v_dot2c_f32_bf16_dpp v19, v31, v71 row_newbcast:8
  s_cbranch_vccz L_d977
  s_waitcnt vmcnt(4)
L_d977:
  s_xor_b32 s68, s70, 0x64d00
  buffer_load_dwordx4 v[92:95], v63, s[16:19], s68 offen nt
  s_waitcnt vmcnt(5)
  v_dot2c_f32_bf16_dpp v12, v30, v72 row_newbcast:4
  v_dot2c_f32_bf16_dpp v13, v31, v72 row_newbcast:4
  v_dot2c_f32_bf16_dpp v14, v30, v73 row_newbcast:4
  v_dot2c_f32_bf16_dpp v15, v31, v73 row_newbcast:4
  v_dot2c_f32_bf16_dpp v16, v30, v74 row_newbcast:4
  v_dot2c_f32_bf16_dpp v17, v31, v74 row_newbcast:4
  v_dot2c_f32_bf16_dpp v18, v30, v75 row_newbcast:4
  v_dot2c_f32_bf16_dpp v19, v31, v75 row_newbcast:4
  s_cbranch_vccz L_d978
  s_waitcnt vmcnt(4)
L_d978:
  s_xor_b32 s68, s70, 0x74000
  buffer_load_dwordx4 v[96:99], v63, s[16:19], s68 offen nt
  s_waitcnt vmcnt(5)
  v_dot2c_f32_bf16_dpp v12, v30, v76 row_newbcast:12
  v_dot2c_f32_bf16_dpp v13, v31, v76 row_newbcast:12
  v_dot2c_f32_bf16_dpp v14, v30, v77 row_newbcast:12
  v_dot2c_f32_bf16_dpp v15, v31, v77 row_newbcast:12
  v_dot2c_f32_bf16_dpp v16, v30, v78 row_newbcast:12
  v_dot2c_f32_bf16_dpp v17, v31, v78 row_newbcast:12
  v_dot2c_f32_bf16_dpp v18, v30, v79 row_newbcast:12
  v_dot2c_f32_bf16_dpp v19, v31, v79 row_newbcast:12
  s_cbranch_vccz L_d979
  s_waitcnt vmcnt(4)
L_d979:
  s_xor_b32 s68, s70, 0x74100
  buffer_load_dwordx4 v[100:103], v63, s[16:19], s68 offen nt
  s_barrier
  v_cvt_pk_bf16_f32 v30, v245, 0
  v_cvt_pk_bf16_f32 v31, 0, v245
  s_waitcnt vmcnt(5)
  v_dot2c_f32_bf16_dpp v12, v30, v80 row_newbcast:0
  v_dot2c_f32_bf16_dpp v13, v31, v80 row_newbcast:0
  v_dot2c_f32_bf16_dpp v14, v30, v81 row_newbcast:0
  v_dot2c_f32_bf16_dpp v15, v31, v81 row_newbcast:0
  v_dot2c_f32_bf16_dpp v16, v30, v82 row_newbcast:0
  v_dot2c_f32_bf16_dpp v17, v31, v82 row_newbcast:0
  v_dot2c_f32_bf16_dpp v18, v30, v83 row_newbcast:0
  v_dot2c_f32_bf16_dpp v19, v31, v83 row_newbcast:0
  s_cbranch_vccz L_d980
  s_waitcnt vmcnt(4)
L_d980:
  s_xor_b32 s68, s70, 0x74400
  buffer_load_dwordx4 v[104:107], v63, s[16:19], s68 offen nt
  v_mov_b32 v26, 0
  ds_read_b32 v35, v26 offset:8512
  s_waitcnt vmcnt(5)
  v_dot2c_f32_bf16_dpp v12, v30, v84 row_newbcast:8
  v_dot2c_f32_bf16_dpp v13, v31, v84 row_newbcast:8
  v_dot2c_f32_bf16_dpp v14, v30, v85 row_newbcast:8
  v_dot2c_f32_bf16_dpp v15, v31, v85 row_newbcast:8
  v_dot2c_f32_bf16_dpp v16, v30, v86 row_newbcast:8
  v_dot2c_f32_bf16_dpp v17, v31, v86 row_newbcast:8
  v_dot2c_f32_bf16_dpp v18, v30, v87 row_newbcast:8
  v_dot2c_f32_bf16_dpp v19, v31, v87 row_newbcast:8
  s_cbranch_vccz L_d981
  s_waitcnt vmcnt(4)
L_d981:
  s_xor_b32 s68, s70, 0x74500
  buffer_load_dwordx4 v[108:111], v63, s[16:19], s68 offen nt
  s_waitcnt vmcnt(5)
  v_dot2c_f32_bf16_dpp v12, v30, v88 row_newbcast:4
  v_dot2c_f32_bf16_dpp v13, v31, v88 row_newbcast:4
  v_dot2c_f32_bf16_dpp v14, v30, v89 row_newbcast:4
  v_dot2c_f32_bf16_dpp v15, v31, v89 row_newbcast:4
  v_dot2c_f32_bf16_dpp v16, v30, v90 row_newbcast:4
  v_dot2c_f32_bf16_dpp v17, v31, v90 row_newbcast:4
  v_dot2c_f32_bf16_dpp v18, v30, v91 row_newbcast:4
  v_dot2c_f32_bf16_dpp v19, v31, v91 row_newbcast:4
  s_cbranch_vccz L_d982
  s_waitcnt vmcnt(4)
L_d982:
  s_xor_b32 s68, s70, 0x74800
  buffer_load_dwordx4 v[112:115], v63, s[16:19], s68 offen nt
  s_waitcnt vmcnt(5)
  v_dot2c_f32_bf16_dpp v12, v30, v92 row_newbcast:12
  v_dot2c_f32_bf16_dpp v13, v31, v92 row_newbcast:12
  v_dot2c_f32_bf16_dpp v14, v30, v93 row_newbcast:12
  v_dot2c_f32_bf16_dpp v15, v31, v93 row_newbcast:12
  v_dot2c_f32_bf16_dpp v16, v30, v94 row_newbcast:12
  v_dot2c_f32_bf16_dpp v17, v31, v94 row_newbcast:12
  v_dot2c_f32_bf16_dpp v18, v30, v95 row_newbcast:12
  v_dot2c_f32_bf16_dpp v19, v31, v95 row_newbcast:12
  s_cbranch_vccz L_d983
  s_waitcnt vmcnt(4)
L_d983:
  s_xor_b32 s68, s70, 0x74900
  buffer_load_dwordx4 v[116:119], v63, s[16:19], s68 offen nt
  s_barrier
  v_cvt_pk_bf16_f32 v30, v246, 0
  v_cvt_pk_bf16_f32 v31, 0, v246
  s_waitcnt vmcnt(5)
  v_dot2c_f32_bf16_dpp v12, v30, v96 row_newbcast:0
  v_dot2c_f32_bf16_dpp v13, v31, v96 row_newbcast:0
  v_dot2c_f32_bf16_dpp v14, v30, v97 row_newbcast:0
  v_dot2c_f32_bf16_dpp v15, v31, v97 row_newbcast:0
  v_dot2c_f32_bf16_dpp v16, v30, v98 row_newbcast:0
  v_dot2c_f32_bf16_dpp v17, v31, v98 row_newbcast:0
  v_dot2c_f32_bf16_dpp v18, v30, v99 row_newbcast:0
  v_dot2c_f32_bf16_dpp v19, v31, v99 row_newbcast:0
  s_cbranch_vccz L_d984
  s_waitcnt vmcnt(4)
L_d984:
  s_xor_b32 s68, s70, 0x74c00
  buffer_load_dwordx4 v[120:123], v63, s[16:19], s68 offen nt
  s_waitcnt lgkmcnt(0)
  v_cmp_ne_u32 vcc, 0, v35
  s_waitcnt vmcnt(5)
  v_dot2c_f32_bf16_dpp v12, v30, v100 row_newbcast:8
  v_dot2c_f32_bf16_dpp v13, v31, v100 row_newbcast:8
  v_dot2c_f32_bf16_dpp v14, v30, v101 row_newbcast:8
  v_dot2c_f32_bf16_dpp v15, v31, v101 row_newbcast:8
  v_dot2c_f32_bf16_dpp v16, v30, v102 row_newbcast:8
  v_dot2c_f32_bf16_dpp v17, v31, v102 row_newbcast:8
  v_dot2c_f32_bf16_dpp v18, v30, v103 row_newbcast:8
  v_dot2c_f32_bf16_dpp v19, v31, v103 row_newbcast:8
  s_cbranch_vccz L_d985
  s_waitcnt vmcnt(4)
L_d985:
  s_xor_b32 s68, s70, 0x74d00
  buffer_load_dwordx4 v[124:127], v63, s[16:19], s68 offen nt
  s_waitcnt vmcnt(5)
  v_dot2c_f32_bf16_dpp v12, v30, v104 row_newbcast:4
  v_dot2c_f32_bf16_dpp v13, v31, v104 row_newbcast:4
  v_dot2c_f32_bf16_dpp v14, v30, v105 row_newbcast:4
  v_dot2c_f32_bf16_dpp v15, v31, v105 row_newbcast:4
  v_dot2c_f32_bf16_dpp v16, v30, v106 row_newbcast:4
  v_dot2c_f32_bf16_dpp v17, v31, v106 row_newbcast:4
  v_dot2c_f32_bf16_dpp v18, v30, v107 row_newbcast:4
  v_dot2c_f32_bf16_dpp v19, v31, v107 row_newbcast:4
  s_cbranch_vccz L_d986
  s_waitcnt vmcnt(4)
L_d986:
  s_xor_b32 s68, s70, 0xc4000
  buffer_load_dwordx4 v[64:67], v63, s[16:19], s68 offen nt
  s_waitcnt vmcnt(5)
  v_dot2c_f32_bf16_dpp v12, v30, v108 row_newbcast:12
  v_dot2c_f32_bf16_dpp v13, v31, v108 row_newbcast:12
  v_dot2c_f32_bf16_dpp v14, v30, v109 row_newbcast:12
  v_dot2c_f32_bf16_dpp v15, v31, v109 row_newbcast:12
  v_dot2c_f32_bf16_dpp v16, v30, v110 row_newbcast:12
  v_dot2c_f32_bf16_dpp v17, v31, v110 row_newbcast:12
  v_dot2c_f32_bf16_dpp v18, v30, v111 row_newbcast:12
  v_dot2c_f32_bf16_dpp v19, v31, v111 row_newbcast:12
  s_cbranch_vccz L_d987
  s_waitcnt vmcnt(4)
L_d987:
  s_xor_b32 s68, s70, 0xc4100
  buffer_load_dwordx4 v[68:71], v63, s[16:19], s68 offen nt
  s_barrier
  v_cvt_pk_bf16_f32 v30, v247, 0
  v_cvt_pk_bf16_f32 v31, 0, v247
  s_waitcnt vmcnt(5)
  v_dot2c_f32_bf16_dpp v12, v30, v112 row_newbcast:0
  v_dot2c_f32_bf16_dpp v13, v31, v112 row_newbcast:0
  v_dot2c_f32_bf16_dpp v14, v30, v113 row_newbcast:0
  v_dot2c_f32_bf16_dpp v15, v31, v113 row_newbcast:0
  v_dot2c_f32_bf16_dpp v16, v30, v114 row_newbcast:0
  v_dot2c_f32_bf16_dpp v17, v31, v114 row_newbcast:0
  v_dot2c_f32_bf16_dpp v18, v30, v115 row_newbcast:0
  v_dot2c_f32_bf16_dpp v19, v31, v115 row_newbcast:0
  s_cbranch_vccz L_d988
  s_waitcnt vmcnt(4)
L_d988:
  s_xor_b32 s68, s70, 0xc4400
  buffer_load_dwordx4 v[72:75], v63, s[16:19], s68 offen nt
  s_waitcnt vmcnt(5)
  v_dot2c_f32_bf16_dpp v12, v30, v116 row_newbcast:8
  v_dot2c_f32_bf16_dpp v13, v31, v116 row_newbcast:8
  v_dot2c_f32_bf16_dpp v14, v30, v117 row_newbcast:8
  v_dot2c_f32_bf16_dpp v15, v31, v117 row_newbcast:8
  v_dot2c_f32_bf16_dpp v16, v30, v118 row_newbcast:8
  v_dot2c_f32_bf16_dpp v17, v31, v118 row_newbcast:8
  v_dot2c_f32_bf16_dpp v18, v30, v119 row_newbcast:8
  v_dot2c_f32_bf16_dpp v19, v31, v119 row_newbcast:8
  s_cbranch_vccz L_d989
  s_waitcnt vmcnt(4)
L_d989:
  s_xor_b32 s68, s70, 0xc4500
  buffer_load_dwordx4 v[76:79], v63, s[16:19], s68 offen nt
  s_waitcnt vmcnt(5)
  v_dot2c_f32_bf16_dpp v12, v30, v120 row_newbcast:4
  v_dot2c_f32_bf16_dpp v13, v31, v120 row_newbcast:4
  v_dot2c_f32_bf16_dpp v14, v30, v121 row_newbcast:4
  v_dot2c_f32_bf16_dpp v15, v31, v121 row_newbcast:4
  v_dot2c_f32_bf16_dpp v16, v30, v122 row_newbcast:4
  v_dot2c_f32_bf16_dpp v17, v31, v122 row_newbcast:4
  v_dot2c_f32_bf16_dpp v18, v30, v123 row_newbcast:4
  v_dot2c_f32_bf16_dpp v19, v31, v123 row_newbcast:4
  s_cbranch_vccz L_d990
  s_waitcnt vmcnt(4)
L_d990:
  s_xor_b32 s68, s70, 0xc4800
  buffer_load_dwordx4 v[80:83], v63, s[16:19], s68 offen nt
  s_waitcnt vmcnt(5)
  v_dot2c_f32_bf16_dpp v12, v30, v124 row_newbcast:12
  v_dot2c_f32_bf16_dpp v13, v31, v124 row_newbcast:12
  v_dot2c_f32_bf16_dpp v14, v30, v125 row_newbcast:12
  v_dot2c_f32_bf16_dpp v15, v31, v125 row_newbcast:12
  v_dot2c_f32_bf16_dpp v16, v30, v126 row_newbcast:12
  v_dot2c_f32_bf16_dpp v17, v31, v126 row_newbcast:12
  v_dot2c_f32_bf16_dpp v18, v30, v127 row_newbcast:12
  v_dot2c_f32_bf16_dpp v19, v31, v127 row_newbcast:12
  s_cbranch_vccz L_d991
  s_waitcnt vmcnt(4)
L_d991:
  s_xor_b32 s68, s70, 0xc4900
  buffer_load_dwordx4 v[84:87], v63, s[16:19], s68 offen nt
  s_barrier
  v_cvt_pk_bf16_f32 v30, v248, 0
  v_cvt_pk_bf16_f32 v31, 0, v248
  s_waitcnt vmcnt(5)
  v_dot2c_f32_bf16_dpp v12, v30, v64 row_newbcast:0
  v_dot2c_f32_bf16_dpp v13, v31, v64 row_newbcast:0
  v_dot2c_f32_bf16_dpp v14, v30, v65 row_newbcast:0
  v_dot2c_f32_bf16_dpp v15, v31, v65 row_newbcast:0
  v_dot2c_f32_bf16_dpp v16, v30, v66 row_newbcast:0
  v_dot2c_f32_bf16_dpp v17, v31, v66 row_newbcast:0
  v_dot2c_f32_bf16_dpp v18, v30, v67 row_newbcast:0
  v_dot2c_f32_bf16_dpp v19, v31, v67 row_newbcast:0
  s_cbranch_vccz L_d992
  s_waitcnt vmcnt(4)
L_d992:
  s_xor_b32 s68, s70, 0xc4c00
  buffer_load_dwordx4 v[88:91], v63, s[16:19], s68 offen nt
  s_waitcnt vmcnt(5)
  v_dot2c_f32_bf16_dpp v12, v30, v68 row_newbcast:8
  v_dot2c_f32_bf16_dpp v13, v31, v68 row_newbcast:8
  v_dot2c_f32_bf16_dpp v14, v30, v69 row_newbcast:8
  v_dot2c_f32_bf16_dpp v15, v31, v69 row_newbcast:8
  v_dot2c_f32_bf16_dpp v16, v30, v70 row_newbcast:8
  v_dot2c_f32_bf16_dpp v17, v31, v70 row_newbcast:8
  v_dot2c_f32_bf16_dpp v18, v30, v71 row_newbcast:8
  v_dot2c_f32_bf16_dpp v19, v31, v71 row_newbcast:8
  s_cbranch_vccz L_d993
  s_waitcnt vmcnt(4)
L_d993:
  s_xor_b32 s68, s70, 0xc4d00
  buffer_load_dwordx4 v[92:95], v63, s[16:19], s68 offen nt
  s_waitcnt vmcnt(5)
  v_dot2c_f32_bf16_dpp v12, v30, v72 row_newbcast:4
  v_dot2c_f32_bf16_dpp v13, v31, v72 row_newbcast:4
  v_dot2c_f32_bf16_dpp v14, v30, v73 row_newbcast:4
  v_dot2c_f32_bf16_dpp v15, v31, v73 row_newbcast:4
  v_dot2c_f32_bf16_dpp v16, v30, v74 row_newbcast:4
  v_dot2c_f32_bf16_dpp v17, v31, v74 row_newbcast:4
  v_dot2c_f32_bf16_dpp v18, v30, v75 row_newbcast:4
  v_dot2c_f32_bf16_dpp v19, v31, v75 row_newbcast:4
  s_cbranch_vccz L_d994
  s_waitcnt vmcnt(4)
L_d994:
  s_xor_b32 s68, s70, 0xd4000
  buffer_load_dwordx4 v[96:99], v63, s[16:19], s68 offen nt
  s_waitcnt vmcnt(5)
  v_dot2c_f32_bf16_dpp v12, v30, v76 row_newbcast:12
  v_dot2c_f32_bf16_dpp v13, v31, v76 row_newbcast:12
  v_dot2c_f32_bf16_dpp v14, v30, v77 row_newbcast:12
  v_dot2c_f32_bf16_dpp v15, v31, v77 row_newbcast:12
  v_dot2c_f32_bf16_dpp v16, v30, v78 row_newbcast:12
  v_dot2c_f32_bf16_dpp v17, v31, v78 row_newbcast:12
  v_dot2c_f32_bf16_dpp v18, v30, v79 row_newbcast:12
  v_dot2c_f32_bf16_dpp v19, v31, v79 row_newbcast:12
  s_cbranch_vccz L_d995
  s_waitcnt vmcnt(4)
L_d995:
  s_xor_b32 s68, s70, 0xd4100
  buffer_load_dwordx4 v[100:103], v63, s[16:19], s68 offen nt
  s_barrier
  v_cvt_pk_bf16_f32 v30, v249, 0
  v_cvt_pk_bf16_f32 v31, 0, v249
  s_waitcnt vmcnt(5)
  v_dot2c_f32_bf16_dpp v12, v30, v80 row_newbcast:0
  v_dot2c_f32_bf16_dpp v13, v31, v80 row_newbcast:0
  v_dot2c_f32_bf16_dpp v14, v30, v81 row_newbcast:0
  v_dot2c_f32_bf16_dpp v15, v31, v81 row_newbcast:0
  v_dot2c_f32_bf16_dpp v16, v30, v82 row_newbcast:0
  v_dot2c_f32_bf16_dpp v17, v31, v82 row_newbcast:0
  v_dot2c_f32_bf16_dpp v18, v30, v83 row_newbcast:0
  v_dot2c_f32_bf16_dpp v19, v31, v83 row_newbcast:0
  s_cbranch_vccz L_d996
  s_waitcnt vmcnt(4)
L_d996:
  s_xor_b32 s68, s70, 0xd4400
  buffer_load_dwordx4 v[104:107], v63, s[16:19], s68 offen nt
  s_waitcnt vmcnt(5)
  v_dot2c_f32_bf16_dpp v12, v30, v84 row_newbcast:8
  v_dot2c_f32_bf16_dpp v13, v31, v84 row_newbcast:8
  v_dot2c_f32_bf16_dpp v14, v30, v85 row_newbcast:8
  v_dot2c_f32_bf16_dpp v15, v31, v85 row_newbcast:8
  v_dot2c_f32_bf16_dpp v16, v30, v86 row_newbcast:8
  v_dot2c_f32_bf16_dpp v17, v31, v86 row_newbcast:8
  v_dot2c_f32_bf16_dpp v18, v30, v87 row_newbcast:8
  v_dot2c_f32_bf16_dpp v19, v31, v87 row_newbcast:8
  s_cbranch_vccz L_d997
  s_waitcnt vmcnt(4)
L_d997:
  s_xor_b32 s68, s70, 0xd4500
  buffer_load_dwordx4 v[108:111], v63, s[16:19], s68 offen nt
  s_waitcnt vmcnt(5)
  v_dot2c_f32_bf16_dpp v12, v30, v88 row_newbcast:4
  v_dot2c_f32_bf16_dpp v13, v31, v88 row_newbcast:4
  v_dot2c_f32_bf16_dpp v14, v30, v89 row_newbcast:4
  v_dot2c_f32_bf16_dpp v15, v31, v89 row_newbcast:4
  v_dot2c_f32_bf16_dpp v16, v30, v90 row_newbcast:4
  v_dot2c_f32_bf16_dpp v17, v31, v90 row_newbcast:4
  v_dot2c_f32_bf16_dpp v18, v30, v91 row_newbcast:4
  v_dot2c_f32_bf16_dpp v19, v31, v91 row_newbcast:4
  s_cbranch_vccz L_d998
  s_waitcnt vmcnt(4)
L_d998:
  s_xor_b32 s68, s70, 0xd4800
  buffer_load_dwordx4 v[112:115], v63, s[16:19], s68 offen nt
  s_waitcnt vmcnt(5)
  v_dot2c_f32_bf16_dpp v12, v30, v92 row_newbcast:12
  v_dot2c_f32_bf16_dpp v13, v31, v92 row_newbcast:12
  v_dot2c_f32_bf16_dpp v14, v30, v93 row_newbcast:12
  v_dot2c_f32_bf16_dpp v15, v31, v93 row_newbcast:12
  v_dot2c_f32_bf16_dpp v16, v30, v94 row_newbcast:12
  v_dot2c_f32_bf16_dpp v17, v31, v94 row_newbcast:12
  v_dot2c_f32_bf16_dpp v18, v30, v95 row_newbcast:12
  v_dot2c_f32_bf16_dpp v19, v31, v95 row_newbcast:12
  s_cbranch_vccz L_d999
  s_waitcnt vmcnt(4)
L_d999:
  s_xor_b32 s68, s70, 0xd4900
  buffer_load_dwordx4 v[116:119], v63, s[16:19], s68 offen nt
  s_barrier
  v_cvt_pk_bf16_f32 v30, v250, 0
  v_cvt_pk_bf16_f32 v31, 0, v250
  s_waitcnt vmcnt(5)
  v_dot2c_f32_bf16_dpp v12, v30, v96 row_newbcast:0
  v_dot2c_f32_bf16_dpp v13, v31, v96 row_newbcast:0
  v_dot2c_f32_bf16_dpp v14, v30, v97 row_newbcast:0
  v_dot2c_f32_bf16_dpp v15, v31, v97 row_newbcast:0
  v_dot2c_f32_bf16_dpp v16, v30, v98 row_newbcast:0
  v_dot2c_f32_bf16_dpp v17, v31, v98 row_newbcast:0
  v_dot2c_f32_bf16_dpp v18, v30, v99 row_newbcast:0
  v_dot2c_f32_bf16_dpp v19, v31, v99 row_newbcast:0
  s_cbranch_vccz L_d1000
  s_waitcnt vmcnt(4)
L_d1000:
  s_xor_b32 s68, s70, 0xd4c00
  buffer_load_dwordx4 v[120:123], v63, s[16:19], s68 offen nt
  s_waitcnt vmcnt(5)
  v_dot2c_f32_bf16_dpp v12, v30, v100 row_newbcast:8
  v_dot2c_f32_bf16_dpp v13, v31, v100 row_newbcast:8
  v_dot2c_f32_bf16_dpp v14, v30, v101 row_newbcast:8
  v_dot2c_f32_bf16_dpp v15, v31, v101 row_newbcast:8
  v_dot2c_f32_bf16_dpp v16, v30, v102 row_newbcast:8
  v_dot2c_f32_bf16_dpp v17, v31, v102 row_newbcast:8
  v_dot2c_f32_bf16_dpp v18, v30, v103 row_newbcast:8
  v_dot2c_f32_bf16_dpp v19, v31, v103 row_newbcast:8
  s_cbranch_vccz L_d1001
  s_waitcnt vmcnt(4)
L_d1001:
  s_xor_b32 s68, s70, 0xd4d00
  buffer_load_dwordx4 v[124:127], v63, s[16:19], s68 offen nt
  s_waitcnt vmcnt(5)
  v_dot2c_f32_bf16_dpp v12, v30, v104 row_newbcast:4
  v_dot2c_f32_bf16_dpp v13, v31, v104 row_newbcast:4
  v_dot2c_f32_bf16_dpp v14, v30, v105 row_newbcast:4
  v_dot2c_f32_bf16_dpp v15, v31, v105 row_newbcast:4
  v_dot2c_f32_bf16_dpp v16, v30, v106 row_newbcast:4
  v_dot2c_f32_bf16_dpp v17, v31, v106 row_newbcast:4
  v_dot2c_f32_bf16_dpp v18, v30, v107 row_newbcast:4
  v_dot2c_f32_bf16_dpp v19, v31, v107 row_newbcast:4
  s_cbranch_vccz L_d1002
  s_waitcnt vmcnt(4)
L_d1002:
  s_xor_b32 s68, s70, 0xe4000
  buffer_load_dwordx4 v[64:67], v63, s[16:19], s68 offen nt
  s_waitcnt vmcnt(5)
  v_dot2c_f32_bf16_dpp v12, v30, v108 row_newbcast:12
  v_dot2c_f32_bf16_dpp v13, v31, v108 row_newbcast:12
  v_dot2c_f32_bf16_dpp v14, v30, v109 row_newbcast:12
  v_dot2c_f32_bf16_dpp v15, v31, v109 row_newbcast:12
  v_dot2c_f32_bf16_dpp v16, v30, v110 row_newbcast:12
  v_dot2c_f32_bf16_dpp v17, v31, v110 row_newbcast:12
  v_dot2c_f32_bf16_dpp v18, v30, v111 row_newbcast:12
  v_dot2c_f32_bf16_dpp v19, v31, v111 row_newbcast:12
  s_cbranch_vccz L_d1003
  s_waitcnt vmcnt(4)
L_d1003:
  s_xor_b32 s68, s70, 0xe4100
  buffer_load_dwordx4 v[68:71], v63, s[16:19], s68 offen nt
  s_barrier
  v_cvt_pk_bf16_f32 v30, v251, 0
  v_cvt_pk_bf16_f32 v31, 0, v251
  s_waitcnt vmcnt(5)
  v_dot2c_f32_bf16_dpp v12, v30, v112 row_newbcast:0
  v_dot2c_f32_bf16_dpp v13, v31, v112 row_newbcast:0
  v_dot2c_f32_bf16_dpp v14, v30, v113 row_newbcast:0
  v_dot2c_f32_bf16_dpp v15, v31, v113 row_newbcast:0
  v_dot2c_f32_bf16_dpp v16, v30, v114 row_newbcast:0
  v_dot2c_f32_bf16_dpp v17, v31, v114 row_newbcast:0
  v_dot2c_f32_bf16_dpp v18, v30, v115 row_newbcast:0
  v_dot2c_f32_bf16_dpp v19, v31, v115 row_newbcast:0
  s_cbranch_vccz L_d1004
  s_waitcnt vmcnt(4)
L_d1004:
  s_xor_b32 s68, s70, 0xe4400
  buffer_load_dwordx4 v[72:75], v63, s[16:19], s68 offen nt
  s_waitcnt vmcnt(5)
  v_dot2c_f32_bf16_dpp v12, v30, v116 row_newbcast:8
  v_dot2c_f32_bf16_dpp v13, v31, v116 row_newbcast:8
  v_dot2c_f32_bf16_dpp v14, v30, v117 row_newbcast:8
  v_dot2c_f32_bf16_dpp v15, v31, v117 row_newbcast:8
  v_dot2c_f32_bf16_dpp v16, v30, v118 row_newbcast:8
  v_dot2c_f32_bf16_dpp v17, v31, v118 row_newbcast:8
  v_dot2c_f32_bf16_dpp v18, v30, v119 row_newbcast:8
  v_dot2c_f32_bf16_dpp v19, v31, v119 row_newbcast:8
  s_cbranch_vccz L_d1005
  s_waitcnt vmcnt(4)
L_d1005:
  s_xor_b32 s68, s70, 0xe4500
  buffer_load_dwordx4 v[76:79], v63, s[16:19], s68 offen nt
  s_waitcnt vmcnt(5)
  v_dot2c_f32_bf16_dpp v12, v30, v120 row_newbcast:4
  v_dot2c_f32_bf16_dpp v13, v31, v120 row_newbcast:4
  v_dot2c_f32_bf16_dpp v14, v30, v121 row_newbcast:4
  v_dot2c_f32_bf16_dpp v15, v31, v121 row_newbcast:4
  v_dot2c_f32_bf16_dpp v16, v30, v122 row_newbcast:4
  v_dot2c_f32_bf16_dpp v17, v31, v122 row_newbcast:4
  v_dot2c_f32_bf16_dpp v18, v30, v123 row_newbcast:4
  v_dot2c_f32_bf16_dpp v19, v31, v123 row_newbcast:4
  s_cbranch_vccz L_d1006
  s_waitcnt vmcnt(4)
L_d1006:
  s_xor_b32 s68, s70, 0xe4800
  buffer_load_dwordx4 v[80:83], v63, s[16:19], s68 offen nt
  s_waitcnt vmcnt(5)
  v_dot2c_f32_bf16_dpp v12, v30, v124 row_newbcast:12
  v_dot2c_f32_bf16_dpp v13, v31, v124 row_newbcast:12
  v_dot2c_f32_bf16_dpp v14, v30, v125 row_newbcast:12
  v_dot2c_f32_bf16_dpp v15, v31, v125 row_newbcast:12
  v_dot2c_f32_bf16_dpp v16, v30, v126 row_newbcast:12
  v_dot2c_f32_bf16_dpp v17, v31, v126 row_newbcast:12
  v_dot2c_f32_bf16_dpp v18, v30, v127 row_newbcast:12
  v_dot2c_f32_bf16_dpp v19, v31, v127 row_newbcast:12
  s_cbranch_vccz L_d1007
  s_waitcnt vmcnt(4)
L_d1007:
  s_xor_b32 s68, s70, 0xe4900
  buffer_load_dwordx4 v[84:87], v63, s[16:19], s68 offen nt
  s_barrier
  v_cvt_pk_bf16_f32 v30, v252, 0
  v_cvt_pk_bf16_f32 v31, 0, v252
  s_waitcnt vmcnt(5)
  v_dot2c_f32_bf16_dpp v12, v30, v64 row_newbcast:0
  v_dot2c_f32_bf16_dpp v13, v31, v64 row_newbcast:0
  v_dot2c_f32_bf16_dpp v14, v30, v65 row_newbcast:0
  v_dot2c_f32_bf16_dpp v15, v31, v65 row_newbcast:0
  v_dot2c_f32_bf16_dpp v16, v30, v66 row_newbcast:0
  v_dot2c_f32_bf16_dpp v17, v31, v66 row_newbcast:0
  v_dot2c_f32_bf16_dpp v18, v30, v67 row_newbcast:0
  v_dot2c_f32_bf16_dpp v19, v31, v67 row_newbcast:0
  s_cbranch_vccz L_d1008
  s_waitcnt vmcnt(4)
L_d1008:
  s_xor_b32 s68, s70, 0xe4c00
  buffer_load_dwordx4 v[88:91], v63, s[16:19], s68 offen nt
  s_waitcnt vmcnt(5)
  v_dot2c_f32_bf16_dpp v12, v30, v68 row_newbcast:8
  v_dot2c_f32_bf16_dpp v13, v31, v68 row_newbcast:8
  v_dot2c_f32_bf16_dpp v14, v30, v69 row_newbcast:8
  v_dot2c_f32_bf16_dpp v15, v31, v69 row_newbcast:8
  v_dot2c_f32_bf16_dpp v16, v30, v70 row_newbcast:8
  v_dot2c_f32_bf16_dpp v17, v31, v70 row_newbcast:8
  v_dot2c_f32_bf16_dpp v18, v30, v71 row_newbcast:8
  v_dot2c_f32_bf16_dpp v19, v31, v71 row_newbcast:8
  s_cbranch_vccz L_d1009
  s_waitcnt vmcnt(4)
L_d1009:
  s_xor_b32 s68, s70, 0xe4d00
  buffer_load_dwordx4 v[92:95], v63, s[16:19], s68 offen nt
  s_waitcnt vmcnt(5)
  v_dot2c_f32_bf16_dpp v12, v30, v72 row_newbcast:4
  v_dot2c_f32_bf16_dpp v13, v31, v72 row_newbcast:4
  v_dot2c_f32_bf16_dpp v14, v30, v73 row_newbcast:4
  v_dot2c_f32_bf16_dpp v15, v31, v73 row_newbcast:4
  v_dot2c_f32_bf16_dpp v16, v30, v74 row_newbcast:4
  v_dot2c_f32_bf16_dpp v17, v31, v74 row_newbcast:4
  v_dot2c_f32_bf16_dpp v18, v30, v75 row_newbcast:4
  v_dot2c_f32_bf16_dpp v19, v31, v75 row_newbcast:4
  s_cbranch_vccz L_d1010
  s_waitcnt vmcnt(4)
L_d1010:
  s_xor_b32 s68, s70, 0xf4000
  buffer_load_dwordx4 v[96:99], v63, s[16:19], s68 offen nt
  s_waitcnt vmcnt(5)
  v_dot2c_f32_bf16_dpp v12, v30, v76 row_newbcast:12
  v_dot2c_f32_bf16_dpp v13, v31, v76 row_newbcast:12
  v_dot2c_f32_bf16_dpp v14, v30, v77 row_newbcast:12
  v_dot2c_f32_bf16_dpp v15, v31, v77 row_newbcast:12
  v_dot2c_f32_bf16_dpp v16, v30, v78 row_newbcast:12
  v_dot2c_f32_bf16_dpp v17, v31, v78 row_newbcast:12
  v_dot2c_f32_bf16_dpp v18, v30, v79 row_newbcast:12
  v_dot2c_f32_bf16_dpp v19, v31, v79 row_newbcast:12
  s_cbranch_vccz L_d1011
  s_waitcnt vmcnt(4)
L_d1011:
  s_xor_b32 s68, s70, 0xf4100
  buffer_load_dwordx4 v[100:103], v63, s[16:19], s68 offen nt
  s_barrier
  v_cvt_pk_bf16_f32 v30, v253, 0
  v_cvt_pk_bf16_f32 v31, 0, v253
  s_waitcnt vmcnt(5)
  v_dot2c_f32_bf16_dpp v12, v30, v80 row_newbcast:0
  v_dot2c_f32_bf16_dpp v13, v31, v80 row_newbcast:0
  v_dot2c_f32_bf16_dpp v14, v30, v81 row_newbcast:0
  v_dot2c_f32_bf16_dpp v15, v31, v81 row_newbcast:0
  v_dot2c_f32_bf16_dpp v16, v30, v82 row_newbcast:0
  v_dot2c_f32_bf16_dpp v17, v31, v82 row_newbcast:0
  v_dot2c_f32_bf16_dpp v18, v30, v83 row_newbcast:0
  v_dot2c_f32_bf16_dpp v19, v31, v83 row_newbcast:0
  s_cbranch_vccz L_d1012
  s_waitcnt vmcnt(4)
L_d1012:
  s_xor_b32 s68, s70, 0xf4400
  buffer_load_dwordx4 v[104:107], v63, s[16:19], s68 offen nt
  s_waitcnt vmcnt(5)
  v_dot2c_f32_bf16_dpp v12, v30, v84 row_newbcast:8
  v_dot2c_f32_bf16_dpp v13, v31, v84 row_newbcast:8
  v_dot2c_f32_bf16_dpp v14, v30, v85 row_newbcast:8
  v_dot2c_f32_bf16_dpp v15, v31, v85 row_newbcast:8
  v_dot2c_f32_bf16_dpp v16, v30, v86 row_newbcast:8
  v_dot2c_f32_bf16_dpp v17, v31, v86 row_newbcast:8
  v_dot2c_f32_bf16_dpp v18, v30, v87 row_newbcast:8
  v_dot2c_f32_bf16_dpp v19, v31, v87 row_newbcast:8
  s_cbranch_vccz L_d1013
  s_waitcnt vmcnt(4)
L_d1013:
  s_xor_b32 s68, s70, 0xf4500
  buffer_load_dwordx4 v[108:111], v63, s[16:19], s68 offen nt
  s_waitcnt vmcnt(5)
  v_dot2c_f32_bf16_dpp v12, v30, v88 row_newbcast:4
  v_dot2c_f32_bf16_dpp v13, v31, v88 row_newbcast:4
  v_dot2c_f32_bf16_dpp v14, v30, v89 row_newbcast:4
  v_dot2c_f32_bf16_dpp v15, v31, v89 row_newbcast:4
  v_dot2c_f32_bf16_dpp v16, v30, v90 row_newbcast:4
  v_dot2c_f32_bf16_dpp v17, v31, v90 row_newbcast:4
  v_dot2c_f32_bf16_dpp v18, v30, v91 row_newbcast:4
  v_dot2c_f32_bf16_dpp v19, v31, v91 row_newbcast:4
  s_cbranch_vccz L_d1014
  s_waitcnt vmcnt(4)
L_d1014:
  s_xor_b32 s68, s70, 0xf4800
  buffer_load_dwordx4 v[112:115], v63, s[16:19], s68 offen nt
  s_waitcnt vmcnt(5)
  v_dot2c_f32_bf16_dpp v12, v30, v92 row_newbcast:12
  v_dot2c_f32_bf16_dpp v13, v31, v92 row_newbcast:12
  v_dot2c_f32_bf16_dpp v14, v30, v93 row_newbcast:12
  v_dot2c_f32_bf16_dpp v15, v31, v93 row_newbcast:12
  v_dot2c_f32_bf16_dpp v16, v30, v94 row_newbcast:12
  v_dot2c_f32_bf16_dpp v17, v31, v94 row_newbcast:12
  v_dot2c_f32_bf16_dpp v18, v30, v95 row_newbcast:12
  v_dot2c_f32_bf16_dpp v19, v31, v95 row_newbcast:12
  s_cbranch_vccz L_d1015
  s_waitcnt vmcnt(4)
L_d1015:
  s_xor_b32 s68, s70, 0xf4900
  buffer_load_dwordx4 v[116:119], v63, s[16:19], s68 offen nt
  s_barrier
  v_cvt_pk_bf16_f32 v30, v254, 0
  v_cvt_pk_bf16_f32 v31, 0, v254
  s_waitcnt vmcnt(5)
  v_dot2c_f32_bf16_dpp v12, v30, v96 row_newbcast:0
  v_dot2c_f32_bf16_dpp v13, v31, v96 row_newbcast:0
  v_dot2c_f32_bf16_dpp v14, v30, v97 row_newbcast:0
  v_dot2c_f32_bf16_dpp v15, v31, v97 row_newbcast:0
  v_dot2c_f32_bf16_dpp v16, v30, v98 row_newbcast:0
  v_dot2c_f32_bf16_dpp v17, v31, v98 row_newbcast:0
  v_dot2c_f32_bf16_dpp v18, v30, v99 row_newbcast:0
  v_dot2c_f32_bf16_dpp v19, v31, v99 row_newbcast:0
  s_cbranch_vccz L_d1016
  s_waitcnt vmcnt(4)
L_d1016:
  s_xor_b32 s68, s70, 0xf4c00
  buffer_load_dwordx4 v[120:123], v63, s[16:19], s68 offen nt
  s_waitcnt vmcnt(5)
  v_dot2c_f32_bf16_dpp v12, v30, v100 row_newbcast:8
  v_dot2c_f32_bf16_dpp v13, v31, v100 row_newbcast:8
  v_dot2c_f32_bf16_dpp v14, v30, v101 row_newbcast:8
  v_dot2c_f32_bf16_dpp v15, v31, v101 row_newbcast:8
  v_dot2c_f32_bf16_dpp v16, v30, v102 row_newbcast:8
  v_dot2c_f32_bf16_dpp v17, v31, v102 row_newbcast:8
  v_dot2c_f32_bf16_dpp v18, v30, v103 row_newbcast:8
  v_dot2c_f32_bf16_dpp v19, v31, v103 row_newbcast:8
  s_cbranch_vccz L_d1017
  s_waitcnt vmcnt(4)
L_d1017:
  s_xor_b32 s68, s70, 0xf4d00
  buffer_load_dwordx4 v[124:127], v63, s[16:19], s68 offen nt
  s_waitcnt vmcnt(5)
  v_dot2c_f32_bf16_dpp v12, v30, v104 row_newbcast:4
  v_dot2c_f32_bf16_dpp v13, v31, v104 row_newbcast:4
  v_dot2c_f32_bf16_dpp v14, v30, v105 row_newbcast:4
  v_dot2c_f32_bf16_dpp v15, v31, v105 row_newbcast:4
  v_dot2c_f32_bf16_dpp v16, v30, v106 row_newbcast:4
  v_dot2c_f32_bf16_dpp v17, v31, v106 row_newbcast:4
  v_dot2c_f32_bf16_dpp v18, v30, v107 row_newbcast:4
  v_dot2c_f32_bf16_dpp v19, v31, v107 row_newbcast:4
  s_waitcnt vmcnt(4)
  v_dot2c_f32_bf16_dpp v12, v30, v108 row_newbcast:12
  v_dot2c_f32_bf16_dpp v13, v31, v108 row_newbcast:12
  v_dot2c_f32_bf16_dpp v14, v30, v109 row_newbcast:12
  v_dot2c_f32_bf16_dpp v15, v31, v109 row_newbcast:12
  v_dot2c_f32_bf16_dpp v16, v30, v110 row_newbcast:12
  v_dot2c_f32_bf16_dpp v17, v31, v110 row_newbcast:12
  v_dot2c_f32_bf16_dpp v18, v30, v111 row_newbcast:12
  v_dot2c_f32_bf16_dpp v19, v31, v111 row_newbcast:12
  s_barrier
  v_cvt_pk_bf16_f32 v30, v255, 0
  v_cvt_pk_bf16_f32 v31, 0, v255
  s_waitcnt vmcnt(3)
  v_dot2c_f32_bf16_dpp v12, v30, v112 row_newbcast:0
  v_dot2c_f32_bf16_dpp v13, v31, v112 row_newbcast:0
  v_dot2c_f32_bf16_dpp v14, v30, v113 row_newbcast:0
  v_dot2c_f32_bf16_dpp v15, v31, v113 row_newbcast:0
  v_dot2c_f32_bf16_dpp v16, v30, v114 row_newbcast:0
  v_dot2c_f32_bf16_dpp v17, v31, v114 row_newbcast:0
  v_dot2c_f32_bf16_dpp v18, v30, v115 row_newbcast:0
  v_dot2c_f32_bf16_dpp v19, v31, v115 row_newbcast:0
  s_waitcnt vmcnt(2)
  v_dot2c_f32_bf16_dpp v12, v30, v116 row_newbcast:8
  v_dot2c_f32_bf16_dpp v13, v31, v116 row_newbcast:8
  v_dot2c_f32_bf16_dpp v14, v30, v117 row_newbcast:8
  v_dot2c_f32_bf16_dpp v15, v31, v117 row_newbcast:8
  v_dot2c_f32_bf16_dpp v16, v30, v118 row_newbcast:8
  v_dot2c_f32_bf16_dpp v17, v31, v118 row_newbcast:8
  v_dot2c_f32_bf16_dpp v18, v30, v119 row_newbcast:8
  v_dot2c_f32_bf16_dpp v19, v31, v119 row_newbcast:8
  s_waitcnt vmcnt(1)
  v_dot2c_f32_bf16_dpp v12, v30, v120 row_newbcast:4
  v_dot2c_f32_bf16_dpp v13, v31, v120 row_newbcast:4
  v_dot2c_f32_bf16_dpp v14, v30, v121 row_newbcast:4
  v_dot2c_f32_bf16_dpp v15, v31, v121 row_newbcast:4
  v_dot2c_f32_bf16_dpp v16, v30, v122 row_newbcast:4
  v_dot2c_f32_bf16_dpp v17, v31, v122 row_newbcast:4
  v_dot2c_f32_bf16_dpp v18, v30, v123 row_newbcast:4
  v_dot2c_f32_bf16_dpp v19, v31, v123 row_newbcast:4
  s_waitcnt vmcnt(0)
  v_dot2c_f32_bf16_dpp v12, v30, v124 row_newbcast:12
  v_dot2c_f32_bf16_dpp v13, v31, v124 row_newbcast:12
  v_dot2c_f32_bf16_dpp v14, v30, v125 row_newbcast:12
  v_dot2c_f32_bf16_dpp v15, v31, v125 row_newbcast:12
  v_dot2c_f32_bf16_dpp v16, v30, v126 row_newbcast:12
  v_dot2c_f32_bf16_dpp v17, v31, v126 row_newbcast:12
  v_dot2c_f32_bf16_dpp v18, v30, v127 row_newbcast:12
  v_dot2c_f32_bf16_dpp v19, v31, v127 row_newbcast:12
  s_barrier
  v_permlane32_swap_b32 v12, v16
  v_permlane32_swap_b32 v13, v17
  v_permlane32_swap_b32 v14, v18
  v_permlane32_swap_b32 v15, v19
  v_add_f32 v12, v12, v16
  v_add_f32 v13, v13, v17
  v_add_f32 v14, v14, v18
  v_add_f32 v15, v15, v19
  s_nop 0
  v_permlane16_swap_b32 v12, v14
  v_permlane16_swap_b32 v13, v15
  v_add_f32 v12, v12, v14
  v_add_f32 v13, v13, v15
  v_pk_mul_f32 v[12:13], v[12:13], v[160:161] op_sel_hi:[1,0]
  ds_write_b64 v36, v[12:13] offset:6144
  s_waitcnt lgkmcnt(0)
  s_barrier
  ds_read_b32 v64, v161 offset:6144
  ds_read_b32 v65, v161 offset:6272
  ds_read_b32 v66, v161 offset:6656
  ds_read_b32 v67, v161 offset:6784
  ds_read_b32 v68, v161 offset:7168
  ds_read_b32 v69, v161 offset:7296
  ds_read_b32 v70, v161 offset:7680
  ds_read_b32 v71, v161 offset:7808
  s_mov_b64 exec, 0xffffffff
  buffer_store_dwordx4 v[56:59], v9, s[20:23], s96 offen sc1
  buffer_store_dwordx4 v[176:179], v9, s[20:23], s97 offen sc1
  s_mov_b64 exec, -1
  s_waitcnt lgkmcnt(4)
  v_pk_add_f32 v[64:65], v[64:65], v[66:67]
  s_waitcnt lgkmcnt(0)
  v_pk_add_f32 v[68:69], v[68:69], v[70:71]
  v_pk_add_f32 v[64:65], v[64:65], v[68:69]
  v_cvt_pk_bf16_f32 v162, v64, v64
  v_cvt_pk_bf16_f32 v163, v65, v65
  s_nop 0
  v_and_b32_dpp v48, v162, v164 row_newbcast:0
  v_and_b32_dpp v49, v162, v165 row_newbcast:0
  v_and_b32_dpp v50, v163, v164 row_newbcast:0
  v_and_b32_dpp v51, v163, v165 row_newbcast:0
  v_and_b32_dpp v52, v162, v164 row_newbcast:1
  v_and_b32_dpp v53, v162, v165 row_newbcast:1
  v_and_b32_dpp v54, v163, v164 row_newbcast:1
  v_and_b32_dpp v55, v163, v165 row_newbcast:1
  v_smfmac_f32_16x16x64_bf16 v[168:171], v[48:51], a[0:7], v166
  v_smfmac_f32_16x16x64_bf16 v[172:175], v[48:51], a[8:15], v166
  v_and_b32_dpp v48, v162, v164 row_newbcast:2
  v_and_b32_dpp v49, v162, v165 row_newbcast:2
  v_and_b32_dpp v50, v163, v164 row_newbcast:2
  v_and_b32_dpp v51, v163, v165 row_newbcast:2
  v_smfmac_f32_16x16x64_bf16 v[168:171], v[52:55], a[16:23], v166
  v_smfmac_f32_16x16x64_bf16 v[172:175], v[52:55], a[24:31], v166
  v_and_b32_dpp v52, v162, v164 row_newbcast:3
  v_and_b32_dpp v53, v162, v165 row_newbcast:3
  v_and_b32_dpp v54, v163, v164 row_newbcast:3
  v_and_b32_dpp v55, v163, v165 row_newbcast:3
  v_smfmac_f32_16x16x64_bf16 v[168:171], v[48:51], a[32:39], v166
  v_smfmac_f32_16x16x64_bf16 v[172:175], v[48:51], a[40:47], v166
  v_and_b32_dpp v48, v162, v164 row_newbcast:4
  v_and_b32_dpp v49, v162, v165 row_newbcast:4
  v_and_b32_dpp v50, v163, v164 row_newbcast:4
  v_and_b32_dpp v51, v163, v165 row_newbcast:4
  v_smfmac_f32_16x16x64_bf16 v[168:171], v[52:55], a[48:55], v166
  v_smfmac_f32_16x16x64_bf16 v[172:175], v[52:55], a[56:63], v166
  v_and_b32_dpp v52, v162, v164 row_newbcast:5
  v_and_b32_dpp v53, v162, v165 row_newbcast:5
  v_and_b32_dpp v54, v163, v164 row_newbcast:5
  v_and_b32_dpp v55, v163, v165 row_newbcast:5
  v_smfmac_f32_16x16x64_bf16 v[168:171], v[48:51], a[64:71], v166
  v_smfmac_f32_16x16x64_bf16 v[172:175], v[48:51], a[72:79], v166
  v_and_b32_dpp v48, v162, v164 row_newbcast:6
  v_and_b32_dpp v49, v162, v165 row_newbcast:6
  v_and_b32_dpp v50, v163, v164 row_newbcast:6
  v_and_b32_dpp v51, v163, v165 row_newbcast:6
  v_smfmac_f32_16x16x64_bf16 v[168:171], v[52:55], a[80:87], v166
  v_smfmac_f32_16x16x64_bf16 v[172:175], v[52:55], a[88:95], v166
  v_and_b32_dpp v52, v162, v164 row_newbcast:7
  v_and_b32_dpp v53, v162, v165 row_newbcast:7
  v_and_b32_dpp v54, v163, v164 row_newbcast:7
  v_and_b32_dpp v55, v163, v165 row_newbcast:7
  v_smfmac_f32_16x16x64_bf16 v[168:171], v[48:51], a[96:103], v166
  v_smfmac_f32_16x16x64_bf16 v[172:175], v[48:51], a[104:111], v166
  v_and_b32_dpp v48, v162, v164 row_newbcast:8
  v_and_b32_dpp v49, v162, v165 row_newbcast:8
  v_and_b32_dpp v50, v163, v164 row_newbcast:8
  v_and_b32_dpp v51, v163, v165 row_newbcast:8
  v_smfmac_f32_16x16x64_bf16 v[168:171], v[52:55], a[112:119], v166
  v_smfmac_f32_16x16x64_bf16 v[172:175], v[52:55], a[120:127], v166
  v_and_b32_dpp v52, v162, v164 row_newbcast:9
  v_and_b32_dpp v53, v162, v165 row_newbcast:9
  v_and_b32_dpp v54, v163, v164 row_newbcast:9
  v_and_b32_dpp v55, v163, v165 row_newbcast:9
  v_smfmac_f32_16x16x64_bf16 v[168:171], v[48:51], a[128:135], v166
  v_smfmac_f32_16x16x64_bf16 v[172:175], v[48:51], a[136:143], v166
  v_and_b32_dpp v48, v162, v164 row_newbcast:10
  v_and_b32_dpp v49, v162, v165 row_newbcast:10
  v_and_b32_dpp v50, v163, v164 row_newbcast:10
  v_and_b32_dpp v51, v163, v165 row_newbcast:10
  v_smfmac_f32_16x16x64_bf16 v[168:171], v[52:55], a[144:151], v166
  v_smfmac_f32_16x16x64_bf16 v[172:175], v[52:55], a[152:159], v166
  v_and_b32_dpp v52, v162, v164 row_newbcast:11
  v_and_b32_dpp v53, v162, v165 row_newbcast:11
  v_and_b32_dpp v54, v163, v164 row_newbcast:11
  v_and_b32_dpp v55, v163, v165 row_newbcast:11
  v_smfmac_f32_16x16x64_bf16 v[168:171], v[48:51], a[160:167], v166
  v_smfmac_f32_16x16x64_bf16 v[172:175], v[48:51], a[168:175], v166
  v_and_b32_dpp v48, v162, v164 row_newbcast:12
  v_and_b32_dpp v49, v162, v165 row_newbcast:12
  v_and_b32_dpp v50, v163, v164 row_newbcast:12
  v_and_b32_dpp v51, v163, v165 row_newbcast:12
  v_smfmac_f32_16x16x64_bf16 v[168:171], v[52:55], a[176:183], v166
  v_smfmac_f32_16x16x64_bf16 v[172:175], v[52:55], a[184:191], v166
  v_and_b32_dpp v52, v162, v164 row_newbcast:13
  v_and_b32_dpp v53, v162, v165 row_newbcast:13
  v_and_b32_dpp v54, v163, v164 row_newbcast:13
  v_and_b32_dpp v55, v163, v165 row_newbcast:13
  v_smfmac_f32_16x16x64_bf16 v[168:171], v[48:51], a[192:199], v166
  v_smfmac_f32_16x16x64_bf16 v[172:175], v[48:51], a[200:207], v166
  v_and_b32_dpp v48, v162, v164 row_newbcast:14
  v_and_b32_dpp v49, v162, v165 row_newbcast:14
  v_and_b32_dpp v50, v163, v164 row_newbcast:14
  v_and_b32_dpp v51, v163, v165 row_newbcast:14
  v_smfmac_f32_16x16x64_bf16 v[168:171], v[52:55], a[208:215], v166
  v_smfmac_f32_16x16x64_bf16 v[172:175], v[52:55], a[216:223], v166
  v_and_b32_dpp v52, v162, v164 row_newbcast:15
  v_and_b32_dpp v53, v162, v165 row_newbcast:15
  v_and_b32_dpp v54, v163, v164 row_newbcast:15
  v_and_b32_dpp v55, v163, v165 row_newbcast:15
  v_smfmac_f32_16x16x64_bf16 v[168:171], v[48:51], a[224:231], v166
  v_smfmac_f32_16x16x64_bf16 v[172:175], v[48:51], a[232:239], v166
  v_smfmac_f32_16x16x64_bf16 v[168:171], v[52:55], a[240:247], v166
  v_smfmac_f32_16x16x64_bf16 v[172:175], v[52:55], a[248:255], v166
  s_mov_b64 exec, 0xffffffff
  s_nop 5
  buffer_store_dwordx4 v[168:171], v9, s[20:23], s98 offen sc1
  buffer_store_dwordx4 v[172:175], v9, s[20:23], s99 offen sc1
  s_mov_b64 exec, -1
  s_cmp_gt_u32 s64, 1
  s_cbranch_scc1 L_end
  s_mov_b32 s85, 15
L_poll:
  s_bitcmp1_b32 s85, 0
  s_cbranch_scc0 L_skipld0
  buffer_load_dwordx4 v[96:99], v1, s[20:23], s95 offen offset:0 sc1
L_skipld0:
  s_bitcmp1_b32 s85, 1
  s_cbranch_scc0 L_skipld1
  buffer_load_dwordx4 v[100:103], v1, s[20:23], s95 offen offset:1024 sc1
L_skipld1:
  s_bitcmp1_b32 s85, 2
  s_cbranch_scc0 L_skipld2
  buffer_load_dwordx4 v[104:107], v1, s[20:23], s95 offen offset:2048 sc1
L_skipld2:
  s_bitcmp1_b32 s85, 3
  s_cbranch_scc0 L_skipld3
  buffer_load_dwordx4 v[108:111], v1, s[20:23], s95 offen offset:3072 sc1
L_skipld3:
  s_waitcnt vmcnt(0)
  v_max3_u32 v11, v96, v97, v98
  v_max3_u32 v8, v99, v100, v101
  v_max3_u32 v11, v11, v102, v103
  v_max3_u32 v8, v8, v104, v105
  v_max3_u32 v11, v11, v106, v107
  v_max3_u32 v8, v8, v108, v109
  v_max3_u32 v11, v11, v110, v111
  v_max_u32 v11, v11, v8
  v_cmp_eq_u32 vcc, -1, v11
  s_nop 1
  s_cbranch_vccz L_sum
  s_mov_b32 s85, 0
  v_max3_u32 v11, v96, v97, v98
  v_max_u32 v11, v11, v99
  v_cmp_eq_u32 vcc, -1, v11
  s_nop 1
  s_cmp_lg_u64 vcc, 0
  s_cselect_b32 s38, 1, 0
  s_or_b32 s85, s85, s38
  v_max3_u32 v11, v100, v101, v102
  v_max_u32 v11, v11, v103
  v_cmp_eq_u32 vcc, -1, v11
  s_nop 1
  s_cmp_lg_u64 vcc, 0
  s_cselect_b32 s38, 2, 0
  s_or_b32 s85, s85, s38
  v_max3_u32 v11, v104, v105, v106
  v_max_u32 v11, v11, v107
  v_cmp_eq_u32 vcc, -1, v11
  s_nop 1
  s_cmp_lg_u64 vcc, 0
  s_cselect_b32 s38, 4, 0
  s_or_b32 s85, s85, s38
  v_max3_u32 v11, v108, v109, v110
  v_max_u32 v11, v11, v111
  v_cmp_eq_u32 vcc, -1, v11
  s_nop 1
  s_cmp_lg_u64 vcc, 0
  s_cselect_b32 s38, 8, 0
  s_or_b32 s85, s85, s38
  s_cmp_eq_u32 s85, 0
  s_cbranch_scc1 L_sum
  s_sub_u32 s87, s87, 1
  s_cmp_eq_u32 s87, 0
  s_cbranch_scc1 L_end
  s_branch L_poll
L_sum:
  v_pk_add_f32 v[96:97], v[96:97], v[104:105]
  v_pk_add_f32 v[98:99], v[98:99], v[106:107]
  v_pk_add_f32 v[100:101], v[100:101], v[108:109]
  v_pk_add_f32 v[102:103], v[102:103], v[110:111]
  v_pk_add_f32 v[96:97], v[96:97], v[100:101]
  v_pk_add_f32 v[98:99], v[98:99], v[102:103]
  s_nop 0
  v_add_f32_dpp v96, v96, v96 row_ror:8
  v_add_f32_dpp v97, v97, v97 row_ror:8
  v_add_f32_dpp v98, v98, v98 row_ror:8
  v_add_f32_dpp v99, v99, v99 row_ror:8
  s_nop 0
  v_permlane32_swap_b32 v96, v98
  v_permlane32_swap_b32 v97, v99
  v_add_f32 v96, v96, v98
  v_add_f32 v97, v97, v99
  v_mov_b32 v98, v96
  v_mov_b32 v99, v97
  s_nop 0
  v_permlane16_swap_b32 v96, v98
  v_permlane16_swap_b32 v97, v99
  v_add_f32 v96, v96, v98
  v_add_f32 v97, v97, v99
  v_cvt_pk_bf16_f32 v96, v96, v97
  s_mov_b32 exec_lo, 0xff
  s_mov_b32 exec_hi, 0xff
  buffer_store_dword v96, v10, s[32:35], s94 offen
L_end:
  s_endpgm
.section .rodata,"a"
.p2align 6
.amdhsa_kernel concat_heads__mha_block_cached__mha_block_cached__decode_kernel
  .amdhsa_next_free_vgpr 512
  .amdhsa_next_free_sgpr 102
  .amdhsa_accum_offset 256
  .amdhsa_group_segment_fixed_size 0
  .amdhsa_kernarg_size 104
  .amdhsa_user_sgpr_count 2
  .amdhsa_user_sgpr_kernarg_segment_ptr 1
  .amdhsa_system_sgpr_workgroup_id_x 1
.end_amdhsa_kernel
```
